```python
import torch

def _softmax(x, axis=-1):
    return torch.softmax(x, dim=axis)
def _gelu(x):
    return torch.nn.functional.gelu(x, approximate="tanh")
def _silu(x):
    return torch.nn.functional.silu(x)
def _sigmoid(x):
    return torch.sigmoid(x)
def _layernorm(x, axis=-1, eps=1e-5):
    m = x.mean(dim=axis, keepdim=True)
    v = x.var(dim=axis, keepdim=True, unbiased=False)
    return (x - m) / torch.sqrt(v + eps)
def _scatter_add(tgt, idx, src, axis=0):
    return tgt.clone().index_add_(axis, idx, src)
def _segment_sum(src, seg, n):
    out = torch.zeros((n,) + src.shape[1:], dtype=src.dtype)
    return out.index_add_(0, seg, src)
def _pad(x, pw):
    flat = tuple(v for pair in reversed(pw) for v in pair)
    return torch.nn.functional.pad(x, flat)

kernel_name = 'sequential_preLN__compressed_kv_cla__dense_activation_silu__prompt'

def setup_inputs():

    _w = (lambda a: (lambda t: t.to(torch.bfloat16) if t.is_floating_point() else t)(torch.as_tensor(a)))
    def _A_setup():
        B, H, Sq, Sk, D, M = 1, 16, 2048, 2048, 256, 448
        Dc = 4 * D
        return {
            "x": _w((lambda *s: torch.randn(*s, dtype=torch.bfloat16) * 0.05)(B, Sq, M)),
            "c_kv": _w((lambda *s: torch.randn(*s, dtype=torch.bfloat16) * 0.4)(B, Sk, Dc)),
            "w_q": _w((lambda *s: torch.randn(*s, dtype=torch.bfloat16) * 1.6)(M, H, D) * (M ** -0.5)),
            "w_uk": _w((lambda *s: torch.randn(*s, dtype=torch.bfloat16) * 1.6)(Dc, H, D) * (Dc ** -0.5)),
            "w_uv": _w((lambda *s: torch.randn(*s, dtype=torch.bfloat16) * 0.4)(Dc, H, D) * (Dc ** -0.5)),
            "w_o": _w((lambda *s: torch.randn(*s, dtype=torch.bfloat16) * 0.4)(H, D, M) * ((H * D) ** -0.5)),
        }
    _A_in = _A_setup()

    def _B_setup():
        B, S, D, F = 1, 2048, 448, 1792
        return {
            "x": _w((lambda *s: torch.randn(*s, dtype=torch.bfloat16) * 0.05)(B, S, D)),
            "w1": _w((lambda *s: torch.randn(*s, dtype=torch.bfloat16) * 0.8)(D, F) * (D ** -0.5)),
            "w2": _w((lambda *s: torch.randn(*s, dtype=torch.bfloat16) * 0.1)(F, D) * (F ** -0.5)),
        }
    _B_in = _B_setup()

    return {
        "A_x": _A_in["x"],
        "A_c_kv": _A_in["c_kv"],
        "A_w_q": _A_in["w_q"],
        "A_w_uk": _A_in["w_uk"],
        "A_w_uv": _A_in["w_uv"],
        "A_w_o": _A_in["w_o"],
        "B_x": _B_in["x"],
        "B_w1": _B_in["w1"],
        "B_w2": _B_in["w2"],
    }

def reference(A_x, A_c_kv, A_w_q, A_w_uk, A_w_uv, A_w_o, B_x, B_w1, B_w2):
    def _A_ref(x, c_kv, w_q, w_uk, w_uv, w_o):
        B, Sq, M = x.shape[0], x.shape[1], x.shape[2]
        Sk = c_kv.shape[1]
        H, D = w_q.shape[1], w_q.shape[2]
        q = torch.einsum("bqm,mhd->bhqd", x, w_q)
        k = torch.einsum("bkc,chd->bhkd", c_kv, w_uk)
        v = torch.einsum("bkc,chd->bhkd", c_kv, w_uv)
        scores = torch.einsum("bhqd,bhkd->bhqk", q, k) * (D ** -0.5)
        off = Sk - Sq
        qi = torch.arange(Sq)[:, None]
        kj = torch.arange(Sk)[None, :]
        cmask = kj <= (qi + off)
        scores = torch.where(cmask[None, None], scores, -1e9)
        p = _softmax(scores, axis=-1)
        ctx = torch.einsum("bhqk,bhkd->bhqd", p, v)
        return torch.einsum("bhqd,hdm->bqm", ctx, w_o)

    def _B_ref(x, w1, w2):
        h = torch.einsum("bsd,df->bsf", x, w1)
        h = _silu(h)
        out = torch.einsum("bsf,fd->bsd", h, w2)
        return out

    x = A_x
    h = x + _A_ref(_layernorm(x, axis=-1), A_c_kv, A_w_q, A_w_uk, A_w_uv, A_w_o)
    h2 = h + _B_ref(_layernorm(h, axis=-1), B_w1, B_w2)
    return h2
```

```asm
; @launch kernel=qkv_kernel grid=(256,1,1) block=(256,1,1) lds=163840
; @launch kernel=attn_kernel grid=(256,1,1) block=(256,1,1) lds=163840
; @launch kernel=tail_kernel grid=(224,1,1) block=(256,1,1) lds=115712
.amdgcn_target "amdgcn-amd-amdhsa--gfx950"
.text
.globl qkv_kernel
.p2align 8
.type qkv_kernel,@function
qkv_kernel:
    s_cmp_ge_u32 s2, 256
    s_cbranch_scc1 L_qkv_end
    s_load_dwordx2 s[4:5], s[0:1], 8
    s_load_dwordx2 s[6:7], s[0:1], 16
    s_load_dwordx4 s[24:27], s[0:1], 24
    s_load_dwordx2 s[28:29], s[0:1], 88
    s_load_dwordx2 s[56:57], s[0:1], 0
    s_load_dwordx2 s[58:59], s[0:1], 80
    s_load_dwordx2 s[70:71], s[0:1], 40
    s_load_dwordx4 s[84:87], s[0:1], 56
    s_and_b32 s30, s2, 7
    s_lshr_b32 s31, s2, 3
    s_and_b32 s32, s31, 7
    s_lshr_b32 s33, s31, 3
    s_lshl_b32 s34, s30, 2
    s_add_u32 s34, s34, s33
    s_lshl_b32 s35, s30, 1
    s_and_b32 s31, s33, 1
    s_add_u32 s35, s35, s31
    s_lshr_b32 s36, s33, 1
    v_lshrrev_b32 v2, 6, v0
    v_and_b32 v1, 63, v0
    s_nop 0
    v_readfirstlane_b32 s37, v2
    s_nop 3
    v_lshrrev_b32 v2, 5, v1
    v_and_b32 v4, 31, v1
    s_nop 1
    s_and_b32 s44, s37, 1
    s_lshr_b32 s45, s37, 1
    s_lshl_b32 s46, s44, 1
    v_or_b32 v3, s46, v2
    v_lshlrev_b32 v3, 1, v3
    v_xor_b32 v3, v3, v4
    v_lshlrev_b32 v3, 4, v3
    s_lshl_b32 s46, s37, 1
    v_add_u32 v2, s46, v2
    v_lshl_add_u32 v26, v2, 13, v3
    v_xor_b32 v4, 128, v26
    v_add_u32 v27, 65536, v4
    v_add_u32 v28, 131072, v26
    v_add_u32 v29, 196608, v4
    v_add_u32 v30, 262144, v26
    v_add_u32 v31, 327680, v4
    v_add_u32 v32, 393216, v26
    v_add_u32 v33, 458752, v4
    v_lshrrev_b32 v2, 3, v1
    v_lshrrev_b32 v3, 1, v2
    s_lshl_b32 s46, s44, 2
    v_or_b32 v3, s46, v3
    v_and_b32 v4, 7, v1
    v_xor_b32 v3, v3, v4
    v_lshlrev_b32 v3, 4, v3
    s_lshl_b32 s46, s37, 3
    v_add_u32_e64 v2, s46, v2
    v_lshl_add_u32 v18, v2, 11, v3
    v_add_u32 v19, 65536, v18
    v_add_u32 v20, 131072, v18
    v_add_u32 v21, 196608, v18
    v_add_u32 v22, 262144, v18
    v_add_u32 v23, 327680, v18
    v_add_u32 v24, 393216, v18
    v_add_u32 v25, 458752, v18
    s_waitcnt lgkmcnt(0)
    s_mov_b32 s60, s56
    s_and_b32 s61, s57, 0xffff
    s_mov_b32 s62, 1835008
    s_mov_b32 s63, 0x00020000
    s_mov_b32 s64, s58
    s_and_b32 s65, s59, 0xffff
    s_mov_b32 s66, 256
    s_mov_b32 s67, 0x00020000
    s_lshl_b32 s46, s2, 2
    s_add_u32 s46, s46, s37
    s_lshl_b32 s46, s46, 3
    v_lshrrev_b32 v37, 3, v1
    v_add_u32 v37, s46, v37
    v_mul_u32_u24 v37, 896, v37
    v_and_b32_e64 v4, 7, v1
    v_lshl_add_u32 v37, v4, 4, v37
    s_cmp_ge_u32 s2, 64
    s_cbranch_scc1 L_qkv_noln0
    buffer_load_dwordx4 v[64:67], v37, s[60:63], 0 offen offset:0
    buffer_load_dwordx4 v[68:71], v37, s[60:63], 0 offen offset:128
    buffer_load_dwordx4 v[72:75], v37, s[60:63], 0 offen offset:256
    buffer_load_dwordx4 v[76:79], v37, s[60:63], 0 offen offset:384
    buffer_load_dwordx4 v[80:83], v37, s[60:63], 0 offen offset:512
    buffer_load_dwordx4 v[84:87], v37, s[60:63], 0 offen offset:640
    buffer_load_dwordx4 v[88:91], v37, s[60:63], 0 offen offset:768
    s_cmp_lg_u32 s2, 0
    s_cbranch_scc1 L_qkv_noln0
    s_add_u32 s48, s28, 95420416
    s_addc_u32 s49, s29, 0
    s_mov_b32 s40, s48
    s_and_b32 s41, s49, 0xffff
    s_mov_b32 s42, 4096
    s_mov_b32 s43, 0x00020000
    v_lshlrev_b32 v100, 4, v0
    v_mov_b32 v96, 0
    v_mov_b32 v97, 0
    v_mov_b32 v98, 0
    v_mov_b32_e64 v99, 0
    buffer_store_dwordx4 v[96:99], v100, s[40:43], 0 offen
L_qkv_noln0:
    s_cmp_eq_u32 s36, 0
    s_cselect_b32 s48, s24, s26
    s_cselect_b32 s49, s25, s27
    s_lshl_b32 s46, s35, 9
    s_add_u32 s48, s48, s46
    s_addc_u32 s49, s49, 0
    s_sub_u32 s47, 8388608, s46
    s_mov_b32 s12, s48
    s_and_b32 s13, s49, 0xffff
    s_mov_b32 s14, s47
    s_mov_b32 s15, 0x00020000
    s_lshl_b32 s46, s32, 19
    s_add_u32 s48, s4, s46
    s_addc_u32 s49, s5, 0
    s_mov_b32 s8, s48
    s_and_b32 s9, s49, 0xffff
    s_mov_b32 s10, 524288
    s_mov_b32 s11, 0x00020000
    s_lshl_b32 s22, s37, 10
    s_add_u32 s23, s22, 32768
    s_mov_b32 s21, 524288
    s_mov_b32 s20, 128
    s_add_u32 m0, s23, 0
    s_nop 0
    buffer_load_dwordx4 v26, s[12:15], 0 offen lds
    s_add_u32 m0, s23, 4096
    s_nop 0
    buffer_load_dwordx4 v27, s[12:15], 0 offen lds
    s_add_u32 m0, s23, 8192
    s_nop 0
    buffer_load_dwordx4 v28, s[12:15], 0 offen lds
    s_add_u32 m0, s23, 12288
    s_nop 0
    buffer_load_dwordx4 v29, s[12:15], 0 offen lds
    s_add_u32 m0, s23, 16384
    s_nop 0
    buffer_load_dwordx4 v30, s[12:15], 0 offen lds
    s_add_u32 m0, s23, 20480
    s_nop 0
    buffer_load_dwordx4 v31, s[12:15], 0 offen lds
    s_add_u32 m0, s23, 24576
    s_nop 0
    buffer_load_dwordx4 v32, s[12:15], 0 offen lds
    s_add_u32 m0, s23, 28672
    s_nop 0
    buffer_load_dwordx4 v33, s[12:15], 0 offen lds
    s_add_u32 m0, s22, 0
    s_nop 0
    buffer_load_dwordx4 v18, s[8:11], 0 offen sc1 lds
    s_add_u32 m0, s22, 4096
    s_nop 0
    buffer_load_dwordx4 v19, s[8:11], 0 offen sc1 lds
    s_add_u32 m0, s22, 8192
    s_nop 0
    buffer_load_dwordx4 v20, s[8:11], 0 offen sc1 lds
    s_add_u32 m0, s22, 12288
    s_nop 0
    buffer_load_dwordx4 v21, s[8:11], 0 offen sc1 lds
    s_add_u32 m0, s22, 16384
    s_nop 0
    buffer_load_dwordx4 v22, s[8:11], 0 offen sc1 lds
    s_add_u32 m0, s22, 20480
    s_nop 0
    buffer_load_dwordx4 v23, s[8:11], 0 offen sc1 lds
    s_add_u32 m0, s22, 24576
    s_nop 0
    buffer_load_dwordx4 v24, s[8:11], 0 offen sc1 lds
    s_add_u32 m0, s22, 28672
    s_nop 0
    buffer_load_dwordx4 v25, s[8:11], 0 offen sc1 lds
    v_mul_u32_u24 v46, 896, v2
    v_add_u32 v46, v46, v3
    v_add_u32 v47, 28672, v46
    v_add_u32 v48, 57344, v46
    v_add_u32 v49, 86016, v46
    v_add_u32 v50, 114688, v46
    v_add_u32 v51, 143360, v46
    v_add_u32 v52, 172032, v46
    v_add_u32 v53, 200704, v46
    v_lshrrev_b32 v2, 4, v1
    s_lshl_b32 s46, s45, 2
    v_or_b32 v3, s46, v2
    v_lshlrev_b32 v3, 1, v3
    v_and_b32 v4, 15, v1
    v_xor_b32 v3, v3, v4
    v_lshlrev_b32 v3, 4, v3
    s_lshl_b32 s46, s37, 2
    v_add_u32_e64 v2, s46, v2
    v_lshl_add_u32 v54, v2, 13, v3
    v_add_u32 v55, 131072, v54
    v_add_u32 v56, 262144, v54
    v_add_u32 v57, 393216, v54
    s_mov_b32 s40, s8
    s_and_b32 s41, s9, 0xffff
    s_mov_b32 s42, 524288
    s_mov_b32 s43, 0x00020000
    s_lshl_b32 s46, s33, 6
    v_add_u32 v2, s46, v1
    v_lshlrev_b32 v35, 11, v2
    s_mov_b32 s50, 512
    s_mov_b32 s51, 128
    s_cmp_eq_u32 s37, 0
    s_cbranch_scc1 L_qkv_pfdone
    s_lshl_b32 s46, s32, 3
    v_bfe_u32 v2, v1, 2, 3
    v_add_u32 v2, s46, v2
    v_and_b32 v3, 3, v1
    v_lshlrev_b32 v3, 7, v3
    v_lshl_add_u32 v35, v2, 13, v3
    s_mov_b32 s40, s12
    s_mov_b32 s41, s13
    s_mov_b32 s42, s14
    s_mov_b32 s50, 2097152
    s_mov_b32 s51, 524288
    s_cmp_eq_u32 s37, 1
    s_cbranch_scc1 L_qkv_pfdone
    s_mul_i32 s46, s32, 56
    v_lshrrev_b32 v2, 1, v1
    v_add_u32 v2, s46, v2
    v_and_b32 v3, 1, v1
    v_lshlrev_b32 v3, 7, v3
    v_lshl_add_u32 v35, v2, 13, v3
    s_lshl_b32 s46, s34, 8
    s_add_u32 s48, s6, s46
    s_addc_u32 s49, s7, 0
    s_mov_b32 s40, s48
    s_and_b32 s41, s49, 0xffff
    s_mul_i32 s47, s32, 458752
    s_add_u32 s47, s47, 458752
    s_sub_u32 s42, s47, s46
    s_mov_b32 s50, 0
    s_mov_b32 s51, 262144
    s_cmp_eq_u32 s37, 2
    s_cbranch_scc1 L_qkv_pfdone
    s_mov_b32 s42, 0
L_qkv_pfdone:
    v_and_b32 v2, 15, v1
    v_lshrrev_b32_e64 v3, 4, v1
    v_bfe_u32 v4, v1, 1, 3
    v_xor_b32 v3, v3, v4
    s_lshl_b32 s46, s44, 14
    v_lshlrev_b32 v2, 7, v2
    v_add_u32 v2, s46, v2
    v_xor_b32_e64 v4, 0, v3
    v_lshl_add_u32 v6, v4, 4, v2
    v_add_u32 v8, 131072, v6
    v_xor_b32_e64 v4, 4, v3
    v_lshl_add_u32 v7, v4, 4, v2
    v_add_u32 v9, 131072, v7
    v_lshrrev_b32_e64 v2, 4, v1
    v_bfe_u32 v3, v1, 2, 2
    v_and_b32_e64 v4, 1, v2
    v_lshl_or_b32 v4, v4, 2, v3
    v_lshl_add_u32 v2, v2, 3, v3
    v_and_b32 v3, 3, v1
    v_lshlrev_b32 v3, 3, v3
    v_add_u32 v3, 32768, v3
    s_lshl_b32 s46, s45, 8
    v_xor_b32 v5, 0, v4
    v_lshl_add_u32 v5, v5, 5, v3
    v_lshl_add_u32 v5, v2, 9, v5
    v_add_u32 v38, s46, v5
    v_xor_b32 v5, 1, v4
    v_lshl_add_u32 v5, v5, 5, v3
    v_lshl_add_u32 v5, v2, 9, v5
    v_add_u32 v39, s46, v5
    v_xor_b32 v5, 2, v4
    v_lshl_add_u32 v5, v5, 5, v3
    v_lshl_add_u32 v5, v2, 9, v5
    v_add_u32 v40, s46, v5
    v_xor_b32 v5, 3, v4
    v_lshl_add_u32 v5, v5, 5, v3
    v_lshl_add_u32 v5, v2, 9, v5
    v_add_u32 v41, s46, v5
    v_xor_b32 v5, 4, v4
    v_lshl_add_u32 v5, v5, 5, v3
    v_lshl_add_u32 v5, v2, 9, v5
    v_add_u32 v42, s46, v5
    v_xor_b32 v5, 5, v4
    v_lshl_add_u32 v5, v5, 5, v3
    v_lshl_add_u32 v5, v2, 9, v5
    v_add_u32 v43, s46, v5
    v_xor_b32 v5, 6, v4
    v_lshl_add_u32 v5, v5, 5, v3
    v_lshl_add_u32 v5, v2, 9, v5
    v_add_u32 v44, s46, v5
    v_xor_b32 v5, 7, v4
    v_lshl_add_u32 v5, v5, 5, v3
    v_lshl_add_u32 v5, v2, 9, v5
    v_add_u32 v45, s46, v5
    s_lshl_b32 s46, s45, 2
    s_add_u32 s47, s46, 0
    v_xor_b32 v5, s47, v4
    v_lshl_add_u32 v5, v5, 5, v3
    v_lshl_add_u32 v10, v2, 8, v5
    v_add_u32 v14, 65536, v10
    s_add_u32 s47, s46, 1
    v_xor_b32 v5, s47, v4
    v_lshl_add_u32 v5, v5, 5, v3
    v_lshl_add_u32 v11, v2, 8, v5
    v_add_u32 v15, 65536, v11
    s_add_u32 s47, s46, 2
    v_xor_b32 v5, s47, v4
    v_lshl_add_u32 v5, v5, 5, v3
    v_lshl_add_u32 v12, v2, 8, v5
    v_add_u32 v16, 65536, v12
    s_add_u32 s47, s46, 3
    v_xor_b32 v5, s47, v4
    v_lshl_add_u32 v5, v5, 5, v3
    v_lshl_add_u32 v13, v2, 8, v5
    v_add_u32 v17, 65536, v13
    s_mul_i32 s46, s36, 16777216
    s_add_u32 s46, s46, 20971520
    s_lshl_b32 s47, s35, 20
    s_add_u32 s46, s46, s47
    s_lshl_b32 s47, s32, 17
    s_add_u32 s46, s46, s47
    s_add_u32 s48, s28, s46
    s_addc_u32 s49, s29, 0
    s_mov_b32 s16, s48
    s_and_b32 s17, s49, 0xffff
    s_mov_b32 s18, 131072
    s_mov_b32 s19, 0x00020000
    s_lshr_b32 s46, s34, 1
    s_lshl_b32 s46, s46, 20
    s_add_u32 s46, s46, 4194304
    s_lshl_b32 s47, s32, 17
    s_add_u32 s46, s46, s47
    s_and_b32 s47, s34, 1
    s_lshl_b32 s47, s47, 12
    s_add_u32 s46, s46, s47
    s_add_u32 s48, s28, s46
    s_addc_u32 s49, s29, 0
    s_sub_u32 s47, 131072, s47
    s_mov_b32 s52, s48
    s_and_b32 s53, s49, 0xffff
    s_mov_b32 s54, s47
    s_mov_b32 s55, 0x00020000
    v_lshlrev_b32 v34, 4, v1
    s_lshl_b32 s46, s44, 16
    s_add_u32 s47, s36, 12
    s_lshl_b32 s47, s45, s47
    s_add_u32 s46, s46, s47
    v_add_u32 v34, s46, v34
    s_cmp_ge_u32 s2, 64
    s_cbranch_scc1 L_qkv_noln1
    s_add_u32 s48, s28, 0
    s_addc_u32 s49, s29, 0
    s_mov_b32 s60, s48
    s_and_b32 s61, s49, 0xffff
    s_mov_b32 s62, 1835008
    s_mov_b32 s63, 0x00020000
    s_waitcnt vmcnt(16)
    v_lshlrev_b32_e64 v96, 16, v64
    v_and_b32 v97, 0xffff0000, v64
    v_lshlrev_b32_e64 v98, 16, v65
    v_and_b32 v99, 0xffff0000, v65
    v_lshlrev_b32_e64 v100, 16, v66
    v_and_b32 v101, 0xffff0000, v66
    v_lshlrev_b32_e64 v102, 16, v67
    v_and_b32 v103, 0xffff0000, v67
    v_lshlrev_b32_e64 v104, 16, v68
    v_and_b32 v105, 0xffff0000, v68
    v_lshlrev_b32_e64 v106, 16, v69
    v_and_b32 v107, 0xffff0000, v69
    v_lshlrev_b32_e64 v108, 16, v70
    v_and_b32 v109, 0xffff0000, v70
    v_lshlrev_b32_e64 v110, 16, v71
    v_and_b32 v111, 0xffff0000, v71
    v_lshlrev_b32_e64 v112, 16, v72
    v_and_b32 v113, 0xffff0000, v72
    v_lshlrev_b32_e64 v114, 16, v73
    v_and_b32 v115, 0xffff0000, v73
    v_lshlrev_b32_e64 v116, 16, v74
    v_and_b32 v117, 0xffff0000, v74
    v_lshlrev_b32_e64 v118, 16, v75
    v_and_b32 v119, 0xffff0000, v75
    v_lshlrev_b32_e64 v120, 16, v76
    v_and_b32 v121, 0xffff0000, v76
    v_lshlrev_b32_e64 v122, 16, v77
    v_and_b32 v123, 0xffff0000, v77
    v_lshlrev_b32_e64 v124, 16, v78
    v_and_b32 v125, 0xffff0000, v78
    v_lshlrev_b32_e64 v126, 16, v79
    v_and_b32 v127, 0xffff0000, v79
    v_lshlrev_b32_e64 v128, 16, v80
    v_and_b32 v129, 0xffff0000, v80
    v_lshlrev_b32_e64 v130, 16, v81
    v_and_b32 v131, 0xffff0000, v81
    v_lshlrev_b32_e64 v132, 16, v82
    v_and_b32 v133, 0xffff0000, v82
    v_lshlrev_b32_e64 v134, 16, v83
    v_and_b32 v135, 0xffff0000, v83
    v_lshlrev_b32_e64 v136, 16, v84
    v_and_b32 v137, 0xffff0000, v84
    v_lshlrev_b32_e64 v138, 16, v85
    v_and_b32 v139, 0xffff0000, v85
    v_lshlrev_b32_e64 v140, 16, v86
    v_and_b32 v141, 0xffff0000, v86
    v_lshlrev_b32_e64 v142, 16, v87
    v_and_b32 v143, 0xffff0000, v87
    v_lshlrev_b32_e64 v144, 16, v88
    v_and_b32 v145, 0xffff0000, v88
    v_lshlrev_b32_e64 v146, 16, v89
    v_and_b32 v147, 0xffff0000, v89
    v_lshlrev_b32_e64 v148, 16, v90
    v_and_b32 v149, 0xffff0000, v90
    v_lshlrev_b32_e64 v150, 16, v91
    v_and_b32 v151, 0xffff0000, v91
    v_add_f32 v160, v96, v100
    v_add_f32 v161, v97, v101
    v_add_f32 v162, v98, v102
    v_add_f32 v163, v99, v103
    v_add_f32 v160, v160, v104
    v_add_f32 v161, v161, v105
    v_add_f32 v162, v162, v106
    v_add_f32 v163, v163, v107
    v_add_f32 v160, v160, v108
    v_add_f32 v161, v161, v109
    v_add_f32 v162, v162, v110
    v_add_f32 v163, v163, v111
    v_add_f32 v160, v160, v112
    v_add_f32 v161, v161, v113
    v_add_f32 v162, v162, v114
    v_add_f32 v163, v163, v115
    v_add_f32 v160, v160, v116
    v_add_f32 v161, v161, v117
    v_add_f32 v162, v162, v118
    v_add_f32 v163, v163, v119
    v_add_f32 v160, v160, v120
    v_add_f32 v161, v161, v121
    v_add_f32 v162, v162, v122
    v_add_f32 v163, v163, v123
    v_add_f32 v160, v160, v124
    v_add_f32 v161, v161, v125
    v_add_f32 v162, v162, v126
    v_add_f32 v163, v163, v127
    v_add_f32 v160, v160, v128
    v_add_f32 v161, v161, v129
    v_add_f32 v162, v162, v130
    v_add_f32 v163, v163, v131
    v_add_f32 v160, v160, v132
    v_add_f32 v161, v161, v133
    v_add_f32 v162, v162, v134
    v_add_f32 v163, v163, v135
    v_add_f32 v160, v160, v136
    v_add_f32 v161, v161, v137
    v_add_f32 v162, v162, v138
    v_add_f32 v163, v163, v139
    v_add_f32 v160, v160, v140
    v_add_f32 v161, v161, v141
    v_add_f32 v162, v162, v142
    v_add_f32 v163, v163, v143
    v_add_f32 v160, v160, v144
    v_add_f32 v161, v161, v145
    v_add_f32 v162, v162, v146
    v_add_f32 v163, v163, v147
    v_add_f32 v160, v160, v148
    v_add_f32 v161, v161, v149
    v_add_f32 v162, v162, v150
    v_add_f32 v163, v163, v151
    v_add_f32 v160, v160, v161
    v_add_f32 v162, v162, v163
    v_add_f32 v160, v160, v162
    s_nop 1
    v_add_f32 v160, v160, v160 quad_perm:[1,0,3,2] row_mask:0xf bank_mask:0xf
    s_nop 1
    v_add_f32 v160, v160, v160 quad_perm:[2,3,0,1] row_mask:0xf bank_mask:0xf
    s_nop 1
    v_add_f32 v160, v160, v160 row_half_mirror row_mask:0xf bank_mask:0xf
    v_mul_f32 v160, 0x3b124925, v160
    v_sub_f32 v96, v96, v160
    v_sub_f32 v97, v97, v160
    v_sub_f32 v98, v98, v160
    v_sub_f32 v99, v99, v160
    v_sub_f32 v100, v100, v160
    v_sub_f32 v101, v101, v160
    v_sub_f32 v102, v102, v160
    v_sub_f32 v103, v103, v160
    v_sub_f32 v104, v104, v160
    v_sub_f32 v105, v105, v160
    v_sub_f32 v106, v106, v160
    v_sub_f32 v107, v107, v160
    v_sub_f32 v108, v108, v160
    v_sub_f32 v109, v109, v160
    v_sub_f32 v110, v110, v160
    v_sub_f32 v111, v111, v160
    v_sub_f32 v112, v112, v160
    v_sub_f32 v113, v113, v160
    v_sub_f32 v114, v114, v160
    v_sub_f32 v115, v115, v160
    v_sub_f32 v116, v116, v160
    v_sub_f32 v117, v117, v160
    v_sub_f32 v118, v118, v160
    v_sub_f32 v119, v119, v160
    v_sub_f32 v120, v120, v160
    v_sub_f32 v121, v121, v160
    v_sub_f32 v122, v122, v160
    v_sub_f32 v123, v123, v160
    v_sub_f32 v124, v124, v160
    v_sub_f32 v125, v125, v160
    v_sub_f32 v126, v126, v160
    v_sub_f32 v127, v127, v160
    v_sub_f32 v128, v128, v160
    v_sub_f32 v129, v129, v160
    v_sub_f32 v130, v130, v160
    v_sub_f32 v131, v131, v160
    v_sub_f32 v132, v132, v160
    v_sub_f32 v133, v133, v160
    v_sub_f32 v134, v134, v160
    v_sub_f32 v135, v135, v160
    v_sub_f32 v136, v136, v160
    v_sub_f32 v137, v137, v160
    v_sub_f32 v138, v138, v160
    v_sub_f32 v139, v139, v160
    v_sub_f32 v140, v140, v160
    v_sub_f32 v141, v141, v160
    v_sub_f32 v142, v142, v160
    v_sub_f32 v143, v143, v160
    v_sub_f32 v144, v144, v160
    v_sub_f32 v145, v145, v160
    v_sub_f32 v146, v146, v160
    v_sub_f32 v147, v147, v160
    v_sub_f32 v148, v148, v160
    v_sub_f32 v149, v149, v160
    v_sub_f32 v150, v150, v160
    v_sub_f32 v151, v151, v160
    v_mul_f32 v164, v96, v96
    v_mul_f32 v165, v97, v97
    v_mul_f32 v166, v98, v98
    v_mul_f32 v167, v99, v99
    v_fmac_f32 v164, v100, v100
    v_fmac_f32 v165, v101, v101
    v_fmac_f32 v166, v102, v102
    v_fmac_f32 v167, v103, v103
    v_fmac_f32 v164, v104, v104
    v_fmac_f32 v165, v105, v105
    v_fmac_f32 v166, v106, v106
    v_fmac_f32 v167, v107, v107
    v_fmac_f32 v164, v108, v108
    v_fmac_f32 v165, v109, v109
    v_fmac_f32 v166, v110, v110
    v_fmac_f32 v167, v111, v111
    v_fmac_f32 v164, v112, v112
    v_fmac_f32 v165, v113, v113
    v_fmac_f32 v166, v114, v114
    v_fmac_f32 v167, v115, v115
    v_fmac_f32 v164, v116, v116
    v_fmac_f32 v165, v117, v117
    v_fmac_f32 v166, v118, v118
    v_fmac_f32 v167, v119, v119
    v_fmac_f32 v164, v120, v120
    v_fmac_f32 v165, v121, v121
    v_fmac_f32 v166, v122, v122
    v_fmac_f32 v167, v123, v123
    v_fmac_f32 v164, v124, v124
    v_fmac_f32 v165, v125, v125
    v_fmac_f32 v166, v126, v126
    v_fmac_f32 v167, v127, v127
    v_fmac_f32 v164, v128, v128
    v_fmac_f32 v165, v129, v129
    v_fmac_f32 v166, v130, v130
    v_fmac_f32 v167, v131, v131
    v_fmac_f32 v164, v132, v132
    v_fmac_f32 v165, v133, v133
    v_fmac_f32 v166, v134, v134
    v_fmac_f32 v167, v135, v135
    v_fmac_f32 v164, v136, v136
    v_fmac_f32 v165, v137, v137
    v_fmac_f32 v166, v138, v138
    v_fmac_f32 v167, v139, v139
    v_fmac_f32 v164, v140, v140
    v_fmac_f32 v165, v141, v141
    v_fmac_f32 v166, v142, v142
    v_fmac_f32 v167, v143, v143
    v_fmac_f32 v164, v144, v144
    v_fmac_f32 v165, v145, v145
    v_fmac_f32 v166, v146, v146
    v_fmac_f32 v167, v147, v147
    v_fmac_f32 v164, v148, v148
    v_fmac_f32 v165, v149, v149
    v_fmac_f32 v166, v150, v150
    v_fmac_f32 v167, v151, v151
    v_add_f32 v164, v164, v165
    v_add_f32 v166, v166, v167
    v_add_f32 v164, v164, v166
    s_nop 1
    v_add_f32 v164, v164, v164 quad_perm:[1,0,3,2] row_mask:0xf bank_mask:0xf
    s_nop 1
    v_add_f32 v164, v164, v164 quad_perm:[2,3,0,1] row_mask:0xf bank_mask:0xf
    s_nop 1
    v_add_f32 v164, v164, v164 row_half_mirror row_mask:0xf bank_mask:0xf
    v_mov_b32 v165, 0x3727c5ac
    v_fmac_f32 v165, 0x3b124925, v164
    v_rsq_f32 v165, v165
    s_nop 0
    v_mul_f32 v165, 0x3db8aa3b, v165
    v_mul_f32 v96, v96, v165
    v_mul_f32 v97, v97, v165
    v_mul_f32 v98, v98, v165
    v_mul_f32 v99, v99, v165
    v_mul_f32 v100, v100, v165
    v_mul_f32 v101, v101, v165
    v_mul_f32 v102, v102, v165
    v_mul_f32 v103, v103, v165
    v_mul_f32 v104, v104, v165
    v_mul_f32 v105, v105, v165
    v_mul_f32 v106, v106, v165
    v_mul_f32 v107, v107, v165
    v_mul_f32 v108, v108, v165
    v_mul_f32 v109, v109, v165
    v_mul_f32 v110, v110, v165
    v_mul_f32 v111, v111, v165
    v_mul_f32 v112, v112, v165
    v_mul_f32 v113, v113, v165
    v_mul_f32 v114, v114, v165
    v_mul_f32 v115, v115, v165
    v_mul_f32 v116, v116, v165
    v_mul_f32 v117, v117, v165
    v_mul_f32 v118, v118, v165
    v_mul_f32 v119, v119, v165
    v_mul_f32 v120, v120, v165
    v_mul_f32 v121, v121, v165
    v_mul_f32 v122, v122, v165
    v_mul_f32 v123, v123, v165
    v_mul_f32 v124, v124, v165
    v_mul_f32 v125, v125, v165
    v_mul_f32 v126, v126, v165
    v_mul_f32 v127, v127, v165
    v_mul_f32 v128, v128, v165
    v_mul_f32 v129, v129, v165
    v_mul_f32 v130, v130, v165
    v_mul_f32 v131, v131, v165
    v_mul_f32 v132, v132, v165
    v_mul_f32 v133, v133, v165
    v_mul_f32 v134, v134, v165
    v_mul_f32 v135, v135, v165
    v_mul_f32 v136, v136, v165
    v_mul_f32 v137, v137, v165
    v_mul_f32 v138, v138, v165
    v_mul_f32 v139, v139, v165
    v_mul_f32 v140, v140, v165
    v_mul_f32 v141, v141, v165
    v_mul_f32 v142, v142, v165
    v_mul_f32 v143, v143, v165
    v_mul_f32 v144, v144, v165
    v_mul_f32 v145, v145, v165
    v_mul_f32 v146, v146, v165
    v_mul_f32 v147, v147, v165
    v_mul_f32 v148, v148, v165
    v_mul_f32 v149, v149, v165
    v_mul_f32 v150, v150, v165
    v_mul_f32 v151, v151, v165
    v_cvt_pk_bf16_f32 v64, v96, v97
    v_cvt_pk_bf16_f32 v65, v98, v99
    v_cvt_pk_bf16_f32 v66, v100, v101
    v_cvt_pk_bf16_f32 v67, v102, v103
    v_cvt_pk_bf16_f32 v68, v104, v105
    v_cvt_pk_bf16_f32 v69, v106, v107
    v_cvt_pk_bf16_f32 v70, v108, v109
    v_cvt_pk_bf16_f32 v71, v110, v111
    v_cvt_pk_bf16_f32 v72, v112, v113
    v_cvt_pk_bf16_f32 v73, v114, v115
    v_cvt_pk_bf16_f32 v74, v116, v117
    v_cvt_pk_bf16_f32 v75, v118, v119
    v_cvt_pk_bf16_f32 v76, v120, v121
    v_cvt_pk_bf16_f32 v77, v122, v123
    v_cvt_pk_bf16_f32 v78, v124, v125
    v_cvt_pk_bf16_f32 v79, v126, v127
    v_cvt_pk_bf16_f32 v80, v128, v129
    v_cvt_pk_bf16_f32 v81, v130, v131
    v_cvt_pk_bf16_f32 v82, v132, v133
    v_cvt_pk_bf16_f32 v83, v134, v135
    v_cvt_pk_bf16_f32 v84, v136, v137
    v_cvt_pk_bf16_f32 v85, v138, v139
    v_cvt_pk_bf16_f32 v86, v140, v141
    v_cvt_pk_bf16_f32 v87, v142, v143
    v_cvt_pk_bf16_f32 v88, v144, v145
    v_cvt_pk_bf16_f32 v89, v146, v147
    v_cvt_pk_bf16_f32 v90, v148, v149
    v_cvt_pk_bf16_f32 v91, v150, v151
    buffer_store_dwordx4 v[64:67], v37, s[60:63], 0 offen offset:0 sc1
    buffer_store_dwordx4 v[68:71], v37, s[60:63], 0 offen offset:128 sc1
    buffer_store_dwordx4 v[72:75], v37, s[60:63], 0 offen offset:256 sc1
    buffer_store_dwordx4 v[76:79], v37, s[60:63], 0 offen offset:384 sc1
    buffer_store_dwordx4 v[80:83], v37, s[60:63], 0 offen offset:512 sc1
    buffer_store_dwordx4 v[84:87], v37, s[60:63], 0 offen offset:640 sc1
    buffer_store_dwordx4 v[88:91], v37, s[60:63], 0 offen offset:768 sc1
L_qkv_noln1:
    v_mov_b32 v192, 0
    v_mov_b32 v193, 0
    v_mov_b32 v194, 0
    v_mov_b32 v195, 0
    s_nop 1
    v_mfma_f32_32x32x16_bf16 a[0:15], v[192:195], v[192:195], 0
    v_mfma_f32_32x32x16_bf16 a[16:31], v[192:195], v[192:195], 0
    v_mfma_f32_32x32x16_bf16 a[32:47], v[192:195], v[192:195], 0
    v_mfma_f32_32x32x16_bf16 a[48:63], v[192:195], v[192:195], 0
    v_mfma_f32_32x32x16_bf16 a[64:79], v[192:195], v[192:195], 0
    v_mfma_f32_32x32x16_bf16 a[80:95], v[192:195], v[192:195], 0
    v_mfma_f32_32x32x16_bf16 a[96:111], v[192:195], v[192:195], 0
    v_mfma_f32_32x32x16_bf16 a[112:127], v[192:195], v[192:195], 0
    v_mfma_f32_32x32x16_bf16 a[128:143], v[192:195], v[192:195], 0
    v_mfma_f32_32x32x16_bf16 a[144:159], v[192:195], v[192:195], 0
    v_mfma_f32_32x32x16_bf16 a[160:175], v[192:195], v[192:195], 0
    v_mfma_f32_32x32x16_bf16 a[176:191], v[192:195], v[192:195], 0
    v_mfma_f32_32x32x16_bf16 a[192:207], v[192:195], v[192:195], 0
    v_mfma_f32_32x32x16_bf16 a[208:223], v[192:195], v[192:195], 0
    v_mfma_f32_32x32x16_bf16 a[224:239], v[192:195], v[192:195], 0
    v_mfma_f32_32x32x16_bf16 a[240:255], v[192:195], v[192:195], 0
    s_add_u32 m0, s23, 65536
    s_nop 0
    buffer_load_dwordx4 v26, s[12:15], s21 offen lds
    s_add_u32 m0, s23, 69632
    s_nop 0
    buffer_load_dwordx4 v27, s[12:15], s21 offen lds
    s_add_u32 m0, s23, 73728
    s_nop 0
    buffer_load_dwordx4 v28, s[12:15], s21 offen lds
    s_add_u32 m0, s23, 77824
    s_nop 0
    buffer_load_dwordx4 v29, s[12:15], s21 offen lds
    s_add_u32 m0, s23, 81920
    s_nop 0
    buffer_load_dwordx4 v30, s[12:15], s21 offen lds
    s_add_u32 m0, s23, 86016
    s_nop 0
    buffer_load_dwordx4 v31, s[12:15], s21 offen lds
    s_add_u32 m0, s23, 90112
    s_nop 0
    buffer_load_dwordx4 v32, s[12:15], s21 offen lds
    s_add_u32 m0, s23, 94208
    s_nop 0
    buffer_load_dwordx4 v33, s[12:15], s21 offen lds
    s_add_u32 m0, s22, 65536
    s_nop 0
    buffer_load_dwordx4 v18, s[8:11], s20 offen sc1 lds
    s_add_u32 m0, s22, 69632
    s_nop 0
    buffer_load_dwordx4 v19, s[8:11], s20 offen sc1 lds
    s_add_u32 m0, s22, 73728
    s_nop 0
    buffer_load_dwordx4 v20, s[8:11], s20 offen sc1 lds
    s_add_u32 m0, s22, 77824
    s_nop 0
    buffer_load_dwordx4 v21, s[8:11], s20 offen sc1 lds
    s_add_u32 m0, s22, 81920
    s_nop 0
    buffer_load_dwordx4 v22, s[8:11], s20 offen sc1 lds
    s_add_u32 m0, s22, 86016
    s_nop 0
    buffer_load_dwordx4 v23, s[8:11], s20 offen sc1 lds
    s_add_u32 m0, s22, 90112
    s_nop 0
    buffer_load_dwordx4 v24, s[8:11], s20 offen sc1 lds
    s_add_u32 m0, s22, 94208
    s_nop 0
    buffer_load_dwordx4 v25, s[8:11], s20 offen sc1 lds
    s_mov_b32 s21, 1048576
    s_mov_b32 s20, 256
    s_mul_i32 s47, s51, 2
    s_sub_u32 s46, s50, s47
    s_cmp_ge_u32 s37, 2
    s_cselect_b32 s46, 2147418112, s46
    buffer_load_dword v36, v35, s[40:43], s46 offen
    s_add_u32 s46, s46, s51
    buffer_load_dword v36, v35, s[40:43], s46 offen
    s_add_u32 s46, s46, s51
    s_cmp_ge_u32 s2, 64
    s_cbranch_scc1 L_qkv_w0
    s_waitcnt vmcnt(25)
    s_branch L_qkv_w1
L_qkv_w0:
    s_waitcnt vmcnt(18)
L_qkv_w1:
    s_barrier
    s_cmp_lt_u32 s2, 64
    s_cselect_b32 s46, 0, 1
    s_or_b32 s46, s46, s37
    s_cmp_eq_u32 s46, 0
    s_cselect_b32 s68, 2, 63
    ds_read_b128 v[64:67], v6 offset:0
    ds_read_b64_tr_b16 v[96:97], v38 offset:0
    ds_read_b64_tr_b16 v[98:99], v38 offset:2048
    ds_read_b64_tr_b16 v[100:101], v39 offset:0
    ds_read_b64_tr_b16 v[102:103], v39 offset:2048
    ds_read_b64_tr_b16 v[104:105], v40 offset:0
    ds_read_b64_tr_b16 v[106:107], v40 offset:2048
    ds_read_b64_tr_b16 v[108:109], v41 offset:0
    ds_read_b64_tr_b16 v[110:111], v41 offset:2048
    ds_read_b64_tr_b16 v[112:113], v42 offset:0
    ds_read_b64_tr_b16 v[114:115], v42 offset:2048
    ds_read_b64_tr_b16 v[116:117], v43 offset:0
    ds_read_b64_tr_b16 v[118:119], v43 offset:2048
    ds_read_b64_tr_b16 v[120:121], v44 offset:0
    ds_read_b64_tr_b16 v[122:123], v44 offset:2048
    ds_read_b64_tr_b16 v[124:125], v45 offset:0
    ds_read_b64_tr_b16 v[126:127], v45 offset:2048
    ds_read_b128 v[68:71], v6 offset:2048
    ds_read_b128 v[72:75], v6 offset:4096
    ds_read_b128 v[76:79], v6 offset:6144
    ds_read_b128 v[80:83], v6 offset:8192
    ds_read_b128 v[84:87], v6 offset:10240
    ds_read_b128 v[88:91], v6 offset:12288
    ds_read_b128 v[92:95], v6 offset:14336
    s_cmp_lg_u32 s36, 0
    s_cbranch_scc1 L_qkv_vtype
    s_mov_b32 s38, 0
    s_mov_b32 s69, 2
.p2align 3
L_qkv_kernel_k_1:
    s_waitcnt lgkmcnt(0)
    v_mfma_f32_16x16x32_bf16 a[0:3], v[96:99], v[64:67], a[0:3]
    ds_read_b128 v[128:131], v7 offset:0
    v_mfma_f32_16x16x32_bf16 a[4:7], v[100:103], v[64:67], a[4:7]
    ds_read_b64_tr_b16 v[160:161], v38 offset:16384
    v_mfma_f32_16x16x32_bf16 a[8:11], v[104:107], v[64:67], a[8:11]
    ds_read_b64_tr_b16 v[162:163], v38 offset:18432
    v_mfma_f32_16x16x32_bf16 a[12:15], v[108:111], v[64:67], a[12:15]
    ds_read_b64_tr_b16 v[164:165], v39 offset:16384
    v_mfma_f32_16x16x32_bf16 a[16:19], v[112:115], v[64:67], a[16:19]
    ds_read_b64_tr_b16 v[166:167], v39 offset:18432
    v_mfma_f32_16x16x32_bf16 a[20:23], v[116:119], v[64:67], a[20:23]
    ds_read_b64_tr_b16 v[168:169], v40 offset:16384
    v_mfma_f32_16x16x32_bf16 a[24:27], v[120:123], v[64:67], a[24:27]
    ds_read_b64_tr_b16 v[170:171], v40 offset:18432
    v_mfma_f32_16x16x32_bf16 a[28:31], v[124:127], v[64:67], a[28:31]
    ds_read_b64_tr_b16 v[172:173], v41 offset:16384
    v_mfma_f32_16x16x32_bf16 a[60:63], v[124:127], v[68:71], a[60:63]
    ds_read_b64_tr_b16 v[174:175], v41 offset:18432
    v_mfma_f32_16x16x32_bf16 a[56:59], v[120:123], v[68:71], a[56:59]
    ds_read_b64_tr_b16 v[176:177], v42 offset:16384
    v_mfma_f32_16x16x32_bf16 a[52:55], v[116:119], v[68:71], a[52:55]
    ds_read_b64_tr_b16 v[178:179], v42 offset:18432
    v_mfma_f32_16x16x32_bf16 a[48:51], v[112:115], v[68:71], a[48:51]
    ds_read_b64_tr_b16 v[180:181], v43 offset:16384
    v_mfma_f32_16x16x32_bf16 a[44:47], v[108:111], v[68:71], a[44:47]
    ds_read_b64_tr_b16 v[182:183], v43 offset:18432
    v_mfma_f32_16x16x32_bf16 a[40:43], v[104:107], v[68:71], a[40:43]
    ds_read_b64_tr_b16 v[184:185], v44 offset:16384
    v_mfma_f32_16x16x32_bf16 a[36:39], v[100:103], v[68:71], a[36:39]
    ds_read_b64_tr_b16 v[186:187], v44 offset:18432
    v_mfma_f32_16x16x32_bf16 a[32:35], v[96:99], v[68:71], a[32:35]
    ds_read_b64_tr_b16 v[188:189], v45 offset:16384
    v_mfma_f32_16x16x32_bf16 a[64:67], v[96:99], v[72:75], a[64:67]
    ds_read_b64_tr_b16 v[190:191], v45 offset:18432
    v_mfma_f32_16x16x32_bf16 a[68:71], v[100:103], v[72:75], a[68:71]
    ds_read_b128 v[132:135], v7 offset:2048
    v_mfma_f32_16x16x32_bf16 a[72:75], v[104:107], v[72:75], a[72:75]
    ds_read_b128 v[136:139], v7 offset:4096
    v_mfma_f32_16x16x32_bf16 a[76:79], v[108:111], v[72:75], a[76:79]
    ds_read_b128 v[140:143], v7 offset:6144
    v_mfma_f32_16x16x32_bf16 a[80:83], v[112:115], v[72:75], a[80:83]
    ds_read_b128 v[144:147], v7 offset:8192
    v_mfma_f32_16x16x32_bf16 a[84:87], v[116:119], v[72:75], a[84:87]
    ds_read_b128 v[148:151], v7 offset:10240
    v_mfma_f32_16x16x32_bf16 a[88:91], v[120:123], v[72:75], a[88:91]
    ds_read_b128 v[152:155], v7 offset:12288
    v_mfma_f32_16x16x32_bf16 a[92:95], v[124:127], v[72:75], a[92:95]
    ds_read_b128 v[156:159], v7 offset:14336
    v_mfma_f32_16x16x32_bf16 a[124:127], v[124:127], v[76:79], a[124:127]
    s_add_u32 s38, s38, 1
    v_mfma_f32_16x16x32_bf16 a[120:123], v[120:123], v[76:79], a[120:123]
    v_xor_b32 v6, 65536, v6
    v_mfma_f32_16x16x32_bf16 a[116:119], v[116:119], v[76:79], a[116:119]
    v_xor_b32 v7, 65536, v7
    v_mfma_f32_16x16x32_bf16 a[112:115], v[112:115], v[76:79], a[112:115]
    v_xor_b32 v38, 65536, v38
    v_mfma_f32_16x16x32_bf16 a[108:111], v[108:111], v[76:79], a[108:111]
    v_xor_b32 v39, 65536, v39
    v_mfma_f32_16x16x32_bf16 a[104:107], v[104:107], v[76:79], a[104:107]
    v_xor_b32 v40, 65536, v40
    v_mfma_f32_16x16x32_bf16 a[100:103], v[100:103], v[76:79], a[100:103]
    v_xor_b32 v41, 65536, v41
    v_mfma_f32_16x16x32_bf16 a[96:99], v[96:99], v[76:79], a[96:99]
    v_xor_b32 v42, 65536, v42
    v_mfma_f32_16x16x32_bf16 a[128:131], v[96:99], v[80:83], a[128:131]
    v_xor_b32 v43, 65536, v43
    v_mfma_f32_16x16x32_bf16 a[132:135], v[100:103], v[80:83], a[132:135]
    v_xor_b32 v44, 65536, v44
    v_mfma_f32_16x16x32_bf16 a[136:139], v[104:107], v[80:83], a[136:139]
    v_xor_b32 v45, 65536, v45
    v_mfma_f32_16x16x32_bf16 a[140:143], v[108:111], v[80:83], a[140:143]
    v_mfma_f32_16x16x32_bf16 a[144:147], v[112:115], v[80:83], a[144:147]
    v_mfma_f32_16x16x32_bf16 a[148:151], v[116:119], v[80:83], a[148:151]
    v_mfma_f32_16x16x32_bf16 a[152:155], v[120:123], v[80:83], a[152:155]
    v_mfma_f32_16x16x32_bf16 a[156:159], v[124:127], v[80:83], a[156:159]
    v_mfma_f32_16x16x32_bf16 a[188:191], v[124:127], v[84:87], a[188:191]
    v_mfma_f32_16x16x32_bf16 a[184:187], v[120:123], v[84:87], a[184:187]
    v_mfma_f32_16x16x32_bf16 a[180:183], v[116:119], v[84:87], a[180:183]
    v_mfma_f32_16x16x32_bf16 a[176:179], v[112:115], v[84:87], a[176:179]
    v_mfma_f32_16x16x32_bf16 a[172:175], v[108:111], v[84:87], a[172:175]
    v_mfma_f32_16x16x32_bf16 a[168:171], v[104:107], v[84:87], a[168:171]
    v_mfma_f32_16x16x32_bf16 a[164:167], v[100:103], v[84:87], a[164:167]
    v_mfma_f32_16x16x32_bf16 a[160:163], v[96:99], v[84:87], a[160:163]
    v_mfma_f32_16x16x32_bf16 a[192:195], v[96:99], v[88:91], a[192:195]
    v_mfma_f32_16x16x32_bf16 a[196:199], v[100:103], v[88:91], a[196:199]
    v_mfma_f32_16x16x32_bf16 a[200:203], v[104:107], v[88:91], a[200:203]
    v_mfma_f32_16x16x32_bf16 a[204:207], v[108:111], v[88:91], a[204:207]
    v_mfma_f32_16x16x32_bf16 a[208:211], v[112:115], v[88:91], a[208:211]
    v_mfma_f32_16x16x32_bf16 a[212:215], v[116:119], v[88:91], a[212:215]
    v_mfma_f32_16x16x32_bf16 a[216:219], v[120:123], v[88:91], a[216:219]
    v_mfma_f32_16x16x32_bf16 a[220:223], v[124:127], v[88:91], a[220:223]
    v_mfma_f32_16x16x32_bf16 a[252:255], v[124:127], v[92:95], a[252:255]
    v_mfma_f32_16x16x32_bf16 a[248:251], v[120:123], v[92:95], a[248:251]
    v_mfma_f32_16x16x32_bf16 a[244:247], v[116:119], v[92:95], a[244:247]
    v_mfma_f32_16x16x32_bf16 a[240:243], v[112:115], v[92:95], a[240:243]
    v_mfma_f32_16x16x32_bf16 a[236:239], v[108:111], v[92:95], a[236:239]
    v_mfma_f32_16x16x32_bf16 a[232:235], v[104:107], v[92:95], a[232:235]
    v_mfma_f32_16x16x32_bf16 a[228:231], v[100:103], v[92:95], a[228:231]
    v_mfma_f32_16x16x32_bf16 a[224:227], v[96:99], v[92:95], a[224:227]
    s_waitcnt lgkmcnt(0) vmcnt(1)
    s_barrier
    v_mfma_f32_16x16x32_bf16 a[0:3], v[160:163], v[128:131], a[0:3]
    ds_read_b128 v[64:67], v6 offset:0
    s_add_u32 m0, s23, 0
    v_mfma_f32_16x16x32_bf16 a[4:7], v[164:167], v[128:131], a[4:7]
    buffer_load_dwordx4 v26, s[12:15], s21 offen lds
    v_mfma_f32_16x16x32_bf16 a[8:11], v[168:171], v[128:131], a[8:11]
    ds_read_b64_tr_b16 v[96:97], v38 offset:0
    v_mfma_f32_16x16x32_bf16 a[12:15], v[172:175], v[128:131], a[12:15]
    ds_read_b64_tr_b16 v[98:99], v38 offset:2048
    s_add_u32 m0, s23, 4096
    v_mfma_f32_16x16x32_bf16 a[16:19], v[176:179], v[128:131], a[16:19]
    buffer_load_dwordx4 v27, s[12:15], s21 offen lds
    v_mfma_f32_16x16x32_bf16 a[20:23], v[180:183], v[128:131], a[20:23]
    v_mfma_f32_16x16x32_bf16 a[24:27], v[184:187], v[128:131], a[24:27]
    v_mfma_f32_16x16x32_bf16 a[28:31], v[188:191], v[128:131], a[28:31]
    ds_read_b64_tr_b16 v[100:101], v39 offset:0
    s_add_u32 m0, s23, 8192
    v_mfma_f32_16x16x32_bf16 a[60:63], v[188:191], v[132:135], a[60:63]
    buffer_load_dwordx4 v28, s[12:15], s21 offen lds
    v_mfma_f32_16x16x32_bf16 a[56:59], v[184:187], v[132:135], a[56:59]
    ds_read_b64_tr_b16 v[102:103], v39 offset:2048
    v_mfma_f32_16x16x32_bf16 a[52:55], v[180:183], v[132:135], a[52:55]
    ds_read_b64_tr_b16 v[104:105], v40 offset:0
    s_add_u32 m0, s23, 12288
    v_mfma_f32_16x16x32_bf16 a[48:51], v[176:179], v[132:135], a[48:51]
    buffer_load_dwordx4 v29, s[12:15], s21 offen lds
    v_mfma_f32_16x16x32_bf16 a[44:47], v[172:175], v[132:135], a[44:47]
    v_mfma_f32_16x16x32_bf16 a[40:43], v[168:171], v[132:135], a[40:43]
    v_mfma_f32_16x16x32_bf16 a[36:39], v[164:167], v[132:135], a[36:39]
    ds_read_b64_tr_b16 v[106:107], v40 offset:2048
    s_add_u32 m0, s23, 16384
    v_mfma_f32_16x16x32_bf16 a[32:35], v[160:163], v[132:135], a[32:35]
    buffer_load_dwordx4 v30, s[12:15], s21 offen lds
    v_mfma_f32_16x16x32_bf16 a[64:67], v[160:163], v[136:139], a[64:67]
    ds_read_b64_tr_b16 v[108:109], v41 offset:0
    v_mfma_f32_16x16x32_bf16 a[68:71], v[164:167], v[136:139], a[68:71]
    ds_read_b64_tr_b16 v[110:111], v41 offset:2048
    s_add_u32 m0, s23, 20480
    v_mfma_f32_16x16x32_bf16 a[72:75], v[168:171], v[136:139], a[72:75]
    buffer_load_dwordx4 v31, s[12:15], s21 offen lds
    v_mfma_f32_16x16x32_bf16 a[76:79], v[172:175], v[136:139], a[76:79]
    v_mfma_f32_16x16x32_bf16 a[80:83], v[176:179], v[136:139], a[80:83]
    v_mfma_f32_16x16x32_bf16 a[84:87], v[180:183], v[136:139], a[84:87]
    ds_read_b64_tr_b16 v[112:113], v42 offset:0
    s_add_u32 m0, s23, 24576
    v_mfma_f32_16x16x32_bf16 a[88:91], v[184:187], v[136:139], a[88:91]
    buffer_load_dwordx4 v32, s[12:15], s21 offen lds
    v_mfma_f32_16x16x32_bf16 a[92:95], v[188:191], v[136:139], a[92:95]
    ds_read_b64_tr_b16 v[114:115], v42 offset:2048
    v_mfma_f32_16x16x32_bf16 a[124:127], v[188:191], v[140:143], a[124:127]
    ds_read_b64_tr_b16 v[116:117], v43 offset:0
    s_add_u32 m0, s23, 28672
    v_mfma_f32_16x16x32_bf16 a[120:123], v[184:187], v[140:143], a[120:123]
    buffer_load_dwordx4 v33, s[12:15], s21 offen lds
    v_mfma_f32_16x16x32_bf16 a[116:119], v[180:183], v[140:143], a[116:119]
    v_mfma_f32_16x16x32_bf16 a[112:115], v[176:179], v[140:143], a[112:115]
    v_mfma_f32_16x16x32_bf16 a[108:111], v[172:175], v[140:143], a[108:111]
    ds_read_b64_tr_b16 v[118:119], v43 offset:2048
    s_add_u32 m0, s22, 0
    v_mfma_f32_16x16x32_bf16 a[104:107], v[168:171], v[140:143], a[104:107]
    buffer_load_dwordx4 v18, s[8:11], s20 offen sc1 lds
    v_mfma_f32_16x16x32_bf16 a[100:103], v[164:167], v[140:143], a[100:103]
    ds_read_b64_tr_b16 v[120:121], v44 offset:0
    v_mfma_f32_16x16x32_bf16 a[96:99], v[160:163], v[140:143], a[96:99]
    ds_read_b64_tr_b16 v[122:123], v44 offset:2048
    s_add_u32 m0, s22, 4096
    v_mfma_f32_16x16x32_bf16 a[128:131], v[160:163], v[144:147], a[128:131]
    buffer_load_dwordx4 v19, s[8:11], s20 offen sc1 lds
    v_mfma_f32_16x16x32_bf16 a[132:135], v[164:167], v[144:147], a[132:135]
    v_mfma_f32_16x16x32_bf16 a[136:139], v[168:171], v[144:147], a[136:139]
    v_mfma_f32_16x16x32_bf16 a[140:143], v[172:175], v[144:147], a[140:143]
    ds_read_b64_tr_b16 v[124:125], v45 offset:0
    s_add_u32 m0, s22, 8192
    v_mfma_f32_16x16x32_bf16 a[144:147], v[176:179], v[144:147], a[144:147]
    buffer_load_dwordx4 v20, s[8:11], s20 offen sc1 lds
    v_mfma_f32_16x16x32_bf16 a[148:151], v[180:183], v[144:147], a[148:151]
    ds_read_b64_tr_b16 v[126:127], v45 offset:2048
    v_mfma_f32_16x16x32_bf16 a[152:155], v[184:187], v[144:147], a[152:155]
    ds_read_b128 v[68:71], v6 offset:2048
    s_add_u32 m0, s22, 12288
    v_mfma_f32_16x16x32_bf16 a[156:159], v[188:191], v[144:147], a[156:159]
    buffer_load_dwordx4 v21, s[8:11], s20 offen sc1 lds
    v_mfma_f32_16x16x32_bf16 a[188:191], v[188:191], v[148:151], a[188:191]
    v_mfma_f32_16x16x32_bf16 a[184:187], v[184:187], v[148:151], a[184:187]
    v_mfma_f32_16x16x32_bf16 a[180:183], v[180:183], v[148:151], a[180:183]
    ds_read_b128 v[72:75], v6 offset:4096
    s_add_u32 m0, s22, 16384
    v_mfma_f32_16x16x32_bf16 a[176:179], v[176:179], v[148:151], a[176:179]
    buffer_load_dwordx4 v22, s[8:11], s20 offen sc1 lds
    v_mfma_f32_16x16x32_bf16 a[172:175], v[172:175], v[148:151], a[172:175]
    ds_read_b128 v[76:79], v6 offset:6144
    v_mfma_f32_16x16x32_bf16 a[168:171], v[168:171], v[148:151], a[168:171]
    ds_read_b128 v[80:83], v6 offset:8192
    s_add_u32 m0, s22, 20480
    v_mfma_f32_16x16x32_bf16 a[164:167], v[164:167], v[148:151], a[164:167]
    buffer_load_dwordx4 v23, s[8:11], s20 offen sc1 lds
    v_mfma_f32_16x16x32_bf16 a[160:163], v[160:163], v[148:151], a[160:163]
    v_mfma_f32_16x16x32_bf16 a[192:195], v[160:163], v[152:155], a[192:195]
    v_mfma_f32_16x16x32_bf16 a[196:199], v[164:167], v[152:155], a[196:199]
    ds_read_b128 v[84:87], v6 offset:10240
    s_add_u32 m0, s22, 24576
    v_mfma_f32_16x16x32_bf16 a[200:203], v[168:171], v[152:155], a[200:203]
    buffer_load_dwordx4 v24, s[8:11], s20 offen sc1 lds
    v_mfma_f32_16x16x32_bf16 a[204:207], v[172:175], v[152:155], a[204:207]
    ds_read_b128 v[88:91], v6 offset:12288
    v_mfma_f32_16x16x32_bf16 a[208:211], v[176:179], v[152:155], a[208:211]
    ds_read_b128 v[92:95], v6 offset:14336
    s_add_u32 m0, s22, 28672
    v_mfma_f32_16x16x32_bf16 a[212:215], v[180:183], v[152:155], a[212:215]
    buffer_load_dwordx4 v25, s[8:11], s20 offen sc1 lds
    v_mfma_f32_16x16x32_bf16 a[216:219], v[184:187], v[152:155], a[216:219]
    v_mfma_f32_16x16x32_bf16 a[220:223], v[188:191], v[152:155], a[220:223]
    v_mfma_f32_16x16x32_bf16 a[252:255], v[188:191], v[156:159], a[252:255]
    s_add_u32 s21, s21, 524288
    s_xor_b32 s23, s23, 65536
    v_mfma_f32_16x16x32_bf16 a[248:251], v[184:187], v[156:159], a[248:251]
    s_add_u32 s20, s20, 128
    s_xor_b32 s22, s22, 65536
    v_mfma_f32_16x16x32_bf16 a[244:247], v[180:183], v[156:159], a[244:247]
    buffer_load_dword v36, v35, s[40:43], s50 offen
    v_mfma_f32_16x16x32_bf16 a[240:243], v[176:179], v[156:159], a[240:243]
    s_add_u32 s50, s50, s51
    v_mfma_f32_16x16x32_bf16 a[236:239], v[172:175], v[156:159], a[236:239]
    v_mfma_f32_16x16x32_bf16 a[232:235], v[168:171], v[156:159], a[232:235]
    v_mfma_f32_16x16x32_bf16 a[228:231], v[164:167], v[156:159], a[228:231]
    v_mfma_f32_16x16x32_bf16 a[224:227], v[160:163], v[156:159], a[224:227]
    s_cmp_lg_u32 s38, s69
    s_cbranch_scc1 L_qkv_kernel_k_1
    s_branch L_qkv_kernel_sw_2
L_qkv_kernel_fin_4:
    v_xor_b32 v4, 65536, v6
    v_xor_b32 v5, 65536, v7
    s_waitcnt lgkmcnt(0)
    v_mfma_f32_16x16x32_bf16 a[0:3], v[96:99], v[64:67], a[0:3]
    ds_read_b64_tr_b16 v[160:161], v38 offset:16384
    v_mfma_f32_16x16x32_bf16 a[4:7], v[100:103], v[64:67], a[4:7]
    ds_read_b64_tr_b16 v[162:163], v38 offset:18432
    v_mfma_f32_16x16x32_bf16 a[8:11], v[104:107], v[64:67], a[8:11]
    ds_read_b64_tr_b16 v[164:165], v39 offset:16384
    v_mfma_f32_16x16x32_bf16 a[12:15], v[108:111], v[64:67], a[12:15]
    ds_read_b64_tr_b16 v[166:167], v39 offset:18432
    v_mfma_f32_16x16x32_bf16 a[16:19], v[112:115], v[64:67], a[16:19]
    ds_read_b64_tr_b16 v[168:169], v40 offset:16384
    v_mfma_f32_16x16x32_bf16 a[20:23], v[116:119], v[64:67], a[20:23]
    ds_read_b64_tr_b16 v[170:171], v40 offset:18432
    v_mfma_f32_16x16x32_bf16 a[24:27], v[120:123], v[64:67], a[24:27]
    ds_read_b64_tr_b16 v[172:173], v41 offset:16384
    v_mfma_f32_16x16x32_bf16 a[28:31], v[124:127], v[64:67], a[28:31]
    ds_read_b128 v[64:67], v7 offset:0
    v_mfma_f32_16x16x32_bf16 a[60:63], v[124:127], v[68:71], a[60:63]
    ds_read_b64_tr_b16 v[174:175], v41 offset:18432
    v_mfma_f32_16x16x32_bf16 a[56:59], v[120:123], v[68:71], a[56:59]
    ds_read_b64_tr_b16 v[176:177], v42 offset:16384
    v_mfma_f32_16x16x32_bf16 a[52:55], v[116:119], v[68:71], a[52:55]
    ds_read_b64_tr_b16 v[178:179], v42 offset:18432
    v_mfma_f32_16x16x32_bf16 a[48:51], v[112:115], v[68:71], a[48:51]
    ds_read_b64_tr_b16 v[180:181], v43 offset:16384
    v_mfma_f32_16x16x32_bf16 a[44:47], v[108:111], v[68:71], a[44:47]
    ds_read_b64_tr_b16 v[182:183], v43 offset:18432
    v_mfma_f32_16x16x32_bf16 a[40:43], v[104:107], v[68:71], a[40:43]
    ds_read_b64_tr_b16 v[184:185], v44 offset:16384
    v_mfma_f32_16x16x32_bf16 a[36:39], v[100:103], v[68:71], a[36:39]
    ds_read_b64_tr_b16 v[186:187], v44 offset:18432
    v_mfma_f32_16x16x32_bf16 a[32:35], v[96:99], v[68:71], a[32:35]
    ds_read_b128 v[68:71], v7 offset:2048
    v_mfma_f32_16x16x32_bf16 a[64:67], v[96:99], v[72:75], a[64:67]
    ds_read_b64_tr_b16 v[188:189], v45 offset:16384
    v_mfma_f32_16x16x32_bf16 a[68:71], v[100:103], v[72:75], a[68:71]
    ds_read_b64_tr_b16 v[190:191], v45 offset:18432
    v_mfma_f32_16x16x32_bf16 a[72:75], v[104:107], v[72:75], a[72:75]
    s_waitcnt vmcnt(1)
    s_barrier
    v_mfma_f32_16x16x32_bf16 a[76:79], v[108:111], v[72:75], a[76:79]
    v_xor_b32 v38, 65536, v38
    v_xor_b32 v39, 65536, v39
    v_mfma_f32_16x16x32_bf16 a[80:83], v[112:115], v[72:75], a[80:83]
    v_xor_b32 v40, 65536, v40
    v_xor_b32 v41, 65536, v41
    v_mfma_f32_16x16x32_bf16 a[84:87], v[116:119], v[72:75], a[84:87]
    v_xor_b32 v42, 65536, v42
    v_xor_b32 v43, 65536, v43
    v_mfma_f32_16x16x32_bf16 a[88:91], v[120:123], v[72:75], a[88:91]
    v_xor_b32 v44, 65536, v44
    v_xor_b32 v45, 65536, v45
    v_mfma_f32_16x16x32_bf16 a[92:95], v[124:127], v[72:75], a[92:95]
    ds_read_b128 v[72:75], v7 offset:4096
    v_mfma_f32_16x16x32_bf16 a[124:127], v[124:127], v[76:79], a[124:127]
    ds_read_b64_tr_b16 v[192:193], v38 offset:0
    v_mfma_f32_16x16x32_bf16 a[120:123], v[120:123], v[76:79], a[120:123]
    ds_read_b64_tr_b16 v[194:195], v38 offset:2048
    v_mfma_f32_16x16x32_bf16 a[116:119], v[116:119], v[76:79], a[116:119]
    ds_read_b64_tr_b16 v[196:197], v39 offset:0
    v_mfma_f32_16x16x32_bf16 a[112:115], v[112:115], v[76:79], a[112:115]
    ds_read_b64_tr_b16 v[198:199], v39 offset:2048
    v_mfma_f32_16x16x32_bf16 a[108:111], v[108:111], v[76:79], a[108:111]
    ds_read_b64_tr_b16 v[200:201], v40 offset:0
    v_mfma_f32_16x16x32_bf16 a[104:107], v[104:107], v[76:79], a[104:107]
    ds_read_b64_tr_b16 v[202:203], v40 offset:2048
    v_mfma_f32_16x16x32_bf16 a[100:103], v[100:103], v[76:79], a[100:103]
    ds_read_b64_tr_b16 v[204:205], v41 offset:0
    v_mfma_f32_16x16x32_bf16 a[96:99], v[96:99], v[76:79], a[96:99]
    ds_read_b128 v[76:79], v7 offset:6144
    v_mfma_f32_16x16x32_bf16 a[128:131], v[96:99], v[80:83], a[128:131]
    ds_read_b64_tr_b16 v[206:207], v41 offset:2048
    v_mfma_f32_16x16x32_bf16 a[132:135], v[100:103], v[80:83], a[132:135]
    ds_read_b64_tr_b16 v[208:209], v42 offset:0
    v_mfma_f32_16x16x32_bf16 a[136:139], v[104:107], v[80:83], a[136:139]
    ds_read_b64_tr_b16 v[210:211], v42 offset:2048
    v_mfma_f32_16x16x32_bf16 a[140:143], v[108:111], v[80:83], a[140:143]
    ds_read_b64_tr_b16 v[212:213], v43 offset:0
    v_mfma_f32_16x16x32_bf16 a[144:147], v[112:115], v[80:83], a[144:147]
    ds_read_b64_tr_b16 v[214:215], v43 offset:2048
    v_mfma_f32_16x16x32_bf16 a[148:151], v[116:119], v[80:83], a[148:151]
    ds_read_b64_tr_b16 v[216:217], v44 offset:0
    v_mfma_f32_16x16x32_bf16 a[152:155], v[120:123], v[80:83], a[152:155]
    ds_read_b64_tr_b16 v[218:219], v44 offset:2048
    v_mfma_f32_16x16x32_bf16 a[156:159], v[124:127], v[80:83], a[156:159]
    ds_read_b128 v[80:83], v7 offset:8192
    v_mfma_f32_16x16x32_bf16 a[188:191], v[124:127], v[84:87], a[188:191]
    ds_read_b64_tr_b16 v[220:221], v45 offset:0
    v_mfma_f32_16x16x32_bf16 a[184:187], v[120:123], v[84:87], a[184:187]
    ds_read_b64_tr_b16 v[222:223], v45 offset:2048
    v_mfma_f32_16x16x32_bf16 a[180:183], v[116:119], v[84:87], a[180:183]
    ds_read_b64_tr_b16 v[224:225], v38 offset:16384
    v_mfma_f32_16x16x32_bf16 a[176:179], v[112:115], v[84:87], a[176:179]
    ds_read_b64_tr_b16 v[226:227], v38 offset:18432
    v_mfma_f32_16x16x32_bf16 a[172:175], v[108:111], v[84:87], a[172:175]
    ds_read_b64_tr_b16 v[228:229], v39 offset:16384
    v_mfma_f32_16x16x32_bf16 a[168:171], v[104:107], v[84:87], a[168:171]
    ds_read_b64_tr_b16 v[230:231], v39 offset:18432
    v_mfma_f32_16x16x32_bf16 a[164:167], v[100:103], v[84:87], a[164:167]
    ds_read_b64_tr_b16 v[232:233], v40 offset:16384
    v_mfma_f32_16x16x32_bf16 a[160:163], v[96:99], v[84:87], a[160:163]
    ds_read_b128 v[84:87], v7 offset:10240
    v_mfma_f32_16x16x32_bf16 a[192:195], v[96:99], v[88:91], a[192:195]
    ds_read_b64_tr_b16 v[234:235], v40 offset:18432
    v_mfma_f32_16x16x32_bf16 a[196:199], v[100:103], v[88:91], a[196:199]
    ds_read_b64_tr_b16 v[236:237], v41 offset:16384
    v_mfma_f32_16x16x32_bf16 a[200:203], v[104:107], v[88:91], a[200:203]
    ds_read_b64_tr_b16 v[238:239], v41 offset:18432
    v_mfma_f32_16x16x32_bf16 a[204:207], v[108:111], v[88:91], a[204:207]
    ds_read_b64_tr_b16 v[240:241], v42 offset:16384
    v_mfma_f32_16x16x32_bf16 a[208:211], v[112:115], v[88:91], a[208:211]
    ds_read_b64_tr_b16 v[242:243], v42 offset:18432
    v_mfma_f32_16x16x32_bf16 a[212:215], v[116:119], v[88:91], a[212:215]
    ds_read_b64_tr_b16 v[244:245], v43 offset:16384
    v_mfma_f32_16x16x32_bf16 a[216:219], v[120:123], v[88:91], a[216:219]
    ds_read_b64_tr_b16 v[246:247], v43 offset:18432
    v_mfma_f32_16x16x32_bf16 a[220:223], v[124:127], v[88:91], a[220:223]
    ds_read_b128 v[88:91], v7 offset:12288
    v_mfma_f32_16x16x32_bf16 a[252:255], v[124:127], v[92:95], a[252:255]
    ds_read_b64_tr_b16 v[248:249], v44 offset:16384
    v_mfma_f32_16x16x32_bf16 a[248:251], v[120:123], v[92:95], a[248:251]
    ds_read_b64_tr_b16 v[250:251], v44 offset:18432
    v_mfma_f32_16x16x32_bf16 a[244:247], v[116:119], v[92:95], a[244:247]
    ds_read_b64_tr_b16 v[252:253], v45 offset:16384
    v_mfma_f32_16x16x32_bf16 a[240:243], v[112:115], v[92:95], a[240:243]
    ds_read_b64_tr_b16 v[254:255], v45 offset:18432
    v_mfma_f32_16x16x32_bf16 a[236:239], v[108:111], v[92:95], a[236:239]
    ds_read_b128 v[128:131], v4 offset:0
    v_mfma_f32_16x16x32_bf16 a[232:235], v[104:107], v[92:95], a[232:235]
    ds_read_b128 v[132:135], v5 offset:0
    v_mfma_f32_16x16x32_bf16 a[228:231], v[100:103], v[92:95], a[228:231]
    ds_read_b128 v[136:139], v4 offset:2048
    ds_read_b128 v[140:143], v5 offset:2048
    v_mfma_f32_16x16x32_bf16 a[224:227], v[96:99], v[92:95], a[224:227]
    ds_read_b128 v[92:95], v7 offset:14336
    s_waitcnt lgkmcnt(0)
    s_barrier
    v_mfma_f32_16x16x32_bf16 a[0:3], v[160:163], v[64:67], a[0:3]
    v_mfma_f32_16x16x32_bf16 a[4:7], v[164:167], v[64:67], a[4:7]
    s_add_u32 m0, s22, 32768
    s_mov_b32 s21, 0
    v_mfma_f32_16x16x32_bf16 a[8:11], v[168:171], v[64:67], a[8:11]
    buffer_load_dwordx4 v26, s[12:15], s21 offen lds
    v_mfma_f32_16x16x32_bf16 a[12:15], v[172:175], v[64:67], a[12:15]
    v_mfma_f32_16x16x32_bf16 a[16:19], v[176:179], v[64:67], a[16:19]
    v_mfma_f32_16x16x32_bf16 a[20:23], v[180:183], v[64:67], a[20:23]
    s_add_u32 m0, s22, 36864
    v_mfma_f32_16x16x32_bf16 a[24:27], v[184:187], v[64:67], a[24:27]
    buffer_load_dwordx4 v27, s[12:15], s21 offen lds
    v_mfma_f32_16x16x32_bf16 a[28:31], v[188:191], v[64:67], a[28:31]
    v_mfma_f32_16x16x32_bf16 a[28:31], v[220:223], v[128:131], a[28:31]
    v_mfma_f32_16x16x32_bf16 a[24:27], v[216:219], v[128:131], a[24:27]
    s_add_u32 m0, s22, 40960
    v_mfma_f32_16x16x32_bf16 a[20:23], v[212:215], v[128:131], a[20:23]
    buffer_load_dwordx4 v28, s[12:15], s21 offen lds
    v_mfma_f32_16x16x32_bf16 a[16:19], v[208:211], v[128:131], a[16:19]
    v_mfma_f32_16x16x32_bf16 a[12:15], v[204:207], v[128:131], a[12:15]
    v_mfma_f32_16x16x32_bf16 a[8:11], v[200:203], v[128:131], a[8:11]
    s_add_u32 m0, s22, 45056
    v_mfma_f32_16x16x32_bf16 a[4:7], v[196:199], v[128:131], a[4:7]
    buffer_load_dwordx4 v29, s[12:15], s21 offen lds
    v_mfma_f32_16x16x32_bf16 a[0:3], v[192:195], v[128:131], a[0:3]
    v_mfma_f32_16x16x32_bf16 a[0:3], v[224:227], v[132:135], a[0:3]
    v_mfma_f32_16x16x32_bf16 a[4:7], v[228:231], v[132:135], a[4:7]
    s_add_u32 m0, s22, 0
    s_mov_b32 s20, 0
    v_mfma_f32_16x16x32_bf16 a[8:11], v[232:235], v[132:135], a[8:11]
    buffer_load_dwordx4 v18, s[8:11], s20 offen sc1 lds
    v_mfma_f32_16x16x32_bf16 a[12:15], v[236:239], v[132:135], a[12:15]
    v_mfma_f32_16x16x32_bf16 a[16:19], v[240:243], v[132:135], a[16:19]
    ds_read_b128 v[144:147], v4 offset:4096
    v_mfma_f32_16x16x32_bf16 a[20:23], v[244:247], v[132:135], a[20:23]
    ds_read_b128 v[148:151], v5 offset:4096
    s_add_u32 m0, s22, 4096
    v_mfma_f32_16x16x32_bf16 a[24:27], v[248:251], v[132:135], a[24:27]
    buffer_load_dwordx4 v19, s[8:11], s20 offen sc1 lds
    v_mfma_f32_16x16x32_bf16 a[28:31], v[252:255], v[132:135], a[28:31]
    s_waitcnt lgkmcnt(2)
    v_mfma_f32_16x16x32_bf16 a[32:35], v[160:163], v[68:71], a[32:35]
    v_mfma_f32_16x16x32_bf16 a[36:39], v[164:167], v[68:71], a[36:39]
    s_add_u32 m0, s22, 8192
    v_mfma_f32_16x16x32_bf16 a[40:43], v[168:171], v[68:71], a[40:43]
    buffer_load_dwordx4 v20, s[8:11], s20 offen sc1 lds
    v_mfma_f32_16x16x32_bf16 a[44:47], v[172:175], v[68:71], a[44:47]
    v_mfma_f32_16x16x32_bf16 a[48:51], v[176:179], v[68:71], a[48:51]
    v_mfma_f32_16x16x32_bf16 a[52:55], v[180:183], v[68:71], a[52:55]
    s_add_u32 m0, s22, 12288
    v_mfma_f32_16x16x32_bf16 a[56:59], v[184:187], v[68:71], a[56:59]
    buffer_load_dwordx4 v21, s[8:11], s20 offen sc1 lds
    v_mfma_f32_16x16x32_bf16 a[60:63], v[188:191], v[68:71], a[60:63]
    v_mfma_f32_16x16x32_bf16 a[60:63], v[220:223], v[136:139], a[60:63]
    v_mfma_f32_16x16x32_bf16 a[56:59], v[216:219], v[136:139], a[56:59]
    s_add_u32 m0, s22, 16384
    v_mfma_f32_16x16x32_bf16 a[52:55], v[212:215], v[136:139], a[52:55]
    buffer_load_dwordx4 v22, s[8:11], s20 offen sc1 lds
    v_mfma_f32_16x16x32_bf16 a[48:51], v[208:211], v[136:139], a[48:51]
    v_accvgpr_read_b32 v38, a0
    v_accvgpr_read_b32 v39, a1
    v_mfma_f32_16x16x32_bf16 a[44:47], v[204:207], v[136:139], a[44:47]
    v_accvgpr_read_b32 v40, a2
    v_accvgpr_read_b32 v41, a3
    v_mfma_f32_16x16x32_bf16 a[40:43], v[200:203], v[136:139], a[40:43]
    s_add_u32 m0, s22, 20480
    v_accvgpr_read_b32 v42, a4
    v_mfma_f32_16x16x32_bf16 a[36:39], v[196:199], v[136:139], a[36:39]
    buffer_load_dwordx4 v23, s[8:11], s20 offen sc1 lds
    v_mfma_f32_16x16x32_bf16 a[32:35], v[192:195], v[136:139], a[32:35]
    v_accvgpr_read_b32 v43, a5
    v_accvgpr_read_b32 v44, a6
    v_mfma_f32_16x16x32_bf16 a[32:35], v[224:227], v[140:143], a[32:35]
    v_accvgpr_read_b32 v45, a7
    v_cvt_pk_bf16_f32 v46, v38, v39
    v_mfma_f32_16x16x32_bf16 a[36:39], v[228:231], v[140:143], a[36:39]
    s_add_u32 m0, s22, 24576
    v_cvt_pk_bf16_f32 v47, v40, v41
    v_mfma_f32_16x16x32_bf16 a[40:43], v[232:235], v[140:143], a[40:43]
    buffer_load_dwordx4 v24, s[8:11], s20 offen sc1 lds
    v_mfma_f32_16x16x32_bf16 a[44:47], v[236:239], v[140:143], a[44:47]
    v_cvt_pk_bf16_f32 v48, v42, v43
    v_cvt_pk_bf16_f32 v49, v44, v45
    v_mfma_f32_16x16x32_bf16 a[48:51], v[240:243], v[140:143], a[48:51]
    ds_read_b128 v[152:155], v4 offset:6144
    s_mov_b32 s39, 0
    v_mfma_f32_16x16x32_bf16 a[52:55], v[244:247], v[140:143], a[52:55]
    ds_read_b128 v[156:159], v5 offset:6144
    s_add_u32 m0, s22, 28672
    v_mfma_f32_16x16x32_bf16 a[56:59], v[248:251], v[140:143], a[56:59]
    buffer_load_dwordx4 v25, s[8:11], s20 offen sc1 lds
    v_mfma_f32_16x16x32_bf16 a[60:63], v[252:255], v[140:143], a[60:63]
    buffer_store_dwordx4 v[46:49], v34, s[16:19], s39 offen offset:0 sc1
    s_waitcnt lgkmcnt(2)
    v_mfma_f32_16x16x32_bf16 a[64:67], v[160:163], v[72:75], a[64:67]
    v_accvgpr_read_b32 v50, a8
    v_accvgpr_read_b32 v51, a9
    v_mfma_f32_16x16x32_bf16 a[68:71], v[164:167], v[72:75], a[68:71]
    s_add_u32 m0, s22, 98304
    s_mov_b32 s21, 524288
    v_accvgpr_read_b32 v52, a10
    v_mfma_f32_16x16x32_bf16 a[72:75], v[168:171], v[72:75], a[72:75]
    buffer_load_dwordx4 v26, s[12:15], s21 offen lds
    v_mfma_f32_16x16x32_bf16 a[76:79], v[172:175], v[72:75], a[76:79]
    v_accvgpr_read_b32 v53, a11
    v_accvgpr_read_b32 v54, a12
    v_mfma_f32_16x16x32_bf16 a[80:83], v[176:179], v[72:75], a[80:83]
    v_accvgpr_read_b32 v55, a13
    v_accvgpr_read_b32 v56, a14
    v_mfma_f32_16x16x32_bf16 a[84:87], v[180:183], v[72:75], a[84:87]
    s_add_u32 m0, s22, 102400
    v_accvgpr_read_b32 v57, a15
    v_mfma_f32_16x16x32_bf16 a[88:91], v[184:187], v[72:75], a[88:91]
    buffer_load_dwordx4 v27, s[12:15], s21 offen lds
    v_mfma_f32_16x16x32_bf16 a[92:95], v[188:191], v[72:75], a[92:95]
    v_cvt_pk_bf16_f32 v58, v50, v51
    v_cvt_pk_bf16_f32 v59, v52, v53
    v_mfma_f32_16x16x32_bf16 a[92:95], v[220:223], v[144:147], a[92:95]
    v_cvt_pk_bf16_f32 v60, v54, v55
    v_cvt_pk_bf16_f32 v61, v56, v57
    v_mfma_f32_16x16x32_bf16 a[88:91], v[216:219], v[144:147], a[88:91]
    s_add_u32 m0, s22, 106496
    s_mov_b32 s39, 0
    v_mfma_f32_16x16x32_bf16 a[84:87], v[212:215], v[144:147], a[84:87]
    buffer_load_dwordx4 v28, s[12:15], s21 offen lds
    v_mfma_f32_16x16x32_bf16 a[80:83], v[208:211], v[144:147], a[80:83]
    buffer_store_dwordx4 v[58:61], v34, s[16:19], s39 offen offset:1024 sc1
    v_mfma_f32_16x16x32_bf16 a[76:79], v[204:207], v[144:147], a[76:79]
    v_accvgpr_read_b32 v38, a16
    v_accvgpr_read_b32 v39, a17
    v_mfma_f32_16x16x32_bf16 a[72:75], v[200:203], v[144:147], a[72:75]
    s_add_u32 m0, s22, 110592
    v_accvgpr_read_b32 v40, a18
    v_mfma_f32_16x16x32_bf16 a[68:71], v[196:199], v[144:147], a[68:71]
    buffer_load_dwordx4 v29, s[12:15], s21 offen lds
    v_mfma_f32_16x16x32_bf16 a[64:67], v[192:195], v[144:147], a[64:67]
    v_accvgpr_read_b32 v41, a19
    v_accvgpr_read_b32 v42, a20
    v_mfma_f32_16x16x32_bf16 a[64:67], v[224:227], v[148:151], a[64:67]
    v_accvgpr_read_b32 v43, a21
    v_accvgpr_read_b32 v44, a22
    v_mfma_f32_16x16x32_bf16 a[68:71], v[228:231], v[148:151], a[68:71]
    s_add_u32 m0, s22, 131072
    s_mov_b32 s20, 128
    v_accvgpr_read_b32 v45, a23
    v_mfma_f32_16x16x32_bf16 a[72:75], v[232:235], v[148:151], a[72:75]
    buffer_load_dwordx4 v18, s[8:11], s20 offen sc1 lds
    v_mfma_f32_16x16x32_bf16 a[76:79], v[236:239], v[148:151], a[76:79]
    v_cvt_pk_bf16_f32 v46, v38, v39
    v_cvt_pk_bf16_f32 v47, v40, v41
    v_mfma_f32_16x16x32_bf16 a[80:83], v[240:243], v[148:151], a[80:83]
    ds_read_b128 v[128:131], v4 offset:8192
    v_cvt_pk_bf16_f32 v48, v42, v43
    v_mfma_f32_16x16x32_bf16 a[84:87], v[244:247], v[148:151], a[84:87]
    ds_read_b128 v[132:135], v5 offset:8192
    s_add_u32 m0, s22, 135168
    v_mfma_f32_16x16x32_bf16 a[88:91], v[248:251], v[148:151], a[88:91]
    buffer_load_dwordx4 v19, s[8:11], s20 offen sc1 lds
    v_mfma_f32_16x16x32_bf16 a[92:95], v[252:255], v[148:151], a[92:95]
    v_cvt_pk_bf16_f32 v49, v44, v45
    s_mov_b32 s39, 0
    s_waitcnt lgkmcnt(2)
    v_mfma_f32_16x16x32_bf16 a[96:99], v[160:163], v[76:79], a[96:99]
    buffer_store_dwordx4 v[46:49], v34, s[16:19], s39 offen offset:2048 sc1
    v_mfma_f32_16x16x32_bf16 a[100:103], v[164:167], v[76:79], a[100:103]
    s_add_u32 m0, s22, 139264
    v_accvgpr_read_b32 v50, a24
    v_mfma_f32_16x16x32_bf16 a[104:107], v[168:171], v[76:79], a[104:107]
    buffer_load_dwordx4 v20, s[8:11], s20 offen sc1 lds
    v_mfma_f32_16x16x32_bf16 a[108:111], v[172:175], v[76:79], a[108:111]
    v_accvgpr_read_b32 v51, a25
    v_accvgpr_read_b32 v52, a26
    v_mfma_f32_16x16x32_bf16 a[112:115], v[176:179], v[76:79], a[112:115]
    v_accvgpr_read_b32 v53, a27
    v_accvgpr_read_b32 v54, a28
    v_mfma_f32_16x16x32_bf16 a[116:119], v[180:183], v[76:79], a[116:119]
    s_add_u32 m0, s22, 143360
    v_accvgpr_read_b32 v55, a29
    v_mfma_f32_16x16x32_bf16 a[120:123], v[184:187], v[76:79], a[120:123]
    buffer_load_dwordx4 v21, s[8:11], s20 offen sc1 lds
    v_mfma_f32_16x16x32_bf16 a[124:127], v[188:191], v[76:79], a[124:127]
    v_accvgpr_read_b32 v56, a30
    v_accvgpr_read_b32 v57, a31
    v_mfma_f32_16x16x32_bf16 a[124:127], v[220:223], v[152:155], a[124:127]
    v_cvt_pk_bf16_f32 v58, v50, v51
    v_cvt_pk_bf16_f32 v59, v52, v53
    v_mfma_f32_16x16x32_bf16 a[120:123], v[216:219], v[152:155], a[120:123]
    s_add_u32 m0, s22, 147456
    v_cvt_pk_bf16_f32 v60, v54, v55
    v_mfma_f32_16x16x32_bf16 a[116:119], v[212:215], v[152:155], a[116:119]
    buffer_load_dwordx4 v22, s[8:11], s20 offen sc1 lds
    v_mfma_f32_16x16x32_bf16 a[112:115], v[208:211], v[152:155], a[112:115]
    v_cvt_pk_bf16_f32 v61, v56, v57
    s_mov_b32 s39, 0
    v_mfma_f32_16x16x32_bf16 a[108:111], v[204:207], v[152:155], a[108:111]
    buffer_store_dwordx4 v[58:61], v34, s[16:19], s39 offen offset:3072 sc1
    v_mfma_f32_16x16x32_bf16 a[104:107], v[200:203], v[152:155], a[104:107]
    s_add_u32 m0, s22, 151552
    v_accvgpr_read_b32 v38, a32
    v_mfma_f32_16x16x32_bf16 a[100:103], v[196:199], v[152:155], a[100:103]
    buffer_load_dwordx4 v23, s[8:11], s20 offen sc1 lds
    v_mfma_f32_16x16x32_bf16 a[96:99], v[192:195], v[152:155], a[96:99]
    v_accvgpr_read_b32 v39, a33
    v_accvgpr_read_b32 v40, a34
    v_mfma_f32_16x16x32_bf16 a[96:99], v[224:227], v[156:159], a[96:99]
    v_accvgpr_read_b32 v41, a35
    v_accvgpr_read_b32 v42, a36
    v_mfma_f32_16x16x32_bf16 a[100:103], v[228:231], v[156:159], a[100:103]
    s_add_u32 m0, s22, 155648
    v_accvgpr_read_b32 v43, a37
    v_mfma_f32_16x16x32_bf16 a[104:107], v[232:235], v[156:159], a[104:107]
    buffer_load_dwordx4 v24, s[8:11], s20 offen sc1 lds
    v_mfma_f32_16x16x32_bf16 a[108:111], v[236:239], v[156:159], a[108:111]
    v_accvgpr_read_b32 v44, a38
    v_accvgpr_read_b32 v45, a39
    v_mfma_f32_16x16x32_bf16 a[112:115], v[240:243], v[156:159], a[112:115]
    ds_read_b128 v[136:139], v4 offset:10240
    v_cvt_pk_bf16_f32 v46, v38, v39
    v_mfma_f32_16x16x32_bf16 a[116:119], v[244:247], v[156:159], a[116:119]
    ds_read_b128 v[140:143], v5 offset:10240
    s_add_u32 m0, s22, 159744
    v_mfma_f32_16x16x32_bf16 a[120:123], v[248:251], v[156:159], a[120:123]
    buffer_load_dwordx4 v25, s[8:11], s20 offen sc1 lds
    v_mfma_f32_16x16x32_bf16 a[124:127], v[252:255], v[156:159], a[124:127]
    v_cvt_pk_bf16_f32 v47, v40, v41
    v_cvt_pk_bf16_f32 v48, v42, v43
    s_waitcnt lgkmcnt(2)
    v_mfma_f32_16x16x32_bf16 a[128:131], v[160:163], v[80:83], a[128:131]
    v_cvt_pk_bf16_f32 v49, v44, v45
    s_mov_b32 s39, 8192
    v_mfma_f32_16x16x32_bf16 a[132:135], v[164:167], v[80:83], a[132:135]
    s_add_u32 m0, s22, 49152
    s_mov_b32 s21, 1048576
    v_mfma_f32_16x16x32_bf16 a[136:139], v[168:171], v[80:83], a[136:139]
    buffer_load_dwordx4 v26, s[12:15], s21 offen lds
    v_mfma_f32_16x16x32_bf16 a[140:143], v[172:175], v[80:83], a[140:143]
    buffer_store_dwordx4 v[46:49], v34, s[16:19], s39 offen offset:0 sc1
    v_mfma_f32_16x16x32_bf16 a[144:147], v[176:179], v[80:83], a[144:147]
    v_accvgpr_read_b32 v50, a40
    v_accvgpr_read_b32 v51, a41
    v_mfma_f32_16x16x32_bf16 a[148:151], v[180:183], v[80:83], a[148:151]
    s_add_u32 m0, s22, 53248
    v_accvgpr_read_b32 v52, a42
    v_mfma_f32_16x16x32_bf16 a[152:155], v[184:187], v[80:83], a[152:155]
    buffer_load_dwordx4 v27, s[12:15], s21 offen lds
    v_mfma_f32_16x16x32_bf16 a[156:159], v[188:191], v[80:83], a[156:159]
    v_accvgpr_read_b32 v53, a43
    v_accvgpr_read_b32 v54, a44
    v_mfma_f32_16x16x32_bf16 a[156:159], v[220:223], v[128:131], a[156:159]
    v_accvgpr_read_b32 v55, a45
    v_accvgpr_read_b32 v56, a46
    v_mfma_f32_16x16x32_bf16 a[152:155], v[216:219], v[128:131], a[152:155]
    s_add_u32 m0, s22, 57344
    v_accvgpr_read_b32 v57, a47
    v_mfma_f32_16x16x32_bf16 a[148:151], v[212:215], v[128:131], a[148:151]
    buffer_load_dwordx4 v28, s[12:15], s21 offen lds
    v_mfma_f32_16x16x32_bf16 a[144:147], v[208:211], v[128:131], a[144:147]
    v_cvt_pk_bf16_f32 v58, v50, v51
    v_cvt_pk_bf16_f32 v59, v52, v53
    v_mfma_f32_16x16x32_bf16 a[140:143], v[204:207], v[128:131], a[140:143]
    v_cvt_pk_bf16_f32 v60, v54, v55
    v_cvt_pk_bf16_f32 v61, v56, v57
    v_mfma_f32_16x16x32_bf16 a[136:139], v[200:203], v[128:131], a[136:139]
    s_add_u32 m0, s22, 61440
    s_mov_b32 s39, 8192
    v_mfma_f32_16x16x32_bf16 a[132:135], v[196:199], v[128:131], a[132:135]
    buffer_load_dwordx4 v29, s[12:15], s21 offen lds
    v_mfma_f32_16x16x32_bf16 a[128:131], v[192:195], v[128:131], a[128:131]
    buffer_store_dwordx4 v[58:61], v34, s[16:19], s39 offen offset:1024 sc1
    v_mfma_f32_16x16x32_bf16 a[128:131], v[224:227], v[132:135], a[128:131]
    v_accvgpr_read_b32 v38, a48
    v_accvgpr_read_b32 v39, a49
    v_mfma_f32_16x16x32_bf16 a[132:135], v[228:231], v[132:135], a[132:135]
    v_accvgpr_read_b32 v40, a50
    v_accvgpr_read_b32 v41, a51
    v_mfma_f32_16x16x32_bf16 a[136:139], v[232:235], v[132:135], a[136:139]
    v_accvgpr_read_b32 v42, a52
    v_accvgpr_read_b32 v43, a53
    v_mfma_f32_16x16x32_bf16 a[140:143], v[236:239], v[132:135], a[140:143]
    v_accvgpr_read_b32 v44, a54
    v_accvgpr_read_b32 v45, a55
    v_mfma_f32_16x16x32_bf16 a[144:147], v[240:243], v[132:135], a[144:147]
    ds_read_b128 v[144:147], v4 offset:12288
    v_cvt_pk_bf16_f32 v46, v38, v39
    v_mfma_f32_16x16x32_bf16 a[148:151], v[244:247], v[132:135], a[148:151]
    ds_read_b128 v[148:151], v5 offset:12288
    v_cvt_pk_bf16_f32 v47, v40, v41
    v_mfma_f32_16x16x32_bf16 a[152:155], v[248:251], v[132:135], a[152:155]
    v_cvt_pk_bf16_f32 v48, v42, v43
    v_cvt_pk_bf16_f32 v49, v44, v45
    v_mfma_f32_16x16x32_bf16 a[156:159], v[252:255], v[132:135], a[156:159]
    s_mov_b32 s39, 8192
    s_waitcnt lgkmcnt(2)
    v_mfma_f32_16x16x32_bf16 a[160:163], v[160:163], v[84:87], a[160:163]
    buffer_store_dwordx4 v[46:49], v34, s[16:19], s39 offen offset:2048 sc1
    v_mfma_f32_16x16x32_bf16 a[164:167], v[164:167], v[84:87], a[164:167]
    v_accvgpr_read_b32 v50, a56
    v_accvgpr_read_b32 v51, a57
    v_mfma_f32_16x16x32_bf16 a[168:171], v[168:171], v[84:87], a[168:171]
    v_accvgpr_read_b32 v52, a58
    v_accvgpr_read_b32 v53, a59
    v_mfma_f32_16x16x32_bf16 a[172:175], v[172:175], v[84:87], a[172:175]
    v_accvgpr_read_b32 v54, a60
    v_accvgpr_read_b32 v55, a61
    v_mfma_f32_16x16x32_bf16 a[176:179], v[176:179], v[84:87], a[176:179]
    v_accvgpr_read_b32 v56, a62
    v_accvgpr_read_b32 v57, a63
    v_mfma_f32_16x16x32_bf16 a[180:183], v[180:183], v[84:87], a[180:183]
    v_cvt_pk_bf16_f32 v58, v50, v51
    v_cvt_pk_bf16_f32 v59, v52, v53
    v_mfma_f32_16x16x32_bf16 a[184:187], v[184:187], v[84:87], a[184:187]
    v_cvt_pk_bf16_f32 v60, v54, v55
    v_cvt_pk_bf16_f32 v61, v56, v57
    v_mfma_f32_16x16x32_bf16 a[188:191], v[188:191], v[84:87], a[188:191]
    s_mov_b32 s39, 8192
    v_mfma_f32_16x16x32_bf16 a[188:191], v[220:223], v[136:139], a[188:191]
    buffer_store_dwordx4 v[58:61], v34, s[16:19], s39 offen offset:3072 sc1
    v_mfma_f32_16x16x32_bf16 a[184:187], v[216:219], v[136:139], a[184:187]
    v_accvgpr_read_b32 v38, a64
    v_accvgpr_read_b32 v39, a65
    v_mfma_f32_16x16x32_bf16 a[180:183], v[212:215], v[136:139], a[180:183]
    v_accvgpr_read_b32 v40, a66
    v_accvgpr_read_b32 v41, a67
    v_mfma_f32_16x16x32_bf16 a[176:179], v[208:211], v[136:139], a[176:179]
    v_accvgpr_read_b32 v42, a68
    v_accvgpr_read_b32 v43, a69
    v_mfma_f32_16x16x32_bf16 a[172:175], v[204:207], v[136:139], a[172:175]
    v_accvgpr_read_b32 v44, a70
    v_accvgpr_read_b32 v45, a71
    v_mfma_f32_16x16x32_bf16 a[168:171], v[200:203], v[136:139], a[168:171]
    v_cvt_pk_bf16_f32 v46, v38, v39
    v_cvt_pk_bf16_f32 v47, v40, v41
    v_mfma_f32_16x16x32_bf16 a[164:167], v[196:199], v[136:139], a[164:167]
    v_cvt_pk_bf16_f32 v48, v42, v43
    v_cvt_pk_bf16_f32 v49, v44, v45
    v_mfma_f32_16x16x32_bf16 a[160:163], v[192:195], v[136:139], a[160:163]
    s_mov_b32 s39, 16384
    v_mfma_f32_16x16x32_bf16 a[160:163], v[224:227], v[140:143], a[160:163]
    buffer_store_dwordx4 v[46:49], v34, s[16:19], s39 offen offset:0 sc1
    v_mfma_f32_16x16x32_bf16 a[164:167], v[228:231], v[140:143], a[164:167]
    v_accvgpr_read_b32 v50, a72
    v_accvgpr_read_b32 v51, a73
    v_mfma_f32_16x16x32_bf16 a[168:171], v[232:235], v[140:143], a[168:171]
    v_accvgpr_read_b32 v52, a74
    v_accvgpr_read_b32 v53, a75
    v_mfma_f32_16x16x32_bf16 a[172:175], v[236:239], v[140:143], a[172:175]
    v_accvgpr_read_b32 v54, a76
    v_accvgpr_read_b32 v55, a77
    v_mfma_f32_16x16x32_bf16 a[176:179], v[240:243], v[140:143], a[176:179]
    ds_read_b128 v[152:155], v4 offset:14336
    v_accvgpr_read_b32 v56, a78
    v_mfma_f32_16x16x32_bf16 a[180:183], v[244:247], v[140:143], a[180:183]
    ds_read_b128 v[156:159], v5 offset:14336
    v_accvgpr_read_b32 v57, a79
    v_mfma_f32_16x16x32_bf16 a[184:187], v[248:251], v[140:143], a[184:187]
    v_cvt_pk_bf16_f32 v58, v50, v51
    v_cvt_pk_bf16_f32 v59, v52, v53
    v_mfma_f32_16x16x32_bf16 a[188:191], v[252:255], v[140:143], a[188:191]
    v_cvt_pk_bf16_f32 v60, v54, v55
    v_cvt_pk_bf16_f32 v61, v56, v57
    s_waitcnt lgkmcnt(2)
    s_waitcnt vmcnt(25)
    s_barrier
    v_mfma_f32_16x16x32_bf16 a[192:195], v[160:163], v[88:91], a[192:195]
    ds_read_b64_tr_b16 v[64:65], v10 offset:0
    s_mov_b32 s39, 16384
    v_mfma_f32_16x16x32_bf16 a[196:199], v[164:167], v[88:91], a[196:199]
    ds_read_b64_tr_b16 v[66:67], v10 offset:1024
    v_mfma_f32_16x16x32_bf16 a[200:203], v[168:171], v[88:91], a[200:203]
    ds_read_b64_tr_b16 v[68:69], v11 offset:0
    v_mfma_f32_16x16x32_bf16 a[204:207], v[172:175], v[88:91], a[204:207]
    ds_read_b64_tr_b16 v[70:71], v11 offset:1024
    v_mfma_f32_16x16x32_bf16 a[208:211], v[176:179], v[88:91], a[208:211]
    ds_read_b64_tr_b16 v[72:73], v12 offset:0
    v_mfma_f32_16x16x32_bf16 a[212:215], v[180:183], v[88:91], a[212:215]
    ds_read_b64_tr_b16 v[74:75], v12 offset:1024
    v_mfma_f32_16x16x32_bf16 a[216:219], v[184:187], v[88:91], a[216:219]
    ds_read_b64_tr_b16 v[76:77], v13 offset:0
    v_mfma_f32_16x16x32_bf16 a[220:223], v[188:191], v[88:91], a[220:223]
    ds_read_b64_tr_b16 v[78:79], v13 offset:1024
    v_mfma_f32_16x16x32_bf16 a[220:223], v[220:223], v[144:147], a[220:223]
    ds_read_b128 v[96:99], v6 offset:0
    v_mfma_f32_16x16x32_bf16 a[216:219], v[216:219], v[144:147], a[216:219]
    ds_read_b128 v[100:103], v6 offset:2048
    v_mfma_f32_16x16x32_bf16 a[212:215], v[212:215], v[144:147], a[212:215]
    ds_read_b128 v[104:107], v6 offset:4096
    v_mfma_f32_16x16x32_bf16 a[208:211], v[208:211], v[144:147], a[208:211]
    ds_read_b128 v[108:111], v6 offset:6144
    v_mfma_f32_16x16x32_bf16 a[204:207], v[204:207], v[144:147], a[204:207]
    ds_read_b128 v[112:115], v6 offset:8192
    v_mfma_f32_16x16x32_bf16 a[200:203], v[200:203], v[144:147], a[200:203]
    ds_read_b128 v[116:119], v6 offset:10240
    v_mfma_f32_16x16x32_bf16 a[196:199], v[196:199], v[144:147], a[196:199]
    ds_read_b128 v[120:123], v6 offset:12288
    v_mfma_f32_16x16x32_bf16 a[192:195], v[192:195], v[144:147], a[192:195]
    ds_read_b128 v[124:127], v6 offset:14336
    v_mfma_f32_16x16x32_bf16 a[192:195], v[224:227], v[148:151], a[192:195]
    buffer_store_dwordx4 v[58:61], v34, s[16:19], s39 offen offset:1024 sc1
    v_mfma_f32_16x16x32_bf16 a[196:199], v[228:231], v[148:151], a[196:199]
    v_accvgpr_read_b32 v38, a80
    v_accvgpr_read_b32 v39, a81
    v_mfma_f32_16x16x32_bf16 a[200:203], v[232:235], v[148:151], a[200:203]
    v_accvgpr_read_b32 v40, a82
    v_accvgpr_read_b32 v41, a83
    v_mfma_f32_16x16x32_bf16 a[204:207], v[236:239], v[148:151], a[204:207]
    v_accvgpr_read_b32 v42, a84
    v_accvgpr_read_b32 v43, a85
    v_mfma_f32_16x16x32_bf16 a[208:211], v[240:243], v[148:151], a[208:211]
    v_accvgpr_read_b32 v44, a86
    v_accvgpr_read_b32 v45, a87
    v_mfma_f32_16x16x32_bf16 a[212:215], v[244:247], v[148:151], a[212:215]
    v_cvt_pk_bf16_f32 v46, v38, v39
    v_cvt_pk_bf16_f32 v47, v40, v41
    v_mfma_f32_16x16x32_bf16 a[216:219], v[248:251], v[148:151], a[216:219]
    v_cvt_pk_bf16_f32 v48, v42, v43
    v_cvt_pk_bf16_f32 v49, v44, v45
    v_mfma_f32_16x16x32_bf16 a[220:223], v[252:255], v[148:151], a[220:223]
    s_mov_b32 s39, 16384
    s_waitcnt lgkmcnt(2)
    v_mfma_f32_16x16x32_bf16 a[224:227], v[160:163], v[92:95], a[224:227]
    buffer_store_dwordx4 v[46:49], v34, s[16:19], s39 offen offset:2048 sc1
    v_mfma_f32_16x16x32_bf16 a[228:231], v[164:167], v[92:95], a[228:231]
    v_accvgpr_read_b32 v50, a88
    v_accvgpr_read_b32 v51, a89
    v_mfma_f32_16x16x32_bf16 a[232:235], v[168:171], v[92:95], a[232:235]
    v_accvgpr_read_b32 v52, a90
    v_accvgpr_read_b32 v53, a91
    v_mfma_f32_16x16x32_bf16 a[236:239], v[172:175], v[92:95], a[236:239]
    v_accvgpr_read_b32 v54, a92
    v_accvgpr_read_b32 v55, a93
    v_mfma_f32_16x16x32_bf16 a[240:243], v[176:179], v[92:95], a[240:243]
    v_accvgpr_read_b32 v56, a94
    v_accvgpr_read_b32 v57, a95
    v_mfma_f32_16x16x32_bf16 a[244:247], v[180:183], v[92:95], a[244:247]
    v_cvt_pk_bf16_f32 v58, v50, v51
    v_cvt_pk_bf16_f32 v59, v52, v53
    v_mfma_f32_16x16x32_bf16 a[248:251], v[184:187], v[92:95], a[248:251]
    v_cvt_pk_bf16_f32 v60, v54, v55
    v_cvt_pk_bf16_f32 v61, v56, v57
    v_mfma_f32_16x16x32_bf16 a[252:255], v[188:191], v[92:95], a[252:255]
    s_mov_b32 s39, 16384
    v_mfma_f32_16x16x32_bf16 a[252:255], v[220:223], v[152:155], a[252:255]
    buffer_store_dwordx4 v[58:61], v34, s[16:19], s39 offen offset:3072 sc1
    v_mfma_f32_16x16x32_bf16 a[248:251], v[216:219], v[152:155], a[248:251]
    v_accvgpr_read_b32 v38, a96
    v_accvgpr_read_b32 v39, a97
    v_mfma_f32_16x16x32_bf16 a[244:247], v[212:215], v[152:155], a[244:247]
    v_accvgpr_read_b32 v40, a98
    v_accvgpr_read_b32 v41, a99
    v_mfma_f32_16x16x32_bf16 a[240:243], v[208:211], v[152:155], a[240:243]
    v_accvgpr_read_b32 v42, a100
    v_accvgpr_read_b32 v43, a101
    v_mfma_f32_16x16x32_bf16 a[236:239], v[204:207], v[152:155], a[236:239]
    v_accvgpr_read_b32 v44, a102
    v_accvgpr_read_b32 v45, a103
    v_mfma_f32_16x16x32_bf16 a[232:235], v[200:203], v[152:155], a[232:235]
    v_cvt_pk_bf16_f32 v46, v38, v39
    v_cvt_pk_bf16_f32 v47, v40, v41
    v_mfma_f32_16x16x32_bf16 a[228:231], v[196:199], v[152:155], a[228:231]
    v_cvt_pk_bf16_f32 v48, v42, v43
    v_cvt_pk_bf16_f32 v49, v44, v45
    v_mfma_f32_16x16x32_bf16 a[224:227], v[192:195], v[152:155], a[224:227]
    s_mov_b32 s39, 24576
    v_mfma_f32_16x16x32_bf16 a[224:227], v[224:227], v[156:159], a[224:227]
    buffer_store_dwordx4 v[46:49], v34, s[16:19], s39 offen offset:0 sc1
    v_mfma_f32_16x16x32_bf16 a[228:231], v[228:231], v[156:159], a[228:231]
    v_accvgpr_read_b32 v50, a104
    v_accvgpr_read_b32 v51, a105
    v_mfma_f32_16x16x32_bf16 a[232:235], v[232:235], v[156:159], a[232:235]
    v_accvgpr_read_b32 v52, a106
    v_accvgpr_read_b32 v53, a107
    v_mfma_f32_16x16x32_bf16 a[236:239], v[236:239], v[156:159], a[236:239]
    v_accvgpr_read_b32 v54, a108
    v_accvgpr_read_b32 v55, a109
    v_mfma_f32_16x16x32_bf16 a[240:243], v[240:243], v[156:159], a[240:243]
    v_accvgpr_read_b32 v56, a110
    v_accvgpr_read_b32 v57, a111
    v_mfma_f32_16x16x32_bf16 a[244:247], v[244:247], v[156:159], a[244:247]
    v_cvt_pk_bf16_f32 v58, v50, v51
    v_cvt_pk_bf16_f32 v59, v52, v53
    v_mfma_f32_16x16x32_bf16 a[248:251], v[248:251], v[156:159], a[248:251]
    v_cvt_pk_bf16_f32 v60, v54, v55
    v_cvt_pk_bf16_f32 v61, v56, v57
    v_mfma_f32_16x16x32_bf16 a[252:255], v[252:255], v[156:159], a[252:255]
    s_mov_b32 s39, 24576
    s_waitcnt lgkmcnt(4)
    s_barrier
    v_mfma_f32_16x16x32_bf16 v[128:131], v[64:67], v[96:99], 0
    buffer_store_dwordx4 v[58:61], v34, s[16:19], s39 offen offset:1024 sc1
    v_mfma_f32_16x16x32_bf16 v[132:135], v[68:71], v[96:99], 0
    ds_read_b64_tr_b16 v[80:81], v10 offset:8192
    v_accvgpr_read_b32 v38, a112
    v_mfma_f32_16x16x32_bf16 v[136:139], v[72:75], v[96:99], 0
    ds_read_b64_tr_b16 v[82:83], v10 offset:9216
    v_accvgpr_read_b32 v39, a113
    v_mfma_f32_16x16x32_bf16 v[140:143], v[76:79], v[96:99], 0
    ds_read_b128 v[96:99], v7 offset:0
    s_add_u32 m0, s22, 65536
    s_mov_b32 s20, 256
    v_mfma_f32_16x16x32_bf16 v[156:159], v[76:79], v[100:103], 0
    buffer_load_dwordx4 v18, s[8:11], s20 offen sc1 lds
    v_mfma_f32_16x16x32_bf16 v[152:155], v[72:75], v[100:103], 0
    ds_read_b64_tr_b16 v[84:85], v11 offset:8192
    v_accvgpr_read_b32 v40, a114
    v_mfma_f32_16x16x32_bf16 v[148:151], v[68:71], v[100:103], 0
    ds_read_b64_tr_b16 v[86:87], v11 offset:9216
    v_accvgpr_read_b32 v41, a115
    v_mfma_f32_16x16x32_bf16 v[144:147], v[64:67], v[100:103], 0
    ds_read_b128 v[100:103], v7 offset:2048
    s_add_u32 m0, s22, 69632
    v_mfma_f32_16x16x32_bf16 v[160:163], v[64:67], v[104:107], 0
    buffer_load_dwordx4 v19, s[8:11], s20 offen sc1 lds
    v_mfma_f32_16x16x32_bf16 v[164:167], v[68:71], v[104:107], 0
    ds_read_b64_tr_b16 v[88:89], v12 offset:8192
    v_accvgpr_read_b32 v42, a116
    v_mfma_f32_16x16x32_bf16 v[168:171], v[72:75], v[104:107], 0
    ds_read_b64_tr_b16 v[90:91], v12 offset:9216
    v_accvgpr_read_b32 v43, a117
    v_mfma_f32_16x16x32_bf16 v[172:175], v[76:79], v[104:107], 0
    ds_read_b128 v[104:107], v7 offset:4096
    s_add_u32 m0, s22, 73728
    v_mfma_f32_16x16x32_bf16 v[188:191], v[76:79], v[108:111], 0
    buffer_load_dwordx4 v20, s[8:11], s20 offen sc1 lds
    v_mfma_f32_16x16x32_bf16 v[184:187], v[72:75], v[108:111], 0
    ds_read_b64_tr_b16 v[92:93], v13 offset:8192
    v_accvgpr_read_b32 v44, a118
    v_mfma_f32_16x16x32_bf16 v[180:183], v[68:71], v[108:111], 0
    ds_read_b64_tr_b16 v[94:95], v13 offset:9216
    v_accvgpr_read_b32 v45, a119
    v_mfma_f32_16x16x32_bf16 v[176:179], v[64:67], v[108:111], 0
    ds_read_b128 v[108:111], v7 offset:6144
    s_add_u32 m0, s22, 77824
    s_waitcnt lgkmcnt(12)
    v_mfma_f32_16x16x32_bf16 v[192:195], v[64:67], v[112:115], 0
    buffer_load_dwordx4 v21, s[8:11], s20 offen sc1 lds
    v_mfma_f32_16x16x32_bf16 v[196:199], v[68:71], v[112:115], 0
    v_cvt_pk_bf16_f32 v46, v38, v39
    v_cvt_pk_bf16_f32 v47, v40, v41
    v_mfma_f32_16x16x32_bf16 v[200:203], v[72:75], v[112:115], 0
    v_cvt_pk_bf16_f32 v48, v42, v43
    v_cvt_pk_bf16_f32 v49, v44, v45
    v_mfma_f32_16x16x32_bf16 v[204:207], v[76:79], v[112:115], 0
    ds_read_b128 v[112:115], v7 offset:8192
    s_add_u32 m0, s22, 81920
    v_mfma_f32_16x16x32_bf16 v[220:223], v[76:79], v[116:119], 0
    buffer_load_dwordx4 v22, s[8:11], s20 offen sc1 lds
    v_mfma_f32_16x16x32_bf16 v[216:219], v[72:75], v[116:119], 0
    s_mov_b32 s39, 24576
    v_mfma_f32_16x16x32_bf16 v[212:215], v[68:71], v[116:119], 0
    buffer_store_dwordx4 v[46:49], v34, s[16:19], s39 offen offset:2048 sc1
    v_mfma_f32_16x16x32_bf16 v[208:211], v[64:67], v[116:119], 0
    ds_read_b128 v[116:119], v7 offset:10240
    s_add_u32 m0, s22, 86016
    v_mfma_f32_16x16x32_bf16 v[224:227], v[64:67], v[120:123], 0
    buffer_load_dwordx4 v23, s[8:11], s20 offen sc1 lds
    v_mfma_f32_16x16x32_bf16 v[228:231], v[68:71], v[120:123], 0
    v_accvgpr_read_b32 v50, a120
    v_accvgpr_read_b32 v51, a121
    v_mfma_f32_16x16x32_bf16 v[232:235], v[72:75], v[120:123], 0
    v_accvgpr_read_b32 v52, a122
    v_accvgpr_read_b32 v53, a123
    v_mfma_f32_16x16x32_bf16 v[236:239], v[76:79], v[120:123], 0
    ds_read_b128 v[120:123], v7 offset:12288
    s_add_u32 m0, s22, 90112
    v_mfma_f32_16x16x32_bf16 v[252:255], v[76:79], v[124:127], 0
    buffer_load_dwordx4 v24, s[8:11], s20 offen sc1 lds
    v_mfma_f32_16x16x32_bf16 v[248:251], v[72:75], v[124:127], 0
    s_add_u32 m0, s22, 94208
    v_accvgpr_read_b32 v54, a124
    v_mfma_f32_16x16x32_bf16 v[244:247], v[68:71], v[124:127], 0
    buffer_load_dwordx4 v25, s[8:11], s20 offen sc1 lds
    v_mfma_f32_16x16x32_bf16 v[240:243], v[64:67], v[124:127], 0
    ds_read_b128 v[124:127], v7 offset:14336
    v_accvgpr_read_b32 v55, a125
    s_waitcnt lgkmcnt(0) vmcnt(23)
    s_barrier
    v_mfma_f32_16x16x32_bf16 v[128:131], v[80:83], v[96:99], v[128:131]
    v_accvgpr_read_b32 v56, a126
    v_accvgpr_read_b32 v57, a127
    v_mfma_f32_16x16x32_bf16 v[132:135], v[84:87], v[96:99], v[132:135]
    ds_read_b64_tr_b16 v[64:65], v14 offset:0
    v_cvt_pk_bf16_f32 v58, v50, v51
    v_mfma_f32_16x16x32_bf16 v[136:139], v[88:91], v[96:99], v[136:139]
    ds_read_b64_tr_b16 v[66:67], v14 offset:1024
    v_cvt_pk_bf16_f32 v59, v52, v53
    v_mfma_f32_16x16x32_bf16 v[140:143], v[92:95], v[96:99], v[140:143]
    ds_read_b128 v[96:99], v8 offset:0
    s_add_u32 m0, s22, 32768
    s_mov_b32 s21, 1572864
    v_mfma_f32_16x16x32_bf16 v[156:159], v[92:95], v[100:103], v[156:159]
    buffer_load_dwordx4 v26, s[12:15], s21 offen lds
    v_mfma_f32_16x16x32_bf16 v[152:155], v[88:91], v[100:103], v[152:155]
    ds_read_b64_tr_b16 v[68:69], v15 offset:0
    v_cvt_pk_bf16_f32 v60, v54, v55
    v_mfma_f32_16x16x32_bf16 v[148:151], v[84:87], v[100:103], v[148:151]
    ds_read_b64_tr_b16 v[70:71], v15 offset:1024
    v_cvt_pk_bf16_f32 v61, v56, v57
    v_mfma_f32_16x16x32_bf16 v[144:147], v[80:83], v[100:103], v[144:147]
    ds_read_b128 v[100:103], v8 offset:2048
    s_add_u32 m0, s22, 36864
    v_mfma_f32_16x16x32_bf16 v[160:163], v[80:83], v[104:107], v[160:163]
    buffer_load_dwordx4 v27, s[12:15], s21 offen lds
    v_mfma_f32_16x16x32_bf16 v[164:167], v[84:87], v[104:107], v[164:167]
    ds_read_b64_tr_b16 v[72:73], v16 offset:0
    s_mov_b32 s39, 24576
    v_mfma_f32_16x16x32_bf16 v[168:171], v[88:91], v[104:107], v[168:171]
    ds_read_b64_tr_b16 v[74:75], v16 offset:1024
    v_mfma_f32_16x16x32_bf16 v[172:175], v[92:95], v[104:107], v[172:175]
    ds_read_b128 v[104:107], v8 offset:4096
    s_add_u32 m0, s22, 40960
    v_mfma_f32_16x16x32_bf16 v[188:191], v[92:95], v[108:111], v[188:191]
    buffer_load_dwordx4 v28, s[12:15], s21 offen lds
    v_mfma_f32_16x16x32_bf16 v[184:187], v[88:91], v[108:111], v[184:187]
    ds_read_b64_tr_b16 v[76:77], v17 offset:0
    v_mfma_f32_16x16x32_bf16 v[180:183], v[84:87], v[108:111], v[180:183]
    ds_read_b64_tr_b16 v[78:79], v17 offset:1024
    v_mfma_f32_16x16x32_bf16 v[176:179], v[80:83], v[108:111], v[176:179]
    ds_read_b128 v[108:111], v8 offset:6144
    s_add_u32 m0, s22, 45056
    v_mfma_f32_16x16x32_bf16 v[192:195], v[80:83], v[112:115], v[192:195]
    buffer_load_dwordx4 v29, s[12:15], s21 offen lds
    v_mfma_f32_16x16x32_bf16 v[196:199], v[84:87], v[112:115], v[196:199]
    buffer_store_dwordx4 v[58:61], v34, s[16:19], s39 offen offset:3072 sc1
    v_mfma_f32_16x16x32_bf16 v[200:203], v[88:91], v[112:115], v[200:203]
    v_accvgpr_read_b32 v38, a128
    v_accvgpr_read_b32 v39, a129
    v_mfma_f32_16x16x32_bf16 v[204:207], v[92:95], v[112:115], v[204:207]
    ds_read_b128 v[112:115], v8 offset:8192
    s_add_u32 m0, s22, 0
    s_mov_b32 s20, 384
    v_mfma_f32_16x16x32_bf16 v[220:223], v[92:95], v[116:119], v[220:223]
    buffer_load_dwordx4 v18, s[8:11], s20 offen sc1 lds
    v_mfma_f32_16x16x32_bf16 v[216:219], v[88:91], v[116:119], v[216:219]
    v_accvgpr_read_b32 v40, a130
    v_accvgpr_read_b32 v41, a131
    v_mfma_f32_16x16x32_bf16 v[212:215], v[84:87], v[116:119], v[212:215]
    v_accvgpr_read_b32 v42, a132
    v_accvgpr_read_b32 v43, a133
    v_mfma_f32_16x16x32_bf16 v[208:211], v[80:83], v[116:119], v[208:211]
    ds_read_b128 v[116:119], v8 offset:10240
    s_add_u32 m0, s22, 4096
    v_mfma_f32_16x16x32_bf16 v[224:227], v[80:83], v[120:123], v[224:227]
    buffer_load_dwordx4 v19, s[8:11], s20 offen sc1 lds
    v_mfma_f32_16x16x32_bf16 v[228:231], v[84:87], v[120:123], v[228:231]
    v_accvgpr_read_b32 v44, a134
    v_accvgpr_read_b32 v45, a135
    v_mfma_f32_16x16x32_bf16 v[232:235], v[88:91], v[120:123], v[232:235]
    v_cvt_pk_bf16_f32 v46, v38, v39
    v_cvt_pk_bf16_f32 v47, v40, v41
    v_mfma_f32_16x16x32_bf16 v[236:239], v[92:95], v[120:123], v[236:239]
    ds_read_b128 v[120:123], v8 offset:12288
    v_cvt_pk_bf16_f32 v48, v42, v43
    v_mfma_f32_16x16x32_bf16 v[252:255], v[92:95], v[124:127], v[252:255]
    v_cvt_pk_bf16_f32 v49, v44, v45
    s_mov_b32 s39, 32768
    v_mfma_f32_16x16x32_bf16 v[248:251], v[88:91], v[124:127], v[248:251]
    buffer_store_dwordx4 v[46:49], v34, s[16:19], s39 offen offset:0 sc1
    v_mfma_f32_16x16x32_bf16 v[244:247], v[84:87], v[124:127], v[244:247]
    v_accvgpr_read_b32 v50, a136
    v_accvgpr_read_b32 v51, a137
    v_mfma_f32_16x16x32_bf16 v[240:243], v[80:83], v[124:127], v[240:243]
    ds_read_b128 v[124:127], v8 offset:14336
    v_accvgpr_read_b32 v52, a138
    s_waitcnt lgkmcnt(4)
    v_mfma_f32_16x16x32_bf16 v[128:131], v[64:67], v[96:99], v[128:131]
    v_accvgpr_read_b32 v53, a139
    v_accvgpr_read_b32 v54, a140
    v_mfma_f32_16x16x32_bf16 v[132:135], v[68:71], v[96:99], v[132:135]
    ds_read_b64_tr_b16 v[80:81], v14 offset:8192
    v_accvgpr_read_b32 v55, a141
    v_mfma_f32_16x16x32_bf16 v[136:139], v[72:75], v[96:99], v[136:139]
    ds_read_b64_tr_b16 v[82:83], v14 offset:9216
    v_accvgpr_read_b32 v56, a142
    v_mfma_f32_16x16x32_bf16 v[140:143], v[76:79], v[96:99], v[140:143]
    ds_read_b128 v[96:99], v9 offset:0
    s_add_u32 m0, s22, 8192
    v_mfma_f32_16x16x32_bf16 v[156:159], v[76:79], v[100:103], v[156:159]
    buffer_load_dwordx4 v20, s[8:11], s20 offen sc1 lds
    v_mfma_f32_16x16x32_bf16 v[152:155], v[72:75], v[100:103], v[152:155]
    ds_read_b64_tr_b16 v[84:85], v15 offset:8192
    v_accvgpr_read_b32 v57, a143
    v_mfma_f32_16x16x32_bf16 v[148:151], v[68:71], v[100:103], v[148:151]
    ds_read_b64_tr_b16 v[86:87], v15 offset:9216
    v_cvt_pk_bf16_f32 v58, v50, v51
    v_mfma_f32_16x16x32_bf16 v[144:147], v[64:67], v[100:103], v[144:147]
    ds_read_b128 v[100:103], v9 offset:2048
    s_add_u32 m0, s22, 12288
    v_mfma_f32_16x16x32_bf16 v[160:163], v[64:67], v[104:107], v[160:163]
    buffer_load_dwordx4 v21, s[8:11], s20 offen sc1 lds
    v_mfma_f32_16x16x32_bf16 v[164:167], v[68:71], v[104:107], v[164:167]
    ds_read_b64_tr_b16 v[88:89], v16 offset:8192
    v_cvt_pk_bf16_f32 v59, v52, v53
    v_mfma_f32_16x16x32_bf16 v[168:171], v[72:75], v[104:107], v[168:171]
    ds_read_b64_tr_b16 v[90:91], v16 offset:9216
    v_cvt_pk_bf16_f32 v60, v54, v55
    v_mfma_f32_16x16x32_bf16 v[172:175], v[76:79], v[104:107], v[172:175]
    ds_read_b128 v[104:107], v9 offset:4096
    s_add_u32 m0, s22, 16384
    v_mfma_f32_16x16x32_bf16 v[188:191], v[76:79], v[108:111], v[188:191]
    buffer_load_dwordx4 v22, s[8:11], s20 offen sc1 lds
    v_mfma_f32_16x16x32_bf16 v[184:187], v[72:75], v[108:111], v[184:187]
    ds_read_b64_tr_b16 v[92:93], v17 offset:8192
    v_cvt_pk_bf16_f32 v61, v56, v57
    v_mfma_f32_16x16x32_bf16 v[180:183], v[68:71], v[108:111], v[180:183]
    ds_read_b64_tr_b16 v[94:95], v17 offset:9216
    s_mov_b32 s39, 32768
    v_mfma_f32_16x16x32_bf16 v[176:179], v[64:67], v[108:111], v[176:179]
    ds_read_b128 v[108:111], v9 offset:6144
    s_add_u32 m0, s22, 20480
    s_waitcnt lgkmcnt(12)
    v_mfma_f32_16x16x32_bf16 v[192:195], v[64:67], v[112:115], v[192:195]
    buffer_load_dwordx4 v23, s[8:11], s20 offen sc1 lds
    v_mfma_f32_16x16x32_bf16 v[196:199], v[68:71], v[112:115], v[196:199]
    buffer_store_dwordx4 v[58:61], v34, s[16:19], s39 offen offset:1024 sc1
    v_mfma_f32_16x16x32_bf16 v[200:203], v[72:75], v[112:115], v[200:203]
    v_accvgpr_read_b32 v38, a144
    v_accvgpr_read_b32 v39, a145
    v_mfma_f32_16x16x32_bf16 v[204:207], v[76:79], v[112:115], v[204:207]
    ds_read_b128 v[112:115], v9 offset:8192
    s_add_u32 m0, s22, 24576
    v_mfma_f32_16x16x32_bf16 v[220:223], v[76:79], v[116:119], v[220:223]
    buffer_load_dwordx4 v24, s[8:11], s20 offen sc1 lds
    v_mfma_f32_16x16x32_bf16 v[216:219], v[72:75], v[116:119], v[216:219]
    v_accvgpr_read_b32 v40, a146
    v_accvgpr_read_b32 v41, a147
    v_mfma_f32_16x16x32_bf16 v[212:215], v[68:71], v[116:119], v[212:215]
    v_accvgpr_read_b32 v42, a148
    v_accvgpr_read_b32 v43, a149
    v_mfma_f32_16x16x32_bf16 v[208:211], v[64:67], v[116:119], v[208:211]
    ds_read_b128 v[116:119], v9 offset:10240
    s_add_u32 m0, s22, 28672
    v_mfma_f32_16x16x32_bf16 v[224:227], v[64:67], v[120:123], v[224:227]
    buffer_load_dwordx4 v25, s[8:11], s20 offen sc1 lds
    v_mfma_f32_16x16x32_bf16 v[228:231], v[68:71], v[120:123], v[228:231]
    v_accvgpr_read_b32 v44, a150
    v_accvgpr_read_b32 v45, a151
    v_mfma_f32_16x16x32_bf16 v[232:235], v[72:75], v[120:123], v[232:235]
    v_cvt_pk_bf16_f32 v46, v38, v39
    v_cvt_pk_bf16_f32 v47, v40, v41
    v_mfma_f32_16x16x32_bf16 v[236:239], v[76:79], v[120:123], v[236:239]
    ds_read_b128 v[120:123], v9 offset:12288
    v_cvt_pk_bf16_f32 v48, v42, v43
    v_mfma_f32_16x16x32_bf16 v[252:255], v[76:79], v[124:127], v[252:255]
    v_cvt_pk_bf16_f32 v49, v44, v45
    s_mov_b32 s39, 32768
    v_mfma_f32_16x16x32_bf16 v[248:251], v[72:75], v[124:127], v[248:251]
    buffer_store_dwordx4 v[46:49], v34, s[16:19], s39 offen offset:2048 sc1
    v_mfma_f32_16x16x32_bf16 v[244:247], v[68:71], v[124:127], v[244:247]
    v_accvgpr_read_b32 v50, a152
    v_accvgpr_read_b32 v51, a153
    v_mfma_f32_16x16x32_bf16 v[240:243], v[64:67], v[124:127], v[240:243]
    ds_read_b128 v[124:127], v9 offset:14336
    v_accvgpr_read_b32 v52, a154
    s_waitcnt lgkmcnt(0) vmcnt(16)
    s_barrier
    v_mfma_f32_16x16x32_bf16 v[128:131], v[80:83], v[96:99], v[128:131]
    v_accvgpr_read_b32 v53, a155
    v_accvgpr_read_b32 v54, a156
    v_mfma_f32_16x16x32_bf16 v[132:135], v[84:87], v[96:99], v[132:135]
    ds_read_b64_tr_b16 v[64:65], v10 offset:16384
    v_accvgpr_read_b32 v55, a157
    v_mfma_f32_16x16x32_bf16 v[136:139], v[88:91], v[96:99], v[136:139]
    ds_read_b64_tr_b16 v[66:67], v10 offset:17408
    v_accvgpr_read_b32 v56, a158
    v_mfma_f32_16x16x32_bf16 v[140:143], v[92:95], v[96:99], v[140:143]
    ds_read_b128 v[96:99], v4 offset:0
    s_add_u32 m0, s22, 98304
    s_mov_b32 s21, 2097152
    v_mfma_f32_16x16x32_bf16 v[156:159], v[92:95], v[100:103], v[156:159]
    buffer_load_dwordx4 v26, s[12:15], s21 offen lds
    v_mfma_f32_16x16x32_bf16 v[152:155], v[88:91], v[100:103], v[152:155]
    ds_read_b64_tr_b16 v[68:69], v11 offset:16384
    v_accvgpr_read_b32 v57, a159
    v_mfma_f32_16x16x32_bf16 v[148:151], v[84:87], v[100:103], v[148:151]
    ds_read_b64_tr_b16 v[70:71], v11 offset:17408
    v_cvt_pk_bf16_f32 v58, v50, v51
    v_mfma_f32_16x16x32_bf16 v[144:147], v[80:83], v[100:103], v[144:147]
    ds_read_b128 v[100:103], v4 offset:2048
    s_add_u32 m0, s22, 102400
    v_mfma_f32_16x16x32_bf16 v[160:163], v[80:83], v[104:107], v[160:163]
    buffer_load_dwordx4 v27, s[12:15], s21 offen lds
    v_mfma_f32_16x16x32_bf16 v[164:167], v[84:87], v[104:107], v[164:167]
    ds_read_b64_tr_b16 v[72:73], v12 offset:16384
    v_cvt_pk_bf16_f32 v59, v52, v53
    v_mfma_f32_16x16x32_bf16 v[168:171], v[88:91], v[104:107], v[168:171]
    ds_read_b64_tr_b16 v[74:75], v12 offset:17408
    v_cvt_pk_bf16_f32 v60, v54, v55
    v_mfma_f32_16x16x32_bf16 v[172:175], v[92:95], v[104:107], v[172:175]
    ds_read_b128 v[104:107], v4 offset:4096
    s_add_u32 m0, s22, 106496
    v_mfma_f32_16x16x32_bf16 v[188:191], v[92:95], v[108:111], v[188:191]
    buffer_load_dwordx4 v28, s[12:15], s21 offen lds
    v_mfma_f32_16x16x32_bf16 v[184:187], v[88:91], v[108:111], v[184:187]
    ds_read_b64_tr_b16 v[76:77], v13 offset:16384
    v_cvt_pk_bf16_f32 v61, v56, v57
    v_mfma_f32_16x16x32_bf16 v[180:183], v[84:87], v[108:111], v[180:183]
    ds_read_b64_tr_b16 v[78:79], v13 offset:17408
    s_mov_b32 s39, 32768
    v_mfma_f32_16x16x32_bf16 v[176:179], v[80:83], v[108:111], v[176:179]
    ds_read_b128 v[108:111], v4 offset:6144
    s_add_u32 m0, s22, 110592
    v_mfma_f32_16x16x32_bf16 v[192:195], v[80:83], v[112:115], v[192:195]
    buffer_load_dwordx4 v29, s[12:15], s21 offen lds
    v_mfma_f32_16x16x32_bf16 v[196:199], v[84:87], v[112:115], v[196:199]
    buffer_store_dwordx4 v[58:61], v34, s[16:19], s39 offen offset:3072 sc1
    v_mfma_f32_16x16x32_bf16 v[200:203], v[88:91], v[112:115], v[200:203]
    v_accvgpr_read_b32 v38, a160
    v_accvgpr_read_b32 v39, a161
    v_mfma_f32_16x16x32_bf16 v[204:207], v[92:95], v[112:115], v[204:207]
    ds_read_b128 v[112:115], v4 offset:8192
    s_add_u32 m0, s22, 131072
    s_mov_b32 s20, 512
    v_mfma_f32_16x16x32_bf16 v[220:223], v[92:95], v[116:119], v[220:223]
    buffer_load_dwordx4 v18, s[8:11], s20 offen sc1 lds
    v_mfma_f32_16x16x32_bf16 v[216:219], v[88:91], v[116:119], v[216:219]
    v_accvgpr_read_b32 v40, a162
    v_accvgpr_read_b32 v41, a163
    v_mfma_f32_16x16x32_bf16 v[212:215], v[84:87], v[116:119], v[212:215]
    v_accvgpr_read_b32 v42, a164
    v_accvgpr_read_b32 v43, a165
    v_mfma_f32_16x16x32_bf16 v[208:211], v[80:83], v[116:119], v[208:211]
    ds_read_b128 v[116:119], v4 offset:10240
    s_add_u32 m0, s22, 135168
    v_mfma_f32_16x16x32_bf16 v[224:227], v[80:83], v[120:123], v[224:227]
    buffer_load_dwordx4 v19, s[8:11], s20 offen sc1 lds
    v_mfma_f32_16x16x32_bf16 v[228:231], v[84:87], v[120:123], v[228:231]
    v_accvgpr_read_b32 v44, a166
    v_accvgpr_read_b32 v45, a167
    v_mfma_f32_16x16x32_bf16 v[232:235], v[88:91], v[120:123], v[232:235]
    v_cvt_pk_bf16_f32 v46, v38, v39
    v_cvt_pk_bf16_f32 v47, v40, v41
    v_mfma_f32_16x16x32_bf16 v[236:239], v[92:95], v[120:123], v[236:239]
    ds_read_b128 v[120:123], v4 offset:12288
    v_cvt_pk_bf16_f32 v48, v42, v43
    v_mfma_f32_16x16x32_bf16 v[252:255], v[92:95], v[124:127], v[252:255]
    v_cvt_pk_bf16_f32 v49, v44, v45
    s_mov_b32 s39, 40960
    v_mfma_f32_16x16x32_bf16 v[248:251], v[88:91], v[124:127], v[248:251]
    buffer_store_dwordx4 v[46:49], v34, s[16:19], s39 offen offset:0 sc1
    v_mfma_f32_16x16x32_bf16 v[244:247], v[84:87], v[124:127], v[244:247]
    v_accvgpr_read_b32 v50, a168
    v_accvgpr_read_b32 v51, a169
    v_mfma_f32_16x16x32_bf16 v[240:243], v[80:83], v[124:127], v[240:243]
    ds_read_b128 v[124:127], v4 offset:14336
    v_accvgpr_read_b32 v52, a170
    s_waitcnt lgkmcnt(4)
    v_mfma_f32_16x16x32_bf16 v[128:131], v[64:67], v[96:99], v[128:131]
    v_accvgpr_read_b32 v53, a171
    v_accvgpr_read_b32 v54, a172
    v_mfma_f32_16x16x32_bf16 v[132:135], v[68:71], v[96:99], v[132:135]
    ds_read_b64_tr_b16 v[80:81], v10 offset:24576
    v_accvgpr_read_b32 v55, a173
    v_mfma_f32_16x16x32_bf16 v[136:139], v[72:75], v[96:99], v[136:139]
    ds_read_b64_tr_b16 v[82:83], v10 offset:25600
    v_accvgpr_read_b32 v56, a174
    v_mfma_f32_16x16x32_bf16 v[140:143], v[76:79], v[96:99], v[140:143]
    ds_read_b128 v[96:99], v5 offset:0
    s_add_u32 m0, s22, 139264
    v_mfma_f32_16x16x32_bf16 v[156:159], v[76:79], v[100:103], v[156:159]
    buffer_load_dwordx4 v20, s[8:11], s20 offen sc1 lds
    v_mfma_f32_16x16x32_bf16 v[152:155], v[72:75], v[100:103], v[152:155]
    ds_read_b64_tr_b16 v[84:85], v11 offset:24576
    v_accvgpr_read_b32 v57, a175
    v_mfma_f32_16x16x32_bf16 v[148:151], v[68:71], v[100:103], v[148:151]
    ds_read_b64_tr_b16 v[86:87], v11 offset:25600
    v_cvt_pk_bf16_f32 v58, v50, v51
    v_mfma_f32_16x16x32_bf16 v[144:147], v[64:67], v[100:103], v[144:147]
    ds_read_b128 v[100:103], v5 offset:2048
    s_add_u32 m0, s22, 143360
    v_mfma_f32_16x16x32_bf16 v[160:163], v[64:67], v[104:107], v[160:163]
    buffer_load_dwordx4 v21, s[8:11], s20 offen sc1 lds
    v_mfma_f32_16x16x32_bf16 v[164:167], v[68:71], v[104:107], v[164:167]
    ds_read_b64_tr_b16 v[88:89], v12 offset:24576
    v_cvt_pk_bf16_f32 v59, v52, v53
    v_mfma_f32_16x16x32_bf16 v[168:171], v[72:75], v[104:107], v[168:171]
    ds_read_b64_tr_b16 v[90:91], v12 offset:25600
    v_cvt_pk_bf16_f32 v60, v54, v55
    v_mfma_f32_16x16x32_bf16 v[172:175], v[76:79], v[104:107], v[172:175]
    ds_read_b128 v[104:107], v5 offset:4096
    s_add_u32 m0, s22, 147456
    v_mfma_f32_16x16x32_bf16 v[188:191], v[76:79], v[108:111], v[188:191]
    buffer_load_dwordx4 v22, s[8:11], s20 offen sc1 lds
    v_mfma_f32_16x16x32_bf16 v[184:187], v[72:75], v[108:111], v[184:187]
    ds_read_b64_tr_b16 v[92:93], v13 offset:24576
    v_cvt_pk_bf16_f32 v61, v56, v57
    v_mfma_f32_16x16x32_bf16 v[180:183], v[68:71], v[108:111], v[180:183]
    ds_read_b64_tr_b16 v[94:95], v13 offset:25600
    s_mov_b32 s39, 40960
    v_mfma_f32_16x16x32_bf16 v[176:179], v[64:67], v[108:111], v[176:179]
    ds_read_b128 v[108:111], v5 offset:6144
    s_add_u32 m0, s22, 151552
    s_waitcnt lgkmcnt(12)
    v_mfma_f32_16x16x32_bf16 v[192:195], v[64:67], v[112:115], v[192:195]
    buffer_load_dwordx4 v23, s[8:11], s20 offen sc1 lds
    v_mfma_f32_16x16x32_bf16 v[196:199], v[68:71], v[112:115], v[196:199]
    buffer_store_dwordx4 v[58:61], v34, s[16:19], s39 offen offset:1024 sc1
    v_mfma_f32_16x16x32_bf16 v[200:203], v[72:75], v[112:115], v[200:203]
    v_accvgpr_read_b32 v38, a176
    v_accvgpr_read_b32 v39, a177
    v_mfma_f32_16x16x32_bf16 v[204:207], v[76:79], v[112:115], v[204:207]
    ds_read_b128 v[112:115], v5 offset:8192
    s_add_u32 m0, s22, 155648
    v_mfma_f32_16x16x32_bf16 v[220:223], v[76:79], v[116:119], v[220:223]
    buffer_load_dwordx4 v24, s[8:11], s20 offen sc1 lds
    v_mfma_f32_16x16x32_bf16 v[216:219], v[72:75], v[116:119], v[216:219]
    v_accvgpr_read_b32 v40, a178
    v_accvgpr_read_b32 v41, a179
    v_mfma_f32_16x16x32_bf16 v[212:215], v[68:71], v[116:119], v[212:215]
    v_accvgpr_read_b32 v42, a180
    v_accvgpr_read_b32 v43, a181
    v_mfma_f32_16x16x32_bf16 v[208:211], v[64:67], v[116:119], v[208:211]
    ds_read_b128 v[116:119], v5 offset:10240
    s_add_u32 m0, s22, 159744
    v_mfma_f32_16x16x32_bf16 v[224:227], v[64:67], v[120:123], v[224:227]
    buffer_load_dwordx4 v25, s[8:11], s20 offen sc1 lds
    v_mfma_f32_16x16x32_bf16 v[228:231], v[68:71], v[120:123], v[228:231]
    v_accvgpr_read_b32 v44, a182
    v_accvgpr_read_b32 v45, a183
    v_mfma_f32_16x16x32_bf16 v[232:235], v[72:75], v[120:123], v[232:235]
    v_cvt_pk_bf16_f32 v46, v38, v39
    v_cvt_pk_bf16_f32 v47, v40, v41
    v_mfma_f32_16x16x32_bf16 v[236:239], v[76:79], v[120:123], v[236:239]
    ds_read_b128 v[120:123], v5 offset:12288
    v_cvt_pk_bf16_f32 v48, v42, v43
    v_mfma_f32_16x16x32_bf16 v[252:255], v[76:79], v[124:127], v[252:255]
    v_cvt_pk_bf16_f32 v49, v44, v45
    s_mov_b32 s39, 40960
    v_mfma_f32_16x16x32_bf16 v[248:251], v[72:75], v[124:127], v[248:251]
    buffer_store_dwordx4 v[46:49], v34, s[16:19], s39 offen offset:2048 sc1
    v_mfma_f32_16x16x32_bf16 v[244:247], v[68:71], v[124:127], v[244:247]
    v_accvgpr_read_b32 v50, a184
    v_accvgpr_read_b32 v51, a185
    v_mfma_f32_16x16x32_bf16 v[240:243], v[64:67], v[124:127], v[240:243]
    ds_read_b128 v[124:127], v5 offset:14336
    v_accvgpr_read_b32 v52, a186
    s_waitcnt lgkmcnt(0) vmcnt(17)
    s_barrier
    v_mfma_f32_16x16x32_bf16 v[128:131], v[80:83], v[96:99], v[128:131]
    v_accvgpr_read_b32 v53, a187
    v_accvgpr_read_b32 v54, a188
    v_mfma_f32_16x16x32_bf16 v[132:135], v[84:87], v[96:99], v[132:135]
    ds_read_b64_tr_b16 v[64:65], v10 offset:0
    v_accvgpr_read_b32 v55, a189
    v_mfma_f32_16x16x32_bf16 v[136:139], v[88:91], v[96:99], v[136:139]
    ds_read_b64_tr_b16 v[66:67], v10 offset:1024
    v_accvgpr_read_b32 v56, a190
    v_mfma_f32_16x16x32_bf16 v[140:143], v[92:95], v[96:99], v[140:143]
    ds_read_b128 v[96:99], v6 offset:0
    s_add_u32 m0, s22, 49152
    s_mov_b32 s21, 2621440
    v_mfma_f32_16x16x32_bf16 v[156:159], v[92:95], v[100:103], v[156:159]
    buffer_load_dwordx4 v26, s[12:15], s21 offen lds
    v_mfma_f32_16x16x32_bf16 v[152:155], v[88:91], v[100:103], v[152:155]
    ds_read_b64_tr_b16 v[68:69], v11 offset:0
    v_accvgpr_read_b32 v57, a191
    v_mfma_f32_16x16x32_bf16 v[148:151], v[84:87], v[100:103], v[148:151]
    ds_read_b64_tr_b16 v[70:71], v11 offset:1024
    v_cvt_pk_bf16_f32 v58, v50, v51
    v_mfma_f32_16x16x32_bf16 v[144:147], v[80:83], v[100:103], v[144:147]
    ds_read_b128 v[100:103], v6 offset:2048
    s_add_u32 m0, s22, 53248
    v_mfma_f32_16x16x32_bf16 v[160:163], v[80:83], v[104:107], v[160:163]
    buffer_load_dwordx4 v27, s[12:15], s21 offen lds
    v_mfma_f32_16x16x32_bf16 v[164:167], v[84:87], v[104:107], v[164:167]
    ds_read_b64_tr_b16 v[72:73], v12 offset:0
    v_cvt_pk_bf16_f32 v59, v52, v53
    v_mfma_f32_16x16x32_bf16 v[168:171], v[88:91], v[104:107], v[168:171]
    ds_read_b64_tr_b16 v[74:75], v12 offset:1024
    v_cvt_pk_bf16_f32 v60, v54, v55
    v_mfma_f32_16x16x32_bf16 v[172:175], v[92:95], v[104:107], v[172:175]
    ds_read_b128 v[104:107], v6 offset:4096
    s_add_u32 m0, s22, 57344
    v_mfma_f32_16x16x32_bf16 v[188:191], v[92:95], v[108:111], v[188:191]
    buffer_load_dwordx4 v28, s[12:15], s21 offen lds
    v_mfma_f32_16x16x32_bf16 v[184:187], v[88:91], v[108:111], v[184:187]
    ds_read_b64_tr_b16 v[76:77], v13 offset:0
    v_cvt_pk_bf16_f32 v61, v56, v57
    v_mfma_f32_16x16x32_bf16 v[180:183], v[84:87], v[108:111], v[180:183]
    ds_read_b64_tr_b16 v[78:79], v13 offset:1024
    s_mov_b32 s39, 40960
    v_mfma_f32_16x16x32_bf16 v[176:179], v[80:83], v[108:111], v[176:179]
    ds_read_b128 v[108:111], v6 offset:6144
    s_add_u32 m0, s22, 61440
    v_mfma_f32_16x16x32_bf16 v[192:195], v[80:83], v[112:115], v[192:195]
    buffer_load_dwordx4 v29, s[12:15], s21 offen lds
    v_mfma_f32_16x16x32_bf16 v[196:199], v[84:87], v[112:115], v[196:199]
    buffer_store_dwordx4 v[58:61], v34, s[16:19], s39 offen offset:3072 sc1
    v_mfma_f32_16x16x32_bf16 v[200:203], v[88:91], v[112:115], v[200:203]
    v_accvgpr_read_b32 v38, a192
    v_accvgpr_read_b32 v39, a193
    v_mfma_f32_16x16x32_bf16 v[204:207], v[92:95], v[112:115], v[204:207]
    ds_read_b128 v[112:115], v6 offset:8192
    s_add_u32 m0, s22, 65536
    s_mov_b32 s20, 640
    v_mfma_f32_16x16x32_bf16 v[220:223], v[92:95], v[116:119], v[220:223]
    buffer_load_dwordx4 v18, s[8:11], s20 offen sc1 lds
    v_mfma_f32_16x16x32_bf16 v[216:219], v[88:91], v[116:119], v[216:219]
    v_accvgpr_read_b32 v40, a194
    v_accvgpr_read_b32 v41, a195
    v_mfma_f32_16x16x32_bf16 v[212:215], v[84:87], v[116:119], v[212:215]
    v_accvgpr_read_b32 v42, a196
    v_accvgpr_read_b32 v43, a197
    v_mfma_f32_16x16x32_bf16 v[208:211], v[80:83], v[116:119], v[208:211]
    ds_read_b128 v[116:119], v6 offset:10240
    s_add_u32 m0, s22, 69632
    v_mfma_f32_16x16x32_bf16 v[224:227], v[80:83], v[120:123], v[224:227]
    buffer_load_dwordx4 v19, s[8:11], s20 offen sc1 lds
    v_mfma_f32_16x16x32_bf16 v[228:231], v[84:87], v[120:123], v[228:231]
    v_accvgpr_read_b32 v44, a198
    v_accvgpr_read_b32 v45, a199
    v_mfma_f32_16x16x32_bf16 v[232:235], v[88:91], v[120:123], v[232:235]
    v_cvt_pk_bf16_f32 v46, v38, v39
    v_cvt_pk_bf16_f32 v47, v40, v41
    v_mfma_f32_16x16x32_bf16 v[236:239], v[92:95], v[120:123], v[236:239]
    ds_read_b128 v[120:123], v6 offset:12288
    v_cvt_pk_bf16_f32 v48, v42, v43
    v_mfma_f32_16x16x32_bf16 v[252:255], v[92:95], v[124:127], v[252:255]
    v_cvt_pk_bf16_f32 v49, v44, v45
    s_mov_b32 s39, 49152
    v_mfma_f32_16x16x32_bf16 v[248:251], v[88:91], v[124:127], v[248:251]
    buffer_store_dwordx4 v[46:49], v34, s[16:19], s39 offen offset:0 sc1
    v_mfma_f32_16x16x32_bf16 v[244:247], v[84:87], v[124:127], v[244:247]
    v_accvgpr_read_b32 v50, a200
    v_accvgpr_read_b32 v51, a201
    v_mfma_f32_16x16x32_bf16 v[240:243], v[80:83], v[124:127], v[240:243]
    ds_read_b128 v[124:127], v6 offset:14336
    v_accvgpr_read_b32 v52, a202
    s_waitcnt lgkmcnt(4)
    v_mfma_f32_16x16x32_bf16 v[128:131], v[64:67], v[96:99], v[128:131]
    v_accvgpr_read_b32 v53, a203
    v_accvgpr_read_b32 v54, a204
    v_mfma_f32_16x16x32_bf16 v[132:135], v[68:71], v[96:99], v[132:135]
    ds_read_b64_tr_b16 v[80:81], v10 offset:8192
    v_accvgpr_read_b32 v55, a205
    v_mfma_f32_16x16x32_bf16 v[136:139], v[72:75], v[96:99], v[136:139]
    ds_read_b64_tr_b16 v[82:83], v10 offset:9216
    v_accvgpr_read_b32 v56, a206
    v_mfma_f32_16x16x32_bf16 v[140:143], v[76:79], v[96:99], v[140:143]
    ds_read_b128 v[96:99], v7 offset:0
    s_add_u32 m0, s22, 73728
    v_mfma_f32_16x16x32_bf16 v[156:159], v[76:79], v[100:103], v[156:159]
    buffer_load_dwordx4 v20, s[8:11], s20 offen sc1 lds
    v_mfma_f32_16x16x32_bf16 v[152:155], v[72:75], v[100:103], v[152:155]
    ds_read_b64_tr_b16 v[84:85], v11 offset:8192
    v_accvgpr_read_b32 v57, a207
    v_mfma_f32_16x16x32_bf16 v[148:151], v[68:71], v[100:103], v[148:151]
    ds_read_b64_tr_b16 v[86:87], v11 offset:9216
    v_cvt_pk_bf16_f32 v58, v50, v51
    v_mfma_f32_16x16x32_bf16 v[144:147], v[64:67], v[100:103], v[144:147]
    ds_read_b128 v[100:103], v7 offset:2048
    s_add_u32 m0, s22, 77824
    v_mfma_f32_16x16x32_bf16 v[160:163], v[64:67], v[104:107], v[160:163]
    buffer_load_dwordx4 v21, s[8:11], s20 offen sc1 lds
    v_mfma_f32_16x16x32_bf16 v[164:167], v[68:71], v[104:107], v[164:167]
    ds_read_b64_tr_b16 v[88:89], v12 offset:8192
    v_cvt_pk_bf16_f32 v59, v52, v53
    v_mfma_f32_16x16x32_bf16 v[168:171], v[72:75], v[104:107], v[168:171]
    ds_read_b64_tr_b16 v[90:91], v12 offset:9216
    v_cvt_pk_bf16_f32 v60, v54, v55
    v_mfma_f32_16x16x32_bf16 v[172:175], v[76:79], v[104:107], v[172:175]
    ds_read_b128 v[104:107], v7 offset:4096
    s_add_u32 m0, s22, 81920
    v_mfma_f32_16x16x32_bf16 v[188:191], v[76:79], v[108:111], v[188:191]
    buffer_load_dwordx4 v22, s[8:11], s20 offen sc1 lds
    v_mfma_f32_16x16x32_bf16 v[184:187], v[72:75], v[108:111], v[184:187]
    ds_read_b64_tr_b16 v[92:93], v13 offset:8192
    v_cvt_pk_bf16_f32 v61, v56, v57
    v_mfma_f32_16x16x32_bf16 v[180:183], v[68:71], v[108:111], v[180:183]
    ds_read_b64_tr_b16 v[94:95], v13 offset:9216
    s_mov_b32 s39, 49152
    v_mfma_f32_16x16x32_bf16 v[176:179], v[64:67], v[108:111], v[176:179]
    ds_read_b128 v[108:111], v7 offset:6144
    s_add_u32 m0, s22, 86016
    s_waitcnt lgkmcnt(12)
    v_mfma_f32_16x16x32_bf16 v[192:195], v[64:67], v[112:115], v[192:195]
    buffer_load_dwordx4 v23, s[8:11], s20 offen sc1 lds
    v_mfma_f32_16x16x32_bf16 v[196:199], v[68:71], v[112:115], v[196:199]
    buffer_store_dwordx4 v[58:61], v34, s[16:19], s39 offen offset:1024 sc1
    v_mfma_f32_16x16x32_bf16 v[200:203], v[72:75], v[112:115], v[200:203]
    v_accvgpr_read_b32 v38, a208
    v_accvgpr_read_b32 v39, a209
    v_mfma_f32_16x16x32_bf16 v[204:207], v[76:79], v[112:115], v[204:207]
    ds_read_b128 v[112:115], v7 offset:8192
    s_add_u32 m0, s22, 90112
    v_mfma_f32_16x16x32_bf16 v[220:223], v[76:79], v[116:119], v[220:223]
    buffer_load_dwordx4 v24, s[8:11], s20 offen sc1 lds
    v_mfma_f32_16x16x32_bf16 v[216:219], v[72:75], v[116:119], v[216:219]
    v_accvgpr_read_b32 v40, a210
    v_accvgpr_read_b32 v41, a211
    v_mfma_f32_16x16x32_bf16 v[212:215], v[68:71], v[116:119], v[212:215]
    v_accvgpr_read_b32 v42, a212
    v_accvgpr_read_b32 v43, a213
    v_mfma_f32_16x16x32_bf16 v[208:211], v[64:67], v[116:119], v[208:211]
    ds_read_b128 v[116:119], v7 offset:10240
    s_add_u32 m0, s22, 94208
    v_mfma_f32_16x16x32_bf16 v[224:227], v[64:67], v[120:123], v[224:227]
    buffer_load_dwordx4 v25, s[8:11], s20 offen sc1 lds
    v_mfma_f32_16x16x32_bf16 v[228:231], v[68:71], v[120:123], v[228:231]
    v_accvgpr_read_b32 v44, a214
    v_accvgpr_read_b32 v45, a215
    v_mfma_f32_16x16x32_bf16 v[232:235], v[72:75], v[120:123], v[232:235]
    v_cvt_pk_bf16_f32 v46, v38, v39
    v_cvt_pk_bf16_f32 v47, v40, v41
    v_mfma_f32_16x16x32_bf16 v[236:239], v[76:79], v[120:123], v[236:239]
    ds_read_b128 v[120:123], v7 offset:12288
    v_cvt_pk_bf16_f32 v48, v42, v43
    v_mfma_f32_16x16x32_bf16 v[252:255], v[76:79], v[124:127], v[252:255]
    v_cvt_pk_bf16_f32 v49, v44, v45
    s_mov_b32 s39, 49152
    v_mfma_f32_16x16x32_bf16 v[248:251], v[72:75], v[124:127], v[248:251]
    buffer_store_dwordx4 v[46:49], v34, s[16:19], s39 offen offset:2048 sc1
    v_mfma_f32_16x16x32_bf16 v[244:247], v[68:71], v[124:127], v[244:247]
    v_accvgpr_read_b32 v50, a216
    v_accvgpr_read_b32 v51, a217
    v_mfma_f32_16x16x32_bf16 v[240:243], v[64:67], v[124:127], v[240:243]
    ds_read_b128 v[124:127], v7 offset:14336
    v_accvgpr_read_b32 v52, a218
    s_waitcnt lgkmcnt(0) vmcnt(17)
    s_barrier
    v_mfma_f32_16x16x32_bf16 v[128:131], v[80:83], v[96:99], v[128:131]
    v_accvgpr_read_b32 v53, a219
    v_accvgpr_read_b32 v54, a220
    v_mfma_f32_16x16x32_bf16 v[132:135], v[84:87], v[96:99], v[132:135]
    ds_read_b64_tr_b16 v[64:65], v14 offset:0
    v_accvgpr_read_b32 v55, a221
    v_mfma_f32_16x16x32_bf16 v[136:139], v[88:91], v[96:99], v[136:139]
    ds_read_b64_tr_b16 v[66:67], v14 offset:1024
    v_accvgpr_read_b32 v56, a222
    v_mfma_f32_16x16x32_bf16 v[140:143], v[92:95], v[96:99], v[140:143]
    ds_read_b128 v[96:99], v8 offset:0
    s_add_u32 m0, s22, 32768
    s_mov_b32 s21, 3145728
    v_mfma_f32_16x16x32_bf16 v[156:159], v[92:95], v[100:103], v[156:159]
    buffer_load_dwordx4 v26, s[12:15], s21 offen lds
    v_mfma_f32_16x16x32_bf16 v[152:155], v[88:91], v[100:103], v[152:155]
    ds_read_b64_tr_b16 v[68:69], v15 offset:0
    v_accvgpr_read_b32 v57, a223
    v_mfma_f32_16x16x32_bf16 v[148:151], v[84:87], v[100:103], v[148:151]
    ds_read_b64_tr_b16 v[70:71], v15 offset:1024
    v_cvt_pk_bf16_f32 v58, v50, v51
    v_mfma_f32_16x16x32_bf16 v[144:147], v[80:83], v[100:103], v[144:147]
    ds_read_b128 v[100:103], v8 offset:2048
    s_add_u32 m0, s22, 36864
    v_mfma_f32_16x16x32_bf16 v[160:163], v[80:83], v[104:107], v[160:163]
    buffer_load_dwordx4 v27, s[12:15], s21 offen lds
    v_mfma_f32_16x16x32_bf16 v[164:167], v[84:87], v[104:107], v[164:167]
    ds_read_b64_tr_b16 v[72:73], v16 offset:0
    v_cvt_pk_bf16_f32 v59, v52, v53
    v_mfma_f32_16x16x32_bf16 v[168:171], v[88:91], v[104:107], v[168:171]
    ds_read_b64_tr_b16 v[74:75], v16 offset:1024
    v_cvt_pk_bf16_f32 v60, v54, v55
    v_mfma_f32_16x16x32_bf16 v[172:175], v[92:95], v[104:107], v[172:175]
    ds_read_b128 v[104:107], v8 offset:4096
    s_add_u32 m0, s22, 40960
    v_mfma_f32_16x16x32_bf16 v[188:191], v[92:95], v[108:111], v[188:191]
    buffer_load_dwordx4 v28, s[12:15], s21 offen lds
    v_mfma_f32_16x16x32_bf16 v[184:187], v[88:91], v[108:111], v[184:187]
    ds_read_b64_tr_b16 v[76:77], v17 offset:0
    v_cvt_pk_bf16_f32 v61, v56, v57
    v_mfma_f32_16x16x32_bf16 v[180:183], v[84:87], v[108:111], v[180:183]
    ds_read_b64_tr_b16 v[78:79], v17 offset:1024
    s_mov_b32 s39, 49152
    v_mfma_f32_16x16x32_bf16 v[176:179], v[80:83], v[108:111], v[176:179]
    ds_read_b128 v[108:111], v8 offset:6144
    s_add_u32 m0, s22, 45056
    v_mfma_f32_16x16x32_bf16 v[192:195], v[80:83], v[112:115], v[192:195]
    buffer_load_dwordx4 v29, s[12:15], s21 offen lds
    v_mfma_f32_16x16x32_bf16 v[196:199], v[84:87], v[112:115], v[196:199]
    buffer_store_dwordx4 v[58:61], v34, s[16:19], s39 offen offset:3072 sc1
    v_mfma_f32_16x16x32_bf16 v[200:203], v[88:91], v[112:115], v[200:203]
    v_accvgpr_read_b32 v38, a224
    v_accvgpr_read_b32 v39, a225
    v_mfma_f32_16x16x32_bf16 v[204:207], v[92:95], v[112:115], v[204:207]
    ds_read_b128 v[112:115], v8 offset:8192
    s_add_u32 m0, s22, 0
    s_mov_b32 s20, 768
    v_mfma_f32_16x16x32_bf16 v[220:223], v[92:95], v[116:119], v[220:223]
    buffer_load_dwordx4 v18, s[8:11], s20 offen sc1 lds
    v_mfma_f32_16x16x32_bf16 v[216:219], v[88:91], v[116:119], v[216:219]
    v_accvgpr_read_b32 v40, a226
    v_accvgpr_read_b32 v41, a227
    v_mfma_f32_16x16x32_bf16 v[212:215], v[84:87], v[116:119], v[212:215]
    v_accvgpr_read_b32 v42, a228
    v_accvgpr_read_b32 v43, a229
    v_mfma_f32_16x16x32_bf16 v[208:211], v[80:83], v[116:119], v[208:211]
    ds_read_b128 v[116:119], v8 offset:10240
    s_add_u32 m0, s22, 4096
    v_mfma_f32_16x16x32_bf16 v[224:227], v[80:83], v[120:123], v[224:227]
    buffer_load_dwordx4 v19, s[8:11], s20 offen sc1 lds
    v_mfma_f32_16x16x32_bf16 v[228:231], v[84:87], v[120:123], v[228:231]
    v_accvgpr_read_b32 v44, a230
    v_accvgpr_read_b32 v45, a231
    v_mfma_f32_16x16x32_bf16 v[232:235], v[88:91], v[120:123], v[232:235]
    v_cvt_pk_bf16_f32 v46, v38, v39
    v_cvt_pk_bf16_f32 v47, v40, v41
    v_mfma_f32_16x16x32_bf16 v[236:239], v[92:95], v[120:123], v[236:239]
    ds_read_b128 v[120:123], v8 offset:12288
    v_cvt_pk_bf16_f32 v48, v42, v43
    v_mfma_f32_16x16x32_bf16 v[252:255], v[92:95], v[124:127], v[252:255]
    v_cvt_pk_bf16_f32 v49, v44, v45
    s_mov_b32 s39, 57344
    v_mfma_f32_16x16x32_bf16 v[248:251], v[88:91], v[124:127], v[248:251]
    buffer_store_dwordx4 v[46:49], v34, s[16:19], s39 offen offset:0 sc1
    v_mfma_f32_16x16x32_bf16 v[244:247], v[84:87], v[124:127], v[244:247]
    v_accvgpr_read_b32 v50, a232
    v_accvgpr_read_b32 v51, a233
    v_mfma_f32_16x16x32_bf16 v[240:243], v[80:83], v[124:127], v[240:243]
    ds_read_b128 v[124:127], v8 offset:14336
    v_accvgpr_read_b32 v52, a234
    s_waitcnt lgkmcnt(4)
    v_mfma_f32_16x16x32_bf16 v[128:131], v[64:67], v[96:99], v[128:131]
    v_accvgpr_read_b32 v53, a235
    v_accvgpr_read_b32 v54, a236
    v_mfma_f32_16x16x32_bf16 v[132:135], v[68:71], v[96:99], v[132:135]
    ds_read_b64_tr_b16 v[80:81], v14 offset:8192
    v_accvgpr_read_b32 v55, a237
    v_mfma_f32_16x16x32_bf16 v[136:139], v[72:75], v[96:99], v[136:139]
    ds_read_b64_tr_b16 v[82:83], v14 offset:9216
    v_accvgpr_read_b32 v56, a238
    v_mfma_f32_16x16x32_bf16 v[140:143], v[76:79], v[96:99], v[140:143]
    ds_read_b128 v[96:99], v9 offset:0
    s_add_u32 m0, s22, 8192
    v_mfma_f32_16x16x32_bf16 v[156:159], v[76:79], v[100:103], v[156:159]
    buffer_load_dwordx4 v20, s[8:11], s20 offen sc1 lds
    v_mfma_f32_16x16x32_bf16 v[152:155], v[72:75], v[100:103], v[152:155]
    ds_read_b64_tr_b16 v[84:85], v15 offset:8192
    v_accvgpr_read_b32 v57, a239
    v_mfma_f32_16x16x32_bf16 v[148:151], v[68:71], v[100:103], v[148:151]
    ds_read_b64_tr_b16 v[86:87], v15 offset:9216
    v_cvt_pk_bf16_f32 v58, v50, v51
    v_mfma_f32_16x16x32_bf16 v[144:147], v[64:67], v[100:103], v[144:147]
    ds_read_b128 v[100:103], v9 offset:2048
    s_add_u32 m0, s22, 12288
    v_mfma_f32_16x16x32_bf16 v[160:163], v[64:67], v[104:107], v[160:163]
    buffer_load_dwordx4 v21, s[8:11], s20 offen sc1 lds
    v_mfma_f32_16x16x32_bf16 v[164:167], v[68:71], v[104:107], v[164:167]
    ds_read_b64_tr_b16 v[88:89], v16 offset:8192
    v_cvt_pk_bf16_f32 v59, v52, v53
    v_mfma_f32_16x16x32_bf16 v[168:171], v[72:75], v[104:107], v[168:171]
    ds_read_b64_tr_b16 v[90:91], v16 offset:9216
    v_cvt_pk_bf16_f32 v60, v54, v55
    v_mfma_f32_16x16x32_bf16 v[172:175], v[76:79], v[104:107], v[172:175]
    ds_read_b128 v[104:107], v9 offset:4096
    s_add_u32 m0, s22, 16384
    v_mfma_f32_16x16x32_bf16 v[188:191], v[76:79], v[108:111], v[188:191]
    buffer_load_dwordx4 v22, s[8:11], s20 offen sc1 lds
    v_mfma_f32_16x16x32_bf16 v[184:187], v[72:75], v[108:111], v[184:187]
    ds_read_b64_tr_b16 v[92:93], v17 offset:8192
    v_cvt_pk_bf16_f32 v61, v56, v57
    v_mfma_f32_16x16x32_bf16 v[180:183], v[68:71], v[108:111], v[180:183]
    ds_read_b64_tr_b16 v[94:95], v17 offset:9216
    s_mov_b32 s39, 57344
    v_mfma_f32_16x16x32_bf16 v[176:179], v[64:67], v[108:111], v[176:179]
    ds_read_b128 v[108:111], v9 offset:6144
    s_add_u32 m0, s22, 20480
    s_waitcnt lgkmcnt(12)
    v_mfma_f32_16x16x32_bf16 v[192:195], v[64:67], v[112:115], v[192:195]
    buffer_load_dwordx4 v23, s[8:11], s20 offen sc1 lds
    v_mfma_f32_16x16x32_bf16 v[196:199], v[68:71], v[112:115], v[196:199]
    buffer_store_dwordx4 v[58:61], v34, s[16:19], s39 offen offset:1024 sc1
    v_mfma_f32_16x16x32_bf16 v[200:203], v[72:75], v[112:115], v[200:203]
    v_accvgpr_read_b32 v38, a240
    v_accvgpr_read_b32 v39, a241
    v_mfma_f32_16x16x32_bf16 v[204:207], v[76:79], v[112:115], v[204:207]
    ds_read_b128 v[112:115], v9 offset:8192
    s_add_u32 m0, s22, 24576
    v_mfma_f32_16x16x32_bf16 v[220:223], v[76:79], v[116:119], v[220:223]
    buffer_load_dwordx4 v24, s[8:11], s20 offen sc1 lds
    v_mfma_f32_16x16x32_bf16 v[216:219], v[72:75], v[116:119], v[216:219]
    v_accvgpr_read_b32 v40, a242
    v_accvgpr_read_b32 v41, a243
    v_mfma_f32_16x16x32_bf16 v[212:215], v[68:71], v[116:119], v[212:215]
    v_accvgpr_read_b32 v42, a244
    v_accvgpr_read_b32 v43, a245
    v_mfma_f32_16x16x32_bf16 v[208:211], v[64:67], v[116:119], v[208:211]
    ds_read_b128 v[116:119], v9 offset:10240
    s_add_u32 m0, s22, 28672
    v_mfma_f32_16x16x32_bf16 v[224:227], v[64:67], v[120:123], v[224:227]
    buffer_load_dwordx4 v25, s[8:11], s20 offen sc1 lds
    v_mfma_f32_16x16x32_bf16 v[228:231], v[68:71], v[120:123], v[228:231]
    v_accvgpr_read_b32 v44, a246
    v_accvgpr_read_b32 v45, a247
    v_mfma_f32_16x16x32_bf16 v[232:235], v[72:75], v[120:123], v[232:235]
    v_cvt_pk_bf16_f32 v46, v38, v39
    v_cvt_pk_bf16_f32 v47, v40, v41
    v_mfma_f32_16x16x32_bf16 v[236:239], v[76:79], v[120:123], v[236:239]
    ds_read_b128 v[120:123], v9 offset:12288
    v_cvt_pk_bf16_f32 v48, v42, v43
    v_mfma_f32_16x16x32_bf16 v[252:255], v[76:79], v[124:127], v[252:255]
    v_cvt_pk_bf16_f32 v49, v44, v45
    s_mov_b32 s39, 57344
    v_mfma_f32_16x16x32_bf16 v[248:251], v[72:75], v[124:127], v[248:251]
    buffer_store_dwordx4 v[46:49], v34, s[16:19], s39 offen offset:2048 sc1
    v_mfma_f32_16x16x32_bf16 v[244:247], v[68:71], v[124:127], v[244:247]
    v_accvgpr_read_b32 v50, a248
    v_accvgpr_read_b32 v51, a249
    v_mfma_f32_16x16x32_bf16 v[240:243], v[64:67], v[124:127], v[240:243]
    ds_read_b128 v[124:127], v9 offset:14336
    v_accvgpr_read_b32 v52, a250
    s_waitcnt lgkmcnt(0) vmcnt(17)
    s_barrier
    v_mfma_f32_16x16x32_bf16 v[128:131], v[80:83], v[96:99], v[128:131]
    v_accvgpr_read_b32 v53, a251
    v_accvgpr_read_b32 v54, a252
    v_mfma_f32_16x16x32_bf16 v[132:135], v[84:87], v[96:99], v[132:135]
    ds_read_b64_tr_b16 v[64:65], v10 offset:16384
    v_accvgpr_read_b32 v55, a253
    v_mfma_f32_16x16x32_bf16 v[136:139], v[88:91], v[96:99], v[136:139]
    ds_read_b64_tr_b16 v[66:67], v10 offset:17408
    v_accvgpr_read_b32 v56, a254
    v_mfma_f32_16x16x32_bf16 v[140:143], v[92:95], v[96:99], v[140:143]
    ds_read_b128 v[96:99], v4 offset:0
    v_accvgpr_read_b32 v57, a255
    v_mfma_f32_16x16x32_bf16 v[156:159], v[92:95], v[100:103], v[156:159]
    v_cvt_pk_bf16_f32 v58, v50, v51
    v_cvt_pk_bf16_f32 v59, v52, v53
    v_mfma_f32_16x16x32_bf16 v[152:155], v[88:91], v[100:103], v[152:155]
    ds_read_b64_tr_b16 v[68:69], v11 offset:16384
    v_cvt_pk_bf16_f32 v60, v54, v55
    v_mfma_f32_16x16x32_bf16 v[148:151], v[84:87], v[100:103], v[148:151]
    ds_read_b64_tr_b16 v[70:71], v11 offset:17408
    v_cvt_pk_bf16_f32 v61, v56, v57
    v_mfma_f32_16x16x32_bf16 v[144:147], v[80:83], v[100:103], v[144:147]
    ds_read_b128 v[100:103], v4 offset:2048
    s_mov_b32 s39, 57344
    v_mfma_f32_16x16x32_bf16 v[160:163], v[80:83], v[104:107], v[160:163]
    buffer_store_dwordx4 v[58:61], v34, s[16:19], s39 offen offset:3072 sc1
    v_mfma_f32_16x16x32_bf16 v[164:167], v[84:87], v[104:107], v[164:167]
    ds_read_b64_tr_b16 v[72:73], v12 offset:16384
    v_mfma_f32_16x16x32_bf16 v[168:171], v[88:91], v[104:107], v[168:171]
    ds_read_b64_tr_b16 v[74:75], v12 offset:17408
    v_mfma_f32_16x16x32_bf16 v[172:175], v[92:95], v[104:107], v[172:175]
    ds_read_b128 v[104:107], v4 offset:4096
    v_mfma_f32_16x16x32_bf16 v[188:191], v[92:95], v[108:111], v[188:191]
    v_mfma_f32_16x16x32_bf16 v[184:187], v[88:91], v[108:111], v[184:187]
    ds_read_b64_tr_b16 v[76:77], v13 offset:16384
    v_mfma_f32_16x16x32_bf16 v[180:183], v[84:87], v[108:111], v[180:183]
    ds_read_b64_tr_b16 v[78:79], v13 offset:17408
    v_mfma_f32_16x16x32_bf16 v[176:179], v[80:83], v[108:111], v[176:179]
    ds_read_b128 v[108:111], v4 offset:6144
    v_mfma_f32_16x16x32_bf16 v[192:195], v[80:83], v[112:115], v[192:195]
    v_mfma_f32_16x16x32_bf16 v[196:199], v[84:87], v[112:115], v[196:199]
    v_mfma_f32_16x16x32_bf16 v[200:203], v[88:91], v[112:115], v[200:203]
    v_mfma_f32_16x16x32_bf16 v[204:207], v[92:95], v[112:115], v[204:207]
    ds_read_b128 v[112:115], v4 offset:8192
    v_mfma_f32_16x16x32_bf16 v[220:223], v[92:95], v[116:119], v[220:223]
    v_mfma_f32_16x16x32_bf16 v[216:219], v[88:91], v[116:119], v[216:219]
    v_mfma_f32_16x16x32_bf16 v[212:215], v[84:87], v[116:119], v[212:215]
    v_mfma_f32_16x16x32_bf16 v[208:211], v[80:83], v[116:119], v[208:211]
    ds_read_b128 v[116:119], v4 offset:10240
    v_mfma_f32_16x16x32_bf16 v[224:227], v[80:83], v[120:123], v[224:227]
    v_mfma_f32_16x16x32_bf16 v[228:231], v[84:87], v[120:123], v[228:231]
    v_mfma_f32_16x16x32_bf16 v[232:235], v[88:91], v[120:123], v[232:235]
    v_mfma_f32_16x16x32_bf16 v[236:239], v[92:95], v[120:123], v[236:239]
    ds_read_b128 v[120:123], v4 offset:12288
    v_mfma_f32_16x16x32_bf16 v[252:255], v[92:95], v[124:127], v[252:255]
    v_mfma_f32_16x16x32_bf16 v[248:251], v[88:91], v[124:127], v[248:251]
    v_mfma_f32_16x16x32_bf16 v[244:247], v[84:87], v[124:127], v[244:247]
    v_mfma_f32_16x16x32_bf16 v[240:243], v[80:83], v[124:127], v[240:243]
    ds_read_b128 v[124:127], v4 offset:14336
    s_waitcnt lgkmcnt(4) vmcnt(2)
    s_barrier
    v_mfma_f32_16x16x32_bf16 v[128:131], v[64:67], v[96:99], v[128:131]
    ds_read_b64_tr_b16 a[0:1], v10 offset:0
    v_mfma_f32_16x16x32_bf16 v[132:135], v[68:71], v[96:99], v[132:135]
    ds_read_b64_tr_b16 v[80:81], v10 offset:24576
    v_mfma_f32_16x16x32_bf16 v[136:139], v[72:75], v[96:99], v[136:139]
    ds_read_b64_tr_b16 v[82:83], v10 offset:25600
    v_mfma_f32_16x16x32_bf16 v[140:143], v[76:79], v[96:99], v[140:143]
    ds_read_b128 v[96:99], v5 offset:0
    v_mfma_f32_16x16x32_bf16 v[156:159], v[76:79], v[100:103], v[156:159]
    ds_read_b64_tr_b16 a[2:3], v10 offset:1024
    v_mfma_f32_16x16x32_bf16 v[152:155], v[72:75], v[100:103], v[152:155]
    ds_read_b64_tr_b16 v[84:85], v11 offset:24576
    v_mfma_f32_16x16x32_bf16 v[148:151], v[68:71], v[100:103], v[148:151]
    ds_read_b64_tr_b16 v[86:87], v11 offset:25600
    v_mfma_f32_16x16x32_bf16 v[144:147], v[64:67], v[100:103], v[144:147]
    ds_read_b128 v[100:103], v5 offset:2048
    v_mfma_f32_16x16x32_bf16 v[160:163], v[64:67], v[104:107], v[160:163]
    ds_read_b64_tr_b16 a[4:5], v11 offset:0
    v_mfma_f32_16x16x32_bf16 v[164:167], v[68:71], v[104:107], v[164:167]
    ds_read_b64_tr_b16 v[88:89], v12 offset:24576
    v_mfma_f32_16x16x32_bf16 v[168:171], v[72:75], v[104:107], v[168:171]
    ds_read_b64_tr_b16 v[90:91], v12 offset:25600
    v_mfma_f32_16x16x32_bf16 v[172:175], v[76:79], v[104:107], v[172:175]
    ds_read_b128 v[104:107], v5 offset:4096
    v_mfma_f32_16x16x32_bf16 v[188:191], v[76:79], v[108:111], v[188:191]
    ds_read_b64_tr_b16 a[6:7], v11 offset:1024
    v_mfma_f32_16x16x32_bf16 v[184:187], v[72:75], v[108:111], v[184:187]
    ds_read_b64_tr_b16 v[92:93], v13 offset:24576
    v_mfma_f32_16x16x32_bf16 v[180:183], v[68:71], v[108:111], v[180:183]
    ds_read_b64_tr_b16 v[94:95], v13 offset:25600
    v_mfma_f32_16x16x32_bf16 v[176:179], v[64:67], v[108:111], v[176:179]
    ds_read_b128 v[108:111], v5 offset:6144
    s_waitcnt lgkmcnt(12)
    v_mfma_f32_16x16x32_bf16 v[192:195], v[64:67], v[112:115], v[192:195]
    ds_read_b64_tr_b16 a[8:9], v12 offset:0
    v_mfma_f32_16x16x32_bf16 v[196:199], v[68:71], v[112:115], v[196:199]
    ds_read_b64_tr_b16 a[10:11], v12 offset:1024
    v_mfma_f32_16x16x32_bf16 v[200:203], v[72:75], v[112:115], v[200:203]
    ds_read_b64_tr_b16 a[12:13], v13 offset:0
    v_mfma_f32_16x16x32_bf16 v[204:207], v[76:79], v[112:115], v[204:207]
    ds_read_b128 v[112:115], v5 offset:8192
    v_mfma_f32_16x16x32_bf16 v[220:223], v[76:79], v[116:119], v[220:223]
    ds_read_b64_tr_b16 a[14:15], v13 offset:1024
    v_mfma_f32_16x16x32_bf16 v[216:219], v[72:75], v[116:119], v[216:219]
    ds_read_b64_tr_b16 a[16:17], v10 offset:8192
    v_mfma_f32_16x16x32_bf16 v[212:215], v[68:71], v[116:119], v[212:215]
    ds_read_b64_tr_b16 a[18:19], v10 offset:9216
    v_mfma_f32_16x16x32_bf16 v[208:211], v[64:67], v[116:119], v[208:211]
    ds_read_b128 v[116:119], v5 offset:10240
    v_mfma_f32_16x16x32_bf16 v[224:227], v[64:67], v[120:123], v[224:227]
    ds_read_b64_tr_b16 a[20:21], v11 offset:8192
    v_mfma_f32_16x16x32_bf16 v[228:231], v[68:71], v[120:123], v[228:231]
    ds_read_b64_tr_b16 a[22:23], v11 offset:9216
    v_mfma_f32_16x16x32_bf16 v[232:235], v[72:75], v[120:123], v[232:235]
    ds_read_b64_tr_b16 a[24:25], v12 offset:8192
    v_mfma_f32_16x16x32_bf16 v[236:239], v[76:79], v[120:123], v[236:239]
    ds_read_b128 v[120:123], v5 offset:12288
    v_mfma_f32_16x16x32_bf16 v[252:255], v[76:79], v[124:127], v[252:255]
    ds_read_b64_tr_b16 a[26:27], v12 offset:9216
    ds_read_b128 a[32:35], v6 offset:0
    v_mfma_f32_16x16x32_bf16 v[248:251], v[72:75], v[124:127], v[248:251]
    ds_read_b64_tr_b16 a[28:29], v13 offset:8192
    ds_read_b128 a[36:39], v7 offset:0
    v_mfma_f32_16x16x32_bf16 v[244:247], v[68:71], v[124:127], v[244:247]
    ds_read_b64_tr_b16 a[30:31], v13 offset:9216
    ds_read_b128 a[40:43], v6 offset:2048
    v_mfma_f32_16x16x32_bf16 v[240:243], v[64:67], v[124:127], v[240:243]
    ds_read_b128 v[124:127], v5 offset:14336
    ds_read_b128 a[44:47], v7 offset:2048
    v_lshlrev_b32 v35, 4, v1
    s_lshl_b32 s46, s44, 16
    s_lshl_b32 s47, s45, 11
    s_add_u32 s46, s46, s47
    v_add_u32 v35, s46, v35
    s_waitcnt lgkmcnt(0)
    v_mfma_f32_16x16x32_bf16 v[128:131], v[80:83], v[96:99], v[128:131]
    v_mfma_f32_16x16x32_bf16 v[132:135], v[84:87], v[96:99], v[132:135]
    v_mfma_f32_16x16x32_bf16 v[136:139], v[88:91], v[96:99], v[136:139]
    v_mfma_f32_16x16x32_bf16 v[140:143], v[92:95], v[96:99], v[140:143]
    v_mfma_f32_16x16x32_bf16 v[140:143], a[12:15], a[32:35], v[140:143]
    v_mfma_f32_16x16x32_bf16 v[136:139], a[8:11], a[32:35], v[136:139]
    v_mfma_f32_16x16x32_bf16 v[132:135], a[4:7], a[32:35], v[132:135]
    v_mfma_f32_16x16x32_bf16 v[128:131], a[0:3], a[32:35], v[128:131]
    v_mfma_f32_16x16x32_bf16 v[128:131], a[16:19], a[36:39], v[128:131]
    v_mfma_f32_16x16x32_bf16 v[132:135], a[20:23], a[36:39], v[132:135]
    v_mfma_f32_16x16x32_bf16 v[136:139], a[24:27], a[36:39], v[136:139]
    ds_read_b128 a[48:51], v6 offset:4096
    v_mfma_f32_16x16x32_bf16 v[140:143], a[28:31], a[36:39], v[140:143]
    ds_read_b128 a[52:55], v7 offset:4096
    s_waitcnt lgkmcnt(2)
    v_mfma_f32_16x16x32_bf16 v[144:147], v[80:83], v[100:103], v[144:147]
    v_mfma_f32_16x16x32_bf16 v[148:151], v[84:87], v[100:103], v[148:151]
    v_mfma_f32_16x16x32_bf16 v[152:155], v[88:91], v[100:103], v[152:155]
    v_mfma_f32_16x16x32_bf16 v[156:159], v[92:95], v[100:103], v[156:159]
    v_mfma_f32_16x16x32_bf16 v[156:159], a[12:15], a[40:43], v[156:159]
    v_mfma_f32_16x16x32_bf16 v[152:155], a[8:11], a[40:43], v[152:155]
    v_cvt_pk_bf16_f32 v64, v128, v129
    v_cvt_pk_bf16_f32 v65, v130, v131
    v_mfma_f32_16x16x32_bf16 v[148:151], a[4:7], a[40:43], v[148:151]
    v_cvt_pk_bf16_f32 v66, v132, v133
    v_cvt_pk_bf16_f32 v67, v134, v135
    v_mfma_f32_16x16x32_bf16 v[144:147], a[0:3], a[40:43], v[144:147]
    s_mov_b32 s39, 0
    v_mfma_f32_16x16x32_bf16 v[144:147], a[16:19], a[44:47], v[144:147]
    buffer_store_dwordx4 v[64:67], v35, s[52:55], s39 offen offset:0 sc1
    v_mfma_f32_16x16x32_bf16 v[148:151], a[20:23], a[44:47], v[148:151]
    v_cvt_pk_bf16_f32 v68, v136, v137
    v_cvt_pk_bf16_f32 v69, v138, v139
    v_mfma_f32_16x16x32_bf16 v[152:155], a[24:27], a[44:47], v[152:155]
    ds_read_b128 a[56:59], v6 offset:6144
    v_cvt_pk_bf16_f32 v70, v140, v141
    v_mfma_f32_16x16x32_bf16 v[156:159], a[28:31], a[44:47], v[156:159]
    ds_read_b128 a[60:63], v7 offset:6144
    v_cvt_pk_bf16_f32 v71, v142, v143
    s_waitcnt lgkmcnt(2)
    v_mfma_f32_16x16x32_bf16 v[160:163], v[80:83], v[104:107], v[160:163]
    buffer_store_dwordx4 v[68:71], v35, s[52:55], s39 offen offset:1024 sc1
    v_mfma_f32_16x16x32_bf16 v[164:167], v[84:87], v[104:107], v[164:167]
    v_mfma_f32_16x16x32_bf16 v[168:171], v[88:91], v[104:107], v[168:171]
    v_mfma_f32_16x16x32_bf16 v[172:175], v[92:95], v[104:107], v[172:175]
    v_mfma_f32_16x16x32_bf16 v[172:175], a[12:15], a[48:51], v[172:175]
    v_mfma_f32_16x16x32_bf16 v[168:171], a[8:11], a[48:51], v[168:171]
    v_cvt_pk_bf16_f32 v72, v144, v145
    v_cvt_pk_bf16_f32 v73, v146, v147
    v_mfma_f32_16x16x32_bf16 v[164:167], a[4:7], a[48:51], v[164:167]
    v_cvt_pk_bf16_f32 v74, v148, v149
    v_cvt_pk_bf16_f32 v75, v150, v151
    v_mfma_f32_16x16x32_bf16 v[160:163], a[0:3], a[48:51], v[160:163]
    s_mov_b32 s39, 8192
    v_mfma_f32_16x16x32_bf16 v[160:163], a[16:19], a[52:55], v[160:163]
    buffer_store_dwordx4 v[72:75], v35, s[52:55], s39 offen offset:0 sc1
    v_mfma_f32_16x16x32_bf16 v[164:167], a[20:23], a[52:55], v[164:167]
    v_cvt_pk_bf16_f32 v76, v152, v153
    v_cvt_pk_bf16_f32 v77, v154, v155
    v_mfma_f32_16x16x32_bf16 v[168:171], a[24:27], a[52:55], v[168:171]
    ds_read_b128 a[32:35], v6 offset:8192
    v_cvt_pk_bf16_f32 v78, v156, v157
    v_mfma_f32_16x16x32_bf16 v[172:175], a[28:31], a[52:55], v[172:175]
    ds_read_b128 a[36:39], v7 offset:8192
    v_cvt_pk_bf16_f32 v79, v158, v159
    s_waitcnt lgkmcnt(2)
    v_mfma_f32_16x16x32_bf16 v[176:179], v[80:83], v[108:111], v[176:179]
    buffer_store_dwordx4 v[76:79], v35, s[52:55], s39 offen offset:1024 sc1
    v_mfma_f32_16x16x32_bf16 v[180:183], v[84:87], v[108:111], v[180:183]
    v_mfma_f32_16x16x32_bf16 v[184:187], v[88:91], v[108:111], v[184:187]
    v_mfma_f32_16x16x32_bf16 v[188:191], v[92:95], v[108:111], v[188:191]
    v_mfma_f32_16x16x32_bf16 v[188:191], a[12:15], a[56:59], v[188:191]
    v_mfma_f32_16x16x32_bf16 v[184:187], a[8:11], a[56:59], v[184:187]
    v_cvt_pk_bf16_f32 v64, v160, v161
    v_cvt_pk_bf16_f32 v65, v162, v163
    v_mfma_f32_16x16x32_bf16 v[180:183], a[4:7], a[56:59], v[180:183]
    v_cvt_pk_bf16_f32 v66, v164, v165
    v_cvt_pk_bf16_f32 v67, v166, v167
    v_mfma_f32_16x16x32_bf16 v[176:179], a[0:3], a[56:59], v[176:179]
    s_mov_b32 s39, 16384
    v_mfma_f32_16x16x32_bf16 v[176:179], a[16:19], a[60:63], v[176:179]
    buffer_store_dwordx4 v[64:67], v35, s[52:55], s39 offen offset:0 sc1
    v_mfma_f32_16x16x32_bf16 v[180:183], a[20:23], a[60:63], v[180:183]
    v_cvt_pk_bf16_f32 v68, v168, v169
    v_cvt_pk_bf16_f32 v69, v170, v171
    v_mfma_f32_16x16x32_bf16 v[184:187], a[24:27], a[60:63], v[184:187]
    ds_read_b128 a[40:43], v6 offset:10240
    v_cvt_pk_bf16_f32 v70, v172, v173
    v_mfma_f32_16x16x32_bf16 v[188:191], a[28:31], a[60:63], v[188:191]
    ds_read_b128 a[44:47], v7 offset:10240
    v_cvt_pk_bf16_f32 v71, v174, v175
    s_waitcnt lgkmcnt(2)
    v_mfma_f32_16x16x32_bf16 v[192:195], v[80:83], v[112:115], v[192:195]
    buffer_store_dwordx4 v[68:71], v35, s[52:55], s39 offen offset:1024 sc1
    v_mfma_f32_16x16x32_bf16 v[196:199], v[84:87], v[112:115], v[196:199]
    v_mfma_f32_16x16x32_bf16 v[200:203], v[88:91], v[112:115], v[200:203]
    v_mfma_f32_16x16x32_bf16 v[204:207], v[92:95], v[112:115], v[204:207]
    v_mfma_f32_16x16x32_bf16 v[204:207], a[12:15], a[32:35], v[204:207]
    v_mfma_f32_16x16x32_bf16 v[200:203], a[8:11], a[32:35], v[200:203]
    v_cvt_pk_bf16_f32 v72, v176, v177
    v_cvt_pk_bf16_f32 v73, v178, v179
    v_mfma_f32_16x16x32_bf16 v[196:199], a[4:7], a[32:35], v[196:199]
    v_cvt_pk_bf16_f32 v74, v180, v181
    v_cvt_pk_bf16_f32 v75, v182, v183
    v_mfma_f32_16x16x32_bf16 v[192:195], a[0:3], a[32:35], v[192:195]
    s_mov_b32 s39, 24576
    v_mfma_f32_16x16x32_bf16 v[192:195], a[16:19], a[36:39], v[192:195]
    buffer_store_dwordx4 v[72:75], v35, s[52:55], s39 offen offset:0 sc1
    v_mfma_f32_16x16x32_bf16 v[196:199], a[20:23], a[36:39], v[196:199]
    v_cvt_pk_bf16_f32 v76, v184, v185
    v_cvt_pk_bf16_f32 v77, v186, v187
    v_mfma_f32_16x16x32_bf16 v[200:203], a[24:27], a[36:39], v[200:203]
    ds_read_b128 a[48:51], v6 offset:12288
    v_cvt_pk_bf16_f32 v78, v188, v189
    v_mfma_f32_16x16x32_bf16 v[204:207], a[28:31], a[36:39], v[204:207]
    ds_read_b128 a[52:55], v7 offset:12288
    v_cvt_pk_bf16_f32 v79, v190, v191
    s_waitcnt lgkmcnt(2)
    v_mfma_f32_16x16x32_bf16 v[208:211], v[80:83], v[116:119], v[208:211]
    buffer_store_dwordx4 v[76:79], v35, s[52:55], s39 offen offset:1024 sc1
    v_mfma_f32_16x16x32_bf16 v[212:215], v[84:87], v[116:119], v[212:215]
    v_mfma_f32_16x16x32_bf16 v[216:219], v[88:91], v[116:119], v[216:219]
    v_mfma_f32_16x16x32_bf16 v[220:223], v[92:95], v[116:119], v[220:223]
    v_mfma_f32_16x16x32_bf16 v[220:223], a[12:15], a[40:43], v[220:223]
    v_mfma_f32_16x16x32_bf16 v[216:219], a[8:11], a[40:43], v[216:219]
    v_cvt_pk_bf16_f32 v64, v192, v193
    v_cvt_pk_bf16_f32 v65, v194, v195
    v_mfma_f32_16x16x32_bf16 v[212:215], a[4:7], a[40:43], v[212:215]
    v_cvt_pk_bf16_f32 v66, v196, v197
    v_cvt_pk_bf16_f32 v67, v198, v199
    v_mfma_f32_16x16x32_bf16 v[208:211], a[0:3], a[40:43], v[208:211]
    s_mov_b32 s39, 32768
    v_mfma_f32_16x16x32_bf16 v[208:211], a[16:19], a[44:47], v[208:211]
    buffer_store_dwordx4 v[64:67], v35, s[52:55], s39 offen offset:0 sc1
    v_mfma_f32_16x16x32_bf16 v[212:215], a[20:23], a[44:47], v[212:215]
    v_cvt_pk_bf16_f32 v68, v200, v201
    v_cvt_pk_bf16_f32 v69, v202, v203
    v_mfma_f32_16x16x32_bf16 v[216:219], a[24:27], a[44:47], v[216:219]
    ds_read_b128 a[56:59], v6 offset:14336
    v_cvt_pk_bf16_f32 v70, v204, v205
    v_mfma_f32_16x16x32_bf16 v[220:223], a[28:31], a[44:47], v[220:223]
    ds_read_b128 a[60:63], v7 offset:14336
    v_cvt_pk_bf16_f32 v71, v206, v207
    s_waitcnt lgkmcnt(2)
    v_mfma_f32_16x16x32_bf16 v[224:227], v[80:83], v[120:123], v[224:227]
    buffer_store_dwordx4 v[68:71], v35, s[52:55], s39 offen offset:1024 sc1
    v_mfma_f32_16x16x32_bf16 v[228:231], v[84:87], v[120:123], v[228:231]
    v_mfma_f32_16x16x32_bf16 v[232:235], v[88:91], v[120:123], v[232:235]
    v_mfma_f32_16x16x32_bf16 v[236:239], v[92:95], v[120:123], v[236:239]
    v_mfma_f32_16x16x32_bf16 v[236:239], a[12:15], a[48:51], v[236:239]
    v_mfma_f32_16x16x32_bf16 v[232:235], a[8:11], a[48:51], v[232:235]
    v_cvt_pk_bf16_f32 v72, v208, v209
    v_cvt_pk_bf16_f32 v73, v210, v211
    v_mfma_f32_16x16x32_bf16 v[228:231], a[4:7], a[48:51], v[228:231]
    v_cvt_pk_bf16_f32 v74, v212, v213
    v_cvt_pk_bf16_f32 v75, v214, v215
    v_mfma_f32_16x16x32_bf16 v[224:227], a[0:3], a[48:51], v[224:227]
    s_mov_b32 s39, 40960
    v_mfma_f32_16x16x32_bf16 v[224:227], a[16:19], a[52:55], v[224:227]
    buffer_store_dwordx4 v[72:75], v35, s[52:55], s39 offen offset:0 sc1
    v_mfma_f32_16x16x32_bf16 v[228:231], a[20:23], a[52:55], v[228:231]
    v_cvt_pk_bf16_f32 v76, v216, v217
    v_cvt_pk_bf16_f32 v77, v218, v219
    v_mfma_f32_16x16x32_bf16 v[232:235], a[24:27], a[52:55], v[232:235]
    v_cvt_pk_bf16_f32 v78, v220, v221
    v_cvt_pk_bf16_f32 v79, v222, v223
    v_mfma_f32_16x16x32_bf16 v[236:239], a[28:31], a[52:55], v[236:239]
    buffer_store_dwordx4 v[76:79], v35, s[52:55], s39 offen offset:1024 sc1
    s_waitcnt lgkmcnt(2)
    v_mfma_f32_16x16x32_bf16 v[240:243], v[80:83], v[124:127], v[240:243]
    v_mfma_f32_16x16x32_bf16 v[244:247], v[84:87], v[124:127], v[244:247]
    v_mfma_f32_16x16x32_bf16 v[248:251], v[88:91], v[124:127], v[248:251]
    v_mfma_f32_16x16x32_bf16 v[252:255], v[92:95], v[124:127], v[252:255]
    v_mfma_f32_16x16x32_bf16 v[252:255], a[12:15], a[56:59], v[252:255]
    v_mfma_f32_16x16x32_bf16 v[248:251], a[8:11], a[56:59], v[248:251]
    v_cvt_pk_bf16_f32 v64, v224, v225
    v_cvt_pk_bf16_f32 v65, v226, v227
    v_mfma_f32_16x16x32_bf16 v[244:247], a[4:7], a[56:59], v[244:247]
    v_cvt_pk_bf16_f32 v66, v228, v229
    v_cvt_pk_bf16_f32 v67, v230, v231
    v_mfma_f32_16x16x32_bf16 v[240:243], a[0:3], a[56:59], v[240:243]
    s_mov_b32 s39, 49152
    v_mfma_f32_16x16x32_bf16 v[240:243], a[16:19], a[60:63], v[240:243]
    buffer_store_dwordx4 v[64:67], v35, s[52:55], s39 offen offset:0 sc1
    v_mfma_f32_16x16x32_bf16 v[244:247], a[20:23], a[60:63], v[244:247]
    v_cvt_pk_bf16_f32 v68, v232, v233
    v_cvt_pk_bf16_f32 v69, v234, v235
    v_mfma_f32_16x16x32_bf16 v[248:251], a[24:27], a[60:63], v[248:251]
    v_cvt_pk_bf16_f32 v70, v236, v237
    v_cvt_pk_bf16_f32 v71, v238, v239
    v_mfma_f32_16x16x32_bf16 v[252:255], a[28:31], a[60:63], v[252:255]
    buffer_store_dwordx4 v[68:71], v35, s[52:55], s39 offen offset:1024 sc1
    s_nop 5
    v_cvt_pk_bf16_f32 v72, v240, v241
    v_cvt_pk_bf16_f32 v73, v242, v243
    v_cvt_pk_bf16_f32 v74, v244, v245
    v_cvt_pk_bf16_f32 v75, v246, v247
    s_mov_b32 s39, 57344
    buffer_store_dwordx4 v[72:75], v35, s[52:55], s39 offen offset:0 sc1
    v_cvt_pk_bf16_f32 v76, v248, v249
    v_cvt_pk_bf16_f32 v77, v250, v251
    v_cvt_pk_bf16_f32 v78, v252, v253
    v_cvt_pk_bf16_f32 v79, v254, v255
    buffer_store_dwordx4 v[76:79], v35, s[52:55], s39 offen offset:1024 sc1
    s_branch L_qkv_qep
L_qkv_vtype:
    s_mov_b32 s38, 0
    s_mov_b32 s69, 2
.p2align 3
L_qkv_kernel_v_5:
    s_waitcnt lgkmcnt(0)
    v_mfma_f32_16x16x32_bf16 a[0:3], v[64:67], v[96:99], a[0:3]
    ds_read_b128 v[128:131], v7 offset:0
    v_mfma_f32_16x16x32_bf16 a[4:7], v[64:67], v[100:103], a[4:7]
    ds_read_b64_tr_b16 v[160:161], v38 offset:16384
    v_mfma_f32_16x16x32_bf16 a[8:11], v[64:67], v[104:107], a[8:11]
    ds_read_b64_tr_b16 v[162:163], v38 offset:18432
    v_mfma_f32_16x16x32_bf16 a[12:15], v[64:67], v[108:111], a[12:15]
    ds_read_b64_tr_b16 v[164:165], v39 offset:16384
    v_mfma_f32_16x16x32_bf16 a[16:19], v[64:67], v[112:115], a[16:19]
    ds_read_b64_tr_b16 v[166:167], v39 offset:18432
    v_mfma_f32_16x16x32_bf16 a[20:23], v[64:67], v[116:119], a[20:23]
    ds_read_b64_tr_b16 v[168:169], v40 offset:16384
    v_mfma_f32_16x16x32_bf16 a[24:27], v[64:67], v[120:123], a[24:27]
    ds_read_b64_tr_b16 v[170:171], v40 offset:18432
    v_mfma_f32_16x16x32_bf16 a[28:31], v[64:67], v[124:127], a[28:31]
    ds_read_b64_tr_b16 v[172:173], v41 offset:16384
    v_mfma_f32_16x16x32_bf16 a[60:63], v[68:71], v[124:127], a[60:63]
    ds_read_b64_tr_b16 v[174:175], v41 offset:18432
    v_mfma_f32_16x16x32_bf16 a[56:59], v[68:71], v[120:123], a[56:59]
    ds_read_b64_tr_b16 v[176:177], v42 offset:16384
    v_mfma_f32_16x16x32_bf16 a[52:55], v[68:71], v[116:119], a[52:55]
    ds_read_b64_tr_b16 v[178:179], v42 offset:18432
    v_mfma_f32_16x16x32_bf16 a[48:51], v[68:71], v[112:115], a[48:51]
    ds_read_b64_tr_b16 v[180:181], v43 offset:16384
    v_mfma_f32_16x16x32_bf16 a[44:47], v[68:71], v[108:111], a[44:47]
    ds_read_b64_tr_b16 v[182:183], v43 offset:18432
    v_mfma_f32_16x16x32_bf16 a[40:43], v[68:71], v[104:107], a[40:43]
    ds_read_b64_tr_b16 v[184:185], v44 offset:16384
    v_mfma_f32_16x16x32_bf16 a[36:39], v[68:71], v[100:103], a[36:39]
    ds_read_b64_tr_b16 v[186:187], v44 offset:18432
    v_mfma_f32_16x16x32_bf16 a[32:35], v[68:71], v[96:99], a[32:35]
    ds_read_b64_tr_b16 v[188:189], v45 offset:16384
    v_mfma_f32_16x16x32_bf16 a[64:67], v[72:75], v[96:99], a[64:67]
    ds_read_b64_tr_b16 v[190:191], v45 offset:18432
    v_mfma_f32_16x16x32_bf16 a[68:71], v[72:75], v[100:103], a[68:71]
    ds_read_b128 v[132:135], v7 offset:2048
    v_mfma_f32_16x16x32_bf16 a[72:75], v[72:75], v[104:107], a[72:75]
    ds_read_b128 v[136:139], v7 offset:4096
    v_mfma_f32_16x16x32_bf16 a[76:79], v[72:75], v[108:111], a[76:79]
    ds_read_b128 v[140:143], v7 offset:6144
    v_mfma_f32_16x16x32_bf16 a[80:83], v[72:75], v[112:115], a[80:83]
    ds_read_b128 v[144:147], v7 offset:8192
    v_mfma_f32_16x16x32_bf16 a[84:87], v[72:75], v[116:119], a[84:87]
    ds_read_b128 v[148:151], v7 offset:10240
    v_mfma_f32_16x16x32_bf16 a[88:91], v[72:75], v[120:123], a[88:91]
    ds_read_b128 v[152:155], v7 offset:12288
    v_mfma_f32_16x16x32_bf16 a[92:95], v[72:75], v[124:127], a[92:95]
    ds_read_b128 v[156:159], v7 offset:14336
    v_mfma_f32_16x16x32_bf16 a[124:127], v[76:79], v[124:127], a[124:127]
    s_add_u32 s38, s38, 1
    v_mfma_f32_16x16x32_bf16 a[120:123], v[76:79], v[120:123], a[120:123]
    v_xor_b32 v6, 65536, v6
    v_mfma_f32_16x16x32_bf16 a[116:119], v[76:79], v[116:119], a[116:119]
    v_xor_b32 v7, 65536, v7
    v_mfma_f32_16x16x32_bf16 a[112:115], v[76:79], v[112:115], a[112:115]
    v_xor_b32 v38, 65536, v38
    v_mfma_f32_16x16x32_bf16 a[108:111], v[76:79], v[108:111], a[108:111]
    v_xor_b32 v39, 65536, v39
    v_mfma_f32_16x16x32_bf16 a[104:107], v[76:79], v[104:107], a[104:107]
    v_xor_b32 v40, 65536, v40
    v_mfma_f32_16x16x32_bf16 a[100:103], v[76:79], v[100:103], a[100:103]
    v_xor_b32 v41, 65536, v41
    v_mfma_f32_16x16x32_bf16 a[96:99], v[76:79], v[96:99], a[96:99]
    v_xor_b32 v42, 65536, v42
    v_mfma_f32_16x16x32_bf16 a[128:131], v[80:83], v[96:99], a[128:131]
    v_xor_b32 v43, 65536, v43
    v_mfma_f32_16x16x32_bf16 a[132:135], v[80:83], v[100:103], a[132:135]
    v_xor_b32 v44, 65536, v44
    v_mfma_f32_16x16x32_bf16 a[136:139], v[80:83], v[104:107], a[136:139]
    v_xor_b32 v45, 65536, v45
    v_mfma_f32_16x16x32_bf16 a[140:143], v[80:83], v[108:111], a[140:143]
    v_mfma_f32_16x16x32_bf16 a[144:147], v[80:83], v[112:115], a[144:147]
    v_mfma_f32_16x16x32_bf16 a[148:151], v[80:83], v[116:119], a[148:151]
    v_mfma_f32_16x16x32_bf16 a[152:155], v[80:83], v[120:123], a[152:155]
    v_mfma_f32_16x16x32_bf16 a[156:159], v[80:83], v[124:127], a[156:159]
    v_mfma_f32_16x16x32_bf16 a[188:191], v[84:87], v[124:127], a[188:191]
    v_mfma_f32_16x16x32_bf16 a[184:187], v[84:87], v[120:123], a[184:187]
    v_mfma_f32_16x16x32_bf16 a[180:183], v[84:87], v[116:119], a[180:183]
    v_mfma_f32_16x16x32_bf16 a[176:179], v[84:87], v[112:115], a[176:179]
    v_mfma_f32_16x16x32_bf16 a[172:175], v[84:87], v[108:111], a[172:175]
    v_mfma_f32_16x16x32_bf16 a[168:171], v[84:87], v[104:107], a[168:171]
    v_mfma_f32_16x16x32_bf16 a[164:167], v[84:87], v[100:103], a[164:167]
    v_mfma_f32_16x16x32_bf16 a[160:163], v[84:87], v[96:99], a[160:163]
    v_mfma_f32_16x16x32_bf16 a[192:195], v[88:91], v[96:99], a[192:195]
    v_mfma_f32_16x16x32_bf16 a[196:199], v[88:91], v[100:103], a[196:199]
    v_mfma_f32_16x16x32_bf16 a[200:203], v[88:91], v[104:107], a[200:203]
    v_mfma_f32_16x16x32_bf16 a[204:207], v[88:91], v[108:111], a[204:207]
    v_mfma_f32_16x16x32_bf16 a[208:211], v[88:91], v[112:115], a[208:211]
    v_mfma_f32_16x16x32_bf16 a[212:215], v[88:91], v[116:119], a[212:215]
    v_mfma_f32_16x16x32_bf16 a[216:219], v[88:91], v[120:123], a[216:219]
    v_mfma_f32_16x16x32_bf16 a[220:223], v[88:91], v[124:127], a[220:223]
    v_mfma_f32_16x16x32_bf16 a[252:255], v[92:95], v[124:127], a[252:255]
    v_mfma_f32_16x16x32_bf16 a[248:251], v[92:95], v[120:123], a[248:251]
    v_mfma_f32_16x16x32_bf16 a[244:247], v[92:95], v[116:119], a[244:247]
    v_mfma_f32_16x16x32_bf16 a[240:243], v[92:95], v[112:115], a[240:243]
    v_mfma_f32_16x16x32_bf16 a[236:239], v[92:95], v[108:111], a[236:239]
    v_mfma_f32_16x16x32_bf16 a[232:235], v[92:95], v[104:107], a[232:235]
    v_mfma_f32_16x16x32_bf16 a[228:231], v[92:95], v[100:103], a[228:231]
    v_mfma_f32_16x16x32_bf16 a[224:227], v[92:95], v[96:99], a[224:227]
    s_waitcnt lgkmcnt(0) vmcnt(1)
    s_barrier
    v_mfma_f32_16x16x32_bf16 a[0:3], v[128:131], v[160:163], a[0:3]
    ds_read_b128 v[64:67], v6 offset:0
    s_add_u32 m0, s23, 0
    v_mfma_f32_16x16x32_bf16 a[4:7], v[128:131], v[164:167], a[4:7]
    buffer_load_dwordx4 v26, s[12:15], s21 offen lds
    v_mfma_f32_16x16x32_bf16 a[8:11], v[128:131], v[168:171], a[8:11]
    ds_read_b64_tr_b16 v[96:97], v38 offset:0
    v_mfma_f32_16x16x32_bf16 a[12:15], v[128:131], v[172:175], a[12:15]
    ds_read_b64_tr_b16 v[98:99], v38 offset:2048
    s_add_u32 m0, s23, 4096
    v_mfma_f32_16x16x32_bf16 a[16:19], v[128:131], v[176:179], a[16:19]
    buffer_load_dwordx4 v27, s[12:15], s21 offen lds
    v_mfma_f32_16x16x32_bf16 a[20:23], v[128:131], v[180:183], a[20:23]
    v_mfma_f32_16x16x32_bf16 a[24:27], v[128:131], v[184:187], a[24:27]
    v_mfma_f32_16x16x32_bf16 a[28:31], v[128:131], v[188:191], a[28:31]
    ds_read_b64_tr_b16 v[100:101], v39 offset:0
    s_add_u32 m0, s23, 8192
    v_mfma_f32_16x16x32_bf16 a[60:63], v[132:135], v[188:191], a[60:63]
    buffer_load_dwordx4 v28, s[12:15], s21 offen lds
    v_mfma_f32_16x16x32_bf16 a[56:59], v[132:135], v[184:187], a[56:59]
    ds_read_b64_tr_b16 v[102:103], v39 offset:2048
    v_mfma_f32_16x16x32_bf16 a[52:55], v[132:135], v[180:183], a[52:55]
    ds_read_b64_tr_b16 v[104:105], v40 offset:0
    s_add_u32 m0, s23, 12288
    v_mfma_f32_16x16x32_bf16 a[48:51], v[132:135], v[176:179], a[48:51]
    buffer_load_dwordx4 v29, s[12:15], s21 offen lds
    v_mfma_f32_16x16x32_bf16 a[44:47], v[132:135], v[172:175], a[44:47]
    v_mfma_f32_16x16x32_bf16 a[40:43], v[132:135], v[168:171], a[40:43]
    v_mfma_f32_16x16x32_bf16 a[36:39], v[132:135], v[164:167], a[36:39]
    ds_read_b64_tr_b16 v[106:107], v40 offset:2048
    s_add_u32 m0, s23, 16384
    v_mfma_f32_16x16x32_bf16 a[32:35], v[132:135], v[160:163], a[32:35]
    buffer_load_dwordx4 v30, s[12:15], s21 offen lds
    v_mfma_f32_16x16x32_bf16 a[64:67], v[136:139], v[160:163], a[64:67]
    ds_read_b64_tr_b16 v[108:109], v41 offset:0
    v_mfma_f32_16x16x32_bf16 a[68:71], v[136:139], v[164:167], a[68:71]
    ds_read_b64_tr_b16 v[110:111], v41 offset:2048
    s_add_u32 m0, s23, 20480
    v_mfma_f32_16x16x32_bf16 a[72:75], v[136:139], v[168:171], a[72:75]
    buffer_load_dwordx4 v31, s[12:15], s21 offen lds
    v_mfma_f32_16x16x32_bf16 a[76:79], v[136:139], v[172:175], a[76:79]
    v_mfma_f32_16x16x32_bf16 a[80:83], v[136:139], v[176:179], a[80:83]
    v_mfma_f32_16x16x32_bf16 a[84:87], v[136:139], v[180:183], a[84:87]
    ds_read_b64_tr_b16 v[112:113], v42 offset:0
    s_add_u32 m0, s23, 24576
    v_mfma_f32_16x16x32_bf16 a[88:91], v[136:139], v[184:187], a[88:91]
    buffer_load_dwordx4 v32, s[12:15], s21 offen lds
    v_mfma_f32_16x16x32_bf16 a[92:95], v[136:139], v[188:191], a[92:95]
    ds_read_b64_tr_b16 v[114:115], v42 offset:2048
    v_mfma_f32_16x16x32_bf16 a[124:127], v[140:143], v[188:191], a[124:127]
    ds_read_b64_tr_b16 v[116:117], v43 offset:0
    s_add_u32 m0, s23, 28672
    v_mfma_f32_16x16x32_bf16 a[120:123], v[140:143], v[184:187], a[120:123]
    buffer_load_dwordx4 v33, s[12:15], s21 offen lds
    v_mfma_f32_16x16x32_bf16 a[116:119], v[140:143], v[180:183], a[116:119]
    v_mfma_f32_16x16x32_bf16 a[112:115], v[140:143], v[176:179], a[112:115]
    v_mfma_f32_16x16x32_bf16 a[108:111], v[140:143], v[172:175], a[108:111]
    ds_read_b64_tr_b16 v[118:119], v43 offset:2048
    s_add_u32 m0, s22, 0
    v_mfma_f32_16x16x32_bf16 a[104:107], v[140:143], v[168:171], a[104:107]
    buffer_load_dwordx4 v18, s[8:11], s20 offen sc1 lds
    v_mfma_f32_16x16x32_bf16 a[100:103], v[140:143], v[164:167], a[100:103]
    ds_read_b64_tr_b16 v[120:121], v44 offset:0
    v_mfma_f32_16x16x32_bf16 a[96:99], v[140:143], v[160:163], a[96:99]
    ds_read_b64_tr_b16 v[122:123], v44 offset:2048
    s_add_u32 m0, s22, 4096
    v_mfma_f32_16x16x32_bf16 a[128:131], v[144:147], v[160:163], a[128:131]
    buffer_load_dwordx4 v19, s[8:11], s20 offen sc1 lds
    v_mfma_f32_16x16x32_bf16 a[132:135], v[144:147], v[164:167], a[132:135]
    v_mfma_f32_16x16x32_bf16 a[136:139], v[144:147], v[168:171], a[136:139]
    v_mfma_f32_16x16x32_bf16 a[140:143], v[144:147], v[172:175], a[140:143]
    ds_read_b64_tr_b16 v[124:125], v45 offset:0
    s_add_u32 m0, s22, 8192
    v_mfma_f32_16x16x32_bf16 a[144:147], v[144:147], v[176:179], a[144:147]
    buffer_load_dwordx4 v20, s[8:11], s20 offen sc1 lds
    v_mfma_f32_16x16x32_bf16 a[148:151], v[144:147], v[180:183], a[148:151]
    ds_read_b64_tr_b16 v[126:127], v45 offset:2048
    v_mfma_f32_16x16x32_bf16 a[152:155], v[144:147], v[184:187], a[152:155]
    ds_read_b128 v[68:71], v6 offset:2048
    s_add_u32 m0, s22, 12288
    v_mfma_f32_16x16x32_bf16 a[156:159], v[144:147], v[188:191], a[156:159]
    buffer_load_dwordx4 v21, s[8:11], s20 offen sc1 lds
    v_mfma_f32_16x16x32_bf16 a[188:191], v[148:151], v[188:191], a[188:191]
    v_mfma_f32_16x16x32_bf16 a[184:187], v[148:151], v[184:187], a[184:187]
    v_mfma_f32_16x16x32_bf16 a[180:183], v[148:151], v[180:183], a[180:183]
    ds_read_b128 v[72:75], v6 offset:4096
    s_add_u32 m0, s22, 16384
    v_mfma_f32_16x16x32_bf16 a[176:179], v[148:151], v[176:179], a[176:179]
    buffer_load_dwordx4 v22, s[8:11], s20 offen sc1 lds
    v_mfma_f32_16x16x32_bf16 a[172:175], v[148:151], v[172:175], a[172:175]
    ds_read_b128 v[76:79], v6 offset:6144
    v_mfma_f32_16x16x32_bf16 a[168:171], v[148:151], v[168:171], a[168:171]
    ds_read_b128 v[80:83], v6 offset:8192
    s_add_u32 m0, s22, 20480
    v_mfma_f32_16x16x32_bf16 a[164:167], v[148:151], v[164:167], a[164:167]
    buffer_load_dwordx4 v23, s[8:11], s20 offen sc1 lds
    v_mfma_f32_16x16x32_bf16 a[160:163], v[148:151], v[160:163], a[160:163]
    v_mfma_f32_16x16x32_bf16 a[192:195], v[152:155], v[160:163], a[192:195]
    v_mfma_f32_16x16x32_bf16 a[196:199], v[152:155], v[164:167], a[196:199]
    ds_read_b128 v[84:87], v6 offset:10240
    s_add_u32 m0, s22, 24576
    v_mfma_f32_16x16x32_bf16 a[200:203], v[152:155], v[168:171], a[200:203]
    buffer_load_dwordx4 v24, s[8:11], s20 offen sc1 lds
    v_mfma_f32_16x16x32_bf16 a[204:207], v[152:155], v[172:175], a[204:207]
    ds_read_b128 v[88:91], v6 offset:12288
    v_mfma_f32_16x16x32_bf16 a[208:211], v[152:155], v[176:179], a[208:211]
    ds_read_b128 v[92:95], v6 offset:14336
    s_add_u32 m0, s22, 28672
    v_mfma_f32_16x16x32_bf16 a[212:215], v[152:155], v[180:183], a[212:215]
    buffer_load_dwordx4 v25, s[8:11], s20 offen sc1 lds
    v_mfma_f32_16x16x32_bf16 a[216:219], v[152:155], v[184:187], a[216:219]
    v_mfma_f32_16x16x32_bf16 a[220:223], v[152:155], v[188:191], a[220:223]
    v_mfma_f32_16x16x32_bf16 a[252:255], v[156:159], v[188:191], a[252:255]
    s_add_u32 s21, s21, 524288
    s_xor_b32 s23, s23, 65536
    v_mfma_f32_16x16x32_bf16 a[248:251], v[156:159], v[184:187], a[248:251]
    s_add_u32 s20, s20, 128
    s_xor_b32 s22, s22, 65536
    v_mfma_f32_16x16x32_bf16 a[244:247], v[156:159], v[180:183], a[244:247]
    buffer_load_dword v36, v35, s[40:43], s50 offen
    v_mfma_f32_16x16x32_bf16 a[240:243], v[156:159], v[176:179], a[240:243]
    s_add_u32 s50, s50, s51
    v_mfma_f32_16x16x32_bf16 a[236:239], v[156:159], v[172:175], a[236:239]
    v_mfma_f32_16x16x32_bf16 a[232:235], v[156:159], v[168:171], a[232:235]
    v_mfma_f32_16x16x32_bf16 a[228:231], v[156:159], v[164:167], a[228:231]
    v_mfma_f32_16x16x32_bf16 a[224:227], v[156:159], v[160:163], a[224:227]
    s_cmp_lg_u32 s38, s69
    s_cbranch_scc1 L_qkv_kernel_v_5
    s_branch L_qkv_kernel_sw_6
L_qkv_kernel_fin_8:
    v_xor_b32 v4, 65536, v6
    v_xor_b32 v5, 65536, v7
    s_waitcnt lgkmcnt(0)
    v_mfma_f32_16x16x32_bf16 a[0:3], v[64:67], v[96:99], a[0:3]
    ds_read_b64_tr_b16 v[160:161], v38 offset:16384
    v_mfma_f32_16x16x32_bf16 a[4:7], v[64:67], v[100:103], a[4:7]
    ds_read_b64_tr_b16 v[162:163], v38 offset:18432
    v_mfma_f32_16x16x32_bf16 a[8:11], v[64:67], v[104:107], a[8:11]
    ds_read_b64_tr_b16 v[164:165], v39 offset:16384
    v_mfma_f32_16x16x32_bf16 a[12:15], v[64:67], v[108:111], a[12:15]
    ds_read_b64_tr_b16 v[166:167], v39 offset:18432
    v_mfma_f32_16x16x32_bf16 a[16:19], v[64:67], v[112:115], a[16:19]
    ds_read_b64_tr_b16 v[168:169], v40 offset:16384
    v_mfma_f32_16x16x32_bf16 a[20:23], v[64:67], v[116:119], a[20:23]
    ds_read_b64_tr_b16 v[170:171], v40 offset:18432
    v_mfma_f32_16x16x32_bf16 a[24:27], v[64:67], v[120:123], a[24:27]
    ds_read_b64_tr_b16 v[172:173], v41 offset:16384
    v_mfma_f32_16x16x32_bf16 a[28:31], v[64:67], v[124:127], a[28:31]
    ds_read_b128 v[64:67], v7 offset:0
    v_mfma_f32_16x16x32_bf16 a[60:63], v[68:71], v[124:127], a[60:63]
    ds_read_b64_tr_b16 v[174:175], v41 offset:18432
    v_mfma_f32_16x16x32_bf16 a[56:59], v[68:71], v[120:123], a[56:59]
    ds_read_b64_tr_b16 v[176:177], v42 offset:16384
    v_mfma_f32_16x16x32_bf16 a[52:55], v[68:71], v[116:119], a[52:55]
    ds_read_b64_tr_b16 v[178:179], v42 offset:18432
    v_mfma_f32_16x16x32_bf16 a[48:51], v[68:71], v[112:115], a[48:51]
    ds_read_b64_tr_b16 v[180:181], v43 offset:16384
    v_mfma_f32_16x16x32_bf16 a[44:47], v[68:71], v[108:111], a[44:47]
    ds_read_b64_tr_b16 v[182:183], v43 offset:18432
    v_mfma_f32_16x16x32_bf16 a[40:43], v[68:71], v[104:107], a[40:43]
    ds_read_b64_tr_b16 v[184:185], v44 offset:16384
    v_mfma_f32_16x16x32_bf16 a[36:39], v[68:71], v[100:103], a[36:39]
    ds_read_b64_tr_b16 v[186:187], v44 offset:18432
    v_mfma_f32_16x16x32_bf16 a[32:35], v[68:71], v[96:99], a[32:35]
    ds_read_b128 v[68:71], v7 offset:2048
    v_mfma_f32_16x16x32_bf16 a[64:67], v[72:75], v[96:99], a[64:67]
    ds_read_b64_tr_b16 v[188:189], v45 offset:16384
    v_mfma_f32_16x16x32_bf16 a[68:71], v[72:75], v[100:103], a[68:71]
    ds_read_b64_tr_b16 v[190:191], v45 offset:18432
    v_mfma_f32_16x16x32_bf16 a[72:75], v[72:75], v[104:107], a[72:75]
    s_waitcnt vmcnt(1)
    s_barrier
    v_mfma_f32_16x16x32_bf16 a[76:79], v[72:75], v[108:111], a[76:79]
    v_xor_b32 v38, 65536, v38
    v_xor_b32 v39, 65536, v39
    v_mfma_f32_16x16x32_bf16 a[80:83], v[72:75], v[112:115], a[80:83]
    v_xor_b32 v40, 65536, v40
    v_xor_b32 v41, 65536, v41
    v_mfma_f32_16x16x32_bf16 a[84:87], v[72:75], v[116:119], a[84:87]
    v_xor_b32 v42, 65536, v42
    v_xor_b32 v43, 65536, v43
    v_mfma_f32_16x16x32_bf16 a[88:91], v[72:75], v[120:123], a[88:91]
    v_xor_b32 v44, 65536, v44
    v_xor_b32 v45, 65536, v45
    v_mfma_f32_16x16x32_bf16 a[92:95], v[72:75], v[124:127], a[92:95]
    ds_read_b128 v[72:75], v7 offset:4096
    v_mfma_f32_16x16x32_bf16 a[124:127], v[76:79], v[124:127], a[124:127]
    ds_read_b64_tr_b16 v[192:193], v38 offset:0
    v_mfma_f32_16x16x32_bf16 a[120:123], v[76:79], v[120:123], a[120:123]
    ds_read_b64_tr_b16 v[194:195], v38 offset:2048
    v_mfma_f32_16x16x32_bf16 a[116:119], v[76:79], v[116:119], a[116:119]
    ds_read_b64_tr_b16 v[196:197], v39 offset:0
    v_mfma_f32_16x16x32_bf16 a[112:115], v[76:79], v[112:115], a[112:115]
    ds_read_b64_tr_b16 v[198:199], v39 offset:2048
    v_mfma_f32_16x16x32_bf16 a[108:111], v[76:79], v[108:111], a[108:111]
    ds_read_b64_tr_b16 v[200:201], v40 offset:0
    v_mfma_f32_16x16x32_bf16 a[104:107], v[76:79], v[104:107], a[104:107]
    ds_read_b64_tr_b16 v[202:203], v40 offset:2048
    v_mfma_f32_16x16x32_bf16 a[100:103], v[76:79], v[100:103], a[100:103]
    ds_read_b64_tr_b16 v[204:205], v41 offset:0
    v_mfma_f32_16x16x32_bf16 a[96:99], v[76:79], v[96:99], a[96:99]
    ds_read_b128 v[76:79], v7 offset:6144
    v_mfma_f32_16x16x32_bf16 a[128:131], v[80:83], v[96:99], a[128:131]
    ds_read_b64_tr_b16 v[206:207], v41 offset:2048
    v_mfma_f32_16x16x32_bf16 a[132:135], v[80:83], v[100:103], a[132:135]
    ds_read_b64_tr_b16 v[208:209], v42 offset:0
    v_mfma_f32_16x16x32_bf16 a[136:139], v[80:83], v[104:107], a[136:139]
    ds_read_b64_tr_b16 v[210:211], v42 offset:2048
    v_mfma_f32_16x16x32_bf16 a[140:143], v[80:83], v[108:111], a[140:143]
    ds_read_b64_tr_b16 v[212:213], v43 offset:0
    v_mfma_f32_16x16x32_bf16 a[144:147], v[80:83], v[112:115], a[144:147]
    ds_read_b64_tr_b16 v[214:215], v43 offset:2048
    v_mfma_f32_16x16x32_bf16 a[148:151], v[80:83], v[116:119], a[148:151]
    ds_read_b64_tr_b16 v[216:217], v44 offset:0
    v_mfma_f32_16x16x32_bf16 a[152:155], v[80:83], v[120:123], a[152:155]
    ds_read_b64_tr_b16 v[218:219], v44 offset:2048
    v_mfma_f32_16x16x32_bf16 a[156:159], v[80:83], v[124:127], a[156:159]
    ds_read_b128 v[80:83], v7 offset:8192
    v_mfma_f32_16x16x32_bf16 a[188:191], v[84:87], v[124:127], a[188:191]
    ds_read_b64_tr_b16 v[220:221], v45 offset:0
    v_mfma_f32_16x16x32_bf16 a[184:187], v[84:87], v[120:123], a[184:187]
    ds_read_b64_tr_b16 v[222:223], v45 offset:2048
    v_mfma_f32_16x16x32_bf16 a[180:183], v[84:87], v[116:119], a[180:183]
    ds_read_b64_tr_b16 v[224:225], v38 offset:16384
    v_mfma_f32_16x16x32_bf16 a[176:179], v[84:87], v[112:115], a[176:179]
    ds_read_b64_tr_b16 v[226:227], v38 offset:18432
    v_mfma_f32_16x16x32_bf16 a[172:175], v[84:87], v[108:111], a[172:175]
    ds_read_b64_tr_b16 v[228:229], v39 offset:16384
    v_mfma_f32_16x16x32_bf16 a[168:171], v[84:87], v[104:107], a[168:171]
    ds_read_b64_tr_b16 v[230:231], v39 offset:18432
    v_mfma_f32_16x16x32_bf16 a[164:167], v[84:87], v[100:103], a[164:167]
    ds_read_b64_tr_b16 v[232:233], v40 offset:16384
    v_mfma_f32_16x16x32_bf16 a[160:163], v[84:87], v[96:99], a[160:163]
    ds_read_b128 v[84:87], v7 offset:10240
    v_mfma_f32_16x16x32_bf16 a[192:195], v[88:91], v[96:99], a[192:195]
    ds_read_b64_tr_b16 v[234:235], v40 offset:18432
    v_mfma_f32_16x16x32_bf16 a[196:199], v[88:91], v[100:103], a[196:199]
    ds_read_b64_tr_b16 v[236:237], v41 offset:16384
    v_mfma_f32_16x16x32_bf16 a[200:203], v[88:91], v[104:107], a[200:203]
    ds_read_b64_tr_b16 v[238:239], v41 offset:18432
    v_mfma_f32_16x16x32_bf16 a[204:207], v[88:91], v[108:111], a[204:207]
    ds_read_b64_tr_b16 v[240:241], v42 offset:16384
    v_mfma_f32_16x16x32_bf16 a[208:211], v[88:91], v[112:115], a[208:211]
    ds_read_b64_tr_b16 v[242:243], v42 offset:18432
    v_mfma_f32_16x16x32_bf16 a[212:215], v[88:91], v[116:119], a[212:215]
    ds_read_b64_tr_b16 v[244:245], v43 offset:16384
    v_mfma_f32_16x16x32_bf16 a[216:219], v[88:91], v[120:123], a[216:219]
    ds_read_b64_tr_b16 v[246:247], v43 offset:18432
    v_mfma_f32_16x16x32_bf16 a[220:223], v[88:91], v[124:127], a[220:223]
    ds_read_b128 v[88:91], v7 offset:12288
    v_mfma_f32_16x16x32_bf16 a[252:255], v[92:95], v[124:127], a[252:255]
    ds_read_b64_tr_b16 v[248:249], v44 offset:16384
    v_mfma_f32_16x16x32_bf16 a[248:251], v[92:95], v[120:123], a[248:251]
    ds_read_b64_tr_b16 v[250:251], v44 offset:18432
    v_mfma_f32_16x16x32_bf16 a[244:247], v[92:95], v[116:119], a[244:247]
    ds_read_b64_tr_b16 v[252:253], v45 offset:16384
    v_mfma_f32_16x16x32_bf16 a[240:243], v[92:95], v[112:115], a[240:243]
    ds_read_b64_tr_b16 v[254:255], v45 offset:18432
    v_mfma_f32_16x16x32_bf16 a[236:239], v[92:95], v[108:111], a[236:239]
    ds_read_b128 v[128:131], v4 offset:0
    v_mfma_f32_16x16x32_bf16 a[232:235], v[92:95], v[104:107], a[232:235]
    ds_read_b128 v[132:135], v5 offset:0
    v_mfma_f32_16x16x32_bf16 a[228:231], v[92:95], v[100:103], a[228:231]
    ds_read_b128 v[136:139], v4 offset:2048
    ds_read_b128 v[140:143], v5 offset:2048
    v_mfma_f32_16x16x32_bf16 a[224:227], v[92:95], v[96:99], a[224:227]
    ds_read_b128 v[92:95], v7 offset:14336
    s_waitcnt lgkmcnt(0)
    s_barrier
    v_mfma_f32_16x16x32_bf16 a[0:3], v[64:67], v[160:163], a[0:3]
    v_mfma_f32_16x16x32_bf16 a[4:7], v[64:67], v[164:167], a[4:7]
    s_add_u32 m0, s22, 32768
    s_mov_b32 s21, 0
    v_mfma_f32_16x16x32_bf16 a[8:11], v[64:67], v[168:171], a[8:11]
    buffer_load_dwordx4 v26, s[12:15], s21 offen lds
    v_mfma_f32_16x16x32_bf16 a[12:15], v[64:67], v[172:175], a[12:15]
    v_mfma_f32_16x16x32_bf16 a[16:19], v[64:67], v[176:179], a[16:19]
    v_mfma_f32_16x16x32_bf16 a[20:23], v[64:67], v[180:183], a[20:23]
    s_add_u32 m0, s22, 36864
    v_mfma_f32_16x16x32_bf16 a[24:27], v[64:67], v[184:187], a[24:27]
    buffer_load_dwordx4 v27, s[12:15], s21 offen lds
    v_mfma_f32_16x16x32_bf16 a[28:31], v[64:67], v[188:191], a[28:31]
    v_mfma_f32_16x16x32_bf16 a[28:31], v[128:131], v[220:223], a[28:31]
    v_mfma_f32_16x16x32_bf16 a[24:27], v[128:131], v[216:219], a[24:27]
    s_add_u32 m0, s22, 40960
    v_mfma_f32_16x16x32_bf16 a[20:23], v[128:131], v[212:215], a[20:23]
    buffer_load_dwordx4 v28, s[12:15], s21 offen lds
    v_mfma_f32_16x16x32_bf16 a[16:19], v[128:131], v[208:211], a[16:19]
    v_mfma_f32_16x16x32_bf16 a[12:15], v[128:131], v[204:207], a[12:15]
    v_mfma_f32_16x16x32_bf16 a[8:11], v[128:131], v[200:203], a[8:11]
    s_add_u32 m0, s22, 45056
    v_mfma_f32_16x16x32_bf16 a[4:7], v[128:131], v[196:199], a[4:7]
    buffer_load_dwordx4 v29, s[12:15], s21 offen lds
    v_mfma_f32_16x16x32_bf16 a[0:3], v[128:131], v[192:195], a[0:3]
    v_mfma_f32_16x16x32_bf16 a[0:3], v[132:135], v[224:227], a[0:3]
    v_mfma_f32_16x16x32_bf16 a[4:7], v[132:135], v[228:231], a[4:7]
    s_add_u32 m0, s22, 0
    s_mov_b32 s20, 0
    v_mfma_f32_16x16x32_bf16 a[8:11], v[132:135], v[232:235], a[8:11]
    buffer_load_dwordx4 v18, s[8:11], s20 offen sc1 lds
    v_mfma_f32_16x16x32_bf16 a[12:15], v[132:135], v[236:239], a[12:15]
    v_mfma_f32_16x16x32_bf16 a[16:19], v[132:135], v[240:243], a[16:19]
    ds_read_b128 v[144:147], v4 offset:4096
    v_mfma_f32_16x16x32_bf16 a[20:23], v[132:135], v[244:247], a[20:23]
    ds_read_b128 v[148:151], v5 offset:4096
    s_add_u32 m0, s22, 4096
    v_mfma_f32_16x16x32_bf16 a[24:27], v[132:135], v[248:251], a[24:27]
    buffer_load_dwordx4 v19, s[8:11], s20 offen sc1 lds
    v_mfma_f32_16x16x32_bf16 a[28:31], v[132:135], v[252:255], a[28:31]
    s_waitcnt lgkmcnt(2)
    v_mfma_f32_16x16x32_bf16 a[32:35], v[68:71], v[160:163], a[32:35]
    v_mfma_f32_16x16x32_bf16 a[36:39], v[68:71], v[164:167], a[36:39]
    s_add_u32 m0, s22, 8192
    v_mfma_f32_16x16x32_bf16 a[40:43], v[68:71], v[168:171], a[40:43]
    buffer_load_dwordx4 v20, s[8:11], s20 offen sc1 lds
    v_mfma_f32_16x16x32_bf16 a[44:47], v[68:71], v[172:175], a[44:47]
    v_mfma_f32_16x16x32_bf16 a[48:51], v[68:71], v[176:179], a[48:51]
    v_mfma_f32_16x16x32_bf16 a[52:55], v[68:71], v[180:183], a[52:55]
    s_add_u32 m0, s22, 12288
    v_mfma_f32_16x16x32_bf16 a[56:59], v[68:71], v[184:187], a[56:59]
    buffer_load_dwordx4 v21, s[8:11], s20 offen sc1 lds
    v_mfma_f32_16x16x32_bf16 a[60:63], v[68:71], v[188:191], a[60:63]
    v_mfma_f32_16x16x32_bf16 a[60:63], v[136:139], v[220:223], a[60:63]
    v_mfma_f32_16x16x32_bf16 a[56:59], v[136:139], v[216:219], a[56:59]
    s_add_u32 m0, s22, 16384
    v_mfma_f32_16x16x32_bf16 a[52:55], v[136:139], v[212:215], a[52:55]
    buffer_load_dwordx4 v22, s[8:11], s20 offen sc1 lds
    v_mfma_f32_16x16x32_bf16 a[48:51], v[136:139], v[208:211], a[48:51]
    v_mfma_f32_16x16x32_bf16 a[44:47], v[136:139], v[204:207], a[44:47]
    v_mfma_f32_16x16x32_bf16 a[40:43], v[136:139], v[200:203], a[40:43]
    s_add_u32 m0, s22, 20480
    v_mfma_f32_16x16x32_bf16 a[36:39], v[136:139], v[196:199], a[36:39]
    buffer_load_dwordx4 v23, s[8:11], s20 offen sc1 lds
    v_mfma_f32_16x16x32_bf16 a[32:35], v[136:139], v[192:195], a[32:35]
    v_mfma_f32_16x16x32_bf16 a[32:35], v[140:143], v[224:227], a[32:35]
    v_mfma_f32_16x16x32_bf16 a[36:39], v[140:143], v[228:231], a[36:39]
    s_add_u32 m0, s22, 24576
    v_mfma_f32_16x16x32_bf16 a[40:43], v[140:143], v[232:235], a[40:43]
    buffer_load_dwordx4 v24, s[8:11], s20 offen sc1 lds
    v_mfma_f32_16x16x32_bf16 a[44:47], v[140:143], v[236:239], a[44:47]
    v_mfma_f32_16x16x32_bf16 a[48:51], v[140:143], v[240:243], a[48:51]
    ds_read_b128 v[152:155], v4 offset:6144
    v_mfma_f32_16x16x32_bf16 a[52:55], v[140:143], v[244:247], a[52:55]
    ds_read_b128 v[156:159], v5 offset:6144
    s_add_u32 m0, s22, 28672
    v_mfma_f32_16x16x32_bf16 a[56:59], v[140:143], v[248:251], a[56:59]
    buffer_load_dwordx4 v25, s[8:11], s20 offen sc1 lds
    v_mfma_f32_16x16x32_bf16 a[60:63], v[140:143], v[252:255], a[60:63]
    s_waitcnt lgkmcnt(2)
    v_mfma_f32_16x16x32_bf16 a[64:67], v[72:75], v[160:163], a[64:67]
    v_mfma_f32_16x16x32_bf16 a[68:71], v[72:75], v[164:167], a[68:71]
    s_add_u32 m0, s22, 98304
    s_mov_b32 s21, 524288
    v_mfma_f32_16x16x32_bf16 a[72:75], v[72:75], v[168:171], a[72:75]
    buffer_load_dwordx4 v26, s[12:15], s21 offen lds
    v_mfma_f32_16x16x32_bf16 a[76:79], v[72:75], v[172:175], a[76:79]
    v_mfma_f32_16x16x32_bf16 a[80:83], v[72:75], v[176:179], a[80:83]
    v_mfma_f32_16x16x32_bf16 a[84:87], v[72:75], v[180:183], a[84:87]
    s_add_u32 m0, s22, 102400
    v_mfma_f32_16x16x32_bf16 a[88:91], v[72:75], v[184:187], a[88:91]
    buffer_load_dwordx4 v27, s[12:15], s21 offen lds
    v_mfma_f32_16x16x32_bf16 a[92:95], v[72:75], v[188:191], a[92:95]
    v_mfma_f32_16x16x32_bf16 a[92:95], v[144:147], v[220:223], a[92:95]
    v_mfma_f32_16x16x32_bf16 a[88:91], v[144:147], v[216:219], a[88:91]
    s_add_u32 m0, s22, 106496
    v_mfma_f32_16x16x32_bf16 a[84:87], v[144:147], v[212:215], a[84:87]
    buffer_load_dwordx4 v28, s[12:15], s21 offen lds
    v_mfma_f32_16x16x32_bf16 a[80:83], v[144:147], v[208:211], a[80:83]
    v_accvgpr_read_b32 v38, a0
    v_accvgpr_read_b32 v39, a1
    v_mfma_f32_16x16x32_bf16 a[76:79], v[144:147], v[204:207], a[76:79]
    v_accvgpr_read_b32 v40, a2
    v_accvgpr_read_b32 v41, a3
    v_mfma_f32_16x16x32_bf16 a[72:75], v[144:147], v[200:203], a[72:75]
    s_add_u32 m0, s22, 110592
    v_accvgpr_read_b32 v42, a32
    v_mfma_f32_16x16x32_bf16 a[68:71], v[144:147], v[196:199], a[68:71]
    buffer_load_dwordx4 v29, s[12:15], s21 offen lds
    v_mfma_f32_16x16x32_bf16 a[64:67], v[144:147], v[192:195], a[64:67]
    v_accvgpr_read_b32 v43, a33
    v_accvgpr_read_b32 v44, a34
    v_mfma_f32_16x16x32_bf16 a[64:67], v[148:151], v[224:227], a[64:67]
    v_accvgpr_read_b32 v45, a35
    v_cvt_pk_bf16_f32 v46, v38, v39
    v_mfma_f32_16x16x32_bf16 a[68:71], v[148:151], v[228:231], a[68:71]
    s_add_u32 m0, s22, 131072
    s_mov_b32 s20, 128
    v_cvt_pk_bf16_f32 v47, v40, v41
    v_mfma_f32_16x16x32_bf16 a[72:75], v[148:151], v[232:235], a[72:75]
    buffer_load_dwordx4 v18, s[8:11], s20 offen sc1 lds
    v_mfma_f32_16x16x32_bf16 a[76:79], v[148:151], v[236:239], a[76:79]
    v_cvt_pk_bf16_f32 v48, v42, v43
    v_cvt_pk_bf16_f32 v49, v44, v45
    v_mfma_f32_16x16x32_bf16 a[80:83], v[148:151], v[240:243], a[80:83]
    ds_read_b128 v[128:131], v4 offset:8192
    s_mov_b32 s39, 0
    v_mfma_f32_16x16x32_bf16 a[84:87], v[148:151], v[244:247], a[84:87]
    ds_read_b128 v[132:135], v5 offset:8192
    s_add_u32 m0, s22, 135168
    v_mfma_f32_16x16x32_bf16 a[88:91], v[148:151], v[248:251], a[88:91]
    buffer_load_dwordx4 v19, s[8:11], s20 offen sc1 lds
    v_mfma_f32_16x16x32_bf16 a[92:95], v[148:151], v[252:255], a[92:95]
    buffer_store_dwordx4 v[46:49], v34, s[16:19], s39 offen offset:0 sc1
    s_waitcnt lgkmcnt(2)
    v_mfma_f32_16x16x32_bf16 a[96:99], v[76:79], v[160:163], a[96:99]
    v_accvgpr_read_b32 v50, a4
    v_accvgpr_read_b32 v51, a5
    v_mfma_f32_16x16x32_bf16 a[100:103], v[76:79], v[164:167], a[100:103]
    s_add_u32 m0, s22, 139264
    v_accvgpr_read_b32 v52, a6
    v_mfma_f32_16x16x32_bf16 a[104:107], v[76:79], v[168:171], a[104:107]
    buffer_load_dwordx4 v20, s[8:11], s20 offen sc1 lds
    v_mfma_f32_16x16x32_bf16 a[108:111], v[76:79], v[172:175], a[108:111]
    v_accvgpr_read_b32 v53, a7
    v_accvgpr_read_b32 v54, a36
    v_mfma_f32_16x16x32_bf16 a[112:115], v[76:79], v[176:179], a[112:115]
    v_accvgpr_read_b32 v55, a37
    v_accvgpr_read_b32 v56, a38
    v_mfma_f32_16x16x32_bf16 a[116:119], v[76:79], v[180:183], a[116:119]
    s_add_u32 m0, s22, 143360
    v_accvgpr_read_b32 v57, a39
    v_mfma_f32_16x16x32_bf16 a[120:123], v[76:79], v[184:187], a[120:123]
    buffer_load_dwordx4 v21, s[8:11], s20 offen sc1 lds
    v_mfma_f32_16x16x32_bf16 a[124:127], v[76:79], v[188:191], a[124:127]
    v_cvt_pk_bf16_f32 v58, v50, v51
    v_cvt_pk_bf16_f32 v59, v52, v53
    v_mfma_f32_16x16x32_bf16 a[124:127], v[152:155], v[220:223], a[124:127]
    v_cvt_pk_bf16_f32 v60, v54, v55
    v_cvt_pk_bf16_f32 v61, v56, v57
    v_mfma_f32_16x16x32_bf16 a[120:123], v[152:155], v[216:219], a[120:123]
    s_add_u32 m0, s22, 147456
    s_mov_b32 s39, 0
    v_mfma_f32_16x16x32_bf16 a[116:119], v[152:155], v[212:215], a[116:119]
    buffer_load_dwordx4 v22, s[8:11], s20 offen sc1 lds
    v_mfma_f32_16x16x32_bf16 a[112:115], v[152:155], v[208:211], a[112:115]
    buffer_store_dwordx4 v[58:61], v34, s[16:19], s39 offen offset:1024 sc1
    v_mfma_f32_16x16x32_bf16 a[108:111], v[152:155], v[204:207], a[108:111]
    v_accvgpr_read_b32 v38, a8
    v_accvgpr_read_b32 v39, a9
    v_mfma_f32_16x16x32_bf16 a[104:107], v[152:155], v[200:203], a[104:107]
    s_add_u32 m0, s22, 151552
    v_accvgpr_read_b32 v40, a10
    v_mfma_f32_16x16x32_bf16 a[100:103], v[152:155], v[196:199], a[100:103]
    buffer_load_dwordx4 v23, s[8:11], s20 offen sc1 lds
    v_mfma_f32_16x16x32_bf16 a[96:99], v[152:155], v[192:195], a[96:99]
    v_accvgpr_read_b32 v41, a11
    v_accvgpr_read_b32 v42, a40
    v_mfma_f32_16x16x32_bf16 a[96:99], v[156:159], v[224:227], a[96:99]
    v_accvgpr_read_b32 v43, a41
    v_accvgpr_read_b32 v44, a42
    v_mfma_f32_16x16x32_bf16 a[100:103], v[156:159], v[228:231], a[100:103]
    s_add_u32 m0, s22, 155648
    v_accvgpr_read_b32 v45, a43
    v_mfma_f32_16x16x32_bf16 a[104:107], v[156:159], v[232:235], a[104:107]
    buffer_load_dwordx4 v24, s[8:11], s20 offen sc1 lds
    v_mfma_f32_16x16x32_bf16 a[108:111], v[156:159], v[236:239], a[108:111]
    v_cvt_pk_bf16_f32 v46, v38, v39
    v_cvt_pk_bf16_f32 v47, v40, v41
    v_mfma_f32_16x16x32_bf16 a[112:115], v[156:159], v[240:243], a[112:115]
    ds_read_b128 v[136:139], v4 offset:10240
    v_cvt_pk_bf16_f32 v48, v42, v43
    v_mfma_f32_16x16x32_bf16 a[116:119], v[156:159], v[244:247], a[116:119]
    ds_read_b128 v[140:143], v5 offset:10240
    s_add_u32 m0, s22, 159744
    v_mfma_f32_16x16x32_bf16 a[120:123], v[156:159], v[248:251], a[120:123]
    buffer_load_dwordx4 v25, s[8:11], s20 offen sc1 lds
    v_mfma_f32_16x16x32_bf16 a[124:127], v[156:159], v[252:255], a[124:127]
    v_cvt_pk_bf16_f32 v49, v44, v45
    s_mov_b32 s39, 0
    s_waitcnt lgkmcnt(2)
    v_mfma_f32_16x16x32_bf16 a[128:131], v[80:83], v[160:163], a[128:131]
    buffer_store_dwordx4 v[46:49], v34, s[16:19], s39 offen offset:2048 sc1
    v_mfma_f32_16x16x32_bf16 a[132:135], v[80:83], v[164:167], a[132:135]
    s_add_u32 m0, s22, 49152
    s_mov_b32 s21, 1048576
    v_accvgpr_read_b32 v50, a12
    v_mfma_f32_16x16x32_bf16 a[136:139], v[80:83], v[168:171], a[136:139]
    buffer_load_dwordx4 v26, s[12:15], s21 offen lds
    v_mfma_f32_16x16x32_bf16 a[140:143], v[80:83], v[172:175], a[140:143]
    v_accvgpr_read_b32 v51, a13
    v_accvgpr_read_b32 v52, a14
    v_mfma_f32_16x16x32_bf16 a[144:147], v[80:83], v[176:179], a[144:147]
    v_accvgpr_read_b32 v53, a15
    v_accvgpr_read_b32 v54, a44
    v_mfma_f32_16x16x32_bf16 a[148:151], v[80:83], v[180:183], a[148:151]
    s_add_u32 m0, s22, 53248
    v_accvgpr_read_b32 v55, a45
    v_mfma_f32_16x16x32_bf16 a[152:155], v[80:83], v[184:187], a[152:155]
    buffer_load_dwordx4 v27, s[12:15], s21 offen lds
    v_mfma_f32_16x16x32_bf16 a[156:159], v[80:83], v[188:191], a[156:159]
    v_accvgpr_read_b32 v56, a46
    v_accvgpr_read_b32 v57, a47
    v_mfma_f32_16x16x32_bf16 a[156:159], v[128:131], v[220:223], a[156:159]
    v_cvt_pk_bf16_f32 v58, v50, v51
    v_cvt_pk_bf16_f32 v59, v52, v53
    v_mfma_f32_16x16x32_bf16 a[152:155], v[128:131], v[216:219], a[152:155]
    s_add_u32 m0, s22, 57344
    v_cvt_pk_bf16_f32 v60, v54, v55
    v_mfma_f32_16x16x32_bf16 a[148:151], v[128:131], v[212:215], a[148:151]
    buffer_load_dwordx4 v28, s[12:15], s21 offen lds
    v_mfma_f32_16x16x32_bf16 a[144:147], v[128:131], v[208:211], a[144:147]
    v_cvt_pk_bf16_f32 v61, v56, v57
    s_mov_b32 s39, 0
    v_mfma_f32_16x16x32_bf16 a[140:143], v[128:131], v[204:207], a[140:143]
    buffer_store_dwordx4 v[58:61], v34, s[16:19], s39 offen offset:3072 sc1
    v_mfma_f32_16x16x32_bf16 a[136:139], v[128:131], v[200:203], a[136:139]
    s_add_u32 m0, s22, 61440
    v_accvgpr_read_b32 v38, a16
    v_mfma_f32_16x16x32_bf16 a[132:135], v[128:131], v[196:199], a[132:135]
    buffer_load_dwordx4 v29, s[12:15], s21 offen lds
    v_mfma_f32_16x16x32_bf16 a[128:131], v[128:131], v[192:195], a[128:131]
    v_accvgpr_read_b32 v39, a17
    v_accvgpr_read_b32 v40, a18
    v_mfma_f32_16x16x32_bf16 a[128:131], v[132:135], v[224:227], a[128:131]
    v_accvgpr_read_b32 v41, a19
    v_accvgpr_read_b32 v42, a48
    v_mfma_f32_16x16x32_bf16 a[132:135], v[132:135], v[228:231], a[132:135]
    v_accvgpr_read_b32 v43, a49
    v_accvgpr_read_b32 v44, a50
    v_mfma_f32_16x16x32_bf16 a[136:139], v[132:135], v[232:235], a[136:139]
    v_accvgpr_read_b32 v45, a51
    v_cvt_pk_bf16_f32 v46, v38, v39
    v_mfma_f32_16x16x32_bf16 a[140:143], v[132:135], v[236:239], a[140:143]
    v_cvt_pk_bf16_f32 v47, v40, v41
    v_cvt_pk_bf16_f32 v48, v42, v43
    v_mfma_f32_16x16x32_bf16 a[144:147], v[132:135], v[240:243], a[144:147]
    ds_read_b128 v[144:147], v4 offset:12288
    v_cvt_pk_bf16_f32 v49, v44, v45
    v_mfma_f32_16x16x32_bf16 a[148:151], v[132:135], v[244:247], a[148:151]
    ds_read_b128 v[148:151], v5 offset:12288
    s_mov_b32 s39, 4096
    v_mfma_f32_16x16x32_bf16 a[152:155], v[132:135], v[248:251], a[152:155]
    buffer_store_dwordx4 v[46:49], v34, s[16:19], s39 offen offset:0 sc1
    v_mfma_f32_16x16x32_bf16 a[156:159], v[132:135], v[252:255], a[156:159]
    v_accvgpr_read_b32 v50, a20
    v_accvgpr_read_b32 v51, a21
    s_waitcnt lgkmcnt(2)
    v_mfma_f32_16x16x32_bf16 a[160:163], v[84:87], v[160:163], a[160:163]
    v_accvgpr_read_b32 v52, a22
    v_accvgpr_read_b32 v53, a23
    v_mfma_f32_16x16x32_bf16 a[164:167], v[84:87], v[164:167], a[164:167]
    v_accvgpr_read_b32 v54, a52
    v_accvgpr_read_b32 v55, a53
    v_mfma_f32_16x16x32_bf16 a[168:171], v[84:87], v[168:171], a[168:171]
    v_accvgpr_read_b32 v56, a54
    v_accvgpr_read_b32 v57, a55
    v_mfma_f32_16x16x32_bf16 a[172:175], v[84:87], v[172:175], a[172:175]
    v_cvt_pk_bf16_f32 v58, v50, v51
    v_cvt_pk_bf16_f32 v59, v52, v53
    v_mfma_f32_16x16x32_bf16 a[176:179], v[84:87], v[176:179], a[176:179]
    v_cvt_pk_bf16_f32 v60, v54, v55
    v_cvt_pk_bf16_f32 v61, v56, v57
    v_mfma_f32_16x16x32_bf16 a[180:183], v[84:87], v[180:183], a[180:183]
    s_mov_b32 s39, 4096
    v_mfma_f32_16x16x32_bf16 a[184:187], v[84:87], v[184:187], a[184:187]
    buffer_store_dwordx4 v[58:61], v34, s[16:19], s39 offen offset:1024 sc1
    v_mfma_f32_16x16x32_bf16 a[188:191], v[84:87], v[188:191], a[188:191]
    v_accvgpr_read_b32 v38, a24
    v_accvgpr_read_b32 v39, a25
    v_mfma_f32_16x16x32_bf16 a[188:191], v[136:139], v[220:223], a[188:191]
    v_accvgpr_read_b32 v40, a26
    v_accvgpr_read_b32 v41, a27
    v_mfma_f32_16x16x32_bf16 a[184:187], v[136:139], v[216:219], a[184:187]
    v_accvgpr_read_b32 v42, a56
    v_accvgpr_read_b32 v43, a57
    v_mfma_f32_16x16x32_bf16 a[180:183], v[136:139], v[212:215], a[180:183]
    v_accvgpr_read_b32 v44, a58
    v_accvgpr_read_b32 v45, a59
    v_mfma_f32_16x16x32_bf16 a[176:179], v[136:139], v[208:211], a[176:179]
    v_cvt_pk_bf16_f32 v46, v38, v39
    v_cvt_pk_bf16_f32 v47, v40, v41
    v_mfma_f32_16x16x32_bf16 a[172:175], v[136:139], v[204:207], a[172:175]
    v_cvt_pk_bf16_f32 v48, v42, v43
    v_cvt_pk_bf16_f32 v49, v44, v45
    v_mfma_f32_16x16x32_bf16 a[168:171], v[136:139], v[200:203], a[168:171]
    s_mov_b32 s39, 4096
    v_mfma_f32_16x16x32_bf16 a[164:167], v[136:139], v[196:199], a[164:167]
    buffer_store_dwordx4 v[46:49], v34, s[16:19], s39 offen offset:2048 sc1
    v_mfma_f32_16x16x32_bf16 a[160:163], v[136:139], v[192:195], a[160:163]
    v_accvgpr_read_b32 v50, a28
    v_accvgpr_read_b32 v51, a29
    v_mfma_f32_16x16x32_bf16 a[160:163], v[140:143], v[224:227], a[160:163]
    v_accvgpr_read_b32 v52, a30
    v_accvgpr_read_b32 v53, a31
    v_mfma_f32_16x16x32_bf16 a[164:167], v[140:143], v[228:231], a[164:167]
    v_accvgpr_read_b32 v54, a60
    v_accvgpr_read_b32 v55, a61
    v_mfma_f32_16x16x32_bf16 a[168:171], v[140:143], v[232:235], a[168:171]
    v_accvgpr_read_b32 v56, a62
    v_accvgpr_read_b32 v57, a63
    v_mfma_f32_16x16x32_bf16 a[172:175], v[140:143], v[236:239], a[172:175]
    v_cvt_pk_bf16_f32 v58, v50, v51
    v_cvt_pk_bf16_f32 v59, v52, v53
    v_mfma_f32_16x16x32_bf16 a[176:179], v[140:143], v[240:243], a[176:179]
    ds_read_b128 v[152:155], v4 offset:14336
    v_cvt_pk_bf16_f32 v60, v54, v55
    v_mfma_f32_16x16x32_bf16 a[180:183], v[140:143], v[244:247], a[180:183]
    ds_read_b128 v[156:159], v5 offset:14336
    v_cvt_pk_bf16_f32 v61, v56, v57
    v_mfma_f32_16x16x32_bf16 a[184:187], v[140:143], v[248:251], a[184:187]
    s_mov_b32 s39, 4096
    v_mfma_f32_16x16x32_bf16 a[188:191], v[140:143], v[252:255], a[188:191]
    buffer_store_dwordx4 v[58:61], v34, s[16:19], s39 offen offset:3072 sc1
    s_waitcnt lgkmcnt(2)
    s_waitcnt vmcnt(24)
    s_barrier
    v_mfma_f32_16x16x32_bf16 a[192:195], v[88:91], v[160:163], a[192:195]
    ds_read_b64_tr_b16 v[64:65], v10 offset:0
    v_accvgpr_read_b32 v38, a64
    v_mfma_f32_16x16x32_bf16 a[196:199], v[88:91], v[164:167], a[196:199]
    ds_read_b64_tr_b16 v[66:67], v10 offset:1024
    v_accvgpr_read_b32 v39, a65
    v_mfma_f32_16x16x32_bf16 a[200:203], v[88:91], v[168:171], a[200:203]
    ds_read_b64_tr_b16 v[68:69], v11 offset:0
    v_accvgpr_read_b32 v40, a66
    v_mfma_f32_16x16x32_bf16 a[204:207], v[88:91], v[172:175], a[204:207]
    ds_read_b64_tr_b16 v[70:71], v11 offset:1024
    v_accvgpr_read_b32 v41, a67
    v_mfma_f32_16x16x32_bf16 a[208:211], v[88:91], v[176:179], a[208:211]
    ds_read_b64_tr_b16 v[72:73], v12 offset:0
    v_accvgpr_read_b32 v42, a96
    v_mfma_f32_16x16x32_bf16 a[212:215], v[88:91], v[180:183], a[212:215]
    ds_read_b64_tr_b16 v[74:75], v12 offset:1024
    v_accvgpr_read_b32 v43, a97
    v_mfma_f32_16x16x32_bf16 a[216:219], v[88:91], v[184:187], a[216:219]
    ds_read_b64_tr_b16 v[76:77], v13 offset:0
    v_accvgpr_read_b32 v44, a98
    v_mfma_f32_16x16x32_bf16 a[220:223], v[88:91], v[188:191], a[220:223]
    ds_read_b64_tr_b16 v[78:79], v13 offset:1024
    v_accvgpr_read_b32 v45, a99
    v_mfma_f32_16x16x32_bf16 a[220:223], v[144:147], v[220:223], a[220:223]
    ds_read_b128 v[96:99], v6 offset:0
    v_cvt_pk_bf16_f32 v46, v38, v39
    v_mfma_f32_16x16x32_bf16 a[216:219], v[144:147], v[216:219], a[216:219]
    ds_read_b128 v[100:103], v6 offset:2048
    v_cvt_pk_bf16_f32 v47, v40, v41
    v_mfma_f32_16x16x32_bf16 a[212:215], v[144:147], v[212:215], a[212:215]
    ds_read_b128 v[104:107], v6 offset:4096
    v_cvt_pk_bf16_f32 v48, v42, v43
    v_mfma_f32_16x16x32_bf16 a[208:211], v[144:147], v[208:211], a[208:211]
    ds_read_b128 v[108:111], v6 offset:6144
    v_cvt_pk_bf16_f32 v49, v44, v45
    v_mfma_f32_16x16x32_bf16 a[204:207], v[144:147], v[204:207], a[204:207]
    ds_read_b128 v[112:115], v6 offset:8192
    s_mov_b32 s39, 16384
    v_mfma_f32_16x16x32_bf16 a[200:203], v[144:147], v[200:203], a[200:203]
    ds_read_b128 v[116:119], v6 offset:10240
    v_mfma_f32_16x16x32_bf16 a[196:199], v[144:147], v[196:199], a[196:199]
    ds_read_b128 v[120:123], v6 offset:12288
    v_mfma_f32_16x16x32_bf16 a[192:195], v[144:147], v[192:195], a[192:195]
    ds_read_b128 v[124:127], v6 offset:14336
    v_mfma_f32_16x16x32_bf16 a[192:195], v[148:151], v[224:227], a[192:195]
    buffer_store_dwordx4 v[46:49], v34, s[16:19], s39 offen offset:0 sc1
    v_mfma_f32_16x16x32_bf16 a[196:199], v[148:151], v[228:231], a[196:199]
    v_accvgpr_read_b32 v50, a68
    v_accvgpr_read_b32 v51, a69
    v_mfma_f32_16x16x32_bf16 a[200:203], v[148:151], v[232:235], a[200:203]
    v_accvgpr_read_b32 v52, a70
    v_accvgpr_read_b32 v53, a71
    v_mfma_f32_16x16x32_bf16 a[204:207], v[148:151], v[236:239], a[204:207]
    v_accvgpr_read_b32 v54, a100
    v_accvgpr_read_b32 v55, a101
    v_mfma_f32_16x16x32_bf16 a[208:211], v[148:151], v[240:243], a[208:211]
    v_accvgpr_read_b32 v56, a102
    v_accvgpr_read_b32 v57, a103
    v_mfma_f32_16x16x32_bf16 a[212:215], v[148:151], v[244:247], a[212:215]
    v_cvt_pk_bf16_f32 v58, v50, v51
    v_cvt_pk_bf16_f32 v59, v52, v53
    v_mfma_f32_16x16x32_bf16 a[216:219], v[148:151], v[248:251], a[216:219]
    v_cvt_pk_bf16_f32 v60, v54, v55
    v_cvt_pk_bf16_f32 v61, v56, v57
    v_mfma_f32_16x16x32_bf16 a[220:223], v[148:151], v[252:255], a[220:223]
    s_mov_b32 s39, 16384
    s_waitcnt lgkmcnt(2)
    v_mfma_f32_16x16x32_bf16 a[224:227], v[92:95], v[160:163], a[224:227]
    buffer_store_dwordx4 v[58:61], v34, s[16:19], s39 offen offset:1024 sc1
    v_mfma_f32_16x16x32_bf16 a[228:231], v[92:95], v[164:167], a[228:231]
    v_accvgpr_read_b32 v38, a72
    v_accvgpr_read_b32 v39, a73
    v_mfma_f32_16x16x32_bf16 a[232:235], v[92:95], v[168:171], a[232:235]
    v_accvgpr_read_b32 v40, a74
    v_accvgpr_read_b32 v41, a75
    v_mfma_f32_16x16x32_bf16 a[236:239], v[92:95], v[172:175], a[236:239]
    v_accvgpr_read_b32 v42, a104
    v_accvgpr_read_b32 v43, a105
    v_mfma_f32_16x16x32_bf16 a[240:243], v[92:95], v[176:179], a[240:243]
    v_accvgpr_read_b32 v44, a106
    v_accvgpr_read_b32 v45, a107
    v_mfma_f32_16x16x32_bf16 a[244:247], v[92:95], v[180:183], a[244:247]
    v_cvt_pk_bf16_f32 v46, v38, v39
    v_cvt_pk_bf16_f32 v47, v40, v41
    v_mfma_f32_16x16x32_bf16 a[248:251], v[92:95], v[184:187], a[248:251]
    v_cvt_pk_bf16_f32 v48, v42, v43
    v_cvt_pk_bf16_f32 v49, v44, v45
    v_mfma_f32_16x16x32_bf16 a[252:255], v[92:95], v[188:191], a[252:255]
    s_mov_b32 s39, 16384
    v_mfma_f32_16x16x32_bf16 a[252:255], v[152:155], v[220:223], a[252:255]
    buffer_store_dwordx4 v[46:49], v34, s[16:19], s39 offen offset:2048 sc1
    v_mfma_f32_16x16x32_bf16 a[248:251], v[152:155], v[216:219], a[248:251]
    v_accvgpr_read_b32 v50, a76
    v_accvgpr_read_b32 v51, a77
    v_mfma_f32_16x16x32_bf16 a[244:247], v[152:155], v[212:215], a[244:247]
    v_accvgpr_read_b32 v52, a78
    v_accvgpr_read_b32 v53, a79
    v_mfma_f32_16x16x32_bf16 a[240:243], v[152:155], v[208:211], a[240:243]
    v_accvgpr_read_b32 v54, a108
    v_accvgpr_read_b32 v55, a109
    v_mfma_f32_16x16x32_bf16 a[236:239], v[152:155], v[204:207], a[236:239]
    v_accvgpr_read_b32 v56, a110
    v_accvgpr_read_b32 v57, a111
    v_mfma_f32_16x16x32_bf16 a[232:235], v[152:155], v[200:203], a[232:235]
    v_cvt_pk_bf16_f32 v58, v50, v51
    v_cvt_pk_bf16_f32 v59, v52, v53
    v_mfma_f32_16x16x32_bf16 a[228:231], v[152:155], v[196:199], a[228:231]
    v_cvt_pk_bf16_f32 v60, v54, v55
    v_cvt_pk_bf16_f32 v61, v56, v57
    v_mfma_f32_16x16x32_bf16 a[224:227], v[152:155], v[192:195], a[224:227]
    s_mov_b32 s39, 16384
    v_mfma_f32_16x16x32_bf16 a[224:227], v[156:159], v[224:227], a[224:227]
    buffer_store_dwordx4 v[58:61], v34, s[16:19], s39 offen offset:3072 sc1
    v_mfma_f32_16x16x32_bf16 a[228:231], v[156:159], v[228:231], a[228:231]
    v_accvgpr_read_b32 v38, a80
    v_accvgpr_read_b32 v39, a81
    v_mfma_f32_16x16x32_bf16 a[232:235], v[156:159], v[232:235], a[232:235]
    v_accvgpr_read_b32 v40, a82
    v_accvgpr_read_b32 v41, a83
    v_mfma_f32_16x16x32_bf16 a[236:239], v[156:159], v[236:239], a[236:239]
    v_accvgpr_read_b32 v42, a112
    v_accvgpr_read_b32 v43, a113
    v_mfma_f32_16x16x32_bf16 a[240:243], v[156:159], v[240:243], a[240:243]
    v_accvgpr_read_b32 v44, a114
    v_accvgpr_read_b32 v45, a115
    v_mfma_f32_16x16x32_bf16 a[244:247], v[156:159], v[244:247], a[244:247]
    v_cvt_pk_bf16_f32 v46, v38, v39
    v_cvt_pk_bf16_f32 v47, v40, v41
    v_mfma_f32_16x16x32_bf16 a[248:251], v[156:159], v[248:251], a[248:251]
    v_cvt_pk_bf16_f32 v48, v42, v43
    v_cvt_pk_bf16_f32 v49, v44, v45
    v_mfma_f32_16x16x32_bf16 a[252:255], v[156:159], v[252:255], a[252:255]
    s_mov_b32 s39, 20480
    s_waitcnt lgkmcnt(4)
    s_barrier
    v_mfma_f32_16x16x32_bf16 v[128:131], v[64:67], v[96:99], 0
    buffer_store_dwordx4 v[46:49], v34, s[16:19], s39 offen offset:0 sc1
    v_mfma_f32_16x16x32_bf16 v[132:135], v[68:71], v[96:99], 0
    ds_read_b64_tr_b16 v[80:81], v10 offset:8192
    v_accvgpr_read_b32 v50, a84
    v_mfma_f32_16x16x32_bf16 v[136:139], v[72:75], v[96:99], 0
    ds_read_b64_tr_b16 v[82:83], v10 offset:9216
    v_accvgpr_read_b32 v51, a85
    v_mfma_f32_16x16x32_bf16 v[140:143], v[76:79], v[96:99], 0
    ds_read_b128 v[96:99], v7 offset:0
    s_add_u32 m0, s22, 65536
    s_mov_b32 s20, 256
    v_mfma_f32_16x16x32_bf16 v[156:159], v[76:79], v[100:103], 0
    buffer_load_dwordx4 v18, s[8:11], s20 offen sc1 lds
    v_mfma_f32_16x16x32_bf16 v[152:155], v[72:75], v[100:103], 0
    ds_read_b64_tr_b16 v[84:85], v11 offset:8192
    v_accvgpr_read_b32 v52, a86
    v_mfma_f32_16x16x32_bf16 v[148:151], v[68:71], v[100:103], 0
    ds_read_b64_tr_b16 v[86:87], v11 offset:9216
    v_accvgpr_read_b32 v53, a87
    v_mfma_f32_16x16x32_bf16 v[144:147], v[64:67], v[100:103], 0
    ds_read_b128 v[100:103], v7 offset:2048
    s_add_u32 m0, s22, 69632
    v_mfma_f32_16x16x32_bf16 v[160:163], v[64:67], v[104:107], 0
    buffer_load_dwordx4 v19, s[8:11], s20 offen sc1 lds
    v_mfma_f32_16x16x32_bf16 v[164:167], v[68:71], v[104:107], 0
    ds_read_b64_tr_b16 v[88:89], v12 offset:8192
    v_accvgpr_read_b32 v54, a116
    v_mfma_f32_16x16x32_bf16 v[168:171], v[72:75], v[104:107], 0
    ds_read_b64_tr_b16 v[90:91], v12 offset:9216
    v_accvgpr_read_b32 v55, a117
    v_mfma_f32_16x16x32_bf16 v[172:175], v[76:79], v[104:107], 0
    ds_read_b128 v[104:107], v7 offset:4096
    s_add_u32 m0, s22, 73728
    v_mfma_f32_16x16x32_bf16 v[188:191], v[76:79], v[108:111], 0
    buffer_load_dwordx4 v20, s[8:11], s20 offen sc1 lds
    v_mfma_f32_16x16x32_bf16 v[184:187], v[72:75], v[108:111], 0
    ds_read_b64_tr_b16 v[92:93], v13 offset:8192
    v_accvgpr_read_b32 v56, a118
    v_mfma_f32_16x16x32_bf16 v[180:183], v[68:71], v[108:111], 0
    ds_read_b64_tr_b16 v[94:95], v13 offset:9216
    v_accvgpr_read_b32 v57, a119
    v_mfma_f32_16x16x32_bf16 v[176:179], v[64:67], v[108:111], 0
    ds_read_b128 v[108:111], v7 offset:6144
    s_add_u32 m0, s22, 77824
    s_waitcnt lgkmcnt(12)
    v_mfma_f32_16x16x32_bf16 v[192:195], v[64:67], v[112:115], 0
    buffer_load_dwordx4 v21, s[8:11], s20 offen sc1 lds
    v_mfma_f32_16x16x32_bf16 v[196:199], v[68:71], v[112:115], 0
    v_cvt_pk_bf16_f32 v58, v50, v51
    v_cvt_pk_bf16_f32 v59, v52, v53
    v_mfma_f32_16x16x32_bf16 v[200:203], v[72:75], v[112:115], 0
    v_cvt_pk_bf16_f32 v60, v54, v55
    v_cvt_pk_bf16_f32 v61, v56, v57
    v_mfma_f32_16x16x32_bf16 v[204:207], v[76:79], v[112:115], 0
    ds_read_b128 v[112:115], v7 offset:8192
    s_add_u32 m0, s22, 81920
    v_mfma_f32_16x16x32_bf16 v[220:223], v[76:79], v[116:119], 0
    buffer_load_dwordx4 v22, s[8:11], s20 offen sc1 lds
    v_mfma_f32_16x16x32_bf16 v[216:219], v[72:75], v[116:119], 0
    s_mov_b32 s39, 20480
    v_mfma_f32_16x16x32_bf16 v[212:215], v[68:71], v[116:119], 0
    buffer_store_dwordx4 v[58:61], v34, s[16:19], s39 offen offset:1024 sc1
    v_mfma_f32_16x16x32_bf16 v[208:211], v[64:67], v[116:119], 0
    ds_read_b128 v[116:119], v7 offset:10240
    s_add_u32 m0, s22, 86016
    v_mfma_f32_16x16x32_bf16 v[224:227], v[64:67], v[120:123], 0
    buffer_load_dwordx4 v23, s[8:11], s20 offen sc1 lds
    v_mfma_f32_16x16x32_bf16 v[228:231], v[68:71], v[120:123], 0
    v_accvgpr_read_b32 v38, a88
    v_accvgpr_read_b32 v39, a89
    v_mfma_f32_16x16x32_bf16 v[232:235], v[72:75], v[120:123], 0
    v_accvgpr_read_b32 v40, a90
    v_accvgpr_read_b32 v41, a91
    v_mfma_f32_16x16x32_bf16 v[236:239], v[76:79], v[120:123], 0
    ds_read_b128 v[120:123], v7 offset:12288
    s_add_u32 m0, s22, 90112
    v_mfma_f32_16x16x32_bf16 v[252:255], v[76:79], v[124:127], 0
    buffer_load_dwordx4 v24, s[8:11], s20 offen sc1 lds
    v_mfma_f32_16x16x32_bf16 v[248:251], v[72:75], v[124:127], 0
    s_add_u32 m0, s22, 94208
    v_accvgpr_read_b32 v42, a120
    v_mfma_f32_16x16x32_bf16 v[244:247], v[68:71], v[124:127], 0
    buffer_load_dwordx4 v25, s[8:11], s20 offen sc1 lds
    v_mfma_f32_16x16x32_bf16 v[240:243], v[64:67], v[124:127], 0
    ds_read_b128 v[124:127], v7 offset:14336
    v_accvgpr_read_b32 v43, a121
    s_waitcnt lgkmcnt(0) vmcnt(24)
    s_barrier
    v_mfma_f32_16x16x32_bf16 v[128:131], v[80:83], v[96:99], v[128:131]
    v_accvgpr_read_b32 v44, a122
    v_accvgpr_read_b32 v45, a123
    v_mfma_f32_16x16x32_bf16 v[132:135], v[84:87], v[96:99], v[132:135]
    ds_read_b64_tr_b16 v[64:65], v14 offset:0
    v_cvt_pk_bf16_f32 v46, v38, v39
    v_mfma_f32_16x16x32_bf16 v[136:139], v[88:91], v[96:99], v[136:139]
    ds_read_b64_tr_b16 v[66:67], v14 offset:1024
    v_cvt_pk_bf16_f32 v47, v40, v41
    v_mfma_f32_16x16x32_bf16 v[140:143], v[92:95], v[96:99], v[140:143]
    ds_read_b128 v[96:99], v8 offset:0
    s_add_u32 m0, s22, 32768
    s_mov_b32 s21, 1572864
    v_mfma_f32_16x16x32_bf16 v[156:159], v[92:95], v[100:103], v[156:159]
    buffer_load_dwordx4 v26, s[12:15], s21 offen lds
    v_mfma_f32_16x16x32_bf16 v[152:155], v[88:91], v[100:103], v[152:155]
    ds_read_b64_tr_b16 v[68:69], v15 offset:0
    v_cvt_pk_bf16_f32 v48, v42, v43
    v_mfma_f32_16x16x32_bf16 v[148:151], v[84:87], v[100:103], v[148:151]
    ds_read_b64_tr_b16 v[70:71], v15 offset:1024
    v_cvt_pk_bf16_f32 v49, v44, v45
    v_mfma_f32_16x16x32_bf16 v[144:147], v[80:83], v[100:103], v[144:147]
    ds_read_b128 v[100:103], v8 offset:2048
    s_add_u32 m0, s22, 36864
    v_mfma_f32_16x16x32_bf16 v[160:163], v[80:83], v[104:107], v[160:163]
    buffer_load_dwordx4 v27, s[12:15], s21 offen lds
    v_mfma_f32_16x16x32_bf16 v[164:167], v[84:87], v[104:107], v[164:167]
    ds_read_b64_tr_b16 v[72:73], v16 offset:0
    s_mov_b32 s39, 20480
    v_mfma_f32_16x16x32_bf16 v[168:171], v[88:91], v[104:107], v[168:171]
    ds_read_b64_tr_b16 v[74:75], v16 offset:1024
    v_mfma_f32_16x16x32_bf16 v[172:175], v[92:95], v[104:107], v[172:175]
    ds_read_b128 v[104:107], v8 offset:4096
    s_add_u32 m0, s22, 40960
    v_mfma_f32_16x16x32_bf16 v[188:191], v[92:95], v[108:111], v[188:191]
    buffer_load_dwordx4 v28, s[12:15], s21 offen lds
    v_mfma_f32_16x16x32_bf16 v[184:187], v[88:91], v[108:111], v[184:187]
    ds_read_b64_tr_b16 v[76:77], v17 offset:0
    v_mfma_f32_16x16x32_bf16 v[180:183], v[84:87], v[108:111], v[180:183]
    ds_read_b64_tr_b16 v[78:79], v17 offset:1024
    v_mfma_f32_16x16x32_bf16 v[176:179], v[80:83], v[108:111], v[176:179]
    ds_read_b128 v[108:111], v8 offset:6144
    s_add_u32 m0, s22, 45056
    v_mfma_f32_16x16x32_bf16 v[192:195], v[80:83], v[112:115], v[192:195]
    buffer_load_dwordx4 v29, s[12:15], s21 offen lds
    v_mfma_f32_16x16x32_bf16 v[196:199], v[84:87], v[112:115], v[196:199]
    buffer_store_dwordx4 v[46:49], v34, s[16:19], s39 offen offset:2048 sc1
    v_mfma_f32_16x16x32_bf16 v[200:203], v[88:91], v[112:115], v[200:203]
    v_accvgpr_read_b32 v50, a92
    v_accvgpr_read_b32 v51, a93
    v_mfma_f32_16x16x32_bf16 v[204:207], v[92:95], v[112:115], v[204:207]
    ds_read_b128 v[112:115], v8 offset:8192
    s_add_u32 m0, s22, 0
    s_mov_b32 s20, 384
    v_mfma_f32_16x16x32_bf16 v[220:223], v[92:95], v[116:119], v[220:223]
    buffer_load_dwordx4 v18, s[8:11], s20 offen sc1 lds
    v_mfma_f32_16x16x32_bf16 v[216:219], v[88:91], v[116:119], v[216:219]
    v_accvgpr_read_b32 v52, a94
    v_accvgpr_read_b32 v53, a95
    v_mfma_f32_16x16x32_bf16 v[212:215], v[84:87], v[116:119], v[212:215]
    v_accvgpr_read_b32 v54, a124
    v_accvgpr_read_b32 v55, a125
    v_mfma_f32_16x16x32_bf16 v[208:211], v[80:83], v[116:119], v[208:211]
    ds_read_b128 v[116:119], v8 offset:10240
    s_add_u32 m0, s22, 4096
    v_mfma_f32_16x16x32_bf16 v[224:227], v[80:83], v[120:123], v[224:227]
    buffer_load_dwordx4 v19, s[8:11], s20 offen sc1 lds
    v_mfma_f32_16x16x32_bf16 v[228:231], v[84:87], v[120:123], v[228:231]
    v_accvgpr_read_b32 v56, a126
    v_accvgpr_read_b32 v57, a127
    v_mfma_f32_16x16x32_bf16 v[232:235], v[88:91], v[120:123], v[232:235]
    v_cvt_pk_bf16_f32 v58, v50, v51
    v_cvt_pk_bf16_f32 v59, v52, v53
    v_mfma_f32_16x16x32_bf16 v[236:239], v[92:95], v[120:123], v[236:239]
    ds_read_b128 v[120:123], v8 offset:12288
    v_cvt_pk_bf16_f32 v60, v54, v55
    v_mfma_f32_16x16x32_bf16 v[252:255], v[92:95], v[124:127], v[252:255]
    v_cvt_pk_bf16_f32 v61, v56, v57
    s_mov_b32 s39, 20480
    v_mfma_f32_16x16x32_bf16 v[248:251], v[88:91], v[124:127], v[248:251]
    buffer_store_dwordx4 v[58:61], v34, s[16:19], s39 offen offset:3072 sc1
    v_mfma_f32_16x16x32_bf16 v[244:247], v[84:87], v[124:127], v[244:247]
    v_accvgpr_read_b32 v38, a128
    v_accvgpr_read_b32 v39, a129
    v_mfma_f32_16x16x32_bf16 v[240:243], v[80:83], v[124:127], v[240:243]
    ds_read_b128 v[124:127], v8 offset:14336
    v_accvgpr_read_b32 v40, a130
    s_waitcnt lgkmcnt(4)
    v_mfma_f32_16x16x32_bf16 v[128:131], v[64:67], v[96:99], v[128:131]
    v_accvgpr_read_b32 v41, a131
    v_accvgpr_read_b32 v42, a160
    v_mfma_f32_16x16x32_bf16 v[132:135], v[68:71], v[96:99], v[132:135]
    ds_read_b64_tr_b16 v[80:81], v14 offset:8192
    v_accvgpr_read_b32 v43, a161
    v_mfma_f32_16x16x32_bf16 v[136:139], v[72:75], v[96:99], v[136:139]
    ds_read_b64_tr_b16 v[82:83], v14 offset:9216
    v_accvgpr_read_b32 v44, a162
    v_mfma_f32_16x16x32_bf16 v[140:143], v[76:79], v[96:99], v[140:143]
    ds_read_b128 v[96:99], v9 offset:0
    s_add_u32 m0, s22, 8192
    v_mfma_f32_16x16x32_bf16 v[156:159], v[76:79], v[100:103], v[156:159]
    buffer_load_dwordx4 v20, s[8:11], s20 offen sc1 lds
    v_mfma_f32_16x16x32_bf16 v[152:155], v[72:75], v[100:103], v[152:155]
    ds_read_b64_tr_b16 v[84:85], v15 offset:8192
    v_accvgpr_read_b32 v45, a163
    v_mfma_f32_16x16x32_bf16 v[148:151], v[68:71], v[100:103], v[148:151]
    ds_read_b64_tr_b16 v[86:87], v15 offset:9216
    v_cvt_pk_bf16_f32 v46, v38, v39
    v_mfma_f32_16x16x32_bf16 v[144:147], v[64:67], v[100:103], v[144:147]
    ds_read_b128 v[100:103], v9 offset:2048
    s_add_u32 m0, s22, 12288
    v_mfma_f32_16x16x32_bf16 v[160:163], v[64:67], v[104:107], v[160:163]
    buffer_load_dwordx4 v21, s[8:11], s20 offen sc1 lds
    v_mfma_f32_16x16x32_bf16 v[164:167], v[68:71], v[104:107], v[164:167]
    ds_read_b64_tr_b16 v[88:89], v16 offset:8192
    v_cvt_pk_bf16_f32 v47, v40, v41
    v_mfma_f32_16x16x32_bf16 v[168:171], v[72:75], v[104:107], v[168:171]
    ds_read_b64_tr_b16 v[90:91], v16 offset:9216
    v_cvt_pk_bf16_f32 v48, v42, v43
    v_mfma_f32_16x16x32_bf16 v[172:175], v[76:79], v[104:107], v[172:175]
    ds_read_b128 v[104:107], v9 offset:4096
    s_add_u32 m0, s22, 16384
    v_mfma_f32_16x16x32_bf16 v[188:191], v[76:79], v[108:111], v[188:191]
    buffer_load_dwordx4 v22, s[8:11], s20 offen sc1 lds
    v_mfma_f32_16x16x32_bf16 v[184:187], v[72:75], v[108:111], v[184:187]
    ds_read_b64_tr_b16 v[92:93], v17 offset:8192
    v_cvt_pk_bf16_f32 v49, v44, v45
    v_mfma_f32_16x16x32_bf16 v[180:183], v[68:71], v[108:111], v[180:183]
    ds_read_b64_tr_b16 v[94:95], v17 offset:9216
    s_mov_b32 s39, 32768
    v_mfma_f32_16x16x32_bf16 v[176:179], v[64:67], v[108:111], v[176:179]
    ds_read_b128 v[108:111], v9 offset:6144
    s_add_u32 m0, s22, 20480
    s_waitcnt lgkmcnt(12)
    v_mfma_f32_16x16x32_bf16 v[192:195], v[64:67], v[112:115], v[192:195]
    buffer_load_dwordx4 v23, s[8:11], s20 offen sc1 lds
    v_mfma_f32_16x16x32_bf16 v[196:199], v[68:71], v[112:115], v[196:199]
    buffer_store_dwordx4 v[46:49], v34, s[16:19], s39 offen offset:0 sc1
    v_mfma_f32_16x16x32_bf16 v[200:203], v[72:75], v[112:115], v[200:203]
    v_accvgpr_read_b32 v50, a132
    v_accvgpr_read_b32 v51, a133
    v_mfma_f32_16x16x32_bf16 v[204:207], v[76:79], v[112:115], v[204:207]
    ds_read_b128 v[112:115], v9 offset:8192
    s_add_u32 m0, s22, 24576
    v_mfma_f32_16x16x32_bf16 v[220:223], v[76:79], v[116:119], v[220:223]
    buffer_load_dwordx4 v24, s[8:11], s20 offen sc1 lds
    v_mfma_f32_16x16x32_bf16 v[216:219], v[72:75], v[116:119], v[216:219]
    v_accvgpr_read_b32 v52, a134
    v_accvgpr_read_b32 v53, a135
    v_mfma_f32_16x16x32_bf16 v[212:215], v[68:71], v[116:119], v[212:215]
    v_accvgpr_read_b32 v54, a164
    v_accvgpr_read_b32 v55, a165
    v_mfma_f32_16x16x32_bf16 v[208:211], v[64:67], v[116:119], v[208:211]
    ds_read_b128 v[116:119], v9 offset:10240
    s_add_u32 m0, s22, 28672
    v_mfma_f32_16x16x32_bf16 v[224:227], v[64:67], v[120:123], v[224:227]
    buffer_load_dwordx4 v25, s[8:11], s20 offen sc1 lds
    v_mfma_f32_16x16x32_bf16 v[228:231], v[68:71], v[120:123], v[228:231]
    v_accvgpr_read_b32 v56, a166
    v_accvgpr_read_b32 v57, a167
    v_mfma_f32_16x16x32_bf16 v[232:235], v[72:75], v[120:123], v[232:235]
    v_cvt_pk_bf16_f32 v58, v50, v51
    v_cvt_pk_bf16_f32 v59, v52, v53
    v_mfma_f32_16x16x32_bf16 v[236:239], v[76:79], v[120:123], v[236:239]
    ds_read_b128 v[120:123], v9 offset:12288
    v_cvt_pk_bf16_f32 v60, v54, v55
    v_mfma_f32_16x16x32_bf16 v[252:255], v[76:79], v[124:127], v[252:255]
    v_cvt_pk_bf16_f32 v61, v56, v57
    s_mov_b32 s39, 32768
    v_mfma_f32_16x16x32_bf16 v[248:251], v[72:75], v[124:127], v[248:251]
    buffer_store_dwordx4 v[58:61], v34, s[16:19], s39 offen offset:1024 sc1
    v_mfma_f32_16x16x32_bf16 v[244:247], v[68:71], v[124:127], v[244:247]
    v_accvgpr_read_b32 v38, a136
    v_accvgpr_read_b32 v39, a137
    v_mfma_f32_16x16x32_bf16 v[240:243], v[64:67], v[124:127], v[240:243]
    ds_read_b128 v[124:127], v9 offset:14336
    v_accvgpr_read_b32 v40, a138
    s_waitcnt lgkmcnt(0) vmcnt(16)
    s_barrier
    v_mfma_f32_16x16x32_bf16 v[128:131], v[80:83], v[96:99], v[128:131]
    v_accvgpr_read_b32 v41, a139
    v_accvgpr_read_b32 v42, a168
    v_mfma_f32_16x16x32_bf16 v[132:135], v[84:87], v[96:99], v[132:135]
    ds_read_b64_tr_b16 v[64:65], v10 offset:16384
    v_accvgpr_read_b32 v43, a169
    v_mfma_f32_16x16x32_bf16 v[136:139], v[88:91], v[96:99], v[136:139]
    ds_read_b64_tr_b16 v[66:67], v10 offset:17408
    v_accvgpr_read_b32 v44, a170
    v_mfma_f32_16x16x32_bf16 v[140:143], v[92:95], v[96:99], v[140:143]
    ds_read_b128 v[96:99], v4 offset:0
    s_add_u32 m0, s22, 98304
    s_mov_b32 s21, 2097152
    v_mfma_f32_16x16x32_bf16 v[156:159], v[92:95], v[100:103], v[156:159]
    buffer_load_dwordx4 v26, s[12:15], s21 offen lds
    v_mfma_f32_16x16x32_bf16 v[152:155], v[88:91], v[100:103], v[152:155]
    ds_read_b64_tr_b16 v[68:69], v11 offset:16384
    v_accvgpr_read_b32 v45, a171
    v_mfma_f32_16x16x32_bf16 v[148:151], v[84:87], v[100:103], v[148:151]
    ds_read_b64_tr_b16 v[70:71], v11 offset:17408
    v_cvt_pk_bf16_f32 v46, v38, v39
    v_mfma_f32_16x16x32_bf16 v[144:147], v[80:83], v[100:103], v[144:147]
    ds_read_b128 v[100:103], v4 offset:2048
    s_add_u32 m0, s22, 102400
    v_mfma_f32_16x16x32_bf16 v[160:163], v[80:83], v[104:107], v[160:163]
    buffer_load_dwordx4 v27, s[12:15], s21 offen lds
    v_mfma_f32_16x16x32_bf16 v[164:167], v[84:87], v[104:107], v[164:167]
    ds_read_b64_tr_b16 v[72:73], v12 offset:16384
    v_cvt_pk_bf16_f32 v47, v40, v41
    v_mfma_f32_16x16x32_bf16 v[168:171], v[88:91], v[104:107], v[168:171]
    ds_read_b64_tr_b16 v[74:75], v12 offset:17408
    v_cvt_pk_bf16_f32 v48, v42, v43
    v_mfma_f32_16x16x32_bf16 v[172:175], v[92:95], v[104:107], v[172:175]
    ds_read_b128 v[104:107], v4 offset:4096
    s_add_u32 m0, s22, 106496
    v_mfma_f32_16x16x32_bf16 v[188:191], v[92:95], v[108:111], v[188:191]
    buffer_load_dwordx4 v28, s[12:15], s21 offen lds
    v_mfma_f32_16x16x32_bf16 v[184:187], v[88:91], v[108:111], v[184:187]
    ds_read_b64_tr_b16 v[76:77], v13 offset:16384
    v_cvt_pk_bf16_f32 v49, v44, v45
    v_mfma_f32_16x16x32_bf16 v[180:183], v[84:87], v[108:111], v[180:183]
    ds_read_b64_tr_b16 v[78:79], v13 offset:17408
    s_mov_b32 s39, 32768
    v_mfma_f32_16x16x32_bf16 v[176:179], v[80:83], v[108:111], v[176:179]
    ds_read_b128 v[108:111], v4 offset:6144
    s_add_u32 m0, s22, 110592
    v_mfma_f32_16x16x32_bf16 v[192:195], v[80:83], v[112:115], v[192:195]
    buffer_load_dwordx4 v29, s[12:15], s21 offen lds
    v_mfma_f32_16x16x32_bf16 v[196:199], v[84:87], v[112:115], v[196:199]
    buffer_store_dwordx4 v[46:49], v34, s[16:19], s39 offen offset:2048 sc1
    v_mfma_f32_16x16x32_bf16 v[200:203], v[88:91], v[112:115], v[200:203]
    v_accvgpr_read_b32 v50, a140
    v_accvgpr_read_b32 v51, a141
    v_mfma_f32_16x16x32_bf16 v[204:207], v[92:95], v[112:115], v[204:207]
    ds_read_b128 v[112:115], v4 offset:8192
    s_add_u32 m0, s22, 131072
    s_mov_b32 s20, 512
    v_mfma_f32_16x16x32_bf16 v[220:223], v[92:95], v[116:119], v[220:223]
    buffer_load_dwordx4 v18, s[8:11], s20 offen sc1 lds
    v_mfma_f32_16x16x32_bf16 v[216:219], v[88:91], v[116:119], v[216:219]
    v_accvgpr_read_b32 v52, a142
    v_accvgpr_read_b32 v53, a143
    v_mfma_f32_16x16x32_bf16 v[212:215], v[84:87], v[116:119], v[212:215]
    v_accvgpr_read_b32 v54, a172
    v_accvgpr_read_b32 v55, a173
    v_mfma_f32_16x16x32_bf16 v[208:211], v[80:83], v[116:119], v[208:211]
    ds_read_b128 v[116:119], v4 offset:10240
    s_add_u32 m0, s22, 135168
    v_mfma_f32_16x16x32_bf16 v[224:227], v[80:83], v[120:123], v[224:227]
    buffer_load_dwordx4 v19, s[8:11], s20 offen sc1 lds
    v_mfma_f32_16x16x32_bf16 v[228:231], v[84:87], v[120:123], v[228:231]
    v_accvgpr_read_b32 v56, a174
    v_accvgpr_read_b32 v57, a175
    v_mfma_f32_16x16x32_bf16 v[232:235], v[88:91], v[120:123], v[232:235]
    v_cvt_pk_bf16_f32 v58, v50, v51
    v_cvt_pk_bf16_f32 v59, v52, v53
    v_mfma_f32_16x16x32_bf16 v[236:239], v[92:95], v[120:123], v[236:239]
    ds_read_b128 v[120:123], v4 offset:12288
    v_cvt_pk_bf16_f32 v60, v54, v55
    v_mfma_f32_16x16x32_bf16 v[252:255], v[92:95], v[124:127], v[252:255]
    v_cvt_pk_bf16_f32 v61, v56, v57
    s_mov_b32 s39, 32768
    v_mfma_f32_16x16x32_bf16 v[248:251], v[88:91], v[124:127], v[248:251]
    buffer_store_dwordx4 v[58:61], v34, s[16:19], s39 offen offset:3072 sc1
    v_mfma_f32_16x16x32_bf16 v[244:247], v[84:87], v[124:127], v[244:247]
    v_accvgpr_read_b32 v38, a144
    v_accvgpr_read_b32 v39, a145
    v_mfma_f32_16x16x32_bf16 v[240:243], v[80:83], v[124:127], v[240:243]
    ds_read_b128 v[124:127], v4 offset:14336
    v_accvgpr_read_b32 v40, a146
    s_waitcnt lgkmcnt(4)
    v_mfma_f32_16x16x32_bf16 v[128:131], v[64:67], v[96:99], v[128:131]
    v_accvgpr_read_b32 v41, a147
    v_accvgpr_read_b32 v42, a176
    v_mfma_f32_16x16x32_bf16 v[132:135], v[68:71], v[96:99], v[132:135]
    ds_read_b64_tr_b16 v[80:81], v10 offset:24576
    v_accvgpr_read_b32 v43, a177
    v_mfma_f32_16x16x32_bf16 v[136:139], v[72:75], v[96:99], v[136:139]
    ds_read_b64_tr_b16 v[82:83], v10 offset:25600
    v_accvgpr_read_b32 v44, a178
    v_mfma_f32_16x16x32_bf16 v[140:143], v[76:79], v[96:99], v[140:143]
    ds_read_b128 v[96:99], v5 offset:0
    s_add_u32 m0, s22, 139264
    v_mfma_f32_16x16x32_bf16 v[156:159], v[76:79], v[100:103], v[156:159]
    buffer_load_dwordx4 v20, s[8:11], s20 offen sc1 lds
    v_mfma_f32_16x16x32_bf16 v[152:155], v[72:75], v[100:103], v[152:155]
    ds_read_b64_tr_b16 v[84:85], v11 offset:24576
    v_accvgpr_read_b32 v45, a179
    v_mfma_f32_16x16x32_bf16 v[148:151], v[68:71], v[100:103], v[148:151]
    ds_read_b64_tr_b16 v[86:87], v11 offset:25600
    v_cvt_pk_bf16_f32 v46, v38, v39
    v_mfma_f32_16x16x32_bf16 v[144:147], v[64:67], v[100:103], v[144:147]
    ds_read_b128 v[100:103], v5 offset:2048
    s_add_u32 m0, s22, 143360
    v_mfma_f32_16x16x32_bf16 v[160:163], v[64:67], v[104:107], v[160:163]
    buffer_load_dwordx4 v21, s[8:11], s20 offen sc1 lds
    v_mfma_f32_16x16x32_bf16 v[164:167], v[68:71], v[104:107], v[164:167]
    ds_read_b64_tr_b16 v[88:89], v12 offset:24576
    v_cvt_pk_bf16_f32 v47, v40, v41
    v_mfma_f32_16x16x32_bf16 v[168:171], v[72:75], v[104:107], v[168:171]
    ds_read_b64_tr_b16 v[90:91], v12 offset:25600
    v_cvt_pk_bf16_f32 v48, v42, v43
    v_mfma_f32_16x16x32_bf16 v[172:175], v[76:79], v[104:107], v[172:175]
    ds_read_b128 v[104:107], v5 offset:4096
    s_add_u32 m0, s22, 147456
    v_mfma_f32_16x16x32_bf16 v[188:191], v[76:79], v[108:111], v[188:191]
    buffer_load_dwordx4 v22, s[8:11], s20 offen sc1 lds
    v_mfma_f32_16x16x32_bf16 v[184:187], v[72:75], v[108:111], v[184:187]
    ds_read_b64_tr_b16 v[92:93], v13 offset:24576
    v_cvt_pk_bf16_f32 v49, v44, v45
    v_mfma_f32_16x16x32_bf16 v[180:183], v[68:71], v[108:111], v[180:183]
    ds_read_b64_tr_b16 v[94:95], v13 offset:25600
    s_mov_b32 s39, 36864
    v_mfma_f32_16x16x32_bf16 v[176:179], v[64:67], v[108:111], v[176:179]
    ds_read_b128 v[108:111], v5 offset:6144
    s_add_u32 m0, s22, 151552
    s_waitcnt lgkmcnt(12)
    v_mfma_f32_16x16x32_bf16 v[192:195], v[64:67], v[112:115], v[192:195]
    buffer_load_dwordx4 v23, s[8:11], s20 offen sc1 lds
    v_mfma_f32_16x16x32_bf16 v[196:199], v[68:71], v[112:115], v[196:199]
    buffer_store_dwordx4 v[46:49], v34, s[16:19], s39 offen offset:0 sc1
    v_mfma_f32_16x16x32_bf16 v[200:203], v[72:75], v[112:115], v[200:203]
    v_accvgpr_read_b32 v50, a148
    v_accvgpr_read_b32 v51, a149
    v_mfma_f32_16x16x32_bf16 v[204:207], v[76:79], v[112:115], v[204:207]
    ds_read_b128 v[112:115], v5 offset:8192
    s_add_u32 m0, s22, 155648
    v_mfma_f32_16x16x32_bf16 v[220:223], v[76:79], v[116:119], v[220:223]
    buffer_load_dwordx4 v24, s[8:11], s20 offen sc1 lds
    v_mfma_f32_16x16x32_bf16 v[216:219], v[72:75], v[116:119], v[216:219]
    v_accvgpr_read_b32 v52, a150
    v_accvgpr_read_b32 v53, a151
    v_mfma_f32_16x16x32_bf16 v[212:215], v[68:71], v[116:119], v[212:215]
    v_accvgpr_read_b32 v54, a180
    v_accvgpr_read_b32 v55, a181
    v_mfma_f32_16x16x32_bf16 v[208:211], v[64:67], v[116:119], v[208:211]
    ds_read_b128 v[116:119], v5 offset:10240
    s_add_u32 m0, s22, 159744
    v_mfma_f32_16x16x32_bf16 v[224:227], v[64:67], v[120:123], v[224:227]
    buffer_load_dwordx4 v25, s[8:11], s20 offen sc1 lds
    v_mfma_f32_16x16x32_bf16 v[228:231], v[68:71], v[120:123], v[228:231]
    v_accvgpr_read_b32 v56, a182
    v_accvgpr_read_b32 v57, a183
    v_mfma_f32_16x16x32_bf16 v[232:235], v[72:75], v[120:123], v[232:235]
    v_cvt_pk_bf16_f32 v58, v50, v51
    v_cvt_pk_bf16_f32 v59, v52, v53
    v_mfma_f32_16x16x32_bf16 v[236:239], v[76:79], v[120:123], v[236:239]
    ds_read_b128 v[120:123], v5 offset:12288
    v_cvt_pk_bf16_f32 v60, v54, v55
    v_mfma_f32_16x16x32_bf16 v[252:255], v[76:79], v[124:127], v[252:255]
    v_cvt_pk_bf16_f32 v61, v56, v57
    s_mov_b32 s39, 36864
    v_mfma_f32_16x16x32_bf16 v[248:251], v[72:75], v[124:127], v[248:251]
    buffer_store_dwordx4 v[58:61], v34, s[16:19], s39 offen offset:1024 sc1
    v_mfma_f32_16x16x32_bf16 v[244:247], v[68:71], v[124:127], v[244:247]
    v_accvgpr_read_b32 v38, a152
    v_accvgpr_read_b32 v39, a153
    v_mfma_f32_16x16x32_bf16 v[240:243], v[64:67], v[124:127], v[240:243]
    ds_read_b128 v[124:127], v5 offset:14336
    v_accvgpr_read_b32 v40, a154
    s_waitcnt lgkmcnt(0) vmcnt(17)
    s_barrier
    v_mfma_f32_16x16x32_bf16 v[128:131], v[80:83], v[96:99], v[128:131]
    v_accvgpr_read_b32 v41, a155
    v_accvgpr_read_b32 v42, a184
    v_mfma_f32_16x16x32_bf16 v[132:135], v[84:87], v[96:99], v[132:135]
    ds_read_b64_tr_b16 v[64:65], v10 offset:0
    v_accvgpr_read_b32 v43, a185
    v_mfma_f32_16x16x32_bf16 v[136:139], v[88:91], v[96:99], v[136:139]
    ds_read_b64_tr_b16 v[66:67], v10 offset:1024
    v_accvgpr_read_b32 v44, a186
    v_mfma_f32_16x16x32_bf16 v[140:143], v[92:95], v[96:99], v[140:143]
    ds_read_b128 v[96:99], v6 offset:0
    s_add_u32 m0, s22, 49152
    s_mov_b32 s21, 2621440
    v_mfma_f32_16x16x32_bf16 v[156:159], v[92:95], v[100:103], v[156:159]
    buffer_load_dwordx4 v26, s[12:15], s21 offen lds
    v_mfma_f32_16x16x32_bf16 v[152:155], v[88:91], v[100:103], v[152:155]
    ds_read_b64_tr_b16 v[68:69], v11 offset:0
    v_accvgpr_read_b32 v45, a187
    v_mfma_f32_16x16x32_bf16 v[148:151], v[84:87], v[100:103], v[148:151]
    ds_read_b64_tr_b16 v[70:71], v11 offset:1024
    v_cvt_pk_bf16_f32 v46, v38, v39
    v_mfma_f32_16x16x32_bf16 v[144:147], v[80:83], v[100:103], v[144:147]
    ds_read_b128 v[100:103], v6 offset:2048
    s_add_u32 m0, s22, 53248
    v_mfma_f32_16x16x32_bf16 v[160:163], v[80:83], v[104:107], v[160:163]
    buffer_load_dwordx4 v27, s[12:15], s21 offen lds
    v_mfma_f32_16x16x32_bf16 v[164:167], v[84:87], v[104:107], v[164:167]
    ds_read_b64_tr_b16 v[72:73], v12 offset:0
    v_cvt_pk_bf16_f32 v47, v40, v41
    v_mfma_f32_16x16x32_bf16 v[168:171], v[88:91], v[104:107], v[168:171]
    ds_read_b64_tr_b16 v[74:75], v12 offset:1024
    v_cvt_pk_bf16_f32 v48, v42, v43
    v_mfma_f32_16x16x32_bf16 v[172:175], v[92:95], v[104:107], v[172:175]
    ds_read_b128 v[104:107], v6 offset:4096
    s_add_u32 m0, s22, 57344
    v_mfma_f32_16x16x32_bf16 v[188:191], v[92:95], v[108:111], v[188:191]
    buffer_load_dwordx4 v28, s[12:15], s21 offen lds
    v_mfma_f32_16x16x32_bf16 v[184:187], v[88:91], v[108:111], v[184:187]
    ds_read_b64_tr_b16 v[76:77], v13 offset:0
    v_cvt_pk_bf16_f32 v49, v44, v45
    v_mfma_f32_16x16x32_bf16 v[180:183], v[84:87], v[108:111], v[180:183]
    ds_read_b64_tr_b16 v[78:79], v13 offset:1024
    s_mov_b32 s39, 36864
    v_mfma_f32_16x16x32_bf16 v[176:179], v[80:83], v[108:111], v[176:179]
    ds_read_b128 v[108:111], v6 offset:6144
    s_add_u32 m0, s22, 61440
    v_mfma_f32_16x16x32_bf16 v[192:195], v[80:83], v[112:115], v[192:195]
    buffer_load_dwordx4 v29, s[12:15], s21 offen lds
    v_mfma_f32_16x16x32_bf16 v[196:199], v[84:87], v[112:115], v[196:199]
    buffer_store_dwordx4 v[46:49], v34, s[16:19], s39 offen offset:2048 sc1
    v_mfma_f32_16x16x32_bf16 v[200:203], v[88:91], v[112:115], v[200:203]
    v_accvgpr_read_b32 v50, a156
    v_accvgpr_read_b32 v51, a157
    v_mfma_f32_16x16x32_bf16 v[204:207], v[92:95], v[112:115], v[204:207]
    ds_read_b128 v[112:115], v6 offset:8192
    s_add_u32 m0, s22, 65536
    s_mov_b32 s20, 640
    v_mfma_f32_16x16x32_bf16 v[220:223], v[92:95], v[116:119], v[220:223]
    buffer_load_dwordx4 v18, s[8:11], s20 offen sc1 lds
    v_mfma_f32_16x16x32_bf16 v[216:219], v[88:91], v[116:119], v[216:219]
    v_accvgpr_read_b32 v52, a158
    v_accvgpr_read_b32 v53, a159
    v_mfma_f32_16x16x32_bf16 v[212:215], v[84:87], v[116:119], v[212:215]
    v_accvgpr_read_b32 v54, a188
    v_accvgpr_read_b32 v55, a189
    v_mfma_f32_16x16x32_bf16 v[208:211], v[80:83], v[116:119], v[208:211]
    ds_read_b128 v[116:119], v6 offset:10240
    s_add_u32 m0, s22, 69632
    v_mfma_f32_16x16x32_bf16 v[224:227], v[80:83], v[120:123], v[224:227]
    buffer_load_dwordx4 v19, s[8:11], s20 offen sc1 lds
    v_mfma_f32_16x16x32_bf16 v[228:231], v[84:87], v[120:123], v[228:231]
    v_accvgpr_read_b32 v56, a190
    v_accvgpr_read_b32 v57, a191
    v_mfma_f32_16x16x32_bf16 v[232:235], v[88:91], v[120:123], v[232:235]
    v_cvt_pk_bf16_f32 v58, v50, v51
    v_cvt_pk_bf16_f32 v59, v52, v53
    v_mfma_f32_16x16x32_bf16 v[236:239], v[92:95], v[120:123], v[236:239]
    ds_read_b128 v[120:123], v6 offset:12288
    v_cvt_pk_bf16_f32 v60, v54, v55
    v_mfma_f32_16x16x32_bf16 v[252:255], v[92:95], v[124:127], v[252:255]
    v_cvt_pk_bf16_f32 v61, v56, v57
    s_mov_b32 s39, 36864
    v_mfma_f32_16x16x32_bf16 v[248:251], v[88:91], v[124:127], v[248:251]
    buffer_store_dwordx4 v[58:61], v34, s[16:19], s39 offen offset:3072 sc1
    v_mfma_f32_16x16x32_bf16 v[244:247], v[84:87], v[124:127], v[244:247]
    v_accvgpr_read_b32 v38, a192
    v_accvgpr_read_b32 v39, a193
    v_mfma_f32_16x16x32_bf16 v[240:243], v[80:83], v[124:127], v[240:243]
    ds_read_b128 v[124:127], v6 offset:14336
    v_accvgpr_read_b32 v40, a194
    s_waitcnt lgkmcnt(4)
    v_mfma_f32_16x16x32_bf16 v[128:131], v[64:67], v[96:99], v[128:131]
    v_accvgpr_read_b32 v41, a195
    v_accvgpr_read_b32 v42, a224
    v_mfma_f32_16x16x32_bf16 v[132:135], v[68:71], v[96:99], v[132:135]
    ds_read_b64_tr_b16 v[80:81], v10 offset:8192
    v_accvgpr_read_b32 v43, a225
    v_mfma_f32_16x16x32_bf16 v[136:139], v[72:75], v[96:99], v[136:139]
    ds_read_b64_tr_b16 v[82:83], v10 offset:9216
    v_accvgpr_read_b32 v44, a226
    v_mfma_f32_16x16x32_bf16 v[140:143], v[76:79], v[96:99], v[140:143]
    ds_read_b128 v[96:99], v7 offset:0
    s_add_u32 m0, s22, 73728
    v_mfma_f32_16x16x32_bf16 v[156:159], v[76:79], v[100:103], v[156:159]
    buffer_load_dwordx4 v20, s[8:11], s20 offen sc1 lds
    v_mfma_f32_16x16x32_bf16 v[152:155], v[72:75], v[100:103], v[152:155]
    ds_read_b64_tr_b16 v[84:85], v11 offset:8192
    v_accvgpr_read_b32 v45, a227
    v_mfma_f32_16x16x32_bf16 v[148:151], v[68:71], v[100:103], v[148:151]
    ds_read_b64_tr_b16 v[86:87], v11 offset:9216
    v_cvt_pk_bf16_f32 v46, v38, v39
    v_mfma_f32_16x16x32_bf16 v[144:147], v[64:67], v[100:103], v[144:147]
    ds_read_b128 v[100:103], v7 offset:2048
    s_add_u32 m0, s22, 77824
    v_mfma_f32_16x16x32_bf16 v[160:163], v[64:67], v[104:107], v[160:163]
    buffer_load_dwordx4 v21, s[8:11], s20 offen sc1 lds
    v_mfma_f32_16x16x32_bf16 v[164:167], v[68:71], v[104:107], v[164:167]
    ds_read_b64_tr_b16 v[88:89], v12 offset:8192
    v_cvt_pk_bf16_f32 v47, v40, v41
    v_mfma_f32_16x16x32_bf16 v[168:171], v[72:75], v[104:107], v[168:171]
    ds_read_b64_tr_b16 v[90:91], v12 offset:9216
    v_cvt_pk_bf16_f32 v48, v42, v43
    v_mfma_f32_16x16x32_bf16 v[172:175], v[76:79], v[104:107], v[172:175]
    ds_read_b128 v[104:107], v7 offset:4096
    s_add_u32 m0, s22, 81920
    v_mfma_f32_16x16x32_bf16 v[188:191], v[76:79], v[108:111], v[188:191]
    buffer_load_dwordx4 v22, s[8:11], s20 offen sc1 lds
    v_mfma_f32_16x16x32_bf16 v[184:187], v[72:75], v[108:111], v[184:187]
    ds_read_b64_tr_b16 v[92:93], v13 offset:8192
    v_cvt_pk_bf16_f32 v49, v44, v45
    v_mfma_f32_16x16x32_bf16 v[180:183], v[68:71], v[108:111], v[180:183]
    ds_read_b64_tr_b16 v[94:95], v13 offset:9216
    s_mov_b32 s39, 49152
    v_mfma_f32_16x16x32_bf16 v[176:179], v[64:67], v[108:111], v[176:179]
    ds_read_b128 v[108:111], v7 offset:6144
    s_add_u32 m0, s22, 86016
    s_waitcnt lgkmcnt(12)
    v_mfma_f32_16x16x32_bf16 v[192:195], v[64:67], v[112:115], v[192:195]
    buffer_load_dwordx4 v23, s[8:11], s20 offen sc1 lds
    v_mfma_f32_16x16x32_bf16 v[196:199], v[68:71], v[112:115], v[196:199]
    buffer_store_dwordx4 v[46:49], v34, s[16:19], s39 offen offset:0 sc1
    v_mfma_f32_16x16x32_bf16 v[200:203], v[72:75], v[112:115], v[200:203]
    v_accvgpr_read_b32 v50, a196
    v_accvgpr_read_b32 v51, a197
    v_mfma_f32_16x16x32_bf16 v[204:207], v[76:79], v[112:115], v[204:207]
    ds_read_b128 v[112:115], v7 offset:8192
    s_add_u32 m0, s22, 90112
    v_mfma_f32_16x16x32_bf16 v[220:223], v[76:79], v[116:119], v[220:223]
    buffer_load_dwordx4 v24, s[8:11], s20 offen sc1 lds
    v_mfma_f32_16x16x32_bf16 v[216:219], v[72:75], v[116:119], v[216:219]
    v_accvgpr_read_b32 v52, a198
    v_accvgpr_read_b32 v53, a199
    v_mfma_f32_16x16x32_bf16 v[212:215], v[68:71], v[116:119], v[212:215]
    v_accvgpr_read_b32 v54, a228
    v_accvgpr_read_b32 v55, a229
    v_mfma_f32_16x16x32_bf16 v[208:211], v[64:67], v[116:119], v[208:211]
    ds_read_b128 v[116:119], v7 offset:10240
    s_add_u32 m0, s22, 94208
    v_mfma_f32_16x16x32_bf16 v[224:227], v[64:67], v[120:123], v[224:227]
    buffer_load_dwordx4 v25, s[8:11], s20 offen sc1 lds
    v_mfma_f32_16x16x32_bf16 v[228:231], v[68:71], v[120:123], v[228:231]
    v_accvgpr_read_b32 v56, a230
    v_accvgpr_read_b32 v57, a231
    v_mfma_f32_16x16x32_bf16 v[232:235], v[72:75], v[120:123], v[232:235]
    v_cvt_pk_bf16_f32 v58, v50, v51
    v_cvt_pk_bf16_f32 v59, v52, v53
    v_mfma_f32_16x16x32_bf16 v[236:239], v[76:79], v[120:123], v[236:239]
    ds_read_b128 v[120:123], v7 offset:12288
    v_cvt_pk_bf16_f32 v60, v54, v55
    v_mfma_f32_16x16x32_bf16 v[252:255], v[76:79], v[124:127], v[252:255]
    v_cvt_pk_bf16_f32 v61, v56, v57
    s_mov_b32 s39, 49152
    v_mfma_f32_16x16x32_bf16 v[248:251], v[72:75], v[124:127], v[248:251]
    buffer_store_dwordx4 v[58:61], v34, s[16:19], s39 offen offset:1024 sc1
    v_mfma_f32_16x16x32_bf16 v[244:247], v[68:71], v[124:127], v[244:247]
    v_accvgpr_read_b32 v38, a200
    v_accvgpr_read_b32 v39, a201
    v_mfma_f32_16x16x32_bf16 v[240:243], v[64:67], v[124:127], v[240:243]
    ds_read_b128 v[124:127], v7 offset:14336
    v_accvgpr_read_b32 v40, a202
    s_waitcnt lgkmcnt(0) vmcnt(17)
    s_barrier
    v_mfma_f32_16x16x32_bf16 v[128:131], v[80:83], v[96:99], v[128:131]
    v_accvgpr_read_b32 v41, a203
    v_accvgpr_read_b32 v42, a232
    v_mfma_f32_16x16x32_bf16 v[132:135], v[84:87], v[96:99], v[132:135]
    ds_read_b64_tr_b16 v[64:65], v14 offset:0
    v_accvgpr_read_b32 v43, a233
    v_mfma_f32_16x16x32_bf16 v[136:139], v[88:91], v[96:99], v[136:139]
    ds_read_b64_tr_b16 v[66:67], v14 offset:1024
    v_accvgpr_read_b32 v44, a234
    v_mfma_f32_16x16x32_bf16 v[140:143], v[92:95], v[96:99], v[140:143]
    ds_read_b128 v[96:99], v8 offset:0
    s_add_u32 m0, s22, 32768
    s_mov_b32 s21, 3145728
    v_mfma_f32_16x16x32_bf16 v[156:159], v[92:95], v[100:103], v[156:159]
    buffer_load_dwordx4 v26, s[12:15], s21 offen lds
    v_mfma_f32_16x16x32_bf16 v[152:155], v[88:91], v[100:103], v[152:155]
    ds_read_b64_tr_b16 v[68:69], v15 offset:0
    v_accvgpr_read_b32 v45, a235
    v_mfma_f32_16x16x32_bf16 v[148:151], v[84:87], v[100:103], v[148:151]
    ds_read_b64_tr_b16 v[70:71], v15 offset:1024
    v_cvt_pk_bf16_f32 v46, v38, v39
    v_mfma_f32_16x16x32_bf16 v[144:147], v[80:83], v[100:103], v[144:147]
    ds_read_b128 v[100:103], v8 offset:2048
    s_add_u32 m0, s22, 36864
    v_mfma_f32_16x16x32_bf16 v[160:163], v[80:83], v[104:107], v[160:163]
    buffer_load_dwordx4 v27, s[12:15], s21 offen lds
    v_mfma_f32_16x16x32_bf16 v[164:167], v[84:87], v[104:107], v[164:167]
    ds_read_b64_tr_b16 v[72:73], v16 offset:0
    v_cvt_pk_bf16_f32 v47, v40, v41
    v_mfma_f32_16x16x32_bf16 v[168:171], v[88:91], v[104:107], v[168:171]
    ds_read_b64_tr_b16 v[74:75], v16 offset:1024
    v_cvt_pk_bf16_f32 v48, v42, v43
    v_mfma_f32_16x16x32_bf16 v[172:175], v[92:95], v[104:107], v[172:175]
    ds_read_b128 v[104:107], v8 offset:4096
    s_add_u32 m0, s22, 40960
    v_mfma_f32_16x16x32_bf16 v[188:191], v[92:95], v[108:111], v[188:191]
    buffer_load_dwordx4 v28, s[12:15], s21 offen lds
    v_mfma_f32_16x16x32_bf16 v[184:187], v[88:91], v[108:111], v[184:187]
    ds_read_b64_tr_b16 v[76:77], v17 offset:0
    v_cvt_pk_bf16_f32 v49, v44, v45
    v_mfma_f32_16x16x32_bf16 v[180:183], v[84:87], v[108:111], v[180:183]
    ds_read_b64_tr_b16 v[78:79], v17 offset:1024
    s_mov_b32 s39, 49152
    v_mfma_f32_16x16x32_bf16 v[176:179], v[80:83], v[108:111], v[176:179]
    ds_read_b128 v[108:111], v8 offset:6144
    s_add_u32 m0, s22, 45056
    v_mfma_f32_16x16x32_bf16 v[192:195], v[80:83], v[112:115], v[192:195]
    buffer_load_dwordx4 v29, s[12:15], s21 offen lds
    v_mfma_f32_16x16x32_bf16 v[196:199], v[84:87], v[112:115], v[196:199]
    buffer_store_dwordx4 v[46:49], v34, s[16:19], s39 offen offset:2048 sc1
    v_mfma_f32_16x16x32_bf16 v[200:203], v[88:91], v[112:115], v[200:203]
    v_accvgpr_read_b32 v50, a204
    v_accvgpr_read_b32 v51, a205
    v_mfma_f32_16x16x32_bf16 v[204:207], v[92:95], v[112:115], v[204:207]
    ds_read_b128 v[112:115], v8 offset:8192
    s_add_u32 m0, s22, 0
    s_mov_b32 s20, 768
    v_mfma_f32_16x16x32_bf16 v[220:223], v[92:95], v[116:119], v[220:223]
    buffer_load_dwordx4 v18, s[8:11], s20 offen sc1 lds
    v_mfma_f32_16x16x32_bf16 v[216:219], v[88:91], v[116:119], v[216:219]
    v_accvgpr_read_b32 v52, a206
    v_accvgpr_read_b32 v53, a207
    v_mfma_f32_16x16x32_bf16 v[212:215], v[84:87], v[116:119], v[212:215]
    v_accvgpr_read_b32 v54, a236
    v_accvgpr_read_b32 v55, a237
    v_mfma_f32_16x16x32_bf16 v[208:211], v[80:83], v[116:119], v[208:211]
    ds_read_b128 v[116:119], v8 offset:10240
    s_add_u32 m0, s22, 4096
    v_mfma_f32_16x16x32_bf16 v[224:227], v[80:83], v[120:123], v[224:227]
    buffer_load_dwordx4 v19, s[8:11], s20 offen sc1 lds
    v_mfma_f32_16x16x32_bf16 v[228:231], v[84:87], v[120:123], v[228:231]
    v_accvgpr_read_b32 v56, a238
    v_accvgpr_read_b32 v57, a239
    v_mfma_f32_16x16x32_bf16 v[232:235], v[88:91], v[120:123], v[232:235]
    v_cvt_pk_bf16_f32 v58, v50, v51
    v_cvt_pk_bf16_f32 v59, v52, v53
    v_mfma_f32_16x16x32_bf16 v[236:239], v[92:95], v[120:123], v[236:239]
    ds_read_b128 v[120:123], v8 offset:12288
    v_cvt_pk_bf16_f32 v60, v54, v55
    v_mfma_f32_16x16x32_bf16 v[252:255], v[92:95], v[124:127], v[252:255]
    v_cvt_pk_bf16_f32 v61, v56, v57
    s_mov_b32 s39, 49152
    v_mfma_f32_16x16x32_bf16 v[248:251], v[88:91], v[124:127], v[248:251]
    buffer_store_dwordx4 v[58:61], v34, s[16:19], s39 offen offset:3072 sc1
    v_mfma_f32_16x16x32_bf16 v[244:247], v[84:87], v[124:127], v[244:247]
    v_accvgpr_read_b32 v38, a208
    v_accvgpr_read_b32 v39, a209
    v_mfma_f32_16x16x32_bf16 v[240:243], v[80:83], v[124:127], v[240:243]
    ds_read_b128 v[124:127], v8 offset:14336
    v_accvgpr_read_b32 v40, a210
    s_waitcnt lgkmcnt(4)
    v_mfma_f32_16x16x32_bf16 v[128:131], v[64:67], v[96:99], v[128:131]
    v_accvgpr_read_b32 v41, a211
    v_accvgpr_read_b32 v42, a240
    v_mfma_f32_16x16x32_bf16 v[132:135], v[68:71], v[96:99], v[132:135]
    ds_read_b64_tr_b16 v[80:81], v14 offset:8192
    v_accvgpr_read_b32 v43, a241
    v_mfma_f32_16x16x32_bf16 v[136:139], v[72:75], v[96:99], v[136:139]
    ds_read_b64_tr_b16 v[82:83], v14 offset:9216
    v_accvgpr_read_b32 v44, a242
    v_mfma_f32_16x16x32_bf16 v[140:143], v[76:79], v[96:99], v[140:143]
    ds_read_b128 v[96:99], v9 offset:0
    s_add_u32 m0, s22, 8192
    v_mfma_f32_16x16x32_bf16 v[156:159], v[76:79], v[100:103], v[156:159]
    buffer_load_dwordx4 v20, s[8:11], s20 offen sc1 lds
    v_mfma_f32_16x16x32_bf16 v[152:155], v[72:75], v[100:103], v[152:155]
    ds_read_b64_tr_b16 v[84:85], v15 offset:8192
    v_accvgpr_read_b32 v45, a243
    v_mfma_f32_16x16x32_bf16 v[148:151], v[68:71], v[100:103], v[148:151]
    ds_read_b64_tr_b16 v[86:87], v15 offset:9216
    v_cvt_pk_bf16_f32 v46, v38, v39
    v_mfma_f32_16x16x32_bf16 v[144:147], v[64:67], v[100:103], v[144:147]
    ds_read_b128 v[100:103], v9 offset:2048
    s_add_u32 m0, s22, 12288
    v_mfma_f32_16x16x32_bf16 v[160:163], v[64:67], v[104:107], v[160:163]
    buffer_load_dwordx4 v21, s[8:11], s20 offen sc1 lds
    v_mfma_f32_16x16x32_bf16 v[164:167], v[68:71], v[104:107], v[164:167]
    ds_read_b64_tr_b16 v[88:89], v16 offset:8192
    v_cvt_pk_bf16_f32 v47, v40, v41
    v_mfma_f32_16x16x32_bf16 v[168:171], v[72:75], v[104:107], v[168:171]
    ds_read_b64_tr_b16 v[90:91], v16 offset:9216
    v_cvt_pk_bf16_f32 v48, v42, v43
    v_mfma_f32_16x16x32_bf16 v[172:175], v[76:79], v[104:107], v[172:175]
    ds_read_b128 v[104:107], v9 offset:4096
    s_add_u32 m0, s22, 16384
    v_mfma_f32_16x16x32_bf16 v[188:191], v[76:79], v[108:111], v[188:191]
    buffer_load_dwordx4 v22, s[8:11], s20 offen sc1 lds
    v_mfma_f32_16x16x32_bf16 v[184:187], v[72:75], v[108:111], v[184:187]
    ds_read_b64_tr_b16 v[92:93], v17 offset:8192
    v_cvt_pk_bf16_f32 v49, v44, v45
    v_mfma_f32_16x16x32_bf16 v[180:183], v[68:71], v[108:111], v[180:183]
    ds_read_b64_tr_b16 v[94:95], v17 offset:9216
    s_mov_b32 s39, 53248
    v_mfma_f32_16x16x32_bf16 v[176:179], v[64:67], v[108:111], v[176:179]
    ds_read_b128 v[108:111], v9 offset:6144
    s_add_u32 m0, s22, 20480
    s_waitcnt lgkmcnt(12)
    v_mfma_f32_16x16x32_bf16 v[192:195], v[64:67], v[112:115], v[192:195]
    buffer_load_dwordx4 v23, s[8:11], s20 offen sc1 lds
    v_mfma_f32_16x16x32_bf16 v[196:199], v[68:71], v[112:115], v[196:199]
    buffer_store_dwordx4 v[46:49], v34, s[16:19], s39 offen offset:0 sc1
    v_mfma_f32_16x16x32_bf16 v[200:203], v[72:75], v[112:115], v[200:203]
    v_accvgpr_read_b32 v50, a212
    v_accvgpr_read_b32 v51, a213
    v_mfma_f32_16x16x32_bf16 v[204:207], v[76:79], v[112:115], v[204:207]
    ds_read_b128 v[112:115], v9 offset:8192
    s_add_u32 m0, s22, 24576
    v_mfma_f32_16x16x32_bf16 v[220:223], v[76:79], v[116:119], v[220:223]
    buffer_load_dwordx4 v24, s[8:11], s20 offen sc1 lds
    v_mfma_f32_16x16x32_bf16 v[216:219], v[72:75], v[116:119], v[216:219]
    v_accvgpr_read_b32 v52, a214
    v_accvgpr_read_b32 v53, a215
    v_mfma_f32_16x16x32_bf16 v[212:215], v[68:71], v[116:119], v[212:215]
    v_accvgpr_read_b32 v54, a244
    v_accvgpr_read_b32 v55, a245
    v_mfma_f32_16x16x32_bf16 v[208:211], v[64:67], v[116:119], v[208:211]
    ds_read_b128 v[116:119], v9 offset:10240
    s_add_u32 m0, s22, 28672
    v_mfma_f32_16x16x32_bf16 v[224:227], v[64:67], v[120:123], v[224:227]
    buffer_load_dwordx4 v25, s[8:11], s20 offen sc1 lds
    v_mfma_f32_16x16x32_bf16 v[228:231], v[68:71], v[120:123], v[228:231]
    v_accvgpr_read_b32 v56, a246
    v_accvgpr_read_b32 v57, a247
    v_mfma_f32_16x16x32_bf16 v[232:235], v[72:75], v[120:123], v[232:235]
    v_cvt_pk_bf16_f32 v58, v50, v51
    v_cvt_pk_bf16_f32 v59, v52, v53
    v_mfma_f32_16x16x32_bf16 v[236:239], v[76:79], v[120:123], v[236:239]
    ds_read_b128 v[120:123], v9 offset:12288
    v_cvt_pk_bf16_f32 v60, v54, v55
    v_mfma_f32_16x16x32_bf16 v[252:255], v[76:79], v[124:127], v[252:255]
    v_cvt_pk_bf16_f32 v61, v56, v57
    s_mov_b32 s39, 53248
    v_mfma_f32_16x16x32_bf16 v[248:251], v[72:75], v[124:127], v[248:251]
    buffer_store_dwordx4 v[58:61], v34, s[16:19], s39 offen offset:1024 sc1
    v_mfma_f32_16x16x32_bf16 v[244:247], v[68:71], v[124:127], v[244:247]
    v_accvgpr_read_b32 v38, a216
    v_accvgpr_read_b32 v39, a217
    v_mfma_f32_16x16x32_bf16 v[240:243], v[64:67], v[124:127], v[240:243]
    ds_read_b128 v[124:127], v9 offset:14336
    v_accvgpr_read_b32 v40, a218
    s_waitcnt lgkmcnt(0) vmcnt(17)
    s_barrier
    v_mfma_f32_16x16x32_bf16 v[128:131], v[80:83], v[96:99], v[128:131]
    v_accvgpr_read_b32 v41, a219
    v_accvgpr_read_b32 v42, a248
    v_mfma_f32_16x16x32_bf16 v[132:135], v[84:87], v[96:99], v[132:135]
    ds_read_b64_tr_b16 v[64:65], v10 offset:16384
    v_accvgpr_read_b32 v43, a249
    v_mfma_f32_16x16x32_bf16 v[136:139], v[88:91], v[96:99], v[136:139]
    ds_read_b64_tr_b16 v[66:67], v10 offset:17408
    v_accvgpr_read_b32 v44, a250
    v_mfma_f32_16x16x32_bf16 v[140:143], v[92:95], v[96:99], v[140:143]
    ds_read_b128 v[96:99], v4 offset:0
    v_accvgpr_read_b32 v45, a251
    v_mfma_f32_16x16x32_bf16 v[156:159], v[92:95], v[100:103], v[156:159]
    v_cvt_pk_bf16_f32 v46, v38, v39
    v_cvt_pk_bf16_f32 v47, v40, v41
    v_mfma_f32_16x16x32_bf16 v[152:155], v[88:91], v[100:103], v[152:155]
    ds_read_b64_tr_b16 v[68:69], v11 offset:16384
    v_cvt_pk_bf16_f32 v48, v42, v43
    v_mfma_f32_16x16x32_bf16 v[148:151], v[84:87], v[100:103], v[148:151]
    ds_read_b64_tr_b16 v[70:71], v11 offset:17408
    v_cvt_pk_bf16_f32 v49, v44, v45
    v_mfma_f32_16x16x32_bf16 v[144:147], v[80:83], v[100:103], v[144:147]
    ds_read_b128 v[100:103], v4 offset:2048
    s_mov_b32 s39, 53248
    v_mfma_f32_16x16x32_bf16 v[160:163], v[80:83], v[104:107], v[160:163]
    buffer_store_dwordx4 v[46:49], v34, s[16:19], s39 offen offset:2048 sc1
    v_mfma_f32_16x16x32_bf16 v[164:167], v[84:87], v[104:107], v[164:167]
    ds_read_b64_tr_b16 v[72:73], v12 offset:16384
    v_accvgpr_read_b32 v50, a220
    v_mfma_f32_16x16x32_bf16 v[168:171], v[88:91], v[104:107], v[168:171]
    ds_read_b64_tr_b16 v[74:75], v12 offset:17408
    v_accvgpr_read_b32 v51, a221
    v_mfma_f32_16x16x32_bf16 v[172:175], v[92:95], v[104:107], v[172:175]
    ds_read_b128 v[104:107], v4 offset:4096
    v_accvgpr_read_b32 v52, a222
    v_mfma_f32_16x16x32_bf16 v[188:191], v[92:95], v[108:111], v[188:191]
    v_accvgpr_read_b32 v53, a223
    v_accvgpr_read_b32 v54, a252
    v_mfma_f32_16x16x32_bf16 v[184:187], v[88:91], v[108:111], v[184:187]
    ds_read_b64_tr_b16 v[76:77], v13 offset:16384
    v_accvgpr_read_b32 v55, a253
    v_mfma_f32_16x16x32_bf16 v[180:183], v[84:87], v[108:111], v[180:183]
    ds_read_b64_tr_b16 v[78:79], v13 offset:17408
    v_accvgpr_read_b32 v56, a254
    v_mfma_f32_16x16x32_bf16 v[176:179], v[80:83], v[108:111], v[176:179]
    ds_read_b128 v[108:111], v4 offset:6144
    v_accvgpr_read_b32 v57, a255
    v_mfma_f32_16x16x32_bf16 v[192:195], v[80:83], v[112:115], v[192:195]
    v_cvt_pk_bf16_f32 v58, v50, v51
    v_cvt_pk_bf16_f32 v59, v52, v53
    v_mfma_f32_16x16x32_bf16 v[196:199], v[84:87], v[112:115], v[196:199]
    v_cvt_pk_bf16_f32 v60, v54, v55
    v_cvt_pk_bf16_f32 v61, v56, v57
    v_mfma_f32_16x16x32_bf16 v[200:203], v[88:91], v[112:115], v[200:203]
    s_mov_b32 s39, 53248
    v_mfma_f32_16x16x32_bf16 v[204:207], v[92:95], v[112:115], v[204:207]
    ds_read_b128 v[112:115], v4 offset:8192
    v_mfma_f32_16x16x32_bf16 v[220:223], v[92:95], v[116:119], v[220:223]
    buffer_store_dwordx4 v[58:61], v34, s[16:19], s39 offen offset:3072 sc1
    v_mfma_f32_16x16x32_bf16 v[216:219], v[88:91], v[116:119], v[216:219]
    v_mfma_f32_16x16x32_bf16 v[212:215], v[84:87], v[116:119], v[212:215]
    v_mfma_f32_16x16x32_bf16 v[208:211], v[80:83], v[116:119], v[208:211]
    ds_read_b128 v[116:119], v4 offset:10240
    v_mfma_f32_16x16x32_bf16 v[224:227], v[80:83], v[120:123], v[224:227]
    v_mfma_f32_16x16x32_bf16 v[228:231], v[84:87], v[120:123], v[228:231]
    v_mfma_f32_16x16x32_bf16 v[232:235], v[88:91], v[120:123], v[232:235]
    v_mfma_f32_16x16x32_bf16 v[236:239], v[92:95], v[120:123], v[236:239]
    ds_read_b128 v[120:123], v4 offset:12288
    v_mfma_f32_16x16x32_bf16 v[252:255], v[92:95], v[124:127], v[252:255]
    v_mfma_f32_16x16x32_bf16 v[248:251], v[88:91], v[124:127], v[248:251]
    v_mfma_f32_16x16x32_bf16 v[244:247], v[84:87], v[124:127], v[244:247]
    v_mfma_f32_16x16x32_bf16 v[240:243], v[80:83], v[124:127], v[240:243]
    ds_read_b128 v[124:127], v4 offset:14336
    s_waitcnt lgkmcnt(4) vmcnt(3)
    s_barrier
    v_mfma_f32_16x16x32_bf16 v[128:131], v[64:67], v[96:99], v[128:131]
    ds_read_b64_tr_b16 a[0:1], v10 offset:0
    v_mfma_f32_16x16x32_bf16 v[132:135], v[68:71], v[96:99], v[132:135]
    ds_read_b64_tr_b16 v[80:81], v10 offset:24576
    v_mfma_f32_16x16x32_bf16 v[136:139], v[72:75], v[96:99], v[136:139]
    ds_read_b64_tr_b16 v[82:83], v10 offset:25600
    v_mfma_f32_16x16x32_bf16 v[140:143], v[76:79], v[96:99], v[140:143]
    ds_read_b128 v[96:99], v5 offset:0
    v_mfma_f32_16x16x32_bf16 v[156:159], v[76:79], v[100:103], v[156:159]
    ds_read_b64_tr_b16 a[2:3], v10 offset:1024
    v_mfma_f32_16x16x32_bf16 v[152:155], v[72:75], v[100:103], v[152:155]
    ds_read_b64_tr_b16 v[84:85], v11 offset:24576
    v_mfma_f32_16x16x32_bf16 v[148:151], v[68:71], v[100:103], v[148:151]
    ds_read_b64_tr_b16 v[86:87], v11 offset:25600
    v_mfma_f32_16x16x32_bf16 v[144:147], v[64:67], v[100:103], v[144:147]
    ds_read_b128 v[100:103], v5 offset:2048
    v_mfma_f32_16x16x32_bf16 v[160:163], v[64:67], v[104:107], v[160:163]
    ds_read_b64_tr_b16 a[4:5], v11 offset:0
    v_mfma_f32_16x16x32_bf16 v[164:167], v[68:71], v[104:107], v[164:167]
    ds_read_b64_tr_b16 v[88:89], v12 offset:24576
    v_mfma_f32_16x16x32_bf16 v[168:171], v[72:75], v[104:107], v[168:171]
    ds_read_b64_tr_b16 v[90:91], v12 offset:25600
    v_mfma_f32_16x16x32_bf16 v[172:175], v[76:79], v[104:107], v[172:175]
    ds_read_b128 v[104:107], v5 offset:4096
    v_mfma_f32_16x16x32_bf16 v[188:191], v[76:79], v[108:111], v[188:191]
    ds_read_b64_tr_b16 a[6:7], v11 offset:1024
    v_mfma_f32_16x16x32_bf16 v[184:187], v[72:75], v[108:111], v[184:187]
    ds_read_b64_tr_b16 v[92:93], v13 offset:24576
    v_mfma_f32_16x16x32_bf16 v[180:183], v[68:71], v[108:111], v[180:183]
    ds_read_b64_tr_b16 v[94:95], v13 offset:25600
    v_mfma_f32_16x16x32_bf16 v[176:179], v[64:67], v[108:111], v[176:179]
    ds_read_b128 v[108:111], v5 offset:6144
    s_waitcnt lgkmcnt(12)
    v_mfma_f32_16x16x32_bf16 v[192:195], v[64:67], v[112:115], v[192:195]
    ds_read_b64_tr_b16 a[8:9], v12 offset:0
    v_mfma_f32_16x16x32_bf16 v[196:199], v[68:71], v[112:115], v[196:199]
    ds_read_b64_tr_b16 a[10:11], v12 offset:1024
    v_mfma_f32_16x16x32_bf16 v[200:203], v[72:75], v[112:115], v[200:203]
    ds_read_b64_tr_b16 a[12:13], v13 offset:0
    v_mfma_f32_16x16x32_bf16 v[204:207], v[76:79], v[112:115], v[204:207]
    ds_read_b128 v[112:115], v5 offset:8192
    v_mfma_f32_16x16x32_bf16 v[220:223], v[76:79], v[116:119], v[220:223]
    ds_read_b64_tr_b16 a[14:15], v13 offset:1024
    v_mfma_f32_16x16x32_bf16 v[216:219], v[72:75], v[116:119], v[216:219]
    ds_read_b64_tr_b16 a[16:17], v10 offset:8192
    v_mfma_f32_16x16x32_bf16 v[212:215], v[68:71], v[116:119], v[212:215]
    ds_read_b64_tr_b16 a[18:19], v10 offset:9216
    v_mfma_f32_16x16x32_bf16 v[208:211], v[64:67], v[116:119], v[208:211]
    ds_read_b128 v[116:119], v5 offset:10240
    v_mfma_f32_16x16x32_bf16 v[224:227], v[64:67], v[120:123], v[224:227]
    ds_read_b64_tr_b16 a[20:21], v11 offset:8192
    v_mfma_f32_16x16x32_bf16 v[228:231], v[68:71], v[120:123], v[228:231]
    ds_read_b64_tr_b16 a[22:23], v11 offset:9216
    v_mfma_f32_16x16x32_bf16 v[232:235], v[72:75], v[120:123], v[232:235]
    ds_read_b64_tr_b16 a[24:25], v12 offset:8192
    v_mfma_f32_16x16x32_bf16 v[236:239], v[76:79], v[120:123], v[236:239]
    ds_read_b128 v[120:123], v5 offset:12288
    v_mfma_f32_16x16x32_bf16 v[252:255], v[76:79], v[124:127], v[252:255]
    ds_read_b64_tr_b16 a[26:27], v12 offset:9216
    ds_read_b128 a[32:35], v6 offset:0
    v_mfma_f32_16x16x32_bf16 v[248:251], v[72:75], v[124:127], v[248:251]
    ds_read_b64_tr_b16 a[28:29], v13 offset:8192
    ds_read_b128 a[36:39], v7 offset:0
    v_mfma_f32_16x16x32_bf16 v[244:247], v[68:71], v[124:127], v[244:247]
    ds_read_b64_tr_b16 a[30:31], v13 offset:9216
    ds_read_b128 a[40:43], v6 offset:2048
    v_mfma_f32_16x16x32_bf16 v[240:243], v[64:67], v[124:127], v[240:243]
    ds_read_b128 v[124:127], v5 offset:14336
    ds_read_b128 a[44:47], v7 offset:2048
    v_lshlrev_b32 v35, 4, v1
    s_lshl_b32 s46, s44, 16
    s_lshl_b32 s47, s45, 11
    s_add_u32 s46, s46, s47
    v_add_u32 v35, s46, v35
    s_waitcnt lgkmcnt(0)
    v_mfma_f32_16x16x32_bf16 v[128:131], v[80:83], v[96:99], v[128:131]
    v_mfma_f32_16x16x32_bf16 v[132:135], v[84:87], v[96:99], v[132:135]
    v_mfma_f32_16x16x32_bf16 v[136:139], v[88:91], v[96:99], v[136:139]
    v_mfma_f32_16x16x32_bf16 v[140:143], v[92:95], v[96:99], v[140:143]
    v_mfma_f32_16x16x32_bf16 v[140:143], a[12:15], a[32:35], v[140:143]
    v_mfma_f32_16x16x32_bf16 v[136:139], a[8:11], a[32:35], v[136:139]
    v_mfma_f32_16x16x32_bf16 v[132:135], a[4:7], a[32:35], v[132:135]
    v_mfma_f32_16x16x32_bf16 v[128:131], a[0:3], a[32:35], v[128:131]
    v_mfma_f32_16x16x32_bf16 v[128:131], a[16:19], a[36:39], v[128:131]
    v_mfma_f32_16x16x32_bf16 v[132:135], a[20:23], a[36:39], v[132:135]
    v_mfma_f32_16x16x32_bf16 v[136:139], a[24:27], a[36:39], v[136:139]
    ds_read_b128 a[48:51], v6 offset:4096
    v_mfma_f32_16x16x32_bf16 v[140:143], a[28:31], a[36:39], v[140:143]
    ds_read_b128 a[52:55], v7 offset:4096
    s_waitcnt lgkmcnt(2)
    v_mfma_f32_16x16x32_bf16 v[144:147], v[80:83], v[100:103], v[144:147]
    v_mfma_f32_16x16x32_bf16 v[148:151], v[84:87], v[100:103], v[148:151]
    v_mfma_f32_16x16x32_bf16 v[152:155], v[88:91], v[100:103], v[152:155]
    v_mfma_f32_16x16x32_bf16 v[156:159], v[92:95], v[100:103], v[156:159]
    v_mfma_f32_16x16x32_bf16 v[156:159], a[12:15], a[40:43], v[156:159]
    v_mfma_f32_16x16x32_bf16 v[152:155], a[8:11], a[40:43], v[152:155]
    v_cvt_pk_bf16_f32 v64, v128, v129
    v_cvt_pk_bf16_f32 v65, v130, v131
    v_mfma_f32_16x16x32_bf16 v[148:151], a[4:7], a[40:43], v[148:151]
    v_cvt_pk_bf16_f32 v66, v132, v133
    v_cvt_pk_bf16_f32 v67, v134, v135
    v_mfma_f32_16x16x32_bf16 v[144:147], a[0:3], a[40:43], v[144:147]
    s_mov_b32 s39, 0
    v_mfma_f32_16x16x32_bf16 v[144:147], a[16:19], a[44:47], v[144:147]
    buffer_store_dwordx4 v[64:67], v35, s[52:55], s39 offen offset:0 sc1
    v_mfma_f32_16x16x32_bf16 v[148:151], a[20:23], a[44:47], v[148:151]
    v_cvt_pk_bf16_f32 v68, v136, v137
    v_cvt_pk_bf16_f32 v69, v138, v139
    v_mfma_f32_16x16x32_bf16 v[152:155], a[24:27], a[44:47], v[152:155]
    ds_read_b128 a[56:59], v6 offset:6144
    v_cvt_pk_bf16_f32 v70, v140, v141
    v_mfma_f32_16x16x32_bf16 v[156:159], a[28:31], a[44:47], v[156:159]
    ds_read_b128 a[60:63], v7 offset:6144
    v_cvt_pk_bf16_f32 v71, v142, v143
    s_waitcnt lgkmcnt(2)
    v_mfma_f32_16x16x32_bf16 v[160:163], v[80:83], v[104:107], v[160:163]
    buffer_store_dwordx4 v[68:71], v35, s[52:55], s39 offen offset:1024 sc1
    v_mfma_f32_16x16x32_bf16 v[164:167], v[84:87], v[104:107], v[164:167]
    v_mfma_f32_16x16x32_bf16 v[168:171], v[88:91], v[104:107], v[168:171]
    v_mfma_f32_16x16x32_bf16 v[172:175], v[92:95], v[104:107], v[172:175]
    v_mfma_f32_16x16x32_bf16 v[172:175], a[12:15], a[48:51], v[172:175]
    v_mfma_f32_16x16x32_bf16 v[168:171], a[8:11], a[48:51], v[168:171]
    v_cvt_pk_bf16_f32 v72, v144, v145
    v_cvt_pk_bf16_f32 v73, v146, v147
    v_mfma_f32_16x16x32_bf16 v[164:167], a[4:7], a[48:51], v[164:167]
    v_cvt_pk_bf16_f32 v74, v148, v149
    v_cvt_pk_bf16_f32 v75, v150, v151
    v_mfma_f32_16x16x32_bf16 v[160:163], a[0:3], a[48:51], v[160:163]
    s_mov_b32 s39, 8192
    v_mfma_f32_16x16x32_bf16 v[160:163], a[16:19], a[52:55], v[160:163]
    buffer_store_dwordx4 v[72:75], v35, s[52:55], s39 offen offset:0 sc1
    v_mfma_f32_16x16x32_bf16 v[164:167], a[20:23], a[52:55], v[164:167]
    v_cvt_pk_bf16_f32 v76, v152, v153
    v_cvt_pk_bf16_f32 v77, v154, v155
    v_mfma_f32_16x16x32_bf16 v[168:171], a[24:27], a[52:55], v[168:171]
    ds_read_b128 a[32:35], v6 offset:8192
    v_cvt_pk_bf16_f32 v78, v156, v157
    v_mfma_f32_16x16x32_bf16 v[172:175], a[28:31], a[52:55], v[172:175]
    ds_read_b128 a[36:39], v7 offset:8192
    v_cvt_pk_bf16_f32 v79, v158, v159
    s_waitcnt lgkmcnt(2)
    v_mfma_f32_16x16x32_bf16 v[176:179], v[80:83], v[108:111], v[176:179]
    buffer_store_dwordx4 v[76:79], v35, s[52:55], s39 offen offset:1024 sc1
    v_mfma_f32_16x16x32_bf16 v[180:183], v[84:87], v[108:111], v[180:183]
    v_mfma_f32_16x16x32_bf16 v[184:187], v[88:91], v[108:111], v[184:187]
    v_mfma_f32_16x16x32_bf16 v[188:191], v[92:95], v[108:111], v[188:191]
    v_mfma_f32_16x16x32_bf16 v[188:191], a[12:15], a[56:59], v[188:191]
    v_mfma_f32_16x16x32_bf16 v[184:187], a[8:11], a[56:59], v[184:187]
    v_cvt_pk_bf16_f32 v64, v160, v161
    v_cvt_pk_bf16_f32 v65, v162, v163
    v_mfma_f32_16x16x32_bf16 v[180:183], a[4:7], a[56:59], v[180:183]
    v_cvt_pk_bf16_f32 v66, v164, v165
    v_cvt_pk_bf16_f32 v67, v166, v167
    v_mfma_f32_16x16x32_bf16 v[176:179], a[0:3], a[56:59], v[176:179]
    s_mov_b32 s39, 16384
    v_mfma_f32_16x16x32_bf16 v[176:179], a[16:19], a[60:63], v[176:179]
    buffer_store_dwordx4 v[64:67], v35, s[52:55], s39 offen offset:0 sc1
    v_mfma_f32_16x16x32_bf16 v[180:183], a[20:23], a[60:63], v[180:183]
    v_cvt_pk_bf16_f32 v68, v168, v169
    v_cvt_pk_bf16_f32 v69, v170, v171
    v_mfma_f32_16x16x32_bf16 v[184:187], a[24:27], a[60:63], v[184:187]
    ds_read_b128 a[40:43], v6 offset:10240
    v_cvt_pk_bf16_f32 v70, v172, v173
    v_mfma_f32_16x16x32_bf16 v[188:191], a[28:31], a[60:63], v[188:191]
    ds_read_b128 a[44:47], v7 offset:10240
    v_cvt_pk_bf16_f32 v71, v174, v175
    s_waitcnt lgkmcnt(2)
    v_mfma_f32_16x16x32_bf16 v[192:195], v[80:83], v[112:115], v[192:195]
    buffer_store_dwordx4 v[68:71], v35, s[52:55], s39 offen offset:1024 sc1
    v_mfma_f32_16x16x32_bf16 v[196:199], v[84:87], v[112:115], v[196:199]
    v_mfma_f32_16x16x32_bf16 v[200:203], v[88:91], v[112:115], v[200:203]
    v_mfma_f32_16x16x32_bf16 v[204:207], v[92:95], v[112:115], v[204:207]
    v_mfma_f32_16x16x32_bf16 v[204:207], a[12:15], a[32:35], v[204:207]
    v_mfma_f32_16x16x32_bf16 v[200:203], a[8:11], a[32:35], v[200:203]
    v_cvt_pk_bf16_f32 v72, v176, v177
    v_cvt_pk_bf16_f32 v73, v178, v179
    v_mfma_f32_16x16x32_bf16 v[196:199], a[4:7], a[32:35], v[196:199]
    v_cvt_pk_bf16_f32 v74, v180, v181
    v_cvt_pk_bf16_f32 v75, v182, v183
    v_mfma_f32_16x16x32_bf16 v[192:195], a[0:3], a[32:35], v[192:195]
    s_mov_b32 s39, 24576
    v_mfma_f32_16x16x32_bf16 v[192:195], a[16:19], a[36:39], v[192:195]
    buffer_store_dwordx4 v[72:75], v35, s[52:55], s39 offen offset:0 sc1
    v_mfma_f32_16x16x32_bf16 v[196:199], a[20:23], a[36:39], v[196:199]
    v_cvt_pk_bf16_f32 v76, v184, v185
    v_cvt_pk_bf16_f32 v77, v186, v187
    v_mfma_f32_16x16x32_bf16 v[200:203], a[24:27], a[36:39], v[200:203]
    ds_read_b128 a[48:51], v6 offset:12288
    v_cvt_pk_bf16_f32 v78, v188, v189
    v_mfma_f32_16x16x32_bf16 v[204:207], a[28:31], a[36:39], v[204:207]
    ds_read_b128 a[52:55], v7 offset:12288
    v_cvt_pk_bf16_f32 v79, v190, v191
    s_waitcnt lgkmcnt(2)
    v_mfma_f32_16x16x32_bf16 v[208:211], v[80:83], v[116:119], v[208:211]
    buffer_store_dwordx4 v[76:79], v35, s[52:55], s39 offen offset:1024 sc1
    v_mfma_f32_16x16x32_bf16 v[212:215], v[84:87], v[116:119], v[212:215]
    v_mfma_f32_16x16x32_bf16 v[216:219], v[88:91], v[116:119], v[216:219]
    v_mfma_f32_16x16x32_bf16 v[220:223], v[92:95], v[116:119], v[220:223]
    v_mfma_f32_16x16x32_bf16 v[220:223], a[12:15], a[40:43], v[220:223]
    v_mfma_f32_16x16x32_bf16 v[216:219], a[8:11], a[40:43], v[216:219]
    v_cvt_pk_bf16_f32 v64, v192, v193
    v_cvt_pk_bf16_f32 v65, v194, v195
    v_mfma_f32_16x16x32_bf16 v[212:215], a[4:7], a[40:43], v[212:215]
    v_cvt_pk_bf16_f32 v66, v196, v197
    v_cvt_pk_bf16_f32 v67, v198, v199
    v_mfma_f32_16x16x32_bf16 v[208:211], a[0:3], a[40:43], v[208:211]
    s_mov_b32 s39, 32768
    v_mfma_f32_16x16x32_bf16 v[208:211], a[16:19], a[44:47], v[208:211]
    buffer_store_dwordx4 v[64:67], v35, s[52:55], s39 offen offset:0 sc1
    v_mfma_f32_16x16x32_bf16 v[212:215], a[20:23], a[44:47], v[212:215]
    v_cvt_pk_bf16_f32 v68, v200, v201
    v_cvt_pk_bf16_f32 v69, v202, v203
    v_mfma_f32_16x16x32_bf16 v[216:219], a[24:27], a[44:47], v[216:219]
    ds_read_b128 a[56:59], v6 offset:14336
    v_cvt_pk_bf16_f32 v70, v204, v205
    v_mfma_f32_16x16x32_bf16 v[220:223], a[28:31], a[44:47], v[220:223]
    ds_read_b128 a[60:63], v7 offset:14336
    v_cvt_pk_bf16_f32 v71, v206, v207
    s_waitcnt lgkmcnt(2)
    v_mfma_f32_16x16x32_bf16 v[224:227], v[80:83], v[120:123], v[224:227]
    buffer_store_dwordx4 v[68:71], v35, s[52:55], s39 offen offset:1024 sc1
    v_mfma_f32_16x16x32_bf16 v[228:231], v[84:87], v[120:123], v[228:231]
    v_mfma_f32_16x16x32_bf16 v[232:235], v[88:91], v[120:123], v[232:235]
    v_mfma_f32_16x16x32_bf16 v[236:239], v[92:95], v[120:123], v[236:239]
    v_mfma_f32_16x16x32_bf16 v[236:239], a[12:15], a[48:51], v[236:239]
    v_mfma_f32_16x16x32_bf16 v[232:235], a[8:11], a[48:51], v[232:235]
    v_cvt_pk_bf16_f32 v72, v208, v209
    v_cvt_pk_bf16_f32 v73, v210, v211
    v_mfma_f32_16x16x32_bf16 v[228:231], a[4:7], a[48:51], v[228:231]
    v_cvt_pk_bf16_f32 v74, v212, v213
    v_cvt_pk_bf16_f32 v75, v214, v215
    v_mfma_f32_16x16x32_bf16 v[224:227], a[0:3], a[48:51], v[224:227]
    s_mov_b32 s39, 40960
    v_mfma_f32_16x16x32_bf16 v[224:227], a[16:19], a[52:55], v[224:227]
    buffer_store_dwordx4 v[72:75], v35, s[52:55], s39 offen offset:0 sc1
    v_mfma_f32_16x16x32_bf16 v[228:231], a[20:23], a[52:55], v[228:231]
    v_cvt_pk_bf16_f32 v76, v216, v217
    v_cvt_pk_bf16_f32 v77, v218, v219
    v_mfma_f32_16x16x32_bf16 v[232:235], a[24:27], a[52:55], v[232:235]
    v_cvt_pk_bf16_f32 v78, v220, v221
    v_cvt_pk_bf16_f32 v79, v222, v223
    v_mfma_f32_16x16x32_bf16 v[236:239], a[28:31], a[52:55], v[236:239]
    buffer_store_dwordx4 v[76:79], v35, s[52:55], s39 offen offset:1024 sc1
    s_waitcnt lgkmcnt(2)
    v_mfma_f32_16x16x32_bf16 v[240:243], v[80:83], v[124:127], v[240:243]
    v_mfma_f32_16x16x32_bf16 v[244:247], v[84:87], v[124:127], v[244:247]
    v_mfma_f32_16x16x32_bf16 v[248:251], v[88:91], v[124:127], v[248:251]
    v_mfma_f32_16x16x32_bf16 v[252:255], v[92:95], v[124:127], v[252:255]
    v_mfma_f32_16x16x32_bf16 v[252:255], a[12:15], a[56:59], v[252:255]
    v_mfma_f32_16x16x32_bf16 v[248:251], a[8:11], a[56:59], v[248:251]
    v_cvt_pk_bf16_f32 v64, v224, v225
    v_cvt_pk_bf16_f32 v65, v226, v227
    v_mfma_f32_16x16x32_bf16 v[244:247], a[4:7], a[56:59], v[244:247]
    v_cvt_pk_bf16_f32 v66, v228, v229
    v_cvt_pk_bf16_f32 v67, v230, v231
    v_mfma_f32_16x16x32_bf16 v[240:243], a[0:3], a[56:59], v[240:243]
    s_mov_b32 s39, 49152
    v_mfma_f32_16x16x32_bf16 v[240:243], a[16:19], a[60:63], v[240:243]
    buffer_store_dwordx4 v[64:67], v35, s[52:55], s39 offen offset:0 sc1
    v_mfma_f32_16x16x32_bf16 v[244:247], a[20:23], a[60:63], v[244:247]
    v_cvt_pk_bf16_f32 v68, v232, v233
    v_cvt_pk_bf16_f32 v69, v234, v235
    v_mfma_f32_16x16x32_bf16 v[248:251], a[24:27], a[60:63], v[248:251]
    v_cvt_pk_bf16_f32 v70, v236, v237
    v_cvt_pk_bf16_f32 v71, v238, v239
    v_mfma_f32_16x16x32_bf16 v[252:255], a[28:31], a[60:63], v[252:255]
    buffer_store_dwordx4 v[68:71], v35, s[52:55], s39 offen offset:1024 sc1
    s_nop 5
    v_cvt_pk_bf16_f32 v72, v240, v241
    v_cvt_pk_bf16_f32 v73, v242, v243
    v_cvt_pk_bf16_f32 v74, v244, v245
    v_cvt_pk_bf16_f32 v75, v246, v247
    s_mov_b32 s39, 57344
    buffer_store_dwordx4 v[72:75], v35, s[52:55], s39 offen offset:0 sc1
    v_cvt_pk_bf16_f32 v76, v248, v249
    v_cvt_pk_bf16_f32 v77, v250, v251
    v_cvt_pk_bf16_f32 v78, v252, v253
    v_cvt_pk_bf16_f32 v79, v254, v255
    buffer_store_dwordx4 v[76:79], v35, s[52:55], s39 offen offset:1024 sc1
L_qkv_qep:
    s_getpc_b64 s[72:73]
L_qkv_kernel_pc_9:
    s_add_u32 s72, s72, attn_kernel-L_qkv_kernel_pc_9
    s_addc_u32 s73, s73, 0
    s_and_b32 s73, s73, 0xffff
    s_mov_b32 s74, tail_kernel-attn_kernel
    s_mov_b32 s75, 0x00020000
    s_lshr_b32 s76, s2, 3
    s_lshl_b32 s76, s76, 2
    s_add_u32 s76, s76, s37
    s_and_b32 s76, s76, 7
    s_lshl_b32 s76, s76, 13
    v_lshlrev_b32 v5, 7, v1
    buffer_load_dword v36, v5, s[72:75], s76 offen
    s_endpgm
L_qkv_kernel_sw_2:
    s_cmp_eq_u32 s38, 12
    s_cbranch_scc1 L_qkv_kernel_s12_10
    s_cmp_eq_u32 s38, 14
    s_cbranch_scc1 L_qkv_kernel_s14_11
    s_cmp_lg_u32 s37, 2
    s_cbranch_scc1 L_qkv_kernel_nc_16
    s_getpc_b64 s[48:49]
L_qkv_kernel_pc_17:
    s_sub_u32 s48, s48, L_qkv_kernel_pc_17-qkv_kernel
    s_subb_u32 s49, s49, 0
    s_mov_b32 s40, s48
    s_and_b32 s41, s49, 0xffff
    s_mov_b32 s42, attn_kernel-qkv_kernel
    s_lshr_b32 s46, s2, 3
    s_and_b32 s46, s46, 7
    s_lshl_b32 s50, s46, 13
    s_mov_b32 s51, 0x100000
    v_lshlrev_b32 v35, 7, v1
L_qkv_kernel_nc_16:
    s_cmp_lg_u32 s37, 3
    s_cbranch_scc1 L_qkv_kernel_n3_14
    s_mul_i32 s46, s2, 14336
    s_add_u32 s48, s70, s46
    s_addc_u32 s49, s71, 0
    s_mov_b32 s40, s48
    s_and_b32 s41, s49, 0xffff
    s_mov_b32 s42, 14336
    s_mov_b32 s50, 0
    s_mov_b32 s51, 8192
    v_lshlrev_b32 v35, 7, v1
L_qkv_kernel_n3_14:
    s_mov_b32 s69, 12
    s_cmp_lg_u32 s68, 2
    s_cbranch_scc1 L_qkv_kernel_k_1
    s_lshr_b32 s46, s2, 3
    s_lshl_b32 s46, s46, 5
    v_mov_b32 v2, 1
    v_mov_b32 v3, s46
    s_mov_b64 exec, 1
    buffer_atomic_add v2, v3, s[64:67], 0 offen sc1
    s_mov_b64 exec, -1
    s_branch L_qkv_kernel_k_1
L_qkv_kernel_s12_10:
    s_cmp_lt_u32 s37, 2
    s_cbranch_scc1 L_qkv_kernel_n2_15
    s_cmp_eq_u32 s37, 2
    s_cselect_b32 s48, s84, s86
    s_cselect_b32 s49, s85, s87
    s_mul_i32 s46, s2, 6272
    s_add_u32 s48, s48, s46
    s_addc_u32 s49, s49, 0
    s_mov_b32 s40, s48
    s_and_b32 s41, s49, 0xffff
    s_mov_b32 s42, 6272
    s_mov_b32 s50, 0
    s_mov_b32 s51, 8192
    v_lshlrev_b32 v35, 7, v1
L_qkv_kernel_n2_15:
    s_lshl_b32 s46, s32, 5
    v_mov_b32 v3, s46
    s_mov_b32 s69, 14
    buffer_load_dword v2, v3, s[64:67], 0 offen sc1
    s_branch L_qkv_kernel_k_1
L_qkv_kernel_s14_11:
L_qkv_kernel_poll_12:
    v_readfirstlane_b32 s46, v2
    s_nop 3
    s_cmp_ge_u32 s46, 8
    s_cbranch_scc1 L_qkv_kernel_ok_13
    buffer_load_dword v2, v3, s[64:67], 0 offen sc1
    s_waitcnt vmcnt(0)
    s_branch L_qkv_kernel_poll_12
L_qkv_kernel_ok_13:
    v_mov_b32 v18, v46
    v_mov_b32 v19, v47
    v_mov_b32 v20, v48
    v_mov_b32 v21, v49
    v_mov_b32 v22, v50
    v_mov_b32 v23, v51
    v_mov_b32 v24, v52
    v_mov_b32 v25, v53
    v_mov_b32 v26, v54
    v_mov_b32 v27, v55
    v_mov_b32 v28, v56
    v_mov_b32_e64 v29, v57
    s_mul_i32 s46, s32, 229376
    s_add_u32 s46, s46, 0
    s_add_u32 s48, s28, s46
    s_addc_u32 s49, s29, 0
    s_mov_b32 s8, s48
    s_and_b32 s9, s49, 0xffff
    s_mov_b32 s10, 229376
    s_mov_b32 s11, 0x00020000
    s_lshl_b32 s46, s34, 8
    s_add_u32 s48, s6, s46
    s_addc_u32 s49, s7, 0
    s_sub_u32 s47, 3670016, s46
    s_mov_b32 s12, s48
    s_and_b32 s13, s49, 0xffff
    s_mov_b32 s14, s47
    s_mov_b32 s15, 0x00020000
    s_mov_b32 s21, 0
    s_mov_b32 s20, 0
    s_lshl_b32 s22, s37, 10
    s_branch L_qkv_kernel_fin_4
L_qkv_kernel_sw_6:
    s_cmp_eq_u32 s38, 12
    s_cbranch_scc1 L_qkv_kernel_s12_18
    s_cmp_eq_u32 s38, 14
    s_cbranch_scc1 L_qkv_kernel_s14_19
    s_cmp_lg_u32 s37, 2
    s_cbranch_scc1 L_qkv_kernel_nc_24
    s_getpc_b64 s[48:49]
L_qkv_kernel_pc_25:
    s_sub_u32 s48, s48, L_qkv_kernel_pc_25-qkv_kernel
    s_subb_u32 s49, s49, 0
    s_mov_b32 s40, s48
    s_and_b32 s41, s49, 0xffff
    s_mov_b32 s42, attn_kernel-qkv_kernel
    s_lshr_b32 s46, s2, 3
    s_and_b32 s46, s46, 7
    s_lshl_b32 s50, s46, 13
    s_mov_b32 s51, 0x100000
    v_lshlrev_b32 v35, 7, v1
L_qkv_kernel_nc_24:
    s_cmp_lg_u32 s37, 3
    s_cbranch_scc1 L_qkv_kernel_n3_22
    s_mul_i32 s46, s2, 14336
    s_add_u32 s48, s70, s46
    s_addc_u32 s49, s71, 0
    s_mov_b32 s40, s48
    s_and_b32 s41, s49, 0xffff
    s_mov_b32 s42, 14336
    s_mov_b32 s50, 0
    s_mov_b32 s51, 8192
    v_lshlrev_b32 v35, 7, v1
L_qkv_kernel_n3_22:
    s_mov_b32 s69, 12
    s_cmp_lg_u32 s68, 2
    s_cbranch_scc1 L_qkv_kernel_v_5
    s_lshr_b32 s46, s2, 3
    s_lshl_b32 s46, s46, 5
    v_mov_b32 v2, 1
    v_mov_b32 v3, s46
    s_mov_b64 exec, 1
    buffer_atomic_add v2, v3, s[64:67], 0 offen sc1
    s_mov_b64 exec, -1
    s_branch L_qkv_kernel_v_5
L_qkv_kernel_s12_18:
    s_cmp_lt_u32 s37, 2
    s_cbranch_scc1 L_qkv_kernel_n2_23
    s_cmp_eq_u32 s37, 2
    s_cselect_b32 s48, s84, s86
    s_cselect_b32 s49, s85, s87
    s_mul_i32 s46, s2, 6272
    s_add_u32 s48, s48, s46
    s_addc_u32 s49, s49, 0
    s_mov_b32 s40, s48
    s_and_b32 s41, s49, 0xffff
    s_mov_b32 s42, 6272
    s_mov_b32 s50, 0
    s_mov_b32 s51, 8192
    v_lshlrev_b32 v35, 7, v1
L_qkv_kernel_n2_23:
    s_lshl_b32 s46, s32, 5
    v_mov_b32 v3, s46
    s_mov_b32 s69, 14
    buffer_load_dword v2, v3, s[64:67], 0 offen sc1
    s_branch L_qkv_kernel_v_5
L_qkv_kernel_s14_19:
L_qkv_kernel_poll_20:
    v_readfirstlane_b32 s46, v2
    s_nop 3
    s_cmp_ge_u32 s46, 8
    s_cbranch_scc1 L_qkv_kernel_ok_21
    buffer_load_dword v2, v3, s[64:67], 0 offen sc1
    s_waitcnt vmcnt(0)
    s_branch L_qkv_kernel_poll_20
L_qkv_kernel_ok_21:
    v_mov_b32 v18, v46
    v_mov_b32 v19, v47
    v_mov_b32 v20, v48
    v_mov_b32 v21, v49
    v_mov_b32 v22, v50
    v_mov_b32 v23, v51
    v_mov_b32 v24, v52
    v_mov_b32 v25, v53
    v_mov_b32 v26, v54
    v_mov_b32 v27, v55
    v_mov_b32 v28, v56
    v_mov_b32_e64 v29, v57
    s_mul_i32 s46, s32, 229376
    s_add_u32 s46, s46, 0
    s_add_u32 s48, s28, s46
    s_addc_u32 s49, s29, 0
    s_mov_b32 s8, s48
    s_and_b32 s9, s49, 0xffff
    s_mov_b32 s10, 229376
    s_mov_b32 s11, 0x00020000
    s_lshl_b32 s46, s34, 8
    s_add_u32 s48, s6, s46
    s_addc_u32 s49, s7, 0
    s_sub_u32 s47, 3670016, s46
    s_mov_b32 s12, s48
    s_and_b32 s13, s49, 0xffff
    s_mov_b32 s14, s47
    s_mov_b32 s15, 0x00020000
    s_mov_b32 s21, 0
    s_mov_b32 s20, 0
    s_lshl_b32 s22, s37, 10
    s_branch L_qkv_kernel_fin_8
L_qkv_end:
    s_endpgm
.globl attn_kernel
.p2align 8
.type attn_kernel,@function
attn_kernel:
    s_cmp_ge_u32 s2, 256
    s_cbranch_scc1 L_attn_end
    s_load_dwordx2 s[46:47], s[0:1], 88
    s_load_dwordx2 s[48:49], s[0:1], 80
    s_load_dwordx2 s[72:73], s[0:1], 40
    s_load_dwordx4 s[92:95], s[0:1], 56
    s_and_b32 s3, s2, 7
    s_lshl_b32 s3, s3, 1
    s_lshr_b32 s4, s2, 7
    s_add_u32 s33, s3, s4
    s_lshr_b32 s3, s2, 3
    s_and_b32 s34, s3, 7
    s_bfe_u32 s35, s3, 0x10003
    s_xor_b32 s35, s35, 1
    v_lshrrev_b32 v2, 6, v0
    v_and_b32 v1, 63, v0
    s_nop 0
    v_readfirstlane_b32 s32, v2
    v_lshlrev_b32 v12, 4, v1
    s_nop 2
    s_lshl_b32 s3, s34, 2
    s_sub_u32 s3, 30, s3
    s_lshl_b32 s4, s3, 14
    s_cmp_eq_u32 s35, 0
    s_cselect_b32 s36, 63, s3
    s_cselect_b32 s39, s4, 0
    s_mov_b32 s37, 0
    s_mov_b32 s38, 0
    s_mov_b32 s40, 0
    s_lshl_b32 s3, s32, 12
    v_add_u32 v8, s3, v12
    s_mov_b32 s42, s3
    s_xor_b32 s43, s3, 0x8000
    s_waitcnt lgkmcnt(0)
    s_lshl_b32 s3, s33, 20
    s_add_u32 s4, s3, 20971520
    s_add_u32 s6, s46, s4
    s_addc_u32 s7, s47, 0
    s_mov_b32 s8, s6
    s_and_b32 s9, s7, 0xffff
    s_mov_b32 s10, 1048576
    s_mov_b32 s11, 0x00020000
    s_add_u32 s4, s3, 4194304
    s_add_u32 s6, s46, s4
    s_addc_u32 s7, s47, 0
    s_mov_b32 s16, s6
    s_and_b32 s17, s7, 0xffff
    s_mov_b32 s18, 1048576
    s_mov_b32 s19, 0x00020000
    s_add_u32 s4, s3, 37748736
    s_add_u32 s6, s46, s4
    s_addc_u32 s7, s47, 0
    s_mov_b32 s12, s6
    s_and_b32 s13, s7, 0xffff
    s_mov_b32 s14, 1048576
    s_mov_b32 s15, 0x00020000
    s_add_u32 m0, s42, 0
    s_mov_b32 s52, s39
    buffer_load_dwordx4 v8, s[8:11], s39 offen offset:0 lds
    buffer_load_dwordx4 v8, s[8:11], s39 offen offset:1024 lds
    buffer_load_dwordx4 v8, s[8:11], s39 offen offset:2048 lds
    buffer_load_dwordx4 v8, s[8:11], s39 offen offset:3072 lds
    s_mov_b32 s41, s40
    s_mov_b32 s40, s39
    s_add_u32 s38, s38, 1
    s_add_u32 s39, s39, 16384
    s_cmp_eq_u32 s38, s36
    s_cselect_b32 s39, s37, s39
    s_cmp_ge_u32 s38, 34
    s_cselect_b32 s39, 2147418112, s39
    s_sub_u32 s5, 15, s34
    s_cmp_eq_u32 s35, 0
    s_cbranch_scc1 L_attn_qa
    s_lshl_b32 s6, s5, 16
    s_lshl_b32 s7, s32, 14
    s_add_u32 s6, s6, s7
    s_add_u32 s7, s6, 8192
    buffer_load_dwordx4 a[128:131], v12, s[16:19], s6 offen offset:0
    buffer_load_dwordx4 a[160:163], v12, s[16:19], s7 offen offset:0
    buffer_load_dwordx4 a[132:135], v12, s[16:19], s6 offen offset:1024
    buffer_load_dwordx4 a[164:167], v12, s[16:19], s7 offen offset:1024
    buffer_load_dwordx4 a[136:139], v12, s[16:19], s6 offen offset:2048
    buffer_load_dwordx4 a[168:171], v12, s[16:19], s7 offen offset:2048
    buffer_load_dwordx4 a[140:143], v12, s[16:19], s6 offen offset:3072
    buffer_load_dwordx4 a[172:175], v12, s[16:19], s7 offen offset:3072
    s_add_u32 s6, s6, 4096
    s_add_u32 s7, s7, 4096
    buffer_load_dwordx4 a[144:147], v12, s[16:19], s6 offen offset:0
    buffer_load_dwordx4 a[176:179], v12, s[16:19], s7 offen offset:0
    buffer_load_dwordx4 a[148:151], v12, s[16:19], s6 offen offset:1024
    buffer_load_dwordx4 a[180:183], v12, s[16:19], s7 offen offset:1024
    buffer_load_dwordx4 a[152:155], v12, s[16:19], s6 offen offset:2048
    buffer_load_dwordx4 a[184:187], v12, s[16:19], s7 offen offset:2048
    buffer_load_dwordx4 a[156:159], v12, s[16:19], s6 offen offset:3072
    buffer_load_dwordx4 a[188:191], v12, s[16:19], s7 offen offset:3072
    s_branch L_attn_qd
L_attn_qa:
    s_lshl_b32 s6, s5, 16
    s_lshl_b32 s7, s32, 14
    s_add_u32 s6, s6, s7
    s_add_u32 s7, s6, 8192
    buffer_load_dwordx4 v[156:159], v12, s[16:19], s6 offen offset:0
    buffer_load_dwordx4 v[188:191], v12, s[16:19], s7 offen offset:0
    buffer_load_dwordx4 v[160:163], v12, s[16:19], s6 offen offset:1024
    buffer_load_dwordx4 v[192:195], v12, s[16:19], s7 offen offset:1024
    buffer_load_dwordx4 v[164:167], v12, s[16:19], s6 offen offset:2048
    buffer_load_dwordx4 v[196:199], v12, s[16:19], s7 offen offset:2048
    buffer_load_dwordx4 v[168:171], v12, s[16:19], s6 offen offset:3072
    buffer_load_dwordx4 v[200:203], v12, s[16:19], s7 offen offset:3072
    s_add_u32 s6, s6, 4096
    s_add_u32 s7, s7, 4096
    buffer_load_dwordx4 v[172:175], v12, s[16:19], s6 offen offset:0
    buffer_load_dwordx4 v[204:207], v12, s[16:19], s7 offen offset:0
    buffer_load_dwordx4 v[176:179], v12, s[16:19], s6 offen offset:1024
    buffer_load_dwordx4 v[208:211], v12, s[16:19], s7 offen offset:1024
    buffer_load_dwordx4 v[180:183], v12, s[16:19], s6 offen offset:2048
    buffer_load_dwordx4 v[212:215], v12, s[16:19], s7 offen offset:2048
    buffer_load_dwordx4 v[184:187], v12, s[16:19], s6 offen offset:3072
    buffer_load_dwordx4 v[216:219], v12, s[16:19], s7 offen offset:3072
L_attn_qd:
    s_add_u32 m0, s42, 16384
    s_mov_b32 s53, s39
    buffer_load_dwordx4 v8, s[8:11], s39 offen offset:0 lds
    buffer_load_dwordx4 v8, s[8:11], s39 offen offset:1024 lds
    buffer_load_dwordx4 v8, s[8:11], s39 offen offset:2048 lds
    buffer_load_dwordx4 v8, s[8:11], s39 offen offset:3072 lds
    s_mov_b32 s41, s40
    s_mov_b32 s40, s39
    s_add_u32 s38, s38, 1
    s_add_u32 s39, s39, 16384
    s_cmp_eq_u32 s38, s36
    s_cselect_b32 s39, s37, s39
    s_cmp_ge_u32 s38, 34
    s_cselect_b32 s39, 2147418112, s39
    v_add_u32 v7, 65536, v12
    v_mov_b32_e64 v6, v12
    v_mov_b32 v11, 0xff800000
    s_mov_b32 s71, 0x40004000
    s_mov_b32 s51, 1000
    v_mov_b32_e64 v255, 0
    v_mov_b32 v88, 0x3f803f80
    v_mov_b32_e64 v228, 0
    v_mov_b32 v89, 0x3f803f80
    v_mov_b32_e64 v229, 0
    v_mov_b32 v90, 0x3f803f80
    v_mov_b32_e64 v230, 0
    v_mov_b32 v91, 0x3f803f80
    v_mov_b32 v231, 0
    v_and_b32 v2, 15, v1
    v_lshrrev_b32 v3, 4, v1
    v_lshlrev_b32 v3, 2, v3
    v_sub_u32 v9, v2, v3
    s_lshl_b32 s3, s32, 5
    v_add_u32_e64 v9, s3, v9
    v_mfma_f32_32x32x16_bf16 a[0:15], v[228:231], v[228:231], 0
    v_mfma_f32_32x32x16_bf16 a[16:31], v[228:231], v[228:231], 0
    v_mfma_f32_32x32x16_bf16 a[32:47], v[228:231], v[228:231], 0
    v_mfma_f32_32x32x16_bf16 a[48:63], v[228:231], v[228:231], 0
    v_mfma_f32_32x32x16_bf16 a[64:79], v[228:231], v[228:231], 0
    v_mfma_f32_32x32x16_bf16 a[80:95], v[228:231], v[228:231], 0
    v_mfma_f32_32x32x16_bf16 a[96:111], v[228:231], v[228:231], 0
    v_mfma_f32_32x32x16_bf16 a[112:127], v[228:231], v[228:231], 0
    s_cmp_eq_u32 s35, 0
    s_cselect_b32 s69, s5, s34
    s_lshl_b32 s6, s69, 3
    s_lshl_b32 s7, s32, 1
    s_add_u32 s6, s6, s7
    s_mul_i32 s6, s6, 229376
    s_lshl_b32 s7, s33, 10
    s_add_u32 s6, s6, s7
    s_add_u32 s6, s6, 109051904
    s_add_u32 s6, s46, s6
    s_addc_u32 s7, s47, 0
    s_mov_b32 s20, s6
    s_and_b32 s21, s7, 0xffff
    s_mov_b32 s22, 443392
    s_mov_b32 s23, 0x00020000
    s_lshl_b32 s6, s33, 3
    s_add_u32 s70, s6, s34
    s_lshl_b32 s6, s70, 2
    s_add_u32 s6, s6, s32
    s_mul_i32 s6, s6, 17408
    s_add_u32 s6, s6, 71303168
    s_add_u32 s6, s46, s6
    s_addc_u32 s7, s47, 0
    s_mov_b32 s24, s6
    s_and_b32 s25, s7, 0xffff
    s_mov_b32 s26, 17408
    s_mov_b32 s27, 0x00020000
    s_mov_b32 s28, s48
    s_and_b32 s29, s49, 0xffff
    s_mov_b32 s30, 256
    s_mov_b32 s31, 0x00020000
    s_lshl_b32 s70, s70, 1
    s_mul_i32 s6, s33, 229376
    s_add_u32 s6, s72, s6
    s_addc_u32 s7, s73, 0
    s_mov_b32 s72, s6
    s_and_b32 s73, s7, 0xffff
    s_mov_b32 s74, 229376
    s_mov_b32 s75, 0x00020000
    s_lshl_b32 s76, s32, 13
    s_mul_i32 s6, s32, 57344
    v_lshrrev_b32 v2, 3, v1
    v_and_b32 v3, 6, v2
    v_and_b32 v4, 7, v1
    v_xor_b32 v3, v3, v4
    v_lshlrev_b32 v3, 4, v3
    v_mul_u32_u24 v2, 896, v2
    v_add_u32 v2, v2, v3
    v_add_u32 v220, s6, v2
    v_lshrrev_b32_e64 v2, 2, v1
    v_bfe_u32 v3, v1, 3, 2
    v_and_b32 v4, 3, v1
    v_lshlrev_b32 v4, 3, v4
    v_lshl_add_u32 v4, v2, 7, v4
    v_xor_b32_e64 v5, 0, v3
    v_lshl_add_u32 v221, v5, 5, v4
    v_xor_b32_e64 v5, 1, v3
    v_lshl_add_u32 v222, v5, 5, v4
    v_xor_b32_e64 v5, 2, v3
    v_lshl_add_u32 v223, v5, 5, v4
    v_xor_b32_e64 v5, 3, v3
    v_lshl_add_u32 v224, v5, 5, v4
    s_add_u32 m0, s42, 32768
    s_mov_b32 s54, s39
    buffer_load_dwordx4 v8, s[8:11], s39 offen offset:0 lds
    buffer_load_dwordx4 v8, s[8:11], s39 offen offset:1024 lds
    buffer_load_dwordx4 v8, s[8:11], s39 offen offset:2048 lds
    buffer_load_dwordx4 v8, s[8:11], s39 offen offset:3072 lds
    s_mov_b32 s41, s40
    s_mov_b32 s40, s39
    s_add_u32 s38, s38, 1
    s_add_u32 s39, s39, 16384
    s_cmp_eq_u32 s38, s36
    s_cselect_b32 s39, s37, s39
    s_cmp_ge_u32 s38, 34
    s_cselect_b32 s39, 2147418112, s39
    s_add_u32 m0, s42, 65536
    s_nop 0
    buffer_load_dwordx4 v8, s[12:15], s52 offen offset:0 lds
    buffer_load_dwordx4 v8, s[12:15], s52 offen offset:1024 lds
    buffer_load_dwordx4 v8, s[12:15], s52 offen offset:2048 lds
    buffer_load_dwordx4 v8, s[12:15], s52 offen offset:3072 lds
    s_add_u32 m0, s42, 49152
    s_mov_b32 s55, s39
    buffer_load_dwordx4 v8, s[8:11], s39 offen offset:0 lds
    buffer_load_dwordx4 v8, s[8:11], s39 offen offset:1024 lds
    buffer_load_dwordx4 v8, s[8:11], s39 offen offset:2048 lds
    buffer_load_dwordx4 v8, s[8:11], s39 offen offset:3072 lds
    s_mov_b32 s41, s40
    s_mov_b32 s40, s39
    s_add_u32 s38, s38, 1
    s_add_u32 s39, s39, 16384
    s_cmp_eq_u32 s38, s36
    s_cselect_b32 s39, s37, s39
    s_cmp_ge_u32 s38, 34
    s_cselect_b32 s39, 2147418112, s39
    s_add_u32 m0, s42, 81920
    s_nop 0
    buffer_load_dwordx4 v8, s[12:15], s53 offen offset:0 lds
    buffer_load_dwordx4 v8, s[12:15], s53 offen offset:1024 lds
    buffer_load_dwordx4 v8, s[12:15], s53 offen offset:2048 lds
    buffer_load_dwordx4 v8, s[12:15], s53 offen offset:3072 lds
    s_cmp_eq_u32 s35, 0
    s_cbranch_scc1 L_attn_A
    s_waitcnt vmcnt(36)
    s_barrier
    ds_read_b128 a[192:195], v6 offset:0
    ds_read_b128 a[224:227], v6 offset:8192
    ds_read_b128 a[196:199], v6 offset:1024
    ds_read_b128 a[228:231], v6 offset:9216
    ds_read_b128 a[200:203], v6 offset:2048
    ds_read_b128 a[232:235], v6 offset:10240
    ds_read_b128 a[204:207], v6 offset:3072
    ds_read_b128 a[236:239], v6 offset:11264
    ds_read_b128 a[208:211], v6 offset:4096
    ds_read_b128 a[240:243], v6 offset:12288
    ds_read_b128 a[212:215], v6 offset:5120
    ds_read_b128 a[244:247], v6 offset:13312
    ds_read_b128 a[216:219], v6 offset:6144
    ds_read_b128 a[248:251], v6 offset:14336
    ds_read_b128 a[220:223], v6 offset:7168
    ds_read_b128 a[252:255], v6 offset:15360
    s_waitcnt vmcnt(34) lgkmcnt(14)
    v_mfma_f32_16x16x32_bf16 v[16:19], a[192:195], a[128:131], 0
    v_mfma_f32_16x16x32_bf16 v[20:23], a[192:195], a[160:163], 0
    v_mfma_f32_16x16x32_bf16 v[24:27], a[224:227], a[128:131], 0
    v_mfma_f32_16x16x32_bf16 v[28:31], a[224:227], a[160:163], 0
    s_waitcnt vmcnt(32) lgkmcnt(12)
    v_mfma_f32_16x16x32_bf16 v[16:19], a[196:199], a[132:135], v[16:19]
    v_mfma_f32_16x16x32_bf16 v[20:23], a[196:199], a[164:167], v[20:23]
    v_mfma_f32_16x16x32_bf16 v[24:27], a[228:231], a[132:135], v[24:27]
    v_mfma_f32_16x16x32_bf16 v[28:31], a[228:231], a[164:167], v[28:31]
    s_waitcnt vmcnt(30) lgkmcnt(10)
    v_mfma_f32_16x16x32_bf16 v[16:19], a[200:203], a[136:139], v[16:19]
    v_mfma_f32_16x16x32_bf16 v[20:23], a[200:203], a[168:171], v[20:23]
    v_mfma_f32_16x16x32_bf16 v[24:27], a[232:235], a[136:139], v[24:27]
    v_mfma_f32_16x16x32_bf16 v[28:31], a[232:235], a[168:171], v[28:31]
    s_waitcnt vmcnt(28) lgkmcnt(8)
    v_mfma_f32_16x16x32_bf16 v[16:19], a[204:207], a[140:143], v[16:19]
    v_mfma_f32_16x16x32_bf16 v[20:23], a[204:207], a[172:175], v[20:23]
    v_mfma_f32_16x16x32_bf16 v[24:27], a[236:239], a[140:143], v[24:27]
    v_mfma_f32_16x16x32_bf16 v[28:31], a[236:239], a[172:175], v[28:31]
    s_waitcnt vmcnt(26) lgkmcnt(6)
    v_mfma_f32_16x16x32_bf16 v[16:19], a[208:211], a[144:147], v[16:19]
    v_mfma_f32_16x16x32_bf16 v[20:23], a[208:211], a[176:179], v[20:23]
    v_mfma_f32_16x16x32_bf16 v[24:27], a[240:243], a[144:147], v[24:27]
    v_mfma_f32_16x16x32_bf16 v[28:31], a[240:243], a[176:179], v[28:31]
    s_waitcnt vmcnt(24) lgkmcnt(4)
    v_mfma_f32_16x16x32_bf16 v[16:19], a[212:215], a[148:151], v[16:19]
    v_mfma_f32_16x16x32_bf16 v[20:23], a[212:215], a[180:183], v[20:23]
    v_mfma_f32_16x16x32_bf16 v[24:27], a[244:247], a[148:151], v[24:27]
    v_mfma_f32_16x16x32_bf16 v[28:31], a[244:247], a[180:183], v[28:31]
    s_waitcnt vmcnt(22) lgkmcnt(2)
    v_mfma_f32_16x16x32_bf16 v[16:19], a[216:219], a[152:155], v[16:19]
    v_mfma_f32_16x16x32_bf16 v[20:23], a[216:219], a[184:187], v[20:23]
    v_mfma_f32_16x16x32_bf16 v[24:27], a[248:251], a[152:155], v[24:27]
    v_mfma_f32_16x16x32_bf16 v[28:31], a[248:251], a[184:187], v[28:31]
    s_waitcnt vmcnt(20) lgkmcnt(0)
    v_mfma_f32_16x16x32_bf16 v[16:19], a[220:223], a[156:159], v[16:19]
    v_mfma_f32_16x16x32_bf16 v[20:23], a[220:223], a[188:191], v[20:23]
    v_mfma_f32_16x16x32_bf16 v[24:27], a[252:255], a[156:159], v[24:27]
    v_mfma_f32_16x16x32_bf16 v[28:31], a[252:255], a[188:191], v[28:31]
    s_waitcnt vmcnt(16)
    s_barrier
    ds_read_b128 a[192:195], v6 offset:16384
    ds_read_b128 a[224:227], v6 offset:24576
    ds_read_b128 a[196:199], v6 offset:17408
    ds_read_b128 a[228:231], v6 offset:25600
    ds_read_b128 a[200:203], v6 offset:18432
    ds_read_b128 a[232:235], v6 offset:26624
    ds_read_b128 a[204:207], v6 offset:19456
    ds_read_b128 a[236:239], v6 offset:27648
    ds_read_b128 a[208:211], v6 offset:20480
    ds_read_b128 a[240:243], v6 offset:28672
    ds_read_b128 a[212:215], v6 offset:21504
    ds_read_b128 a[244:247], v6 offset:29696
    ds_read_b128 a[216:219], v6 offset:22528
    ds_read_b128 a[248:251], v6 offset:30720
    ds_read_b128 a[220:223], v6 offset:23552
    ds_read_b128 a[252:255], v6 offset:31744
    s_waitcnt vmcnt(8) lgkmcnt(0)
    s_barrier
    s_mov_b32 m0, s42
    s_nop 0
    buffer_load_dwordx4 v8, s[8:11], s39 offen offset:0 lds
    buffer_load_dwordx4 v8, s[8:11], s39 offen offset:1024 lds
    buffer_load_dwordx4 v8, s[8:11], s39 offen offset:2048 lds
    buffer_load_dwordx4 v8, s[8:11], s39 offen offset:3072 lds
    s_add_u32 m0, s42, 98304
    s_nop 0
    buffer_load_dwordx4 v8, s[12:15], s41 offen offset:0 lds
    buffer_load_dwordx4 v8, s[12:15], s41 offen offset:1024 lds
    buffer_load_dwordx4 v8, s[12:15], s41 offen offset:2048 lds
    buffer_load_dwordx4 v8, s[12:15], s41 offen offset:3072 lds
    s_mov_b32 s41, s40
    s_mov_b32 s40, s39
    s_add_u32 s38, s38, 1
    s_add_u32 s39, s39, 16384
    s_cmp_eq_u32 s38, s36
    s_cselect_b32 s39, s37, s39
    s_cmp_ge_u32 s38, 34
    s_cselect_b32 s39, 2147418112, s39
    v_xor_b32 v6, 0x8000, v6
    s_mov_b32 s45, 4096
    v_add_u32 v10, s45, v9
    v_cmp_gt_i32 s[52:53], 0, v10
    v_cmp_gt_i32 s[54:55], 1, v10
    v_cmp_gt_i32 s[56:57], 2, v10
    v_cmp_gt_i32 s[58:59], 3, v10
    v_cmp_gt_i32 s[60:61], -16, v10
    v_cmp_gt_i32 s[62:63], -15, v10
    v_cmp_gt_i32 s[64:65], -14, v10
    v_cmp_gt_i32 s[66:67], -13, v10
    v_cndmask_b32 v16, v16, v11, s[52:53]
    v_cndmask_b32 v17, v17, v11, s[54:55]
    v_cndmask_b32 v18, v18, v11, s[56:57]
    v_cndmask_b32 v19, v19, v11, s[58:59]
    v_cndmask_b32 v20, v20, v11, s[60:61]
    v_cndmask_b32 v21, v21, v11, s[62:63]
    v_cndmask_b32 v22, v22, v11, s[64:65]
    v_cndmask_b32 v23, v23, v11, s[66:67]
    v_cmp_gt_i32 s[52:53], 16, v10
    v_cmp_gt_i32 s[54:55], 17, v10
    v_cmp_gt_i32 s[56:57], 18, v10
    v_cmp_gt_i32 s[58:59], 19, v10
    v_cmp_gt_i32 s[60:61], 0, v10
    v_cmp_gt_i32 s[62:63], 1, v10
    v_cmp_gt_i32 s[64:65], 2, v10
    v_cmp_gt_i32 s[66:67], 3, v10
    v_cndmask_b32 v24, v24, v11, s[52:53]
    v_cndmask_b32 v25, v25, v11, s[54:55]
    v_cndmask_b32 v26, v26, v11, s[56:57]
    v_cndmask_b32 v27, v27, v11, s[58:59]
    v_cndmask_b32 v28, v28, v11, s[60:61]
    v_cndmask_b32 v29, v29, v11, s[62:63]
    v_cndmask_b32 v30, v30, v11, s[64:65]
    v_cndmask_b32 v31, v31, v11, s[66:67]
    v_mov_b32 v80, 0
    v_mov_b32 v81, 0
    v_mov_b32 v82, 0
    v_mov_b32 v83, 0
    v_mov_b32 v84, 0
    v_mov_b32 v85, 0
    v_mov_b32 v86, 0
    v_mov_b32 v87, 0
    v_max3_f32 v2, v16, v17, v18
    v_max3_f32 v2, v2, v19, v24
    v_max3_f32 v2, v2, v25, v26
    v_max_f32 v2, v2, v27
    v_mov_b32 v3, v2
    s_nop 1
    v_permlane16_swap_b32 v2, v3
    s_nop 1
    v_max_f32 v2, v2, v3
    v_mov_b32 v3, v2
    s_nop 1
    v_permlane32_swap_b32 v2, v3
    s_nop 1
    v_max_f32_e64 v2, v2, v3
    v_add_f32 v2, 0x41400000, v2
    v_sub_f32 v72, 0, v2
    v_sub_f32 v73, 0, v2
    v_sub_f32 v74, 0, v2
    v_sub_f32 v75, 0, v2
    v_sub_f32 v16, v16, v2
    v_sub_f32 v17, v17, v2
    v_sub_f32 v18, v18, v2
    v_sub_f32 v19, v19, v2
    v_sub_f32 v24, v24, v2
    v_sub_f32 v25, v25, v2
    v_sub_f32 v26, v26, v2
    v_sub_f32 v27, v27, v2
    v_max3_f32 v2, v20, v21, v22
    v_max3_f32 v2, v2, v23, v28
    v_max3_f32 v2, v2, v29, v30
    v_max_f32 v2, v2, v31
    v_mov_b32 v3, v2
    s_nop 1
    v_permlane16_swap_b32 v2, v3
    s_nop 1
    v_max_f32 v2, v2, v3
    v_mov_b32 v3, v2
    s_nop 1
    v_permlane32_swap_b32 v2, v3
    s_nop 1
    v_max_f32_e64 v2, v2, v3
    v_add_f32 v2, 0x41400000, v2
    v_sub_f32 v76, 0, v2
    v_sub_f32 v77, 0, v2
    v_sub_f32 v78, 0, v2
    v_sub_f32 v79, 0, v2
    v_sub_f32 v20, v20, v2
    v_sub_f32 v21, v21, v2
    v_sub_f32 v22, v22, v2
    v_sub_f32 v23, v23, v2
    v_sub_f32 v28, v28, v2
    v_sub_f32 v29, v29, v2
    v_sub_f32 v30, v30, v2
    v_sub_f32 v31, v31, v2
    s_lshr_b32 s44, s36, 1
    s_sub_u32 s44, s44, 1
    s_mov_b32 s77, 0
    s_cmp_eq_u32 s44, 0
    s_cbranch_scc1 L_attn_q2
    s_sub_u32 s3, s44, 1
.p2align 3
L_attn_j1loop:
    v_mfma_f32_16x16x32_bf16 v[32:35], a[192:195], a[128:131], v[72:75]
    v_exp_f32_e64 v48, v16
    v_mfma_f32_16x16x32_bf16 v[36:39], a[192:195], a[160:163], v[76:79]
    v_exp_f32_e64 v49, v17
    v_mfma_f32_16x16x32_bf16 v[40:43], a[224:227], a[128:131], v[72:75]
    ds_read_b128 v[92:95], v7 offset:0
    v_cvt_pk_bf16_f32 v64, v48, v49
    v_mfma_f32_16x16x32_bf16 v[44:47], a[224:227], a[160:163], v[76:79]
    ds_read_b128 v[96:99], v7 offset:1024
    v_mfma_f32_16x16x32_bf16 v[32:35], a[196:199], a[132:135], v[32:35]
    v_exp_f32_e64 v50, v18
    v_mfma_f32_16x16x32_bf16 v[36:39], a[196:199], a[164:167], v[36:39]
    v_exp_f32_e64 v51, v19
    v_mfma_f32_16x16x32_bf16 v[40:43], a[228:231], a[132:135], v[40:43]
    ds_read_b128 v[100:103], v7 offset:2048
    v_cvt_pk_bf16_f32 v65, v50, v51
    v_mfma_f32_16x16x32_bf16 v[44:47], a[228:231], a[164:167], v[44:47]
    ds_read_b128 v[104:107], v7 offset:3072
    v_mfma_f32_16x16x32_bf16 v[32:35], a[200:203], a[136:139], v[32:35]
    v_exp_f32_e64 v52, v24
    v_mfma_f32_16x16x32_bf16 v[36:39], a[200:203], a[168:171], v[36:39]
    v_exp_f32_e64 v53, v25
    v_mfma_f32_16x16x32_bf16 v[40:43], a[232:235], a[136:139], v[40:43]
    ds_read_b128 v[108:111], v7 offset:4096
    v_cvt_pk_bf16_f32 v66, v52, v53
    v_mfma_f32_16x16x32_bf16 v[44:47], a[232:235], a[168:171], v[44:47]
    ds_read_b128 v[112:115], v7 offset:5120
    v_or3_b32 v13, v64, v65, v66
    v_mfma_f32_16x16x32_bf16 v[32:35], a[204:207], a[140:143], v[32:35]
    v_exp_f32_e64 v54, v26
    v_mfma_f32_16x16x32_bf16 v[36:39], a[204:207], a[172:175], v[36:39]
    v_exp_f32_e64 v55, v27
    v_mfma_f32_16x16x32_bf16 v[40:43], a[236:239], a[140:143], v[40:43]
    ds_read_b128 v[116:119], v7 offset:6144
    v_cvt_pk_bf16_f32 v67, v54, v55
    v_mfma_f32_16x16x32_bf16 v[44:47], a[236:239], a[172:175], v[44:47]
    ds_read_b128 v[120:123], v7 offset:7168
    v_mfma_f32_16x16x32_bf16 v[32:35], a[208:211], a[144:147], v[32:35]
    v_exp_f32_e64 v56, v20
    v_mfma_f32_16x16x32_bf16 v[36:39], a[208:211], a[176:179], v[36:39]
    v_exp_f32_e64 v57, v21
    v_mfma_f32_16x16x32_bf16 v[40:43], a[240:243], a[144:147], v[40:43]
    ds_read_b128 v[124:127], v7 offset:8192
    v_cvt_pk_bf16_f32 v68, v56, v57
    v_mfma_f32_16x16x32_bf16 v[44:47], a[240:243], a[176:179], v[44:47]
    ds_read_b128 v[128:131], v7 offset:9216
    v_or3_b32 v13, v13, v67, v68
    v_mfma_f32_16x16x32_bf16 v[32:35], a[212:215], a[148:151], v[32:35]
    v_exp_f32_e64 v58, v22
    v_mfma_f32_16x16x32_bf16 v[36:39], a[212:215], a[180:183], v[36:39]
    v_exp_f32_e64 v59, v23
    v_mfma_f32_16x16x32_bf16 v[40:43], a[244:247], a[148:151], v[40:43]
    ds_read_b128 v[132:135], v7 offset:10240
    v_cvt_pk_bf16_f32 v69, v58, v59
    v_mfma_f32_16x16x32_bf16 v[44:47], a[244:247], a[180:183], v[44:47]
    ds_read_b128 v[136:139], v7 offset:11264
    v_mfma_f32_16x16x32_bf16 v[32:35], a[216:219], a[152:155], v[32:35]
    v_exp_f32_e64 v60, v28
    v_mfma_f32_16x16x32_bf16 v[36:39], a[216:219], a[184:187], v[36:39]
    v_exp_f32_e64 v61, v29
    v_mfma_f32_16x16x32_bf16 v[40:43], a[248:251], a[152:155], v[40:43]
    ds_read_b128 v[140:143], v7 offset:12288
    v_cvt_pk_bf16_f32 v70, v60, v61
    v_mfma_f32_16x16x32_bf16 v[44:47], a[248:251], a[184:187], v[44:47]
    ds_read_b128 v[144:147], v7 offset:13312
    v_or3_b32 v13, v13, v69, v70
    v_mfma_f32_16x16x32_bf16 v[32:35], a[220:223], a[156:159], v[32:35]
    v_exp_f32_e64 v62, v30
    v_mfma_f32_16x16x32_bf16 v[36:39], a[220:223], a[188:191], v[36:39]
    v_exp_f32_e64 v63, v31
    v_mfma_f32_16x16x32_bf16 v[40:43], a[252:255], a[156:159], v[40:43]
    v_cvt_pk_bf16_f32 v71, v62, v63
    v_and_b32_e64 v13, s71, v13
    v_mfma_f32_16x16x32_bf16 v[44:47], a[252:255], a[188:191], v[44:47]
    v_and_or_b32 v13, v71, s71, v13
    v_cmp_ne_u32 vcc, 0, v13
    s_waitcnt vmcnt(8)
    s_barrier
    s_cbranch_vccnz L_attn_kernel_slow_1
L_attn_kernel_ret_2:
    s_waitcnt lgkmcnt(2)
    v_mfma_f32_16x16x32_bf16 a[0:3], v[92:95], v[64:67], a[0:3]
    ds_read_b128 v[148:151], v7 offset:14336
    v_mfma_f32_16x16x32_bf16 a[4:7], v[92:95], v[68:71], a[4:7]
    ds_read_b128 v[152:155], v7 offset:15360
    s_add_u32 m0, s42, 16384
    v_mfma_f32_16x16x32_bf16 a[8:11], v[96:99], v[64:67], a[8:11]
    buffer_load_dwordx4 v8, s[8:11], s39 offen offset:0 lds
    v_mfma_f32_16x16x32_bf16 a[12:15], v[96:99], v[68:71], a[12:15]
    ds_read_b128 a[192:195], v6 offset:0
    v_mfma_f32_16x16x32_bf16 a[16:19], v[100:103], v[64:67], a[16:19]
    ds_read_b128 a[224:227], v6 offset:8192
    v_mfma_f32_16x16x32_bf16 a[20:23], v[100:103], v[68:71], a[20:23]
    ds_read_b128 a[196:199], v6 offset:1024
    v_mfma_f32_16x16x32_bf16 a[24:27], v[104:107], v[64:67], a[24:27]
    buffer_load_dwordx4 v8, s[8:11], s39 offen offset:1024 lds
    v_mfma_f32_16x16x32_bf16 a[28:31], v[104:107], v[68:71], a[28:31]
    ds_read_b128 a[228:231], v6 offset:9216
    v_mfma_f32_16x16x32_bf16 a[32:35], v[108:111], v[64:67], a[32:35]
    ds_read_b128 a[200:203], v6 offset:2048
    v_mfma_f32_16x16x32_bf16 a[36:39], v[108:111], v[68:71], a[36:39]
    ds_read_b128 a[232:235], v6 offset:10240
    v_mfma_f32_16x16x32_bf16 a[40:43], v[112:115], v[64:67], a[40:43]
    buffer_load_dwordx4 v8, s[8:11], s39 offen offset:2048 lds
    v_mfma_f32_16x16x32_bf16 a[44:47], v[112:115], v[68:71], a[44:47]
    ds_read_b128 a[204:207], v6 offset:3072
    v_mfma_f32_16x16x32_bf16 v[80:83], v[88:91], v[64:67], v[80:83]
    ds_read_b128 a[236:239], v6 offset:11264
    v_mfma_f32_16x16x32_bf16 a[48:51], v[116:119], v[64:67], a[48:51]
    ds_read_b128 a[208:211], v6 offset:4096
    v_mfma_f32_16x16x32_bf16 a[52:55], v[116:119], v[68:71], a[52:55]
    buffer_load_dwordx4 v8, s[8:11], s39 offen offset:3072 lds
    v_mfma_f32_16x16x32_bf16 a[56:59], v[120:123], v[64:67], a[56:59]
    ds_read_b128 a[240:243], v6 offset:12288
    v_mfma_f32_16x16x32_bf16 a[60:63], v[120:123], v[68:71], a[60:63]
    ds_read_b128 a[212:215], v6 offset:5120
    v_mfma_f32_16x16x32_bf16 a[64:67], v[124:127], v[64:67], a[64:67]
    ds_read_b128 a[244:247], v6 offset:13312
    s_add_u32 m0, s43, 81920
    v_mfma_f32_16x16x32_bf16 a[68:71], v[124:127], v[68:71], a[68:71]
    buffer_load_dwordx4 v8, s[12:15], s41 offen offset:0 lds
    v_mfma_f32_16x16x32_bf16 a[72:75], v[128:131], v[64:67], a[72:75]
    ds_read_b128 a[216:219], v6 offset:6144
    s_mov_b32 s68, s39
    v_mfma_f32_16x16x32_bf16 a[76:79], v[128:131], v[68:71], a[76:79]
    ds_read_b128 a[248:251], v6 offset:14336
    s_add_u32 s38, s38, 1
    v_mfma_f32_16x16x32_bf16 v[84:87], v[88:91], v[68:71], v[84:87]
    ds_read_b128 a[220:223], v6 offset:7168
    s_add_u32 s39, s39, 16384
    v_mfma_f32_16x16x32_bf16 a[80:83], v[132:135], v[64:67], a[80:83]
    buffer_load_dwordx4 v8, s[12:15], s41 offen offset:1024 lds
    v_mfma_f32_16x16x32_bf16 a[84:87], v[132:135], v[68:71], a[84:87]
    ds_read_b128 a[252:255], v6 offset:15360
    v_mfma_f32_16x16x32_bf16 a[88:91], v[136:139], v[64:67], a[88:91]
    s_cmp_eq_u32 s38, s36
    s_cselect_b32 s39, s37, s39
    v_mfma_f32_16x16x32_bf16 a[92:95], v[136:139], v[68:71], a[92:95]
    s_cmp_ge_u32 s38, 34
    s_cselect_b32 s39, 2147418112, s39
    s_waitcnt lgkmcnt(15)
    v_mfma_f32_16x16x32_bf16 a[96:99], v[140:143], v[64:67], a[96:99]
    buffer_load_dwordx4 v8, s[12:15], s41 offen offset:2048 lds
    v_mfma_f32_16x16x32_bf16 a[100:103], v[140:143], v[68:71], a[100:103]
    v_mfma_f32_16x16x32_bf16 a[104:107], v[144:147], v[64:67], a[104:107]
    v_mfma_f32_16x16x32_bf16 a[108:111], v[144:147], v[68:71], a[108:111]
    v_mfma_f32_16x16x32_bf16 a[112:115], v[148:151], v[64:67], a[112:115]
    buffer_load_dwordx4 v8, s[12:15], s41 offen offset:3072 lds
    v_mfma_f32_16x16x32_bf16 a[116:119], v[148:151], v[68:71], a[116:119]
    s_mov_b32 s41, s40
    s_mov_b32 s40, s68
    v_mfma_f32_16x16x32_bf16 a[120:123], v[152:155], v[64:67], a[120:123]
    v_mfma_f32_16x16x32_bf16 a[124:127], v[152:155], v[68:71], a[124:127]
    s_waitcnt lgkmcnt(0)
    v_mfma_f32_16x16x32_bf16 v[16:19], a[192:195], a[128:131], v[72:75]
    v_exp_f32_e64 v48, v32
    v_mfma_f32_16x16x32_bf16 v[20:23], a[192:195], a[160:163], v[76:79]
    v_exp_f32_e64 v49, v33
    v_mfma_f32_16x16x32_bf16 v[24:27], a[224:227], a[128:131], v[72:75]
    ds_read_b128 v[92:95], v7 offset:16384
    v_cvt_pk_bf16_f32 v64, v48, v49
    v_mfma_f32_16x16x32_bf16 v[28:31], a[224:227], a[160:163], v[76:79]
    ds_read_b128 v[96:99], v7 offset:17408
    v_mfma_f32_16x16x32_bf16 v[16:19], a[196:199], a[132:135], v[16:19]
    v_exp_f32_e64 v50, v34
    v_mfma_f32_16x16x32_bf16 v[20:23], a[196:199], a[164:167], v[20:23]
    v_exp_f32_e64 v51, v35
    v_mfma_f32_16x16x32_bf16 v[24:27], a[228:231], a[132:135], v[24:27]
    ds_read_b128 v[100:103], v7 offset:18432
    v_cvt_pk_bf16_f32 v65, v50, v51
    v_mfma_f32_16x16x32_bf16 v[28:31], a[228:231], a[164:167], v[28:31]
    ds_read_b128 v[104:107], v7 offset:19456
    v_mfma_f32_16x16x32_bf16 v[16:19], a[200:203], a[136:139], v[16:19]
    v_exp_f32_e64 v52, v40
    v_mfma_f32_16x16x32_bf16 v[20:23], a[200:203], a[168:171], v[20:23]
    v_exp_f32_e64 v53, v41
    v_mfma_f32_16x16x32_bf16 v[24:27], a[232:235], a[136:139], v[24:27]
    ds_read_b128 v[108:111], v7 offset:20480
    v_cvt_pk_bf16_f32 v66, v52, v53
    v_mfma_f32_16x16x32_bf16 v[28:31], a[232:235], a[168:171], v[28:31]
    ds_read_b128 v[112:115], v7 offset:21504
    v_or3_b32 v13, v64, v65, v66
    v_mfma_f32_16x16x32_bf16 v[16:19], a[204:207], a[140:143], v[16:19]
    v_exp_f32_e64 v54, v42
    v_mfma_f32_16x16x32_bf16 v[20:23], a[204:207], a[172:175], v[20:23]
    v_exp_f32_e64 v55, v43
    v_mfma_f32_16x16x32_bf16 v[24:27], a[236:239], a[140:143], v[24:27]
    ds_read_b128 v[116:119], v7 offset:22528
    v_cvt_pk_bf16_f32 v67, v54, v55
    v_mfma_f32_16x16x32_bf16 v[28:31], a[236:239], a[172:175], v[28:31]
    ds_read_b128 v[120:123], v7 offset:23552
    v_mfma_f32_16x16x32_bf16 v[16:19], a[208:211], a[144:147], v[16:19]
    v_exp_f32_e64 v56, v36
    v_mfma_f32_16x16x32_bf16 v[20:23], a[208:211], a[176:179], v[20:23]
    v_exp_f32_e64 v57, v37
    v_mfma_f32_16x16x32_bf16 v[24:27], a[240:243], a[144:147], v[24:27]
    ds_read_b128 v[124:127], v7 offset:24576
    v_cvt_pk_bf16_f32 v68, v56, v57
    v_mfma_f32_16x16x32_bf16 v[28:31], a[240:243], a[176:179], v[28:31]
    ds_read_b128 v[128:131], v7 offset:25600
    v_or3_b32 v13, v13, v67, v68
    v_mfma_f32_16x16x32_bf16 v[16:19], a[212:215], a[148:151], v[16:19]
    v_exp_f32_e64 v58, v38
    v_mfma_f32_16x16x32_bf16 v[20:23], a[212:215], a[180:183], v[20:23]
    v_exp_f32_e64 v59, v39
    v_mfma_f32_16x16x32_bf16 v[24:27], a[244:247], a[148:151], v[24:27]
    ds_read_b128 v[132:135], v7 offset:26624
    v_cvt_pk_bf16_f32 v69, v58, v59
    v_mfma_f32_16x16x32_bf16 v[28:31], a[244:247], a[180:183], v[28:31]
    ds_read_b128 v[136:139], v7 offset:27648
    v_mfma_f32_16x16x32_bf16 v[16:19], a[216:219], a[152:155], v[16:19]
    v_exp_f32_e64 v60, v44
    v_mfma_f32_16x16x32_bf16 v[20:23], a[216:219], a[184:187], v[20:23]
    v_exp_f32_e64 v61, v45
    v_mfma_f32_16x16x32_bf16 v[24:27], a[248:251], a[152:155], v[24:27]
    ds_read_b128 v[140:143], v7 offset:28672
    v_cvt_pk_bf16_f32 v70, v60, v61
    v_mfma_f32_16x16x32_bf16 v[28:31], a[248:251], a[184:187], v[28:31]
    ds_read_b128 v[144:147], v7 offset:29696
    v_or3_b32 v13, v13, v69, v70
    v_mfma_f32_16x16x32_bf16 v[16:19], a[220:223], a[156:159], v[16:19]
    v_exp_f32_e64 v62, v46
    v_mfma_f32_16x16x32_bf16 v[20:23], a[220:223], a[188:191], v[20:23]
    v_exp_f32_e64 v63, v47
    v_mfma_f32_16x16x32_bf16 v[24:27], a[252:255], a[156:159], v[24:27]
    v_cvt_pk_bf16_f32 v71, v62, v63
    v_and_b32_e64 v13, s71, v13
    v_mfma_f32_16x16x32_bf16 v[28:31], a[252:255], a[188:191], v[28:31]
    v_and_or_b32 v13, v71, s71, v13
    v_cmp_ne_u32 vcc, 0, v13
    s_waitcnt vmcnt(8)
    s_barrier
    s_cbranch_vccnz L_attn_kernel_slow_3
L_attn_kernel_ret_4:
    s_waitcnt lgkmcnt(2)
    v_mfma_f32_16x16x32_bf16 a[0:3], v[92:95], v[64:67], a[0:3]
    ds_read_b128 v[148:151], v7 offset:30720
    v_mfma_f32_16x16x32_bf16 a[4:7], v[92:95], v[68:71], a[4:7]
    ds_read_b128 v[152:155], v7 offset:31744
    s_mov_b32 m0, s43
    v_mfma_f32_16x16x32_bf16 a[8:11], v[96:99], v[64:67], a[8:11]
    buffer_load_dwordx4 v8, s[8:11], s39 offen offset:0 lds
    v_mfma_f32_16x16x32_bf16 a[12:15], v[96:99], v[68:71], a[12:15]
    ds_read_b128 a[192:195], v6 offset:16384
    v_mfma_f32_16x16x32_bf16 a[16:19], v[100:103], v[64:67], a[16:19]
    ds_read_b128 a[224:227], v6 offset:24576
    v_mfma_f32_16x16x32_bf16 a[20:23], v[100:103], v[68:71], a[20:23]
    ds_read_b128 a[196:199], v6 offset:17408
    v_mfma_f32_16x16x32_bf16 a[24:27], v[104:107], v[64:67], a[24:27]
    buffer_load_dwordx4 v8, s[8:11], s39 offen offset:1024 lds
    v_mfma_f32_16x16x32_bf16 a[28:31], v[104:107], v[68:71], a[28:31]
    ds_read_b128 a[228:231], v6 offset:25600
    v_mfma_f32_16x16x32_bf16 a[32:35], v[108:111], v[64:67], a[32:35]
    ds_read_b128 a[200:203], v6 offset:18432
    v_mfma_f32_16x16x32_bf16 a[36:39], v[108:111], v[68:71], a[36:39]
    ds_read_b128 a[232:235], v6 offset:26624
    v_mfma_f32_16x16x32_bf16 a[40:43], v[112:115], v[64:67], a[40:43]
    buffer_load_dwordx4 v8, s[8:11], s39 offen offset:2048 lds
    v_mfma_f32_16x16x32_bf16 a[44:47], v[112:115], v[68:71], a[44:47]
    ds_read_b128 a[204:207], v6 offset:19456
    v_mfma_f32_16x16x32_bf16 v[80:83], v[88:91], v[64:67], v[80:83]
    ds_read_b128 a[236:239], v6 offset:27648
    v_mfma_f32_16x16x32_bf16 a[48:51], v[116:119], v[64:67], a[48:51]
    ds_read_b128 a[208:211], v6 offset:20480
    v_mfma_f32_16x16x32_bf16 a[52:55], v[116:119], v[68:71], a[52:55]
    buffer_load_dwordx4 v8, s[8:11], s39 offen offset:3072 lds
    v_mfma_f32_16x16x32_bf16 a[56:59], v[120:123], v[64:67], a[56:59]
    ds_read_b128 a[240:243], v6 offset:28672
    v_mfma_f32_16x16x32_bf16 a[60:63], v[120:123], v[68:71], a[60:63]
    ds_read_b128 a[212:215], v6 offset:21504
    v_mfma_f32_16x16x32_bf16 a[64:67], v[124:127], v[64:67], a[64:67]
    ds_read_b128 a[244:247], v6 offset:29696
    s_add_u32 m0, s42, 65536
    v_mfma_f32_16x16x32_bf16 a[68:71], v[124:127], v[68:71], a[68:71]
    buffer_load_dwordx4 v8, s[12:15], s41 offen offset:0 lds
    v_mfma_f32_16x16x32_bf16 a[72:75], v[128:131], v[64:67], a[72:75]
    ds_read_b128 a[216:219], v6 offset:22528
    s_mov_b32 s68, s39
    v_mfma_f32_16x16x32_bf16 a[76:79], v[128:131], v[68:71], a[76:79]
    ds_read_b128 a[248:251], v6 offset:30720
    s_add_u32 s38, s38, 1
    v_mfma_f32_16x16x32_bf16 v[84:87], v[88:91], v[68:71], v[84:87]
    ds_read_b128 a[220:223], v6 offset:23552
    s_add_u32 s39, s39, 16384
    v_mfma_f32_16x16x32_bf16 a[80:83], v[132:135], v[64:67], a[80:83]
    buffer_load_dwordx4 v8, s[12:15], s41 offen offset:1024 lds
    v_mfma_f32_16x16x32_bf16 a[84:87], v[132:135], v[68:71], a[84:87]
    ds_read_b128 a[252:255], v6 offset:31744
    v_mfma_f32_16x16x32_bf16 a[88:91], v[136:139], v[64:67], a[88:91]
    s_cmp_eq_u32 s38, s36
    s_cselect_b32 s39, s37, s39
    v_mfma_f32_16x16x32_bf16 a[92:95], v[136:139], v[68:71], a[92:95]
    s_cmp_ge_u32 s38, 34
    s_cselect_b32 s39, 2147418112, s39
    s_waitcnt lgkmcnt(15)
    v_mfma_f32_16x16x32_bf16 a[96:99], v[140:143], v[64:67], a[96:99]
    buffer_load_dwordx4 v8, s[12:15], s41 offen offset:2048 lds
    v_mfma_f32_16x16x32_bf16 a[100:103], v[140:143], v[68:71], a[100:103]
    s_xor_b32 s42, s42, 0x8000
    s_xor_b32 s43, s43, 0x8000
    v_mfma_f32_16x16x32_bf16 a[104:107], v[144:147], v[64:67], a[104:107]
    v_xor_b32 v7, 0x8000, v7
    v_mfma_f32_16x16x32_bf16 a[108:111], v[144:147], v[68:71], a[108:111]
    v_mfma_f32_16x16x32_bf16 a[112:115], v[148:151], v[64:67], a[112:115]
    buffer_load_dwordx4 v8, s[12:15], s41 offen offset:3072 lds
    v_mfma_f32_16x16x32_bf16 a[116:119], v[148:151], v[68:71], a[116:119]
    s_mov_b32 s41, s40
    s_mov_b32 s40, s68
    v_xor_b32 v6, 0x8000, v6
    v_mfma_f32_16x16x32_bf16 a[120:123], v[152:155], v[64:67], a[120:123]
    v_mfma_f32_16x16x32_bf16 a[124:127], v[152:155], v[68:71], a[124:127]
    s_waitcnt lgkmcnt(0)
    s_sub_u32 s44, s44, 1
    s_cmp_lg_u32 s44, s3
    s_cbranch_scc1 L_attn_j1loop
    s_cmp_lg_u32 s77, 0
    s_cbranch_scc1 L_attn_j1tail
L_attn_q2:
    s_lshl_b32 s6, s34, 16
    s_lshl_b32 s7, s32, 14
    s_add_u32 s6, s6, s7
    s_add_u32 s7, s6, 8192
    buffer_load_dwordx4 v[156:159], v12, s[16:19], s6 offen offset:0
    buffer_load_dwordx4 v[188:191], v12, s[16:19], s7 offen offset:0
    buffer_load_dwordx4 v[160:163], v12, s[16:19], s6 offen offset:1024
    buffer_load_dwordx4 v[192:195], v12, s[16:19], s7 offen offset:1024
    buffer_load_dwordx4 v[164:167], v12, s[16:19], s6 offen offset:2048
    buffer_load_dwordx4 v[196:199], v12, s[16:19], s7 offen offset:2048
    buffer_load_dwordx4 v[168:171], v12, s[16:19], s6 offen offset:3072
    buffer_load_dwordx4 v[200:203], v12, s[16:19], s7 offen offset:3072
    s_add_u32 s6, s6, 4096
    s_add_u32 s7, s7, 4096
    buffer_load_dwordx4 v[172:175], v12, s[16:19], s6 offen offset:0
    buffer_load_dwordx4 v[204:207], v12, s[16:19], s7 offen offset:0
    buffer_load_dwordx4 v[176:179], v12, s[16:19], s6 offen offset:1024
    buffer_load_dwordx4 v[208:211], v12, s[16:19], s7 offen offset:1024
    buffer_load_dwordx4 v[180:183], v12, s[16:19], s6 offen offset:2048
    buffer_load_dwordx4 v[212:215], v12, s[16:19], s7 offen offset:2048
    buffer_load_dwordx4 v[184:187], v12, s[16:19], s6 offen offset:3072
    buffer_load_dwordx4 v[216:219], v12, s[16:19], s7 offen offset:3072
    s_mov_b32 s77, 1
    s_mov_b32 s3, 0
    s_cmp_lg_u32 s44, 0
    s_cbranch_scc1 L_attn_j1loop
L_attn_j1tail:
    v_mfma_f32_16x16x32_bf16 v[32:35], a[192:195], a[128:131], v[72:75]
    v_exp_f32 v48, v16
    v_mfma_f32_16x16x32_bf16 v[36:39], a[192:195], a[160:163], v[76:79]
    v_exp_f32_e64 v49, v17
    v_mfma_f32_16x16x32_bf16 v[40:43], a[224:227], a[128:131], v[72:75]
    ds_read_b128 v[92:95], v7 offset:0
    v_cvt_pk_bf16_f32 v64, v48, v49
    v_mfma_f32_16x16x32_bf16 v[44:47], a[224:227], a[160:163], v[76:79]
    ds_read_b128 v[96:99], v7 offset:1024
    v_mfma_f32_16x16x32_bf16 v[32:35], a[196:199], a[132:135], v[32:35]
    v_exp_f32_e64 v50, v18
    v_mfma_f32_16x16x32_bf16 v[36:39], a[196:199], a[164:167], v[36:39]
    v_exp_f32_e64 v51, v19
    v_mfma_f32_16x16x32_bf16 v[40:43], a[228:231], a[132:135], v[40:43]
    ds_read_b128 v[100:103], v7 offset:2048
    v_cvt_pk_bf16_f32 v65, v50, v51
    v_mfma_f32_16x16x32_bf16 v[44:47], a[228:231], a[164:167], v[44:47]
    ds_read_b128 v[104:107], v7 offset:3072
    v_mfma_f32_16x16x32_bf16 v[32:35], a[200:203], a[136:139], v[32:35]
    v_exp_f32_e64 v52, v24
    v_mfma_f32_16x16x32_bf16 v[36:39], a[200:203], a[168:171], v[36:39]
    v_exp_f32_e64 v53, v25
    v_mfma_f32_16x16x32_bf16 v[40:43], a[232:235], a[136:139], v[40:43]
    ds_read_b128 v[108:111], v7 offset:4096
    v_cvt_pk_bf16_f32 v66, v52, v53
    v_mfma_f32_16x16x32_bf16 v[44:47], a[232:235], a[168:171], v[44:47]
    ds_read_b128 v[112:115], v7 offset:5120
    v_or3_b32 v13, v64, v65, v66
    v_mfma_f32_16x16x32_bf16 v[32:35], a[204:207], a[140:143], v[32:35]
    v_exp_f32_e64 v54, v26
    v_mfma_f32_16x16x32_bf16 v[36:39], a[204:207], a[172:175], v[36:39]
    v_exp_f32_e64 v55, v27
    v_mfma_f32_16x16x32_bf16 v[40:43], a[236:239], a[140:143], v[40:43]
    ds_read_b128 v[116:119], v7 offset:6144
    v_cvt_pk_bf16_f32 v67, v54, v55
    v_mfma_f32_16x16x32_bf16 v[44:47], a[236:239], a[172:175], v[44:47]
    ds_read_b128 v[120:123], v7 offset:7168
    v_mfma_f32_16x16x32_bf16 v[32:35], a[208:211], a[144:147], v[32:35]
    v_exp_f32_e64 v56, v20
    v_mfma_f32_16x16x32_bf16 v[36:39], a[208:211], a[176:179], v[36:39]
    v_exp_f32_e64 v57, v21
    v_mfma_f32_16x16x32_bf16 v[40:43], a[240:243], a[144:147], v[40:43]
    ds_read_b128 v[124:127], v7 offset:8192
    v_cvt_pk_bf16_f32 v68, v56, v57
    v_mfma_f32_16x16x32_bf16 v[44:47], a[240:243], a[176:179], v[44:47]
    ds_read_b128 v[128:131], v7 offset:9216
    v_or3_b32 v13, v13, v67, v68
    v_mfma_f32_16x16x32_bf16 v[32:35], a[212:215], a[148:151], v[32:35]
    v_exp_f32_e64 v58, v22
    v_mfma_f32_16x16x32_bf16 v[36:39], a[212:215], a[180:183], v[36:39]
    v_exp_f32_e64 v59, v23
    v_mfma_f32_16x16x32_bf16 v[40:43], a[244:247], a[148:151], v[40:43]
    ds_read_b128 v[132:135], v7 offset:10240
    v_cvt_pk_bf16_f32 v69, v58, v59
    v_mfma_f32_16x16x32_bf16 v[44:47], a[244:247], a[180:183], v[44:47]
    ds_read_b128 v[136:139], v7 offset:11264
    v_mfma_f32_16x16x32_bf16 v[32:35], a[216:219], a[152:155], v[32:35]
    v_exp_f32_e64 v60, v28
    v_mfma_f32_16x16x32_bf16 v[36:39], a[216:219], a[184:187], v[36:39]
    v_exp_f32_e64 v61, v29
    v_mfma_f32_16x16x32_bf16 v[40:43], a[248:251], a[152:155], v[40:43]
    ds_read_b128 v[140:143], v7 offset:12288
    v_cvt_pk_bf16_f32 v70, v60, v61
    v_mfma_f32_16x16x32_bf16 v[44:47], a[248:251], a[184:187], v[44:47]
    ds_read_b128 v[144:147], v7 offset:13312
    v_or3_b32 v13, v13, v69, v70
    v_mfma_f32_16x16x32_bf16 v[32:35], a[220:223], a[156:159], v[32:35]
    v_exp_f32_e64 v62, v30
    v_mfma_f32_16x16x32_bf16 v[36:39], a[220:223], a[188:191], v[36:39]
    v_exp_f32_e64 v63, v31
    v_mfma_f32_16x16x32_bf16 v[40:43], a[252:255], a[156:159], v[40:43]
    v_cvt_pk_bf16_f32 v71, v62, v63
    v_and_b32_e64 v13, s71, v13
    v_mfma_f32_16x16x32_bf16 v[44:47], a[252:255], a[188:191], v[44:47]
    v_and_or_b32 v13, v71, s71, v13
    v_cmp_ne_u32 vcc, 0, v13
    s_waitcnt vmcnt(8)
    s_barrier
    s_cbranch_vccnz L_attn_kernel_slow_5
L_attn_kernel_ret_6:
    s_waitcnt lgkmcnt(2)
    v_mfma_f32_16x16x32_bf16 a[0:3], v[92:95], v[64:67], a[0:3]
    ds_read_b128 v[148:151], v7 offset:14336
    v_mfma_f32_16x16x32_bf16 a[4:7], v[92:95], v[68:71], a[4:7]
    ds_read_b128 v[152:155], v7 offset:15360
    s_add_u32 m0, s42, 16384
    v_mfma_f32_16x16x32_bf16 a[8:11], v[96:99], v[64:67], a[8:11]
    buffer_load_dwordx4 v8, s[8:11], s39 offen offset:0 lds
    v_mfma_f32_16x16x32_bf16 a[12:15], v[96:99], v[68:71], a[12:15]
    ds_read_b128 a[192:195], v6 offset:0
    v_mfma_f32_16x16x32_bf16 a[16:19], v[100:103], v[64:67], a[16:19]
    ds_read_b128 a[224:227], v6 offset:8192
    v_mfma_f32_16x16x32_bf16 a[20:23], v[100:103], v[68:71], a[20:23]
    ds_read_b128 a[196:199], v6 offset:1024
    v_mfma_f32_16x16x32_bf16 a[24:27], v[104:107], v[64:67], a[24:27]
    buffer_load_dwordx4 v8, s[8:11], s39 offen offset:1024 lds
    v_mfma_f32_16x16x32_bf16 a[28:31], v[104:107], v[68:71], a[28:31]
    ds_read_b128 a[228:231], v6 offset:9216
    v_mfma_f32_16x16x32_bf16 a[32:35], v[108:111], v[64:67], a[32:35]
    ds_read_b128 a[200:203], v6 offset:2048
    v_mfma_f32_16x16x32_bf16 a[36:39], v[108:111], v[68:71], a[36:39]
    ds_read_b128 a[232:235], v6 offset:10240
    v_mfma_f32_16x16x32_bf16 a[40:43], v[112:115], v[64:67], a[40:43]
    buffer_load_dwordx4 v8, s[8:11], s39 offen offset:2048 lds
    v_mfma_f32_16x16x32_bf16 a[44:47], v[112:115], v[68:71], a[44:47]
    ds_read_b128 a[204:207], v6 offset:3072
    v_mfma_f32_16x16x32_bf16 v[80:83], v[88:91], v[64:67], v[80:83]
    ds_read_b128 a[236:239], v6 offset:11264
    v_mfma_f32_16x16x32_bf16 a[48:51], v[116:119], v[64:67], a[48:51]
    ds_read_b128 a[208:211], v6 offset:4096
    v_mfma_f32_16x16x32_bf16 a[52:55], v[116:119], v[68:71], a[52:55]
    buffer_load_dwordx4 v8, s[8:11], s39 offen offset:3072 lds
    v_mfma_f32_16x16x32_bf16 a[56:59], v[120:123], v[64:67], a[56:59]
    ds_read_b128 a[240:243], v6 offset:12288
    v_mfma_f32_16x16x32_bf16 a[60:63], v[120:123], v[68:71], a[60:63]
    ds_read_b128 a[212:215], v6 offset:5120
    v_mfma_f32_16x16x32_bf16 a[64:67], v[124:127], v[64:67], a[64:67]
    ds_read_b128 a[244:247], v6 offset:13312
    s_add_u32 m0, s43, 81920
    v_mfma_f32_16x16x32_bf16 a[68:71], v[124:127], v[68:71], a[68:71]
    buffer_load_dwordx4 v8, s[12:15], s41 offen offset:0 lds
    v_mfma_f32_16x16x32_bf16 a[72:75], v[128:131], v[64:67], a[72:75]
    ds_read_b128 a[216:219], v6 offset:6144
    s_mov_b32 s68, s39
    v_mfma_f32_16x16x32_bf16 a[76:79], v[128:131], v[68:71], a[76:79]
    ds_read_b128 a[248:251], v6 offset:14336
    s_add_u32 s38, s38, 1
    v_mfma_f32_16x16x32_bf16 v[84:87], v[88:91], v[68:71], v[84:87]
    ds_read_b128 a[220:223], v6 offset:7168
    s_add_u32 s39, s39, 16384
    v_mfma_f32_16x16x32_bf16 a[80:83], v[132:135], v[64:67], a[80:83]
    buffer_load_dwordx4 v8, s[12:15], s41 offen offset:1024 lds
    v_mfma_f32_16x16x32_bf16 a[84:87], v[132:135], v[68:71], a[84:87]
    ds_read_b128 a[252:255], v6 offset:15360
    v_mfma_f32_16x16x32_bf16 a[88:91], v[136:139], v[64:67], a[88:91]
    s_cmp_eq_u32 s38, s36
    s_cselect_b32 s39, s37, s39
    v_mfma_f32_16x16x32_bf16 a[92:95], v[136:139], v[68:71], a[92:95]
    s_cmp_ge_u32 s38, 34
    s_cselect_b32 s39, 2147418112, s39
    s_waitcnt lgkmcnt(15)
    v_mfma_f32_16x16x32_bf16 a[96:99], v[140:143], v[64:67], a[96:99]
    buffer_load_dwordx4 v8, s[12:15], s41 offen offset:2048 lds
    v_mfma_f32_16x16x32_bf16 a[100:103], v[140:143], v[68:71], a[100:103]
    v_mfma_f32_16x16x32_bf16 a[104:107], v[144:147], v[64:67], a[104:107]
    v_mfma_f32_16x16x32_bf16 a[108:111], v[144:147], v[68:71], a[108:111]
    v_mfma_f32_16x16x32_bf16 a[112:115], v[148:151], v[64:67], a[112:115]
    buffer_load_dwordx4 v8, s[12:15], s41 offen offset:3072 lds
    v_mfma_f32_16x16x32_bf16 a[116:119], v[148:151], v[68:71], a[116:119]
    s_mov_b32 s41, s40
    s_mov_b32 s40, s68
    v_mfma_f32_16x16x32_bf16 a[120:123], v[152:155], v[64:67], a[120:123]
    v_mfma_f32_16x16x32_bf16 a[124:127], v[152:155], v[68:71], a[124:127]
    s_waitcnt vmcnt(8) lgkmcnt(0)
    v_mfma_f32_16x16x32_bf16 v[16:19], a[192:195], v[156:159], 0
    v_exp_f32_e64 v48, v32
    v_mfma_f32_16x16x32_bf16 v[20:23], a[192:195], v[188:191], 0
    v_exp_f32_e64 v49, v33
    v_mfma_f32_16x16x32_bf16 v[24:27], a[224:227], v[156:159], 0
    ds_read_b128 v[92:95], v7 offset:16384
    v_cvt_pk_bf16_f32 v64, v48, v49
    v_mfma_f32_16x16x32_bf16 v[28:31], a[224:227], v[188:191], 0
    ds_read_b128 v[96:99], v7 offset:17408
    v_mfma_f32_16x16x32_bf16 v[16:19], a[196:199], v[160:163], v[16:19]
    v_exp_f32_e64 v50, v34
    v_mfma_f32_16x16x32_bf16 v[20:23], a[196:199], v[192:195], v[20:23]
    v_exp_f32_e64 v51, v35
    v_mfma_f32_16x16x32_bf16 v[24:27], a[228:231], v[160:163], v[24:27]
    ds_read_b128 v[100:103], v7 offset:18432
    v_cvt_pk_bf16_f32 v65, v50, v51
    v_mfma_f32_16x16x32_bf16 v[28:31], a[228:231], v[192:195], v[28:31]
    ds_read_b128 v[104:107], v7 offset:19456
    v_mfma_f32_16x16x32_bf16 v[16:19], a[200:203], v[164:167], v[16:19]
    v_exp_f32_e64 v52, v40
    v_mfma_f32_16x16x32_bf16 v[20:23], a[200:203], v[196:199], v[20:23]
    v_exp_f32_e64 v53, v41
    v_mfma_f32_16x16x32_bf16 v[24:27], a[232:235], v[164:167], v[24:27]
    ds_read_b128 v[108:111], v7 offset:20480
    v_cvt_pk_bf16_f32 v66, v52, v53
    v_mfma_f32_16x16x32_bf16 v[28:31], a[232:235], v[196:199], v[28:31]
    ds_read_b128 v[112:115], v7 offset:21504
    v_or3_b32 v13, v64, v65, v66
    v_mfma_f32_16x16x32_bf16 v[16:19], a[204:207], v[168:171], v[16:19]
    v_exp_f32_e64 v54, v42
    v_mfma_f32_16x16x32_bf16 v[20:23], a[204:207], v[200:203], v[20:23]
    v_exp_f32_e64 v55, v43
    v_mfma_f32_16x16x32_bf16 v[24:27], a[236:239], v[168:171], v[24:27]
    ds_read_b128 v[116:119], v7 offset:22528
    v_cvt_pk_bf16_f32 v67, v54, v55
    v_mfma_f32_16x16x32_bf16 v[28:31], a[236:239], v[200:203], v[28:31]
    ds_read_b128 v[120:123], v7 offset:23552
    v_mfma_f32_16x16x32_bf16 v[16:19], a[208:211], v[172:175], v[16:19]
    v_exp_f32_e64 v56, v36
    v_mfma_f32_16x16x32_bf16 v[20:23], a[208:211], v[204:207], v[20:23]
    v_exp_f32_e64 v57, v37
    v_mfma_f32_16x16x32_bf16 v[24:27], a[240:243], v[172:175], v[24:27]
    ds_read_b128 v[124:127], v7 offset:24576
    v_cvt_pk_bf16_f32 v68, v56, v57
    v_mfma_f32_16x16x32_bf16 v[28:31], a[240:243], v[204:207], v[28:31]
    ds_read_b128 v[128:131], v7 offset:25600
    v_or3_b32 v13, v13, v67, v68
    v_mfma_f32_16x16x32_bf16 v[16:19], a[212:215], v[176:179], v[16:19]
    v_exp_f32_e64 v58, v38
    v_mfma_f32_16x16x32_bf16 v[20:23], a[212:215], v[208:211], v[20:23]
    v_exp_f32_e64 v59, v39
    v_mfma_f32_16x16x32_bf16 v[24:27], a[244:247], v[176:179], v[24:27]
    ds_read_b128 v[132:135], v7 offset:26624
    v_cvt_pk_bf16_f32 v69, v58, v59
    v_mfma_f32_16x16x32_bf16 v[28:31], a[244:247], v[208:211], v[28:31]
    ds_read_b128 v[136:139], v7 offset:27648
    v_mfma_f32_16x16x32_bf16 v[16:19], a[216:219], v[180:183], v[16:19]
    v_exp_f32_e64 v60, v44
    v_mfma_f32_16x16x32_bf16 v[20:23], a[216:219], v[212:215], v[20:23]
    v_exp_f32_e64 v61, v45
    v_mfma_f32_16x16x32_bf16 v[24:27], a[248:251], v[180:183], v[24:27]
    ds_read_b128 v[140:143], v7 offset:28672
    v_cvt_pk_bf16_f32 v70, v60, v61
    v_mfma_f32_16x16x32_bf16 v[28:31], a[248:251], v[212:215], v[28:31]
    ds_read_b128 v[144:147], v7 offset:29696
    v_or3_b32 v13, v13, v69, v70
    v_mfma_f32_16x16x32_bf16 v[16:19], a[220:223], v[184:187], v[16:19]
    v_exp_f32_e64 v62, v46
    v_mfma_f32_16x16x32_bf16 v[20:23], a[220:223], v[216:219], v[20:23]
    v_exp_f32_e64 v63, v47
    v_mfma_f32_16x16x32_bf16 v[24:27], a[252:255], v[184:187], v[24:27]
    v_cvt_pk_bf16_f32 v71, v62, v63
    v_and_b32_e64 v13, s71, v13
    v_mfma_f32_16x16x32_bf16 v[28:31], a[252:255], v[216:219], v[28:31]
    v_and_or_b32 v13, v71, s71, v13
    v_cmp_ne_u32 vcc, 0, v13
    s_waitcnt vmcnt(8)
    s_barrier
    s_cbranch_vccnz L_attn_kernel_slow_7
L_attn_kernel_ret_8:
    s_waitcnt lgkmcnt(2)
    v_mfma_f32_16x16x32_bf16 a[0:3], v[92:95], v[64:67], a[0:3]
    ds_read_b128 v[148:151], v7 offset:30720
    v_mfma_f32_16x16x32_bf16 a[4:7], v[92:95], v[68:71], a[4:7]
    ds_read_b128 v[152:155], v7 offset:31744
    s_mov_b32 m0, s43
    v_mfma_f32_16x16x32_bf16 a[8:11], v[96:99], v[64:67], a[8:11]
    buffer_load_dwordx4 v8, s[8:11], s39 offen offset:0 lds
    v_mfma_f32_16x16x32_bf16 a[12:15], v[96:99], v[68:71], a[12:15]
    ds_read_b128 a[192:195], v6 offset:16384
    v_mfma_f32_16x16x32_bf16 a[16:19], v[100:103], v[64:67], a[16:19]
    ds_read_b128 a[224:227], v6 offset:24576
    v_mfma_f32_16x16x32_bf16 a[20:23], v[100:103], v[68:71], a[20:23]
    ds_read_b128 a[196:199], v6 offset:17408
    v_mfma_f32_16x16x32_bf16 a[24:27], v[104:107], v[64:67], a[24:27]
    buffer_load_dwordx4 v8, s[8:11], s39 offen offset:1024 lds
    v_mfma_f32_16x16x32_bf16 a[28:31], v[104:107], v[68:71], a[28:31]
    ds_read_b128 a[228:231], v6 offset:25600
    v_mfma_f32_16x16x32_bf16 a[32:35], v[108:111], v[64:67], a[32:35]
    ds_read_b128 a[200:203], v6 offset:18432
    v_mfma_f32_16x16x32_bf16 a[36:39], v[108:111], v[68:71], a[36:39]
    ds_read_b128 a[232:235], v6 offset:26624
    v_mfma_f32_16x16x32_bf16 a[40:43], v[112:115], v[64:67], a[40:43]
    buffer_load_dwordx4 v8, s[8:11], s39 offen offset:2048 lds
    v_mfma_f32_16x16x32_bf16 a[44:47], v[112:115], v[68:71], a[44:47]
    ds_read_b128 a[204:207], v6 offset:19456
    v_mfma_f32_16x16x32_bf16 v[80:83], v[88:91], v[64:67], v[80:83]
    ds_read_b128 a[236:239], v6 offset:27648
    v_mfma_f32_16x16x32_bf16 a[48:51], v[116:119], v[64:67], a[48:51]
    ds_read_b128 a[208:211], v6 offset:20480
    v_mfma_f32_16x16x32_bf16 a[52:55], v[116:119], v[68:71], a[52:55]
    buffer_load_dwordx4 v8, s[8:11], s39 offen offset:3072 lds
    v_mfma_f32_16x16x32_bf16 a[56:59], v[120:123], v[64:67], a[56:59]
    ds_read_b128 a[240:243], v6 offset:28672
    v_mfma_f32_16x16x32_bf16 a[60:63], v[120:123], v[68:71], a[60:63]
    ds_read_b128 a[212:215], v6 offset:21504
    v_mfma_f32_16x16x32_bf16 a[64:67], v[124:127], v[64:67], a[64:67]
    ds_read_b128 a[244:247], v6 offset:29696
    s_add_u32 m0, s42, 65536
    v_mfma_f32_16x16x32_bf16 a[68:71], v[124:127], v[68:71], a[68:71]
    buffer_load_dwordx4 v8, s[12:15], s41 offen offset:0 lds
    v_mfma_f32_16x16x32_bf16 a[72:75], v[128:131], v[64:67], a[72:75]
    ds_read_b128 a[216:219], v6 offset:22528
    s_mov_b32 s68, s39
    v_mfma_f32_16x16x32_bf16 a[76:79], v[128:131], v[68:71], a[76:79]
    ds_read_b128 a[248:251], v6 offset:30720
    s_add_u32 s38, s38, 1
    v_mfma_f32_16x16x32_bf16 v[84:87], v[88:91], v[68:71], v[84:87]
    ds_read_b128 a[220:223], v6 offset:23552
    s_add_u32 s39, s39, 16384
    v_mfma_f32_16x16x32_bf16 a[80:83], v[132:135], v[64:67], a[80:83]
    buffer_load_dwordx4 v8, s[12:15], s41 offen offset:1024 lds
    v_mfma_f32_16x16x32_bf16 a[84:87], v[132:135], v[68:71], a[84:87]
    ds_read_b128 a[252:255], v6 offset:31744
    v_mfma_f32_16x16x32_bf16 a[88:91], v[136:139], v[64:67], a[88:91]
    s_cmp_eq_u32 s38, s36
    s_cselect_b32 s39, s37, s39
    v_mfma_f32_16x16x32_bf16 a[92:95], v[136:139], v[68:71], a[92:95]
    s_cmp_ge_u32 s38, 34
    s_cselect_b32 s39, 2147418112, s39
    s_waitcnt lgkmcnt(15)
    v_mfma_f32_16x16x32_bf16 a[96:99], v[140:143], v[64:67], a[96:99]
    buffer_load_dwordx4 v8, s[12:15], s41 offen offset:2048 lds
    v_mfma_f32_16x16x32_bf16 a[100:103], v[140:143], v[68:71], a[100:103]
    s_xor_b32 s42, s42, 0x8000
    s_xor_b32 s43, s43, 0x8000
    v_mfma_f32_16x16x32_bf16 a[104:107], v[144:147], v[64:67], a[104:107]
    v_xor_b32 v7, 0x8000, v7
    v_mfma_f32_16x16x32_bf16 a[108:111], v[144:147], v[68:71], a[108:111]
    v_mfma_f32_16x16x32_bf16 a[112:115], v[148:151], v[64:67], a[112:115]
    buffer_load_dwordx4 v8, s[12:15], s41 offen offset:3072 lds
    v_mfma_f32_16x16x32_bf16 a[116:119], v[148:151], v[68:71], a[116:119]
    s_mov_b32 s41, s40
    s_mov_b32 s40, s68
    v_xor_b32 v6, 0x8000, v6
    v_mfma_f32_16x16x32_bf16 a[120:123], v[152:155], v[64:67], a[120:123]
    v_mfma_f32_16x16x32_bf16 a[124:127], v[152:155], v[68:71], a[124:127]
    s_waitcnt lgkmcnt(0)
    v_mov_b32 v232, v72
    v_mov_b32 v233, v76
    v_mov_b32 v234, v80
    v_mov_b32_e64 v235, v84
    s_mov_b32 s6, 16384
    s_nop 2
    buffer_store_dwordx4 v[232:235], v12, s[24:27], s6 offen sc1
    v_accvgpr_read_b32 v92, a0
    v_accvgpr_read_b32 v93, a1
    v_accvgpr_read_b32 v94, a2
    v_accvgpr_read_b32 v95, a3
    v_accvgpr_read_b32 v96, a4
    v_accvgpr_read_b32 v97, a5
    v_accvgpr_read_b32 v98, a6
    v_accvgpr_read_b32 v99, a7
    v_cvt_pk_bf16_f32 v100, v92, v93
    v_cvt_pk_bf16_f32 v101, v94, v95
    v_cvt_pk_bf16_f32 v102, v96, v97
    v_cvt_pk_bf16_f32 v103, v98, v99
    s_mov_b32 s6, 0
    buffer_store_dwordx4 v[100:103], v12, s[24:27], s6 offen offset:0 sc1
    v_accvgpr_read_b32 v104, a8
    v_accvgpr_read_b32 v105, a9
    v_accvgpr_read_b32 v106, a10
    v_accvgpr_read_b32 v107, a11
    v_accvgpr_read_b32 v108, a12
    v_accvgpr_read_b32 v109, a13
    v_accvgpr_read_b32 v110, a14
    v_accvgpr_read_b32 v111, a15
    v_mfma_f32_32x32x16_bf16 a[0:15], v[228:231], v[228:231], 0
    v_cvt_pk_bf16_f32 v112, v104, v105
    v_cvt_pk_bf16_f32 v113, v106, v107
    v_cvt_pk_bf16_f32 v114, v108, v109
    v_cvt_pk_bf16_f32 v115, v110, v111
    buffer_store_dwordx4 v[112:115], v12, s[24:27], s6 offen offset:1024 sc1
    v_accvgpr_read_b32 v116, a16
    v_accvgpr_read_b32 v117, a17
    v_accvgpr_read_b32 v118, a18
    v_accvgpr_read_b32 v119, a19
    v_accvgpr_read_b32 v120, a20
    v_accvgpr_read_b32 v121, a21
    v_accvgpr_read_b32 v122, a22
    v_accvgpr_read_b32 v123, a23
    v_cvt_pk_bf16_f32 v124, v116, v117
    v_cvt_pk_bf16_f32 v125, v118, v119
    v_cvt_pk_bf16_f32 v126, v120, v121
    v_cvt_pk_bf16_f32 v127, v122, v123
    buffer_store_dwordx4 v[124:127], v12, s[24:27], s6 offen offset:2048 sc1
    v_accvgpr_read_b32 v128, a24
    v_accvgpr_read_b32 v129, a25
    v_accvgpr_read_b32 v130, a26
    v_accvgpr_read_b32 v131, a27
    v_accvgpr_read_b32 v132, a28
    v_accvgpr_read_b32 v133, a29
    v_accvgpr_read_b32 v134, a30
    v_accvgpr_read_b32 v135, a31
    v_mfma_f32_32x32x16_bf16 a[16:31], v[228:231], v[228:231], 0
    v_cvt_pk_bf16_f32 v136, v128, v129
    v_cvt_pk_bf16_f32 v137, v130, v131
    v_cvt_pk_bf16_f32 v138, v132, v133
    v_cvt_pk_bf16_f32 v139, v134, v135
    buffer_store_dwordx4 v[136:139], v12, s[24:27], s6 offen offset:3072 sc1
    v_accvgpr_read_b32 v92, a32
    v_accvgpr_read_b32 v93, a33
    v_accvgpr_read_b32 v94, a34
    v_accvgpr_read_b32 v95, a35
    v_accvgpr_read_b32 v96, a36
    v_accvgpr_read_b32 v97, a37
    v_accvgpr_read_b32 v98, a38
    v_accvgpr_read_b32 v99, a39
    v_cvt_pk_bf16_f32 v100, v92, v93
    v_cvt_pk_bf16_f32 v101, v94, v95
    v_cvt_pk_bf16_f32 v102, v96, v97
    v_cvt_pk_bf16_f32 v103, v98, v99
    s_mov_b32 s6, 4096
    buffer_store_dwordx4 v[100:103], v12, s[24:27], s6 offen offset:0 sc1
    v_accvgpr_read_b32 v104, a40
    v_accvgpr_read_b32 v105, a41
    v_accvgpr_read_b32 v106, a42
    v_accvgpr_read_b32 v107, a43
    v_accvgpr_read_b32 v108, a44
    v_accvgpr_read_b32 v109, a45
    v_accvgpr_read_b32 v110, a46
    v_accvgpr_read_b32 v111, a47
    v_mfma_f32_32x32x16_bf16 a[32:47], v[228:231], v[228:231], 0
    v_cvt_pk_bf16_f32 v112, v104, v105
    v_cvt_pk_bf16_f32 v113, v106, v107
    v_cvt_pk_bf16_f32 v114, v108, v109
    v_cvt_pk_bf16_f32 v115, v110, v111
    buffer_store_dwordx4 v[112:115], v12, s[24:27], s6 offen offset:1024 sc1
    v_accvgpr_read_b32 v116, a48
    v_accvgpr_read_b32 v117, a49
    v_accvgpr_read_b32 v118, a50
    v_accvgpr_read_b32 v119, a51
    v_accvgpr_read_b32 v120, a52
    v_accvgpr_read_b32 v121, a53
    v_accvgpr_read_b32 v122, a54
    v_accvgpr_read_b32 v123, a55
    v_cvt_pk_bf16_f32 v124, v116, v117
    v_cvt_pk_bf16_f32 v125, v118, v119
    v_cvt_pk_bf16_f32 v126, v120, v121
    v_cvt_pk_bf16_f32 v127, v122, v123
    buffer_store_dwordx4 v[124:127], v12, s[24:27], s6 offen offset:2048 sc1
    v_accvgpr_read_b32 v128, a56
    v_accvgpr_read_b32 v129, a57
    v_accvgpr_read_b32 v130, a58
    v_accvgpr_read_b32 v131, a59
    v_accvgpr_read_b32 v132, a60
    v_accvgpr_read_b32 v133, a61
    v_accvgpr_read_b32 v134, a62
    v_accvgpr_read_b32 v135, a63
    v_mfma_f32_32x32x16_bf16 a[48:63], v[228:231], v[228:231], 0
    v_cvt_pk_bf16_f32 v136, v128, v129
    v_cvt_pk_bf16_f32 v137, v130, v131
    v_cvt_pk_bf16_f32 v138, v132, v133
    v_cvt_pk_bf16_f32 v139, v134, v135
    buffer_store_dwordx4 v[136:139], v12, s[24:27], s6 offen offset:3072 sc1
    v_accvgpr_read_b32 v92, a64
    v_accvgpr_read_b32 v93, a65
    v_accvgpr_read_b32 v94, a66
    v_accvgpr_read_b32 v95, a67
    v_accvgpr_read_b32 v96, a68
    v_accvgpr_read_b32 v97, a69
    v_accvgpr_read_b32 v98, a70
    v_accvgpr_read_b32 v99, a71
    v_cvt_pk_bf16_f32 v100, v92, v93
    v_cvt_pk_bf16_f32 v101, v94, v95
    v_cvt_pk_bf16_f32 v102, v96, v97
    v_cvt_pk_bf16_f32 v103, v98, v99
    s_mov_b32 s6, 8192
    buffer_store_dwordx4 v[100:103], v12, s[24:27], s6 offen offset:0 sc1
    v_accvgpr_read_b32 v104, a72
    v_accvgpr_read_b32 v105, a73
    v_accvgpr_read_b32 v106, a74
    v_accvgpr_read_b32 v107, a75
    v_accvgpr_read_b32 v108, a76
    v_accvgpr_read_b32 v109, a77
    v_accvgpr_read_b32 v110, a78
    v_accvgpr_read_b32 v111, a79
    v_mfma_f32_32x32x16_bf16 a[64:79], v[228:231], v[228:231], 0
    v_cvt_pk_bf16_f32 v112, v104, v105
    v_cvt_pk_bf16_f32 v113, v106, v107
    v_cvt_pk_bf16_f32 v114, v108, v109
    v_cvt_pk_bf16_f32 v115, v110, v111
    buffer_store_dwordx4 v[112:115], v12, s[24:27], s6 offen offset:1024 sc1
    v_accvgpr_read_b32 v116, a80
    v_accvgpr_read_b32 v117, a81
    v_accvgpr_read_b32 v118, a82
    v_accvgpr_read_b32 v119, a83
    v_accvgpr_read_b32 v120, a84
    v_accvgpr_read_b32 v121, a85
    v_accvgpr_read_b32 v122, a86
    v_accvgpr_read_b32 v123, a87
    v_cvt_pk_bf16_f32 v124, v116, v117
    v_cvt_pk_bf16_f32 v125, v118, v119
    v_cvt_pk_bf16_f32 v126, v120, v121
    v_cvt_pk_bf16_f32 v127, v122, v123
    buffer_store_dwordx4 v[124:127], v12, s[24:27], s6 offen offset:2048 sc1
    v_accvgpr_read_b32 v128, a88
    v_accvgpr_read_b32 v129, a89
    v_accvgpr_read_b32 v130, a90
    v_accvgpr_read_b32 v131, a91
    v_accvgpr_read_b32 v132, a92
    v_accvgpr_read_b32 v133, a93
    v_accvgpr_read_b32 v134, a94
    v_accvgpr_read_b32 v135, a95
    v_mfma_f32_32x32x16_bf16 a[80:95], v[228:231], v[228:231], 0
    v_cvt_pk_bf16_f32 v136, v128, v129
    v_cvt_pk_bf16_f32 v137, v130, v131
    v_cvt_pk_bf16_f32 v138, v132, v133
    v_cvt_pk_bf16_f32 v139, v134, v135
    buffer_store_dwordx4 v[136:139], v12, s[24:27], s6 offen offset:3072 sc1
    v_accvgpr_read_b32 v92, a96
    v_accvgpr_read_b32 v93, a97
    v_accvgpr_read_b32 v94, a98
    v_accvgpr_read_b32 v95, a99
    v_accvgpr_read_b32 v96, a100
    v_accvgpr_read_b32 v97, a101
    v_accvgpr_read_b32 v98, a102
    v_accvgpr_read_b32 v99, a103
    v_cvt_pk_bf16_f32 v100, v92, v93
    v_cvt_pk_bf16_f32 v101, v94, v95
    v_cvt_pk_bf16_f32 v102, v96, v97
    v_cvt_pk_bf16_f32 v103, v98, v99
    s_mov_b32 s6, 12288
    buffer_store_dwordx4 v[100:103], v12, s[24:27], s6 offen offset:0 sc1
    v_accvgpr_read_b32 v104, a104
    v_accvgpr_read_b32 v105, a105
    v_accvgpr_read_b32 v106, a106
    v_accvgpr_read_b32 v107, a107
    v_accvgpr_read_b32 v108, a108
    v_accvgpr_read_b32 v109, a109
    v_accvgpr_read_b32 v110, a110
    v_accvgpr_read_b32 v111, a111
    v_mfma_f32_32x32x16_bf16 a[96:111], v[228:231], v[228:231], 0
    v_cvt_pk_bf16_f32 v112, v104, v105
    v_cvt_pk_bf16_f32 v113, v106, v107
    v_cvt_pk_bf16_f32 v114, v108, v109
    v_cvt_pk_bf16_f32 v115, v110, v111
    buffer_store_dwordx4 v[112:115], v12, s[24:27], s6 offen offset:1024 sc1
    v_accvgpr_read_b32 v116, a112
    v_accvgpr_read_b32 v117, a113
    v_accvgpr_read_b32 v118, a114
    v_accvgpr_read_b32 v119, a115
    v_accvgpr_read_b32 v120, a116
    v_accvgpr_read_b32 v121, a117
    v_accvgpr_read_b32 v122, a118
    v_accvgpr_read_b32 v123, a119
    v_cvt_pk_bf16_f32 v124, v116, v117
    v_cvt_pk_bf16_f32 v125, v118, v119
    v_cvt_pk_bf16_f32 v126, v120, v121
    v_cvt_pk_bf16_f32 v127, v122, v123
    buffer_store_dwordx4 v[124:127], v12, s[24:27], s6 offen offset:2048 sc1
    v_accvgpr_read_b32 v128, a120
    v_accvgpr_read_b32 v129, a121
    v_accvgpr_read_b32 v130, a122
    v_accvgpr_read_b32 v131, a123
    v_accvgpr_read_b32 v132, a124
    v_accvgpr_read_b32 v133, a125
    v_accvgpr_read_b32 v134, a126
    v_accvgpr_read_b32 v135, a127
    v_mfma_f32_32x32x16_bf16 a[112:127], v[228:231], v[228:231], 0
    v_cvt_pk_bf16_f32 v136, v128, v129
    v_cvt_pk_bf16_f32 v137, v130, v131
    v_cvt_pk_bf16_f32 v138, v132, v133
    v_cvt_pk_bf16_f32 v139, v134, v135
    buffer_store_dwordx4 v[136:139], v12, s[24:27], s6 offen offset:3072 sc1
    s_cmp_eq_u32 s32, 0
    s_cselect_b32 s51, 1, s51
    s_lshl_b32 s44, s34, 1
    s_lshl_b32 s45, s69, 7
    v_add_u32_e64 v10, s45, v9
    v_cmp_gt_i32 s[52:53], 0, v10
    v_cmp_gt_i32 s[54:55], 1, v10
    v_cmp_gt_i32 s[56:57], 2, v10
    v_cmp_gt_i32 s[58:59], 3, v10
    v_cmp_gt_i32 s[60:61], -16, v10
    v_cmp_gt_i32 s[62:63], -15, v10
    v_cmp_gt_i32 s[64:65], -14, v10
    v_cmp_gt_i32 s[66:67], -13, v10
    v_cndmask_b32 v16, v16, v11, s[52:53]
    v_cndmask_b32 v17, v17, v11, s[54:55]
    v_cndmask_b32 v18, v18, v11, s[56:57]
    v_cndmask_b32 v19, v19, v11, s[58:59]
    v_cndmask_b32 v20, v20, v11, s[60:61]
    v_cndmask_b32 v21, v21, v11, s[62:63]
    v_cndmask_b32 v22, v22, v11, s[64:65]
    v_cndmask_b32 v23, v23, v11, s[66:67]
    v_cmp_gt_i32 s[52:53], 16, v10
    v_cmp_gt_i32 s[54:55], 17, v10
    v_cmp_gt_i32 s[56:57], 18, v10
    v_cmp_gt_i32 s[58:59], 19, v10
    v_cmp_gt_i32 s[60:61], 0, v10
    v_cmp_gt_i32 s[62:63], 1, v10
    v_cmp_gt_i32 s[64:65], 2, v10
    v_cmp_gt_i32 s[66:67], 3, v10
    v_cndmask_b32 v24, v24, v11, s[52:53]
    v_cndmask_b32 v25, v25, v11, s[54:55]
    v_cndmask_b32 v26, v26, v11, s[56:57]
    v_cndmask_b32 v27, v27, v11, s[58:59]
    v_cndmask_b32 v28, v28, v11, s[60:61]
    v_cndmask_b32 v29, v29, v11, s[62:63]
    v_cndmask_b32 v30, v30, v11, s[64:65]
    v_cndmask_b32 v31, v31, v11, s[66:67]
    v_mov_b32 v80, 0
    v_mov_b32 v81, 0
    v_mov_b32 v82, 0
    v_mov_b32 v83, 0
    v_mov_b32 v84, 0
    v_mov_b32 v85, 0
    v_mov_b32 v86, 0
    v_mov_b32 v87, 0
    v_max3_f32 v2, v16, v17, v18
    v_max3_f32 v2, v2, v19, v24
    v_max3_f32 v2, v2, v25, v26
    v_max_f32 v2, v2, v27
    v_mov_b32 v3, v2
    s_nop 1
    v_permlane16_swap_b32 v2, v3
    s_nop 1
    v_max_f32 v2, v2, v3
    v_mov_b32 v3, v2
    s_nop 1
    v_permlane32_swap_b32 v2, v3
    s_nop 1
    v_max_f32_e64 v2, v2, v3
    v_add_f32 v2, 0x41400000, v2
    v_sub_f32 v72, 0, v2
    v_sub_f32 v73, 0, v2
    v_sub_f32 v74, 0, v2
    v_sub_f32 v75, 0, v2
    v_sub_f32 v16, v16, v2
    v_sub_f32 v17, v17, v2
    v_sub_f32 v18, v18, v2
    v_sub_f32 v19, v19, v2
    v_sub_f32 v24, v24, v2
    v_sub_f32 v25, v25, v2
    v_sub_f32 v26, v26, v2
    v_sub_f32 v27, v27, v2
    v_max3_f32 v2, v20, v21, v22
    v_max3_f32 v2, v2, v23, v28
    v_max3_f32 v2, v2, v29, v30
    v_max_f32 v2, v2, v31
    v_mov_b32 v3, v2
    s_nop 1
    v_permlane16_swap_b32 v2, v3
    s_nop 1
    v_max_f32 v2, v2, v3
    v_mov_b32 v3, v2
    s_nop 1
    v_permlane32_swap_b32 v2, v3
    s_nop 1
    v_max_f32_e64 v2, v2, v3
    v_add_f32 v2, 0x41400000, v2
    v_sub_f32 v76, 0, v2
    v_sub_f32 v77, 0, v2
    v_sub_f32 v78, 0, v2
    v_sub_f32 v79, 0, v2
    v_sub_f32 v20, v20, v2
    v_sub_f32 v21, v21, v2
    v_sub_f32 v22, v22, v2
    v_sub_f32 v23, v23, v2
    v_sub_f32 v28, v28, v2
    v_sub_f32 v29, v29, v2
    v_sub_f32 v30, v30, v2
    v_sub_f32 v31, v31, v2
    s_cmp_lg_u32 s34, 0
    s_cbranch_scc1 L_attn_job2
    s_waitcnt vmcnt(0)
    s_barrier
    s_cmp_lg_u32 s32, 0
    s_cbranch_scc1 L_attn_job2
    v_mov_b32 v2, 1
    v_mov_b32 v3, s70
    s_mov_b32 s51, 1000
    s_mov_b64 exec, 1
    buffer_store_short v2, v3, s[28:31], 0 offen sc1
    s_mov_b64 exec, -1
    s_branch L_attn_job2
L_attn_A:
    s_waitcnt vmcnt(36)
    s_barrier
    ds_read_b128 a[192:195], v6 offset:0
    ds_read_b128 a[224:227], v6 offset:8192
    ds_read_b128 a[196:199], v6 offset:1024
    ds_read_b128 a[228:231], v6 offset:9216
    ds_read_b128 a[200:203], v6 offset:2048
    ds_read_b128 a[232:235], v6 offset:10240
    ds_read_b128 a[204:207], v6 offset:3072
    ds_read_b128 a[236:239], v6 offset:11264
    ds_read_b128 a[208:211], v6 offset:4096
    ds_read_b128 a[240:243], v6 offset:12288
    ds_read_b128 a[212:215], v6 offset:5120
    ds_read_b128 a[244:247], v6 offset:13312
    ds_read_b128 a[216:219], v6 offset:6144
    ds_read_b128 a[248:251], v6 offset:14336
    ds_read_b128 a[220:223], v6 offset:7168
    ds_read_b128 a[252:255], v6 offset:15360
    s_waitcnt vmcnt(34) lgkmcnt(14)
    v_mfma_f32_16x16x32_bf16 v[16:19], a[192:195], v[156:159], 0
    v_mfma_f32_16x16x32_bf16 v[20:23], a[192:195], v[188:191], 0
    v_mfma_f32_16x16x32_bf16 v[24:27], a[224:227], v[156:159], 0
    v_mfma_f32_16x16x32_bf16 v[28:31], a[224:227], v[188:191], 0
    s_waitcnt vmcnt(32) lgkmcnt(12)
    v_mfma_f32_16x16x32_bf16 v[16:19], a[196:199], v[160:163], v[16:19]
    v_mfma_f32_16x16x32_bf16 v[20:23], a[196:199], v[192:195], v[20:23]
    v_mfma_f32_16x16x32_bf16 v[24:27], a[228:231], v[160:163], v[24:27]
    v_mfma_f32_16x16x32_bf16 v[28:31], a[228:231], v[192:195], v[28:31]
    s_waitcnt vmcnt(30) lgkmcnt(10)
    v_mfma_f32_16x16x32_bf16 v[16:19], a[200:203], v[164:167], v[16:19]
    v_mfma_f32_16x16x32_bf16 v[20:23], a[200:203], v[196:199], v[20:23]
    v_mfma_f32_16x16x32_bf16 v[24:27], a[232:235], v[164:167], v[24:27]
    v_mfma_f32_16x16x32_bf16 v[28:31], a[232:235], v[196:199], v[28:31]
    s_waitcnt vmcnt(28) lgkmcnt(8)
    v_mfma_f32_16x16x32_bf16 v[16:19], a[204:207], v[168:171], v[16:19]
    v_mfma_f32_16x16x32_bf16 v[20:23], a[204:207], v[200:203], v[20:23]
    v_mfma_f32_16x16x32_bf16 v[24:27], a[236:239], v[168:171], v[24:27]
    v_mfma_f32_16x16x32_bf16 v[28:31], a[236:239], v[200:203], v[28:31]
    s_waitcnt vmcnt(26) lgkmcnt(6)
    v_mfma_f32_16x16x32_bf16 v[16:19], a[208:211], v[172:175], v[16:19]
    v_mfma_f32_16x16x32_bf16 v[20:23], a[208:211], v[204:207], v[20:23]
    v_mfma_f32_16x16x32_bf16 v[24:27], a[240:243], v[172:175], v[24:27]
    v_mfma_f32_16x16x32_bf16 v[28:31], a[240:243], v[204:207], v[28:31]
    s_waitcnt vmcnt(24) lgkmcnt(4)
    v_mfma_f32_16x16x32_bf16 v[16:19], a[212:215], v[176:179], v[16:19]
    v_mfma_f32_16x16x32_bf16 v[20:23], a[212:215], v[208:211], v[20:23]
    v_mfma_f32_16x16x32_bf16 v[24:27], a[244:247], v[176:179], v[24:27]
    v_mfma_f32_16x16x32_bf16 v[28:31], a[244:247], v[208:211], v[28:31]
    s_waitcnt vmcnt(22) lgkmcnt(2)
    v_mfma_f32_16x16x32_bf16 v[16:19], a[216:219], v[180:183], v[16:19]
    v_mfma_f32_16x16x32_bf16 v[20:23], a[216:219], v[212:215], v[20:23]
    v_mfma_f32_16x16x32_bf16 v[24:27], a[248:251], v[180:183], v[24:27]
    v_mfma_f32_16x16x32_bf16 v[28:31], a[248:251], v[212:215], v[28:31]
    s_waitcnt vmcnt(20) lgkmcnt(0)
    v_mfma_f32_16x16x32_bf16 v[16:19], a[220:223], v[184:187], v[16:19]
    v_mfma_f32_16x16x32_bf16 v[20:23], a[220:223], v[216:219], v[20:23]
    v_mfma_f32_16x16x32_bf16 v[24:27], a[252:255], v[184:187], v[24:27]
    v_mfma_f32_16x16x32_bf16 v[28:31], a[252:255], v[216:219], v[28:31]
    s_waitcnt vmcnt(16)
    s_barrier
    ds_read_b128 a[192:195], v6 offset:16384
    ds_read_b128 a[224:227], v6 offset:24576
    ds_read_b128 a[196:199], v6 offset:17408
    ds_read_b128 a[228:231], v6 offset:25600
    ds_read_b128 a[200:203], v6 offset:18432
    ds_read_b128 a[232:235], v6 offset:26624
    ds_read_b128 a[204:207], v6 offset:19456
    ds_read_b128 a[236:239], v6 offset:27648
    ds_read_b128 a[208:211], v6 offset:20480
    ds_read_b128 a[240:243], v6 offset:28672
    ds_read_b128 a[212:215], v6 offset:21504
    ds_read_b128 a[244:247], v6 offset:29696
    ds_read_b128 a[216:219], v6 offset:22528
    ds_read_b128 a[248:251], v6 offset:30720
    ds_read_b128 a[220:223], v6 offset:23552
    ds_read_b128 a[252:255], v6 offset:31744
    s_waitcnt vmcnt(8) lgkmcnt(0)
    s_barrier
    s_mov_b32 m0, s42
    s_nop 0
    buffer_load_dwordx4 v8, s[8:11], s39 offen offset:0 lds
    buffer_load_dwordx4 v8, s[8:11], s39 offen offset:1024 lds
    buffer_load_dwordx4 v8, s[8:11], s39 offen offset:2048 lds
    buffer_load_dwordx4 v8, s[8:11], s39 offen offset:3072 lds
    s_add_u32 m0, s42, 98304
    s_nop 0
    buffer_load_dwordx4 v8, s[12:15], s41 offen offset:0 lds
    buffer_load_dwordx4 v8, s[12:15], s41 offen offset:1024 lds
    buffer_load_dwordx4 v8, s[12:15], s41 offen offset:2048 lds
    buffer_load_dwordx4 v8, s[12:15], s41 offen offset:3072 lds
    s_mov_b32 s41, s40
    s_mov_b32 s40, s39
    s_add_u32 s38, s38, 1
    s_add_u32 s39, s39, 16384
    s_cmp_eq_u32 s38, s36
    s_cselect_b32 s39, s37, s39
    s_cmp_ge_u32 s38, 34
    s_cselect_b32 s39, 2147418112, s39
    v_xor_b32 v6, 0x8000, v6
    s_mov_b32 s44, 15
    s_mov_b32 s45, 4096
    v_add_u32 v10, s45, v9
    v_cmp_gt_i32 s[52:53], 0, v10
    v_cmp_gt_i32 s[54:55], 1, v10
    v_cmp_gt_i32 s[56:57], 2, v10
    v_cmp_gt_i32 s[58:59], 3, v10
    v_cmp_gt_i32 s[60:61], -16, v10
    v_cmp_gt_i32 s[62:63], -15, v10
    v_cmp_gt_i32 s[64:65], -14, v10
    v_cmp_gt_i32 s[66:67], -13, v10
    v_cndmask_b32 v16, v16, v11, s[52:53]
    v_cndmask_b32 v17, v17, v11, s[54:55]
    v_cndmask_b32 v18, v18, v11, s[56:57]
    v_cndmask_b32 v19, v19, v11, s[58:59]
    v_cndmask_b32 v20, v20, v11, s[60:61]
    v_cndmask_b32 v21, v21, v11, s[62:63]
    v_cndmask_b32 v22, v22, v11, s[64:65]
    v_cndmask_b32 v23, v23, v11, s[66:67]
    v_cmp_gt_i32 s[52:53], 16, v10
    v_cmp_gt_i32 s[54:55], 17, v10
    v_cmp_gt_i32 s[56:57], 18, v10
    v_cmp_gt_i32 s[58:59], 19, v10
    v_cmp_gt_i32 s[60:61], 0, v10
    v_cmp_gt_i32 s[62:63], 1, v10
    v_cmp_gt_i32 s[64:65], 2, v10
    v_cmp_gt_i32 s[66:67], 3, v10
    v_cndmask_b32 v24, v24, v11, s[52:53]
    v_cndmask_b32 v25, v25, v11, s[54:55]
    v_cndmask_b32 v26, v26, v11, s[56:57]
    v_cndmask_b32 v27, v27, v11, s[58:59]
    v_cndmask_b32 v28, v28, v11, s[60:61]
    v_cndmask_b32 v29, v29, v11, s[62:63]
    v_cndmask_b32 v30, v30, v11, s[64:65]
    v_cndmask_b32 v31, v31, v11, s[66:67]
    v_mov_b32 v80, 0
    v_mov_b32 v81, 0
    v_mov_b32 v82, 0
    v_mov_b32 v83, 0
    v_mov_b32 v84, 0
    v_mov_b32 v85, 0
    v_mov_b32 v86, 0
    v_mov_b32 v87, 0
    v_max3_f32 v2, v16, v17, v18
    v_max3_f32 v2, v2, v19, v24
    v_max3_f32 v2, v2, v25, v26
    v_max_f32 v2, v2, v27
    v_mov_b32 v3, v2
    s_nop 1
    v_permlane16_swap_b32 v2, v3
    s_nop 1
    v_max_f32 v2, v2, v3
    v_mov_b32 v3, v2
    s_nop 1
    v_permlane32_swap_b32 v2, v3
    s_nop 1
    v_max_f32_e64 v2, v2, v3
    v_add_f32 v2, 0x41400000, v2
    v_sub_f32 v72, 0, v2
    v_sub_f32 v73, 0, v2
    v_sub_f32 v74, 0, v2
    v_sub_f32 v75, 0, v2
    v_sub_f32 v16, v16, v2
    v_sub_f32 v17, v17, v2
    v_sub_f32 v18, v18, v2
    v_sub_f32 v19, v19, v2
    v_sub_f32 v24, v24, v2
    v_sub_f32 v25, v25, v2
    v_sub_f32 v26, v26, v2
    v_sub_f32 v27, v27, v2
    v_max3_f32 v2, v20, v21, v22
    v_max3_f32 v2, v2, v23, v28
    v_max3_f32 v2, v2, v29, v30
    v_max_f32 v2, v2, v31
    v_mov_b32 v3, v2
    s_nop 1
    v_permlane16_swap_b32 v2, v3
    s_nop 1
    v_max_f32 v2, v2, v3
    v_mov_b32 v3, v2
    s_nop 1
    v_permlane32_swap_b32 v2, v3
    s_nop 1
    v_max_f32_e64 v2, v2, v3
    v_add_f32 v2, 0x41400000, v2
    v_sub_f32 v76, 0, v2
    v_sub_f32 v77, 0, v2
    v_sub_f32 v78, 0, v2
    v_sub_f32 v79, 0, v2
    v_sub_f32 v20, v20, v2
    v_sub_f32 v21, v21, v2
    v_sub_f32 v22, v22, v2
    v_sub_f32 v23, v23, v2
    v_sub_f32 v28, v28, v2
    v_sub_f32 v29, v29, v2
    v_sub_f32 v30, v30, v2
    v_sub_f32 v31, v31, v2
L_attn_job2:
    s_mov_b32 s69, 0
    s_mov_b32 s77, 0
    s_branch L_attn_seg
.p2align 3
L_attn_j2loop:
    v_mfma_f32_16x16x32_bf16 v[32:35], a[192:195], v[156:159], v[72:75]
    v_exp_f32_e64 v48, v16
    v_mfma_f32_16x16x32_bf16 v[36:39], a[192:195], v[188:191], v[76:79]
    v_exp_f32_e64 v49, v17
    v_mfma_f32_16x16x32_bf16 v[40:43], a[224:227], v[156:159], v[72:75]
    ds_read_b128 v[92:95], v7 offset:0
    v_cvt_pk_bf16_f32 v64, v48, v49
    v_mfma_f32_16x16x32_bf16 v[44:47], a[224:227], v[188:191], v[76:79]
    ds_read_b128 v[96:99], v7 offset:1024
    v_mfma_f32_16x16x32_bf16 v[32:35], a[196:199], v[160:163], v[32:35]
    v_exp_f32_e64 v50, v18
    v_mfma_f32_16x16x32_bf16 v[36:39], a[196:199], v[192:195], v[36:39]
    v_exp_f32_e64 v51, v19
    v_mfma_f32_16x16x32_bf16 v[40:43], a[228:231], v[160:163], v[40:43]
    ds_read_b128 v[100:103], v7 offset:2048
    v_cvt_pk_bf16_f32 v65, v50, v51
    v_mfma_f32_16x16x32_bf16 v[44:47], a[228:231], v[192:195], v[44:47]
    ds_read_b128 v[104:107], v7 offset:3072
    v_mfma_f32_16x16x32_bf16 v[32:35], a[200:203], v[164:167], v[32:35]
    v_exp_f32_e64 v52, v24
    v_mfma_f32_16x16x32_bf16 v[36:39], a[200:203], v[196:199], v[36:39]
    v_exp_f32_e64 v53, v25
    v_mfma_f32_16x16x32_bf16 v[40:43], a[232:235], v[164:167], v[40:43]
    ds_read_b128 v[108:111], v7 offset:4096
    v_cvt_pk_bf16_f32 v66, v52, v53
    v_mfma_f32_16x16x32_bf16 v[44:47], a[232:235], v[196:199], v[44:47]
    ds_read_b128 v[112:115], v7 offset:5120
    v_or3_b32 v13, v64, v65, v66
    v_mfma_f32_16x16x32_bf16 v[32:35], a[204:207], v[168:171], v[32:35]
    v_exp_f32_e64 v54, v26
    v_mfma_f32_16x16x32_bf16 v[36:39], a[204:207], v[200:203], v[36:39]
    v_exp_f32_e64 v55, v27
    v_mfma_f32_16x16x32_bf16 v[40:43], a[236:239], v[168:171], v[40:43]
    ds_read_b128 v[116:119], v7 offset:6144
    v_cvt_pk_bf16_f32 v67, v54, v55
    v_mfma_f32_16x16x32_bf16 v[44:47], a[236:239], v[200:203], v[44:47]
    ds_read_b128 v[120:123], v7 offset:7168
    v_mfma_f32_16x16x32_bf16 v[32:35], a[208:211], v[172:175], v[32:35]
    v_exp_f32_e64 v56, v20
    v_mfma_f32_16x16x32_bf16 v[36:39], a[208:211], v[204:207], v[36:39]
    v_exp_f32_e64 v57, v21
    v_mfma_f32_16x16x32_bf16 v[40:43], a[240:243], v[172:175], v[40:43]
    ds_read_b128 v[124:127], v7 offset:8192
    v_cvt_pk_bf16_f32 v68, v56, v57
    v_mfma_f32_16x16x32_bf16 v[44:47], a[240:243], v[204:207], v[44:47]
    ds_read_b128 v[128:131], v7 offset:9216
    v_or3_b32 v13, v13, v67, v68
    v_mfma_f32_16x16x32_bf16 v[32:35], a[212:215], v[176:179], v[32:35]
    v_exp_f32_e64 v58, v22
    v_mfma_f32_16x16x32_bf16 v[36:39], a[212:215], v[208:211], v[36:39]
    v_exp_f32_e64 v59, v23
    v_mfma_f32_16x16x32_bf16 v[40:43], a[244:247], v[176:179], v[40:43]
    ds_read_b128 v[132:135], v7 offset:10240
    v_cvt_pk_bf16_f32 v69, v58, v59
    v_mfma_f32_16x16x32_bf16 v[44:47], a[244:247], v[208:211], v[44:47]
    ds_read_b128 v[136:139], v7 offset:11264
    v_mfma_f32_16x16x32_bf16 v[32:35], a[216:219], v[180:183], v[32:35]
    v_exp_f32_e64 v60, v28
    v_mfma_f32_16x16x32_bf16 v[36:39], a[216:219], v[212:215], v[36:39]
    v_exp_f32_e64 v61, v29
    v_mfma_f32_16x16x32_bf16 v[40:43], a[248:251], v[180:183], v[40:43]
    ds_read_b128 v[140:143], v7 offset:12288
    v_cvt_pk_bf16_f32 v70, v60, v61
    v_mfma_f32_16x16x32_bf16 v[44:47], a[248:251], v[212:215], v[44:47]
    ds_read_b128 v[144:147], v7 offset:13312
    v_or3_b32 v13, v13, v69, v70
    v_mfma_f32_16x16x32_bf16 v[32:35], a[220:223], v[184:187], v[32:35]
    v_exp_f32_e64 v62, v30
    v_mfma_f32_16x16x32_bf16 v[36:39], a[220:223], v[216:219], v[36:39]
    v_exp_f32_e64 v63, v31
    v_mfma_f32_16x16x32_bf16 v[40:43], a[252:255], v[184:187], v[40:43]
    v_cvt_pk_bf16_f32 v71, v62, v63
    v_and_b32_e64 v13, s71, v13
    v_mfma_f32_16x16x32_bf16 v[44:47], a[252:255], v[216:219], v[44:47]
    v_and_or_b32 v13, v71, s71, v13
    v_cmp_ne_u32 vcc, 0, v13
    s_waitcnt vmcnt(8)
    s_barrier
    s_cbranch_vccnz L_attn_kernel_slow_9
L_attn_kernel_ret_10:
    s_waitcnt lgkmcnt(2)
    v_mfma_f32_16x16x32_bf16 a[0:3], v[92:95], v[64:67], a[0:3]
    ds_read_b128 v[148:151], v7 offset:14336
    v_mfma_f32_16x16x32_bf16 a[4:7], v[92:95], v[68:71], a[4:7]
    ds_read_b128 v[152:155], v7 offset:15360
    s_add_u32 m0, s42, 16384
    v_mfma_f32_16x16x32_bf16 a[8:11], v[96:99], v[64:67], a[8:11]
    buffer_load_dwordx4 v8, s[8:11], s39 offen offset:0 lds
    v_mfma_f32_16x16x32_bf16 a[12:15], v[96:99], v[68:71], a[12:15]
    ds_read_b128 a[192:195], v6 offset:0
    v_mfma_f32_16x16x32_bf16 a[16:19], v[100:103], v[64:67], a[16:19]
    ds_read_b128 a[224:227], v6 offset:8192
    v_mfma_f32_16x16x32_bf16 a[20:23], v[100:103], v[68:71], a[20:23]
    ds_read_b128 a[196:199], v6 offset:1024
    v_mfma_f32_16x16x32_bf16 a[24:27], v[104:107], v[64:67], a[24:27]
    buffer_load_dwordx4 v8, s[8:11], s39 offen offset:1024 lds
    v_mfma_f32_16x16x32_bf16 a[28:31], v[104:107], v[68:71], a[28:31]
    ds_read_b128 a[228:231], v6 offset:9216
    v_mfma_f32_16x16x32_bf16 a[32:35], v[108:111], v[64:67], a[32:35]
    ds_read_b128 a[200:203], v6 offset:2048
    v_mfma_f32_16x16x32_bf16 a[36:39], v[108:111], v[68:71], a[36:39]
    ds_read_b128 a[232:235], v6 offset:10240
    v_mfma_f32_16x16x32_bf16 a[40:43], v[112:115], v[64:67], a[40:43]
    buffer_load_dwordx4 v8, s[8:11], s39 offen offset:2048 lds
    v_mfma_f32_16x16x32_bf16 a[44:47], v[112:115], v[68:71], a[44:47]
    ds_read_b128 a[204:207], v6 offset:3072
    v_mfma_f32_16x16x32_bf16 v[80:83], v[88:91], v[64:67], v[80:83]
    ds_read_b128 a[236:239], v6 offset:11264
    v_mfma_f32_16x16x32_bf16 a[48:51], v[116:119], v[64:67], a[48:51]
    ds_read_b128 a[208:211], v6 offset:4096
    v_mfma_f32_16x16x32_bf16 a[52:55], v[116:119], v[68:71], a[52:55]
    buffer_load_dwordx4 v8, s[8:11], s39 offen offset:3072 lds
    v_mfma_f32_16x16x32_bf16 a[56:59], v[120:123], v[64:67], a[56:59]
    ds_read_b128 a[240:243], v6 offset:12288
    v_mfma_f32_16x16x32_bf16 a[60:63], v[120:123], v[68:71], a[60:63]
    ds_read_b128 a[212:215], v6 offset:5120
    v_mfma_f32_16x16x32_bf16 a[64:67], v[124:127], v[64:67], a[64:67]
    ds_read_b128 a[244:247], v6 offset:13312
    s_add_u32 m0, s43, 81920
    v_mfma_f32_16x16x32_bf16 a[68:71], v[124:127], v[68:71], a[68:71]
    buffer_load_dwordx4 v8, s[12:15], s41 offen offset:0 lds
    v_mfma_f32_16x16x32_bf16 a[72:75], v[128:131], v[64:67], a[72:75]
    ds_read_b128 a[216:219], v6 offset:6144
    s_mov_b32 s68, s39
    v_mfma_f32_16x16x32_bf16 a[76:79], v[128:131], v[68:71], a[76:79]
    ds_read_b128 a[248:251], v6 offset:14336
    s_add_u32 s38, s38, 1
    v_mfma_f32_16x16x32_bf16 v[84:87], v[88:91], v[68:71], v[84:87]
    ds_read_b128 a[220:223], v6 offset:7168
    s_add_u32 s39, s39, 16384
    v_mfma_f32_16x16x32_bf16 a[80:83], v[132:135], v[64:67], a[80:83]
    buffer_load_dwordx4 v8, s[12:15], s41 offen offset:1024 lds
    v_mfma_f32_16x16x32_bf16 a[84:87], v[132:135], v[68:71], a[84:87]
    ds_read_b128 a[252:255], v6 offset:15360
    v_mfma_f32_16x16x32_bf16 a[88:91], v[136:139], v[64:67], a[88:91]
    s_cmp_eq_u32 s38, s36
    s_cselect_b32 s39, s37, s39
    v_mfma_f32_16x16x32_bf16 a[92:95], v[136:139], v[68:71], a[92:95]
    s_cmp_ge_u32 s38, 34
    s_cselect_b32 s39, 2147418112, s39
    s_waitcnt lgkmcnt(15)
    v_mfma_f32_16x16x32_bf16 a[96:99], v[140:143], v[64:67], a[96:99]
    buffer_load_dwordx4 v8, s[12:15], s41 offen offset:2048 lds
    v_mfma_f32_16x16x32_bf16 a[100:103], v[140:143], v[68:71], a[100:103]
    v_mfma_f32_16x16x32_bf16 a[104:107], v[144:147], v[64:67], a[104:107]
    v_mfma_f32_16x16x32_bf16 a[108:111], v[144:147], v[68:71], a[108:111]
    v_mfma_f32_16x16x32_bf16 a[112:115], v[148:151], v[64:67], a[112:115]
    buffer_load_dwordx4 v8, s[12:15], s41 offen offset:3072 lds
    v_mfma_f32_16x16x32_bf16 a[116:119], v[148:151], v[68:71], a[116:119]
    s_mov_b32 s41, s40
    s_mov_b32 s40, s68
    v_mfma_f32_16x16x32_bf16 a[120:123], v[152:155], v[64:67], a[120:123]
    v_mfma_f32_16x16x32_bf16 a[124:127], v[152:155], v[68:71], a[124:127]
    s_waitcnt lgkmcnt(0)
    v_mfma_f32_16x16x32_bf16 v[16:19], a[192:195], v[156:159], v[72:75]
    v_exp_f32_e64 v48, v32
    v_mfma_f32_16x16x32_bf16 v[20:23], a[192:195], v[188:191], v[76:79]
    v_exp_f32_e64 v49, v33
    v_mfma_f32_16x16x32_bf16 v[24:27], a[224:227], v[156:159], v[72:75]
    ds_read_b128 v[92:95], v7 offset:16384
    v_cvt_pk_bf16_f32 v64, v48, v49
    v_mfma_f32_16x16x32_bf16 v[28:31], a[224:227], v[188:191], v[76:79]
    ds_read_b128 v[96:99], v7 offset:17408
    v_mfma_f32_16x16x32_bf16 v[16:19], a[196:199], v[160:163], v[16:19]
    v_exp_f32_e64 v50, v34
    v_mfma_f32_16x16x32_bf16 v[20:23], a[196:199], v[192:195], v[20:23]
    v_exp_f32_e64 v51, v35
    v_mfma_f32_16x16x32_bf16 v[24:27], a[228:231], v[160:163], v[24:27]
    ds_read_b128 v[100:103], v7 offset:18432
    v_cvt_pk_bf16_f32 v65, v50, v51
    v_mfma_f32_16x16x32_bf16 v[28:31], a[228:231], v[192:195], v[28:31]
    ds_read_b128 v[104:107], v7 offset:19456
    v_mfma_f32_16x16x32_bf16 v[16:19], a[200:203], v[164:167], v[16:19]
    v_exp_f32_e64 v52, v40
    v_mfma_f32_16x16x32_bf16 v[20:23], a[200:203], v[196:199], v[20:23]
    v_exp_f32_e64 v53, v41
    v_mfma_f32_16x16x32_bf16 v[24:27], a[232:235], v[164:167], v[24:27]
    ds_read_b128 v[108:111], v7 offset:20480
    v_cvt_pk_bf16_f32 v66, v52, v53
    v_mfma_f32_16x16x32_bf16 v[28:31], a[232:235], v[196:199], v[28:31]
    ds_read_b128 v[112:115], v7 offset:21504
    v_or3_b32 v13, v64, v65, v66
    v_mfma_f32_16x16x32_bf16 v[16:19], a[204:207], v[168:171], v[16:19]
    v_exp_f32_e64 v54, v42
    v_mfma_f32_16x16x32_bf16 v[20:23], a[204:207], v[200:203], v[20:23]
    v_exp_f32_e64 v55, v43
    v_mfma_f32_16x16x32_bf16 v[24:27], a[236:239], v[168:171], v[24:27]
    ds_read_b128 v[116:119], v7 offset:22528
    v_cvt_pk_bf16_f32 v67, v54, v55
    v_mfma_f32_16x16x32_bf16 v[28:31], a[236:239], v[200:203], v[28:31]
    ds_read_b128 v[120:123], v7 offset:23552
    v_mfma_f32_16x16x32_bf16 v[16:19], a[208:211], v[172:175], v[16:19]
    v_exp_f32_e64 v56, v36
    v_mfma_f32_16x16x32_bf16 v[20:23], a[208:211], v[204:207], v[20:23]
    v_exp_f32_e64 v57, v37
    v_mfma_f32_16x16x32_bf16 v[24:27], a[240:243], v[172:175], v[24:27]
    ds_read_b128 v[124:127], v7 offset:24576
    v_cvt_pk_bf16_f32 v68, v56, v57
    v_mfma_f32_16x16x32_bf16 v[28:31], a[240:243], v[204:207], v[28:31]
    ds_read_b128 v[128:131], v7 offset:25600
    v_or3_b32 v13, v13, v67, v68
    v_mfma_f32_16x16x32_bf16 v[16:19], a[212:215], v[176:179], v[16:19]
    v_exp_f32_e64 v58, v38
    v_mfma_f32_16x16x32_bf16 v[20:23], a[212:215], v[208:211], v[20:23]
    v_exp_f32_e64 v59, v39
    v_mfma_f32_16x16x32_bf16 v[24:27], a[244:247], v[176:179], v[24:27]
    ds_read_b128 v[132:135], v7 offset:26624
    v_cvt_pk_bf16_f32 v69, v58, v59
    v_mfma_f32_16x16x32_bf16 v[28:31], a[244:247], v[208:211], v[28:31]
    ds_read_b128 v[136:139], v7 offset:27648
    v_mfma_f32_16x16x32_bf16 v[16:19], a[216:219], v[180:183], v[16:19]
    v_exp_f32_e64 v60, v44
    v_mfma_f32_16x16x32_bf16 v[20:23], a[216:219], v[212:215], v[20:23]
    v_exp_f32_e64 v61, v45
    v_mfma_f32_16x16x32_bf16 v[24:27], a[248:251], v[180:183], v[24:27]
    ds_read_b128 v[140:143], v7 offset:28672
    v_cvt_pk_bf16_f32 v70, v60, v61
    v_mfma_f32_16x16x32_bf16 v[28:31], a[248:251], v[212:215], v[28:31]
    ds_read_b128 v[144:147], v7 offset:29696
    v_or3_b32 v13, v13, v69, v70
    v_mfma_f32_16x16x32_bf16 v[16:19], a[220:223], v[184:187], v[16:19]
    v_exp_f32_e64 v62, v46
    v_mfma_f32_16x16x32_bf16 v[20:23], a[220:223], v[216:219], v[20:23]
    v_exp_f32_e64 v63, v47
    v_mfma_f32_16x16x32_bf16 v[24:27], a[252:255], v[184:187], v[24:27]
    v_cvt_pk_bf16_f32 v71, v62, v63
    v_and_b32_e64 v13, s71, v13
    v_mfma_f32_16x16x32_bf16 v[28:31], a[252:255], v[216:219], v[28:31]
    v_and_or_b32 v13, v71, s71, v13
    v_cmp_ne_u32 vcc, 0, v13
    s_waitcnt vmcnt(8)
    s_barrier
    s_cbranch_vccnz L_attn_kernel_slow_11
L_attn_kernel_ret_12:
    s_waitcnt lgkmcnt(2)
    v_mfma_f32_16x16x32_bf16 a[0:3], v[92:95], v[64:67], a[0:3]
    ds_read_b128 v[148:151], v7 offset:30720
    v_mfma_f32_16x16x32_bf16 a[4:7], v[92:95], v[68:71], a[4:7]
    ds_read_b128 v[152:155], v7 offset:31744
    s_mov_b32 m0, s43
    v_mfma_f32_16x16x32_bf16 a[8:11], v[96:99], v[64:67], a[8:11]
    buffer_load_dwordx4 v8, s[8:11], s39 offen offset:0 lds
    v_mfma_f32_16x16x32_bf16 a[12:15], v[96:99], v[68:71], a[12:15]
    ds_read_b128 a[192:195], v6 offset:16384
    v_mfma_f32_16x16x32_bf16 a[16:19], v[100:103], v[64:67], a[16:19]
    ds_read_b128 a[224:227], v6 offset:24576
    v_mfma_f32_16x16x32_bf16 a[20:23], v[100:103], v[68:71], a[20:23]
    ds_read_b128 a[196:199], v6 offset:17408
    v_mfma_f32_16x16x32_bf16 a[24:27], v[104:107], v[64:67], a[24:27]
    buffer_load_dwordx4 v8, s[8:11], s39 offen offset:1024 lds
    v_mfma_f32_16x16x32_bf16 a[28:31], v[104:107], v[68:71], a[28:31]
    ds_read_b128 a[228:231], v6 offset:25600
    v_mfma_f32_16x16x32_bf16 a[32:35], v[108:111], v[64:67], a[32:35]
    ds_read_b128 a[200:203], v6 offset:18432
    v_mfma_f32_16x16x32_bf16 a[36:39], v[108:111], v[68:71], a[36:39]
    ds_read_b128 a[232:235], v6 offset:26624
    v_mfma_f32_16x16x32_bf16 a[40:43], v[112:115], v[64:67], a[40:43]
    buffer_load_dwordx4 v8, s[8:11], s39 offen offset:2048 lds
    v_mfma_f32_16x16x32_bf16 a[44:47], v[112:115], v[68:71], a[44:47]
    ds_read_b128 a[204:207], v6 offset:19456
    v_mfma_f32_16x16x32_bf16 v[80:83], v[88:91], v[64:67], v[80:83]
    ds_read_b128 a[236:239], v6 offset:27648
    v_mfma_f32_16x16x32_bf16 a[48:51], v[116:119], v[64:67], a[48:51]
    ds_read_b128 a[208:211], v6 offset:20480
    v_mfma_f32_16x16x32_bf16 a[52:55], v[116:119], v[68:71], a[52:55]
    buffer_load_dwordx4 v8, s[8:11], s39 offen offset:3072 lds
    v_mfma_f32_16x16x32_bf16 a[56:59], v[120:123], v[64:67], a[56:59]
    ds_read_b128 a[240:243], v6 offset:28672
    v_mfma_f32_16x16x32_bf16 a[60:63], v[120:123], v[68:71], a[60:63]
    ds_read_b128 a[212:215], v6 offset:21504
    v_mfma_f32_16x16x32_bf16 a[64:67], v[124:127], v[64:67], a[64:67]
    ds_read_b128 a[244:247], v6 offset:29696
    s_add_u32 m0, s42, 65536
    v_mfma_f32_16x16x32_bf16 a[68:71], v[124:127], v[68:71], a[68:71]
    buffer_load_dwordx4 v8, s[12:15], s41 offen offset:0 lds
    v_mfma_f32_16x16x32_bf16 a[72:75], v[128:131], v[64:67], a[72:75]
    ds_read_b128 a[216:219], v6 offset:22528
    s_mov_b32 s68, s39
    v_mfma_f32_16x16x32_bf16 a[76:79], v[128:131], v[68:71], a[76:79]
    ds_read_b128 a[248:251], v6 offset:30720
    s_add_u32 s38, s38, 1
    v_mfma_f32_16x16x32_bf16 v[84:87], v[88:91], v[68:71], v[84:87]
    ds_read_b128 a[220:223], v6 offset:23552
    s_add_u32 s39, s39, 16384
    v_mfma_f32_16x16x32_bf16 a[80:83], v[132:135], v[64:67], a[80:83]
    buffer_load_dwordx4 v8, s[12:15], s41 offen offset:1024 lds
    v_mfma_f32_16x16x32_bf16 a[84:87], v[132:135], v[68:71], a[84:87]
    ds_read_b128 a[252:255], v6 offset:31744
    v_mfma_f32_16x16x32_bf16 a[88:91], v[136:139], v[64:67], a[88:91]
    s_cmp_eq_u32 s38, s36
    s_cselect_b32 s39, s37, s39
    v_mfma_f32_16x16x32_bf16 a[92:95], v[136:139], v[68:71], a[92:95]
    s_cmp_ge_u32 s38, 34
    s_cselect_b32 s39, 2147418112, s39
    s_waitcnt lgkmcnt(15)
    v_mfma_f32_16x16x32_bf16 a[96:99], v[140:143], v[64:67], a[96:99]
    buffer_load_dwordx4 v8, s[12:15], s41 offen offset:2048 lds
    v_mfma_f32_16x16x32_bf16 a[100:103], v[140:143], v[68:71], a[100:103]
    s_xor_b32 s42, s42, 0x8000
    s_xor_b32 s43, s43, 0x8000
    v_mfma_f32_16x16x32_bf16 a[104:107], v[144:147], v[64:67], a[104:107]
    v_xor_b32 v7, 0x8000, v7
    v_mfma_f32_16x16x32_bf16 a[108:111], v[144:147], v[68:71], a[108:111]
    v_mfma_f32_16x16x32_bf16 a[112:115], v[148:151], v[64:67], a[112:115]
    buffer_load_dwordx4 v8, s[12:15], s41 offen offset:3072 lds
    v_mfma_f32_16x16x32_bf16 a[116:119], v[148:151], v[68:71], a[116:119]
    s_mov_b32 s41, s40
    s_mov_b32 s40, s68
    v_xor_b32 v6, 0x8000, v6
    v_mfma_f32_16x16x32_bf16 a[120:123], v[152:155], v[64:67], a[120:123]
    v_mfma_f32_16x16x32_bf16 a[124:127], v[152:155], v[68:71], a[124:127]
    s_waitcnt lgkmcnt(0)
    s_sub_u32 s44, s44, 1
    s_cmp_lg_u32 s44, s3
    s_cbranch_scc1 L_attn_j2loop
L_attn_seg:
    s_cmp_eq_u32 s77, 3
    s_cbranch_scc1 L_attn_diag
    s_branch L_attn_segx
L_attn_diag:
    s_mov_b32 s45, 0
    v_add_u32_e64 v10, s45, v9
    v_cmp_gt_i32 s[52:53], 0, v10
    v_cmp_gt_i32 s[54:55], 1, v10
    v_cmp_gt_i32 s[56:57], 2, v10
    v_cmp_gt_i32 s[58:59], 3, v10
    v_cmp_gt_i32 s[60:61], -16, v10
    v_cmp_gt_i32 s[62:63], -15, v10
    v_cmp_gt_i32 s[64:65], -14, v10
    v_cmp_gt_i32 s[66:67], -13, v10
    v_cndmask_b32 v16, v16, v11, s[52:53]
    v_cndmask_b32 v17, v17, v11, s[54:55]
    v_cndmask_b32 v18, v18, v11, s[56:57]
    v_cndmask_b32 v19, v19, v11, s[58:59]
    v_cndmask_b32 v20, v20, v11, s[60:61]
    v_cndmask_b32 v21, v21, v11, s[62:63]
    v_cndmask_b32 v22, v22, v11, s[64:65]
    v_cndmask_b32 v23, v23, v11, s[66:67]
    v_cmp_gt_i32 s[52:53], 16, v10
    v_cmp_gt_i32 s[54:55], 17, v10
    v_cmp_gt_i32 s[56:57], 18, v10
    v_cmp_gt_i32 s[58:59], 19, v10
    v_cmp_gt_i32 s[60:61], 0, v10
    v_cmp_gt_i32 s[62:63], 1, v10
    v_cmp_gt_i32 s[64:65], 2, v10
    v_cmp_gt_i32 s[66:67], 3, v10
    v_cndmask_b32 v24, v24, v11, s[52:53]
    v_cndmask_b32 v25, v25, v11, s[54:55]
    v_cndmask_b32 v26, v26, v11, s[56:57]
    v_cndmask_b32 v27, v27, v11, s[58:59]
    v_cndmask_b32 v28, v28, v11, s[60:61]
    v_cndmask_b32 v29, v29, v11, s[62:63]
    v_cndmask_b32 v30, v30, v11, s[64:65]
    v_cndmask_b32 v31, v31, v11, s[66:67]
    s_sub_u32 s45, s45, 32
    v_mfma_f32_16x16x32_bf16 v[32:35], a[192:195], v[156:159], v[72:75]
    v_exp_f32 v48, v16
    v_mfma_f32_16x16x32_bf16 v[36:39], a[192:195], v[188:191], v[76:79]
    v_exp_f32_e64 v49, v17
    v_mfma_f32_16x16x32_bf16 v[40:43], a[224:227], v[156:159], v[72:75]
    ds_read_b128 v[92:95], v7 offset:0
    v_cvt_pk_bf16_f32 v64, v48, v49
    v_mfma_f32_16x16x32_bf16 v[44:47], a[224:227], v[188:191], v[76:79]
    ds_read_b128 v[96:99], v7 offset:1024
    v_mfma_f32_16x16x32_bf16 v[32:35], a[196:199], v[160:163], v[32:35]
    v_exp_f32_e64 v50, v18
    v_mfma_f32_16x16x32_bf16 v[36:39], a[196:199], v[192:195], v[36:39]
    v_exp_f32_e64 v51, v19
    v_mfma_f32_16x16x32_bf16 v[40:43], a[228:231], v[160:163], v[40:43]
    ds_read_b128 v[100:103], v7 offset:2048
    v_cvt_pk_bf16_f32 v65, v50, v51
    v_mfma_f32_16x16x32_bf16 v[44:47], a[228:231], v[192:195], v[44:47]
    ds_read_b128 v[104:107], v7 offset:3072
    v_mfma_f32_16x16x32_bf16 v[32:35], a[200:203], v[164:167], v[32:35]
    v_exp_f32_e64 v52, v24
    v_mfma_f32_16x16x32_bf16 v[36:39], a[200:203], v[196:199], v[36:39]
    v_exp_f32_e64 v53, v25
    v_mfma_f32_16x16x32_bf16 v[40:43], a[232:235], v[164:167], v[40:43]
    ds_read_b128 v[108:111], v7 offset:4096
    v_cvt_pk_bf16_f32 v66, v52, v53
    v_mfma_f32_16x16x32_bf16 v[44:47], a[232:235], v[196:199], v[44:47]
    ds_read_b128 v[112:115], v7 offset:5120
    v_or3_b32 v13, v64, v65, v66
    v_mfma_f32_16x16x32_bf16 v[32:35], a[204:207], v[168:171], v[32:35]
    v_exp_f32_e64 v54, v26
    v_mfma_f32_16x16x32_bf16 v[36:39], a[204:207], v[200:203], v[36:39]
    v_exp_f32_e64 v55, v27
    v_mfma_f32_16x16x32_bf16 v[40:43], a[236:239], v[168:171], v[40:43]
    ds_read_b128 v[116:119], v7 offset:6144
    v_cvt_pk_bf16_f32 v67, v54, v55
    v_mfma_f32_16x16x32_bf16 v[44:47], a[236:239], v[200:203], v[44:47]
    ds_read_b128 v[120:123], v7 offset:7168
    v_mfma_f32_16x16x32_bf16 v[32:35], a[208:211], v[172:175], v[32:35]
    v_exp_f32_e64 v56, v20
    v_mfma_f32_16x16x32_bf16 v[36:39], a[208:211], v[204:207], v[36:39]
    v_exp_f32_e64 v57, v21
    v_mfma_f32_16x16x32_bf16 v[40:43], a[240:243], v[172:175], v[40:43]
    ds_read_b128 v[124:127], v7 offset:8192
    v_cvt_pk_bf16_f32 v68, v56, v57
    v_mfma_f32_16x16x32_bf16 v[44:47], a[240:243], v[204:207], v[44:47]
    ds_read_b128 v[128:131], v7 offset:9216
    v_or3_b32 v13, v13, v67, v68
    v_mfma_f32_16x16x32_bf16 v[32:35], a[212:215], v[176:179], v[32:35]
    v_exp_f32_e64 v58, v22
    v_mfma_f32_16x16x32_bf16 v[36:39], a[212:215], v[208:211], v[36:39]
    v_exp_f32_e64 v59, v23
    v_mfma_f32_16x16x32_bf16 v[40:43], a[244:247], v[176:179], v[40:43]
    ds_read_b128 v[132:135], v7 offset:10240
    v_cvt_pk_bf16_f32 v69, v58, v59
    v_mfma_f32_16x16x32_bf16 v[44:47], a[244:247], v[208:211], v[44:47]
    ds_read_b128 v[136:139], v7 offset:11264
    v_mfma_f32_16x16x32_bf16 v[32:35], a[216:219], v[180:183], v[32:35]
    v_exp_f32_e64 v60, v28
    v_mfma_f32_16x16x32_bf16 v[36:39], a[216:219], v[212:215], v[36:39]
    v_exp_f32_e64 v61, v29
    v_mfma_f32_16x16x32_bf16 v[40:43], a[248:251], v[180:183], v[40:43]
    ds_read_b128 v[140:143], v7 offset:12288
    v_cvt_pk_bf16_f32 v70, v60, v61
    v_mfma_f32_16x16x32_bf16 v[44:47], a[248:251], v[212:215], v[44:47]
    ds_read_b128 v[144:147], v7 offset:13312
    v_or3_b32 v13, v13, v69, v70
    v_mfma_f32_16x16x32_bf16 v[32:35], a[220:223], v[184:187], v[32:35]
    v_exp_f32_e64 v62, v30
    v_mfma_f32_16x16x32_bf16 v[36:39], a[220:223], v[216:219], v[36:39]
    v_exp_f32_e64 v63, v31
    v_mfma_f32_16x16x32_bf16 v[40:43], a[252:255], v[184:187], v[40:43]
    v_cvt_pk_bf16_f32 v71, v62, v63
    v_and_b32_e64 v13, s71, v13
    v_mfma_f32_16x16x32_bf16 v[44:47], a[252:255], v[216:219], v[44:47]
    v_and_or_b32 v13, v71, s71, v13
    v_cmp_ne_u32 vcc, 0, v13
    s_waitcnt vmcnt(8)
    s_barrier
    s_cbranch_vccnz L_attn_kernel_slow_13
L_attn_kernel_ret_14:
    s_waitcnt lgkmcnt(2)
    v_mfma_f32_16x16x32_bf16 a[0:3], v[92:95], v[64:67], a[0:3]
    ds_read_b128 v[148:151], v7 offset:14336
    v_mfma_f32_16x16x32_bf16 a[4:7], v[92:95], v[68:71], a[4:7]
    ds_read_b128 v[152:155], v7 offset:15360
    s_add_u32 m0, s43, 81920
    v_mfma_f32_16x16x32_bf16 a[8:11], v[96:99], v[64:67], a[8:11]
    buffer_load_dwordx4 v8, s[12:15], s41 offen offset:0 lds
    v_mfma_f32_16x16x32_bf16 a[12:15], v[96:99], v[68:71], a[12:15]
    ds_read_b128 a[192:195], v6 offset:0
    v_add_u32 v10, s45, v9
    v_mfma_f32_16x16x32_bf16 a[16:19], v[100:103], v[64:67], a[16:19]
    ds_read_b128 a[224:227], v6 offset:8192
    v_cmp_gt_i32 s[52:53], 0, v10
    v_mfma_f32_16x16x32_bf16 a[20:23], v[100:103], v[68:71], a[20:23]
    ds_read_b128 a[196:199], v6 offset:1024
    v_cmp_gt_i32 s[54:55], 1, v10
    v_mfma_f32_16x16x32_bf16 a[24:27], v[104:107], v[64:67], a[24:27]
    buffer_load_dwordx4 v8, s[12:15], s41 offen offset:1024 lds
    v_mfma_f32_16x16x32_bf16 a[28:31], v[104:107], v[68:71], a[28:31]
    ds_read_b128 a[228:231], v6 offset:9216
    v_cmp_gt_i32 s[56:57], 2, v10
    v_mfma_f32_16x16x32_bf16 a[32:35], v[108:111], v[64:67], a[32:35]
    ds_read_b128 a[200:203], v6 offset:2048
    v_cmp_gt_i32 s[58:59], 3, v10
    v_mfma_f32_16x16x32_bf16 a[36:39], v[108:111], v[68:71], a[36:39]
    ds_read_b128 a[232:235], v6 offset:10240
    v_cmp_gt_i32 s[60:61], -16, v10
    v_mfma_f32_16x16x32_bf16 a[40:43], v[112:115], v[64:67], a[40:43]
    buffer_load_dwordx4 v8, s[12:15], s41 offen offset:2048 lds
    v_mfma_f32_16x16x32_bf16 a[44:47], v[112:115], v[68:71], a[44:47]
    ds_read_b128 a[204:207], v6 offset:3072
    v_cmp_gt_i32 s[62:63], -15, v10
    v_mfma_f32_16x16x32_bf16 v[80:83], v[88:91], v[64:67], v[80:83]
    ds_read_b128 a[236:239], v6 offset:11264
    v_cmp_gt_i32 s[64:65], -14, v10
    v_mfma_f32_16x16x32_bf16 a[48:51], v[116:119], v[64:67], a[48:51]
    ds_read_b128 a[208:211], v6 offset:4096
    v_cmp_gt_i32 s[66:67], -13, v10
    v_mfma_f32_16x16x32_bf16 a[52:55], v[116:119], v[68:71], a[52:55]
    buffer_load_dwordx4 v8, s[12:15], s41 offen offset:3072 lds
    v_mfma_f32_16x16x32_bf16 a[56:59], v[120:123], v[64:67], a[56:59]
    ds_read_b128 a[240:243], v6 offset:12288
    v_cndmask_b32 v32, v32, v11, s[52:53]
    v_mfma_f32_16x16x32_bf16 a[60:63], v[120:123], v[68:71], a[60:63]
    ds_read_b128 a[212:215], v6 offset:5120
    v_cndmask_b32 v33, v33, v11, s[54:55]
    v_mfma_f32_16x16x32_bf16 a[64:67], v[124:127], v[64:67], a[64:67]
    ds_read_b128 a[244:247], v6 offset:13312
    v_cndmask_b32 v34, v34, v11, s[56:57]
    v_mfma_f32_16x16x32_bf16 a[68:71], v[124:127], v[68:71], a[68:71]
    ds_read_b128 a[216:219], v6 offset:6144
    v_cndmask_b32 v35, v35, v11, s[58:59]
    v_mfma_f32_16x16x32_bf16 a[72:75], v[128:131], v[64:67], a[72:75]
    ds_read_b128 a[248:251], v6 offset:14336
    v_cndmask_b32 v36, v36, v11, s[60:61]
    v_mfma_f32_16x16x32_bf16 a[76:79], v[128:131], v[68:71], a[76:79]
    ds_read_b128 a[220:223], v6 offset:7168
    v_cndmask_b32 v37, v37, v11, s[62:63]
    v_mfma_f32_16x16x32_bf16 v[84:87], v[88:91], v[68:71], v[84:87]
    ds_read_b128 a[252:255], v6 offset:15360
    v_cndmask_b32 v38, v38, v11, s[64:65]
    v_mfma_f32_16x16x32_bf16 a[80:83], v[132:135], v[64:67], a[80:83]
    v_cndmask_b32 v39, v39, v11, s[66:67]
    v_cmp_gt_i32 s[52:53], 16, v10
    v_mfma_f32_16x16x32_bf16 a[84:87], v[132:135], v[68:71], a[84:87]
    v_cmp_gt_i32 s[54:55], 17, v10
    v_cmp_gt_i32 s[56:57], 18, v10
    v_mfma_f32_16x16x32_bf16 a[88:91], v[136:139], v[64:67], a[88:91]
    v_cmp_gt_i32 s[58:59], 19, v10
    v_cmp_gt_i32 s[60:61], 0, v10
    v_mfma_f32_16x16x32_bf16 a[92:95], v[136:139], v[68:71], a[92:95]
    v_cmp_gt_i32 s[62:63], 1, v10
    v_cmp_gt_i32 s[64:65], 2, v10
    s_waitcnt lgkmcnt(15)
    v_mfma_f32_16x16x32_bf16 a[96:99], v[140:143], v[64:67], a[96:99]
    v_cmp_gt_i32 s[66:67], 3, v10
    v_cndmask_b32 v40, v40, v11, s[52:53]
    v_mfma_f32_16x16x32_bf16 a[100:103], v[140:143], v[68:71], a[100:103]
    v_cndmask_b32 v41, v41, v11, s[54:55]
    v_cndmask_b32 v42, v42, v11, s[56:57]
    v_mfma_f32_16x16x32_bf16 a[104:107], v[144:147], v[64:67], a[104:107]
    v_cndmask_b32 v43, v43, v11, s[58:59]
    v_cndmask_b32 v44, v44, v11, s[60:61]
    v_mfma_f32_16x16x32_bf16 a[108:111], v[144:147], v[68:71], a[108:111]
    v_cndmask_b32 v45, v45, v11, s[62:63]
    v_cndmask_b32 v46, v46, v11, s[64:65]
    v_mfma_f32_16x16x32_bf16 a[112:115], v[148:151], v[64:67], a[112:115]
    v_cndmask_b32 v47, v47, v11, s[66:67]
    s_sub_u32 s45, s45, 32
    v_mfma_f32_16x16x32_bf16 a[116:119], v[148:151], v[68:71], a[116:119]
    v_mfma_f32_16x16x32_bf16 a[120:123], v[152:155], v[64:67], a[120:123]
    v_mfma_f32_16x16x32_bf16 a[124:127], v[152:155], v[68:71], a[124:127]
    s_sub_u32 s51, s51, 1
    s_cbranch_scc1 L_attn_kernel_flag_15
L_attn_kernel_fb_16:
    s_waitcnt lgkmcnt(0)
    s_cmp_lt_u32 s32, 1
    s_cbranch_scc1 L_attn_kernel_light_17
    v_mfma_f32_16x16x32_bf16 v[16:19], a[192:195], v[156:159], v[72:75]
    v_exp_f32 v48, v32
    v_mfma_f32_16x16x32_bf16 v[20:23], a[192:195], v[188:191], v[76:79]
    v_exp_f32_e64 v49, v33
    v_mfma_f32_16x16x32_bf16 v[24:27], a[224:227], v[156:159], v[72:75]
    ds_read_b128 v[92:95], v7 offset:16384
    v_cvt_pk_bf16_f32 v64, v48, v49
    v_mfma_f32_16x16x32_bf16 v[28:31], a[224:227], v[188:191], v[76:79]
    ds_read_b128 v[96:99], v7 offset:17408
    v_mfma_f32_16x16x32_bf16 v[16:19], a[196:199], v[160:163], v[16:19]
    v_exp_f32_e64 v50, v34
    v_mfma_f32_16x16x32_bf16 v[20:23], a[196:199], v[192:195], v[20:23]
    v_exp_f32_e64 v51, v35
    v_mfma_f32_16x16x32_bf16 v[24:27], a[228:231], v[160:163], v[24:27]
    ds_read_b128 v[100:103], v7 offset:18432
    v_cvt_pk_bf16_f32 v65, v50, v51
    v_mfma_f32_16x16x32_bf16 v[28:31], a[228:231], v[192:195], v[28:31]
    ds_read_b128 v[104:107], v7 offset:19456
    v_mfma_f32_16x16x32_bf16 v[16:19], a[200:203], v[164:167], v[16:19]
    v_exp_f32_e64 v52, v40
    v_mfma_f32_16x16x32_bf16 v[20:23], a[200:203], v[196:199], v[20:23]
    v_exp_f32_e64 v53, v41
    v_mfma_f32_16x16x32_bf16 v[24:27], a[232:235], v[164:167], v[24:27]
    ds_read_b128 v[108:111], v7 offset:20480
    v_cvt_pk_bf16_f32 v66, v52, v53
    v_mfma_f32_16x16x32_bf16 v[28:31], a[232:235], v[196:199], v[28:31]
    ds_read_b128 v[112:115], v7 offset:21504
    v_or3_b32 v13, v64, v65, v66
    v_mfma_f32_16x16x32_bf16 v[16:19], a[204:207], v[168:171], v[16:19]
    v_exp_f32_e64 v54, v42
    v_mfma_f32_16x16x32_bf16 v[20:23], a[204:207], v[200:203], v[20:23]
    v_exp_f32_e64 v55, v43
    v_mfma_f32_16x16x32_bf16 v[24:27], a[236:239], v[168:171], v[24:27]
    ds_read_b128 v[116:119], v7 offset:22528
    v_cvt_pk_bf16_f32 v67, v54, v55
    v_mfma_f32_16x16x32_bf16 v[28:31], a[236:239], v[200:203], v[28:31]
    ds_read_b128 v[120:123], v7 offset:23552
    v_mfma_f32_16x16x32_bf16 v[16:19], a[208:211], v[172:175], v[16:19]
    v_exp_f32_e64 v56, v36
    v_mfma_f32_16x16x32_bf16 v[20:23], a[208:211], v[204:207], v[20:23]
    v_exp_f32_e64 v57, v37
    v_mfma_f32_16x16x32_bf16 v[24:27], a[240:243], v[172:175], v[24:27]
    ds_read_b128 v[124:127], v7 offset:24576
    v_cvt_pk_bf16_f32 v68, v56, v57
    v_mfma_f32_16x16x32_bf16 v[28:31], a[240:243], v[204:207], v[28:31]
    ds_read_b128 v[128:131], v7 offset:25600
    v_or3_b32 v13, v13, v67, v68
    v_mfma_f32_16x16x32_bf16 v[16:19], a[212:215], v[176:179], v[16:19]
    v_exp_f32_e64 v58, v38
    v_mfma_f32_16x16x32_bf16 v[20:23], a[212:215], v[208:211], v[20:23]
    v_exp_f32_e64 v59, v39
    v_mfma_f32_16x16x32_bf16 v[24:27], a[244:247], v[176:179], v[24:27]
    ds_read_b128 v[132:135], v7 offset:26624
    v_cvt_pk_bf16_f32 v69, v58, v59
    v_mfma_f32_16x16x32_bf16 v[28:31], a[244:247], v[208:211], v[28:31]
    ds_read_b128 v[136:139], v7 offset:27648
    v_mfma_f32_16x16x32_bf16 v[16:19], a[216:219], v[180:183], v[16:19]
    v_exp_f32_e64 v60, v44
    v_mfma_f32_16x16x32_bf16 v[20:23], a[216:219], v[212:215], v[20:23]
    v_exp_f32_e64 v61, v45
    v_mfma_f32_16x16x32_bf16 v[24:27], a[248:251], v[180:183], v[24:27]
    ds_read_b128 v[140:143], v7 offset:28672
    v_cvt_pk_bf16_f32 v70, v60, v61
    v_mfma_f32_16x16x32_bf16 v[28:31], a[248:251], v[212:215], v[28:31]
    ds_read_b128 v[144:147], v7 offset:29696
    v_or3_b32 v13, v13, v69, v70
    v_mfma_f32_16x16x32_bf16 v[16:19], a[220:223], v[184:187], v[16:19]
    v_exp_f32_e64 v62, v46
    v_mfma_f32_16x16x32_bf16 v[20:23], a[220:223], v[216:219], v[20:23]
    v_exp_f32_e64 v63, v47
    v_mfma_f32_16x16x32_bf16 v[24:27], a[252:255], v[184:187], v[24:27]
    v_cvt_pk_bf16_f32 v71, v62, v63
    v_and_b32_e64 v13, s71, v13
    v_mfma_f32_16x16x32_bf16 v[28:31], a[252:255], v[216:219], v[28:31]
    v_and_or_b32 v13, v71, s71, v13
    v_cmp_ne_u32 vcc, 0, v13
    s_waitcnt vmcnt(4)
    s_barrier
    s_cbranch_vccnz L_attn_kernel_slow_19
L_attn_kernel_ret_20:
    s_waitcnt lgkmcnt(2)
    v_mfma_f32_16x16x32_bf16 a[0:3], v[92:95], v[64:67], a[0:3]
    ds_read_b128 v[148:151], v7 offset:30720
    v_mfma_f32_16x16x32_bf16 a[4:7], v[92:95], v[68:71], a[4:7]
    ds_read_b128 v[152:155], v7 offset:31744
    s_add_u32 m0, s76, 32768
    s_mov_b32 s68, 0
    v_mfma_f32_16x16x32_bf16 a[8:11], v[96:99], v[64:67], a[8:11]
    buffer_load_dwordx4 v220, s[72:75], s68 offen lds
    v_mfma_f32_16x16x32_bf16 a[12:15], v[96:99], v[68:71], a[12:15]
    ds_read_b128 a[192:195], v6 offset:16384
    v_add_u32_e64 v10, s45, v9
    v_mfma_f32_16x16x32_bf16 a[16:19], v[100:103], v[64:67], a[16:19]
    ds_read_b128 a[224:227], v6 offset:24576
    v_cmp_gt_i32 s[52:53], 0, v10
    v_mfma_f32_16x16x32_bf16 a[20:23], v[100:103], v[68:71], a[20:23]
    ds_read_b128 a[196:199], v6 offset:17408
    s_add_u32 m0, s76, 33792
    s_mov_b32 s68, 7168
    v_mfma_f32_16x16x32_bf16 a[24:27], v[104:107], v[64:67], a[24:27]
    buffer_load_dwordx4 v220, s[72:75], s68 offen lds
    v_mfma_f32_16x16x32_bf16 a[28:31], v[104:107], v[68:71], a[28:31]
    ds_read_b128 a[228:231], v6 offset:25600
    v_cmp_gt_i32 s[54:55], 1, v10
    v_mfma_f32_16x16x32_bf16 a[32:35], v[108:111], v[64:67], a[32:35]
    ds_read_b128 a[200:203], v6 offset:18432
    v_cmp_gt_i32 s[56:57], 2, v10
    v_mfma_f32_16x16x32_bf16 a[36:39], v[108:111], v[68:71], a[36:39]
    ds_read_b128 a[232:235], v6 offset:26624
    s_add_u32 m0, s76, 34816
    s_mov_b32 s68, 14336
    v_mfma_f32_16x16x32_bf16 a[40:43], v[112:115], v[64:67], a[40:43]
    buffer_load_dwordx4 v220, s[72:75], s68 offen lds
    v_mfma_f32_16x16x32_bf16 a[44:47], v[112:115], v[68:71], a[44:47]
    ds_read_b128 a[204:207], v6 offset:19456
    v_cmp_gt_i32 s[58:59], 3, v10
    v_mfma_f32_16x16x32_bf16 v[80:83], v[88:91], v[64:67], v[80:83]
    ds_read_b128 a[236:239], v6 offset:27648
    v_cmp_gt_i32 s[60:61], -16, v10
    v_mfma_f32_16x16x32_bf16 a[48:51], v[116:119], v[64:67], a[48:51]
    ds_read_b128 a[208:211], v6 offset:20480
    s_add_u32 m0, s76, 35840
    s_mov_b32 s68, 21504
    v_mfma_f32_16x16x32_bf16 a[52:55], v[116:119], v[68:71], a[52:55]
    buffer_load_dwordx4 v220, s[72:75], s68 offen lds
    v_mfma_f32_16x16x32_bf16 a[56:59], v[120:123], v[64:67], a[56:59]
    ds_read_b128 a[240:243], v6 offset:28672
    v_cmp_gt_i32 s[62:63], -15, v10
    v_mfma_f32_16x16x32_bf16 a[60:63], v[120:123], v[68:71], a[60:63]
    ds_read_b128 a[212:215], v6 offset:21504
    v_cmp_gt_i32 s[64:65], -14, v10
    v_mfma_f32_16x16x32_bf16 a[64:67], v[124:127], v[64:67], a[64:67]
    ds_read_b128 a[244:247], v6 offset:29696
    s_add_u32 m0, s76, 36864
    s_mov_b32 s68, 28672
    v_mfma_f32_16x16x32_bf16 a[68:71], v[124:127], v[68:71], a[68:71]
    buffer_load_dwordx4 v220, s[72:75], s68 offen lds
    v_mfma_f32_16x16x32_bf16 a[72:75], v[128:131], v[64:67], a[72:75]
    ds_read_b128 a[216:219], v6 offset:22528
    v_cmp_gt_i32 s[66:67], -13, v10
    v_mfma_f32_16x16x32_bf16 a[76:79], v[128:131], v[68:71], a[76:79]
    ds_read_b128 a[248:251], v6 offset:30720
    v_cndmask_b32 v16, v16, v11, s[52:53]
    v_mfma_f32_16x16x32_bf16 v[84:87], v[88:91], v[68:71], v[84:87]
    ds_read_b128 a[220:223], v6 offset:23552
    s_add_u32 m0, s76, 37888
    s_mov_b32 s68, 35840
    v_mfma_f32_16x16x32_bf16 a[80:83], v[132:135], v[64:67], a[80:83]
    buffer_load_dwordx4 v220, s[72:75], s68 offen lds
    v_mfma_f32_16x16x32_bf16 a[84:87], v[132:135], v[68:71], a[84:87]
    ds_read_b128 a[252:255], v6 offset:31744
    v_cndmask_b32 v17, v17, v11, s[54:55]
    v_mfma_f32_16x16x32_bf16 a[88:91], v[136:139], v[64:67], a[88:91]
    v_cndmask_b32 v18, v18, v11, s[56:57]
    v_cndmask_b32 v19, v19, v11, s[58:59]
    v_mfma_f32_16x16x32_bf16 a[92:95], v[136:139], v[68:71], a[92:95]
    s_add_u32 m0, s76, 38912
    s_mov_b32 s68, 43008
    s_waitcnt lgkmcnt(15)
    v_mfma_f32_16x16x32_bf16 a[96:99], v[140:143], v[64:67], a[96:99]
    buffer_load_dwordx4 v220, s[72:75], s68 offen lds
    v_mfma_f32_16x16x32_bf16 a[100:103], v[140:143], v[68:71], a[100:103]
    v_cndmask_b32 v20, v20, v11, s[60:61]
    v_cndmask_b32 v21, v21, v11, s[62:63]
    v_mfma_f32_16x16x32_bf16 a[104:107], v[144:147], v[64:67], a[104:107]
    v_cndmask_b32 v22, v22, v11, s[64:65]
    v_cndmask_b32 v23, v23, v11, s[66:67]
    v_mfma_f32_16x16x32_bf16 a[108:111], v[144:147], v[68:71], a[108:111]
    s_add_u32 m0, s76, 39936
    s_mov_b32 s68, 50176
    v_mfma_f32_16x16x32_bf16 a[112:115], v[148:151], v[64:67], a[112:115]
    buffer_load_dwordx4 v220, s[72:75], s68 offen lds
    v_mfma_f32_16x16x32_bf16 a[116:119], v[148:151], v[68:71], a[116:119]
    v_cmp_gt_i32 s[52:53], 16, v10
    v_cmp_gt_i32 s[54:55], 17, v10
    s_xor_b32 s42, s42, 0x8000
    v_mfma_f32_16x16x32_bf16 a[120:123], v[152:155], v[64:67], a[120:123]
    v_cmp_gt_i32 s[56:57], 18, v10
    v_cmp_gt_i32 s[58:59], 19, v10
    s_xor_b32 s43, s43, 0x8000
    v_mfma_f32_16x16x32_bf16 a[124:127], v[152:155], v[68:71], a[124:127]
    v_cmp_gt_i32 s[60:61], 0, v10
    v_cmp_gt_i32 s[62:63], 1, v10
    v_cmp_gt_i32 s[64:65], 2, v10
    v_cmp_gt_i32 s[66:67], 3, v10
    v_cndmask_b32 v24, v24, v11, s[52:53]
    v_cndmask_b32 v25, v25, v11, s[54:55]
    v_cndmask_b32 v26, v26, v11, s[56:57]
    v_cndmask_b32 v27, v27, v11, s[58:59]
    v_cndmask_b32 v28, v28, v11, s[60:61]
    v_cndmask_b32 v29, v29, v11, s[62:63]
    v_cndmask_b32 v30, v30, v11, s[64:65]
    v_cndmask_b32 v31, v31, v11, s[66:67]
    s_sub_u32 s45, s45, 32
    v_xor_b32 v7, 0x8000, v7
    v_xor_b32 v6, 0x8000, v6
    s_sub_u32 s51, s51, 1
    s_cbranch_scc1 L_attn_kernel_flag_21
L_attn_kernel_fb_22:
    s_waitcnt lgkmcnt(0)
    s_branch L_attn_kernel_join_18
L_attn_kernel_light_17:
    s_waitcnt vmcnt(4)
    s_barrier
L_attn_kernel_ret_24:
    s_waitcnt lgkmcnt(2)
    s_add_u32 m0, s76, 32768
    s_mov_b32 s68, 0
    buffer_load_dwordx4 v220, s[72:75], s68 offen lds
    s_add_u32 m0, s76, 33792
    s_mov_b32 s68, 7168
    buffer_load_dwordx4 v220, s[72:75], s68 offen lds
    s_add_u32 m0, s76, 34816
    s_mov_b32 s68, 14336
    buffer_load_dwordx4 v220, s[72:75], s68 offen lds
    s_add_u32 m0, s76, 35840
    s_mov_b32 s68, 21504
    buffer_load_dwordx4 v220, s[72:75], s68 offen lds
    s_add_u32 m0, s76, 36864
    s_mov_b32 s68, 28672
    buffer_load_dwordx4 v220, s[72:75], s68 offen lds
    s_add_u32 m0, s76, 37888
    s_mov_b32 s68, 35840
    buffer_load_dwordx4 v220, s[72:75], s68 offen lds
    s_add_u32 m0, s76, 38912
    s_mov_b32 s68, 43008
    s_waitcnt lgkmcnt(15)
    buffer_load_dwordx4 v220, s[72:75], s68 offen lds
    s_add_u32 m0, s76, 39936
    s_mov_b32 s68, 50176
    buffer_load_dwordx4 v220, s[72:75], s68 offen lds
    s_xor_b32 s42, s42, 0x8000
    s_xor_b32 s43, s43, 0x8000
    s_sub_u32 s45, s45, 32
    s_sub_u32 s51, s51, 1
    s_cbranch_scc1 L_attn_kernel_flag_25
L_attn_kernel_fb_26:
    s_waitcnt lgkmcnt(0)
L_attn_kernel_join_18:
    v_mov_b32 v255, s70
    s_nop 0
    buffer_load_ushort v227, v255, s[28:31], 0 offen sc1
    s_cmp_lt_u32 s32, 2
    s_cbranch_scc1 L_attn_kernel_light_27
    v_mfma_f32_16x16x32_bf16 v[32:35], a[192:195], v[156:159], v[72:75]
    v_exp_f32 v48, v16
    v_mfma_f32_16x16x32_bf16 v[36:39], a[192:195], v[188:191], v[76:79]
    v_exp_f32_e64 v49, v17
    v_mfma_f32_16x16x32_bf16 v[40:43], a[224:227], v[156:159], v[72:75]
    ds_read_b128 v[92:95], v7 offset:0
    v_cvt_pk_bf16_f32 v64, v48, v49
    v_mfma_f32_16x16x32_bf16 v[44:47], a[224:227], v[188:191], v[76:79]
    ds_read_b128 v[96:99], v7 offset:1024
    v_mfma_f32_16x16x32_bf16 v[32:35], a[196:199], v[160:163], v[32:35]
    v_exp_f32_e64 v50, v18
    v_mfma_f32_16x16x32_bf16 v[36:39], a[196:199], v[192:195], v[36:39]
    v_exp_f32_e64 v51, v19
    v_mfma_f32_16x16x32_bf16 v[40:43], a[228:231], v[160:163], v[40:43]
    ds_read_b128 v[100:103], v7 offset:2048
    v_cvt_pk_bf16_f32 v65, v50, v51
    v_mfma_f32_16x16x32_bf16 v[44:47], a[228:231], v[192:195], v[44:47]
    ds_read_b128 v[104:107], v7 offset:3072
    v_mfma_f32_16x16x32_bf16 v[32:35], a[200:203], v[164:167], v[32:35]
    v_exp_f32_e64 v52, v24
    v_mfma_f32_16x16x32_bf16 v[36:39], a[200:203], v[196:199], v[36:39]
    v_exp_f32_e64 v53, v25
    v_mfma_f32_16x16x32_bf16 v[40:43], a[232:235], v[164:167], v[40:43]
    ds_read_b128 v[108:111], v7 offset:4096
    v_cvt_pk_bf16_f32 v66, v52, v53
    v_mfma_f32_16x16x32_bf16 v[44:47], a[232:235], v[196:199], v[44:47]
    ds_read_b128 v[112:115], v7 offset:5120
    v_or3_b32 v13, v64, v65, v66
    v_mfma_f32_16x16x32_bf16 v[32:35], a[204:207], v[168:171], v[32:35]
    v_exp_f32_e64 v54, v26
    v_mfma_f32_16x16x32_bf16 v[36:39], a[204:207], v[200:203], v[36:39]
    v_exp_f32_e64 v55, v27
    v_mfma_f32_16x16x32_bf16 v[40:43], a[236:239], v[168:171], v[40:43]
    ds_read_b128 v[116:119], v7 offset:6144
    v_cvt_pk_bf16_f32 v67, v54, v55
    v_mfma_f32_16x16x32_bf16 v[44:47], a[236:239], v[200:203], v[44:47]
    ds_read_b128 v[120:123], v7 offset:7168
    v_mfma_f32_16x16x32_bf16 v[32:35], a[208:211], v[172:175], v[32:35]
    v_exp_f32_e64 v56, v20
    v_mfma_f32_16x16x32_bf16 v[36:39], a[208:211], v[204:207], v[36:39]
    v_exp_f32_e64 v57, v21
    v_mfma_f32_16x16x32_bf16 v[40:43], a[240:243], v[172:175], v[40:43]
    ds_read_b128 v[124:127], v7 offset:8192
    v_cvt_pk_bf16_f32 v68, v56, v57
    v_mfma_f32_16x16x32_bf16 v[44:47], a[240:243], v[204:207], v[44:47]
    ds_read_b128 v[128:131], v7 offset:9216
    v_or3_b32 v13, v13, v67, v68
    v_mfma_f32_16x16x32_bf16 v[32:35], a[212:215], v[176:179], v[32:35]
    v_exp_f32_e64 v58, v22
    v_mfma_f32_16x16x32_bf16 v[36:39], a[212:215], v[208:211], v[36:39]
    v_exp_f32_e64 v59, v23
    v_mfma_f32_16x16x32_bf16 v[40:43], a[244:247], v[176:179], v[40:43]
    ds_read_b128 v[132:135], v7 offset:10240
    v_cvt_pk_bf16_f32 v69, v58, v59
    v_mfma_f32_16x16x32_bf16 v[44:47], a[244:247], v[208:211], v[44:47]
    ds_read_b128 v[136:139], v7 offset:11264
    v_mfma_f32_16x16x32_bf16 v[32:35], a[216:219], v[180:183], v[32:35]
    v_exp_f32_e64 v60, v28
    v_mfma_f32_16x16x32_bf16 v[36:39], a[216:219], v[212:215], v[36:39]
    v_exp_f32_e64 v61, v29
    v_mfma_f32_16x16x32_bf16 v[40:43], a[248:251], v[180:183], v[40:43]
    ds_read_b128 v[140:143], v7 offset:12288
    v_cvt_pk_bf16_f32 v70, v60, v61
    v_mfma_f32_16x16x32_bf16 v[44:47], a[248:251], v[212:215], v[44:47]
    ds_read_b128 v[144:147], v7 offset:13312
    v_or3_b32 v13, v13, v69, v70
    v_mfma_f32_16x16x32_bf16 v[32:35], a[220:223], v[184:187], v[32:35]
    v_exp_f32_e64 v62, v30
    v_mfma_f32_16x16x32_bf16 v[36:39], a[220:223], v[216:219], v[36:39]
    v_exp_f32_e64 v63, v31
    v_mfma_f32_16x16x32_bf16 v[40:43], a[252:255], v[184:187], v[40:43]
    v_cvt_pk_bf16_f32 v71, v62, v63
    v_and_b32_e64 v13, s71, v13
    v_mfma_f32_16x16x32_bf16 v[44:47], a[252:255], v[216:219], v[44:47]
    v_and_or_b32 v13, v71, s71, v13
    v_cmp_ne_u32 vcc, 0, v13
    s_waitcnt vmcnt(9)
    s_barrier
    s_cbranch_vccnz L_attn_kernel_slow_29
L_attn_kernel_ret_30:
    s_waitcnt lgkmcnt(2)
    v_mfma_f32_16x16x32_bf16 a[0:3], v[92:95], v[64:67], a[0:3]
    ds_read_b128 v[148:151], v7 offset:14336
    v_mfma_f32_16x16x32_bf16 a[4:7], v[92:95], v[68:71], a[4:7]
    ds_read_b128 v[152:155], v7 offset:15360
    s_add_u32 m0, s76, 0
    s_mov_b32 s68, 128
    v_mfma_f32_16x16x32_bf16 a[8:11], v[96:99], v[64:67], a[8:11]
    buffer_load_dwordx4 v220, s[72:75], s68 offen lds
    v_mfma_f32_16x16x32_bf16 a[12:15], v[96:99], v[68:71], a[12:15]
    ds_read_b128 a[192:195], v6 offset:0
    v_add_u32_e64 v10, s45, v9
    v_mfma_f32_16x16x32_bf16 a[16:19], v[100:103], v[64:67], a[16:19]
    ds_read_b128 a[224:227], v6 offset:8192
    v_cmp_gt_i32 s[52:53], 0, v10
    v_mfma_f32_16x16x32_bf16 a[20:23], v[100:103], v[68:71], a[20:23]
    ds_read_b128 a[196:199], v6 offset:1024
    s_add_u32 m0, s76, 1024
    s_mov_b32 s68, 7296
    v_mfma_f32_16x16x32_bf16 a[24:27], v[104:107], v[64:67], a[24:27]
    buffer_load_dwordx4 v220, s[72:75], s68 offen lds
    v_mfma_f32_16x16x32_bf16 a[28:31], v[104:107], v[68:71], a[28:31]
    ds_read_b128 a[228:231], v6 offset:9216
    v_cmp_gt_i32 s[54:55], 1, v10
    v_mfma_f32_16x16x32_bf16 a[32:35], v[108:111], v[64:67], a[32:35]
    ds_read_b128 a[200:203], v6 offset:2048
    v_cmp_gt_i32 s[56:57], 2, v10
    v_mfma_f32_16x16x32_bf16 a[36:39], v[108:111], v[68:71], a[36:39]
    ds_read_b128 a[232:235], v6 offset:10240
    s_add_u32 m0, s76, 2048
    s_mov_b32 s68, 14464
    v_mfma_f32_16x16x32_bf16 a[40:43], v[112:115], v[64:67], a[40:43]
    buffer_load_dwordx4 v220, s[72:75], s68 offen lds
    v_mfma_f32_16x16x32_bf16 a[44:47], v[112:115], v[68:71], a[44:47]
    ds_read_b128 a[204:207], v6 offset:3072
    v_cmp_gt_i32 s[58:59], 3, v10
    v_mfma_f32_16x16x32_bf16 v[80:83], v[88:91], v[64:67], v[80:83]
    ds_read_b128 a[236:239], v6 offset:11264
    v_cmp_gt_i32 s[60:61], -16, v10
    v_mfma_f32_16x16x32_bf16 a[48:51], v[116:119], v[64:67], a[48:51]
    ds_read_b128 a[208:211], v6 offset:4096
    s_add_u32 m0, s76, 3072
    s_mov_b32 s68, 21632
    v_mfma_f32_16x16x32_bf16 a[52:55], v[116:119], v[68:71], a[52:55]
    buffer_load_dwordx4 v220, s[72:75], s68 offen lds
    v_mfma_f32_16x16x32_bf16 a[56:59], v[120:123], v[64:67], a[56:59]
    ds_read_b128 a[240:243], v6 offset:12288
    v_cmp_gt_i32 s[62:63], -15, v10
    v_mfma_f32_16x16x32_bf16 a[60:63], v[120:123], v[68:71], a[60:63]
    ds_read_b128 a[212:215], v6 offset:5120
    v_cmp_gt_i32 s[64:65], -14, v10
    v_mfma_f32_16x16x32_bf16 a[64:67], v[124:127], v[64:67], a[64:67]
    ds_read_b128 a[244:247], v6 offset:13312
    s_add_u32 m0, s76, 4096
    s_mov_b32 s68, 28800
    v_mfma_f32_16x16x32_bf16 a[68:71], v[124:127], v[68:71], a[68:71]
    buffer_load_dwordx4 v220, s[72:75], s68 offen lds
    v_mfma_f32_16x16x32_bf16 a[72:75], v[128:131], v[64:67], a[72:75]
    ds_read_b128 a[216:219], v6 offset:6144
    v_cmp_gt_i32 s[66:67], -13, v10
    v_mfma_f32_16x16x32_bf16 a[76:79], v[128:131], v[68:71], a[76:79]
    ds_read_b128 a[248:251], v6 offset:14336
    v_cndmask_b32 v32, v32, v11, s[52:53]
    v_mfma_f32_16x16x32_bf16 v[84:87], v[88:91], v[68:71], v[84:87]
    ds_read_b128 a[220:223], v6 offset:7168
    s_add_u32 m0, s76, 5120
    s_mov_b32 s68, 35968
    v_mfma_f32_16x16x32_bf16 a[80:83], v[132:135], v[64:67], a[80:83]
    buffer_load_dwordx4 v220, s[72:75], s68 offen lds
    v_mfma_f32_16x16x32_bf16 a[84:87], v[132:135], v[68:71], a[84:87]
    ds_read_b128 a[252:255], v6 offset:15360
    v_cndmask_b32 v33, v33, v11, s[54:55]
    v_mfma_f32_16x16x32_bf16 a[88:91], v[136:139], v[64:67], a[88:91]
    v_cndmask_b32 v34, v34, v11, s[56:57]
    v_cndmask_b32 v35, v35, v11, s[58:59]
    v_mfma_f32_16x16x32_bf16 a[92:95], v[136:139], v[68:71], a[92:95]
    s_add_u32 m0, s76, 6144
    s_mov_b32 s68, 43136
    s_waitcnt lgkmcnt(15)
    v_mfma_f32_16x16x32_bf16 a[96:99], v[140:143], v[64:67], a[96:99]
    buffer_load_dwordx4 v220, s[72:75], s68 offen lds
    v_mfma_f32_16x16x32_bf16 a[100:103], v[140:143], v[68:71], a[100:103]
    v_cndmask_b32 v36, v36, v11, s[60:61]
    v_cndmask_b32 v37, v37, v11, s[62:63]
    v_mfma_f32_16x16x32_bf16 a[104:107], v[144:147], v[64:67], a[104:107]
    v_cndmask_b32 v38, v38, v11, s[64:65]
    v_cndmask_b32 v39, v39, v11, s[66:67]
    v_mfma_f32_16x16x32_bf16 a[108:111], v[144:147], v[68:71], a[108:111]
    s_add_u32 m0, s76, 7168
    s_mov_b32 s68, 50304
    v_mfma_f32_16x16x32_bf16 a[112:115], v[148:151], v[64:67], a[112:115]
    buffer_load_dwordx4 v220, s[72:75], s68 offen lds
    v_mfma_f32_16x16x32_bf16 a[116:119], v[148:151], v[68:71], a[116:119]
    v_cmp_gt_i32 s[52:53], 16, v10
    v_cmp_gt_i32 s[54:55], 17, v10
    v_mfma_f32_16x16x32_bf16 a[120:123], v[152:155], v[64:67], a[120:123]
    v_cmp_gt_i32 s[56:57], 18, v10
    v_cmp_gt_i32 s[58:59], 19, v10
    v_mfma_f32_16x16x32_bf16 a[124:127], v[152:155], v[68:71], a[124:127]
    v_cmp_gt_i32 s[60:61], 0, v10
    v_cmp_gt_i32 s[62:63], 1, v10
    v_cmp_gt_i32 s[64:65], 2, v10
    v_cmp_gt_i32 s[66:67], 3, v10
    v_cndmask_b32 v40, v40, v11, s[52:53]
    v_cndmask_b32 v41, v41, v11, s[54:55]
    v_cndmask_b32 v42, v42, v11, s[56:57]
    v_cndmask_b32 v43, v43, v11, s[58:59]
    v_cndmask_b32 v44, v44, v11, s[60:61]
    v_cndmask_b32 v45, v45, v11, s[62:63]
    v_cndmask_b32 v46, v46, v11, s[64:65]
    v_cndmask_b32 v47, v47, v11, s[66:67]
    s_sub_u32 s45, s45, 32
    s_waitcnt lgkmcnt(0)
    s_branch L_attn_kernel_join_28
L_attn_kernel_light_27:
    s_waitcnt vmcnt(9)
    s_barrier
L_attn_kernel_ret_32:
    s_waitcnt lgkmcnt(2)
    s_add_u32 m0, s76, 0
    s_mov_b32 s68, 128
    buffer_load_dwordx4 v220, s[72:75], s68 offen lds
    s_add_u32 m0, s76, 1024
    s_mov_b32 s68, 7296
    buffer_load_dwordx4 v220, s[72:75], s68 offen lds
    s_add_u32 m0, s76, 2048
    s_mov_b32 s68, 14464
    buffer_load_dwordx4 v220, s[72:75], s68 offen lds
    s_add_u32 m0, s76, 3072
    s_mov_b32 s68, 21632
    buffer_load_dwordx4 v220, s[72:75], s68 offen lds
    s_add_u32 m0, s76, 4096
    s_mov_b32 s68, 28800
    buffer_load_dwordx4 v220, s[72:75], s68 offen lds
    s_add_u32 m0, s76, 5120
    s_mov_b32 s68, 35968
    buffer_load_dwordx4 v220, s[72:75], s68 offen lds
    s_add_u32 m0, s76, 6144
    s_mov_b32 s68, 43136
    s_waitcnt lgkmcnt(15)
    buffer_load_dwordx4 v220, s[72:75], s68 offen lds
    s_add_u32 m0, s76, 7168
    s_mov_b32 s68, 50304
    buffer_load_dwordx4 v220, s[72:75], s68 offen lds
    s_sub_u32 s45, s45, 32
    s_waitcnt lgkmcnt(0)
L_attn_kernel_join_28:
    s_mov_b32 s77, 1
    s_cmp_lg_u32 s35, 0
    s_cbranch_scc1 L_attn_nopart
    s_waitcnt vmcnt(8)
    v_readfirstlane_b32 s77, v227
    s_nop 3
    s_cmp_eq_u32 s77, 0
    s_cbranch_scc1 L_attn_nopart
    s_mov_b32 s6, 16384
    buffer_load_dwordx4 v[232:235], v12, s[24:27], s6 offen sc1
    s_mov_b32 s6, 0
    buffer_load_dwordx4 v[156:159], v12, s[24:27], s6 offen offset:0 sc1
    buffer_load_dwordx4 v[160:163], v12, s[24:27], s6 offen offset:1024 sc1
    buffer_load_dwordx4 v[164:167], v12, s[24:27], s6 offen offset:2048 sc1
    buffer_load_dwordx4 v[168:171], v12, s[24:27], s6 offen offset:3072 sc1
    s_mov_b32 s6, 4096
    buffer_load_dwordx4 v[172:175], v12, s[24:27], s6 offen offset:0 sc1
    buffer_load_dwordx4 v[176:179], v12, s[24:27], s6 offen offset:1024 sc1
    buffer_load_dwordx4 v[180:183], v12, s[24:27], s6 offen offset:2048 sc1
    buffer_load_dwordx4 v[184:187], v12, s[24:27], s6 offen offset:3072 sc1
    s_mov_b32 s6, 8192
    buffer_load_dwordx4 v[188:191], v12, s[24:27], s6 offen offset:0 sc1
    buffer_load_dwordx4 v[192:195], v12, s[24:27], s6 offen offset:1024 sc1
    buffer_load_dwordx4 v[196:199], v12, s[24:27], s6 offen offset:2048 sc1
    buffer_load_dwordx4 v[200:203], v12, s[24:27], s6 offen offset:3072 sc1
    s_mov_b32 s6, 12288
    buffer_load_dwordx4 v[204:207], v12, s[24:27], s6 offen offset:0 sc1
    buffer_load_dwordx4 v[208:211], v12, s[24:27], s6 offen offset:1024 sc1
    buffer_load_dwordx4 v[212:215], v12, s[24:27], s6 offen offset:2048 sc1
    buffer_load_dwordx4 v[216:219], v12, s[24:27], s6 offen offset:3072 sc1
L_attn_nopart:
    s_cmp_lt_u32 s32, 3
    s_cbranch_scc1 L_attn_kernel_light_33
    ds_read_b128 v[92:95], v7 offset:16384
    ds_read_b128 v[96:99], v7 offset:17408
    ds_read_b128 v[100:103], v7 offset:18432
    ds_read_b128 v[104:107], v7 offset:19456
    ds_read_b128 v[108:111], v7 offset:20480
    ds_read_b128 v[112:115], v7 offset:21504
    ds_read_b128 v[116:119], v7 offset:22528
    ds_read_b128 v[120:123], v7 offset:23552
    ds_read_b128 v[124:127], v7 offset:24576
    ds_read_b128 v[128:131], v7 offset:25600
    ds_read_b128 v[132:135], v7 offset:26624
    ds_read_b128 v[136:139], v7 offset:27648
    ds_read_b128 v[140:143], v7 offset:28672
    ds_read_b128 v[144:147], v7 offset:29696
    v_exp_f32 v48, v32
    v_exp_f32 v49, v33
    v_exp_f32 v50, v34
    v_exp_f32 v51, v35
    v_exp_f32 v52, v40
    v_exp_f32 v53, v41
    v_exp_f32 v54, v42
    v_exp_f32 v55, v43
    v_exp_f32 v56, v36
    v_exp_f32 v57, v37
    v_exp_f32 v58, v38
    v_exp_f32 v59, v39
    v_exp_f32 v60, v44
    v_exp_f32 v61, v45
    v_exp_f32 v62, v46
    v_exp_f32 v63, v47
    s_nop 0
    v_cvt_pk_bf16_f32 v64, v48, v49
    v_cvt_pk_bf16_f32 v65, v50, v51
    v_cvt_pk_bf16_f32 v66, v52, v53
    v_cvt_pk_bf16_f32 v67, v54, v55
    v_cvt_pk_bf16_f32 v68, v56, v57
    v_cvt_pk_bf16_f32 v69, v58, v59
    v_cvt_pk_bf16_f32 v70, v60, v61
    v_cvt_pk_bf16_f32 v71, v62, v63
    v_or3_b32 v13, v64, v65, v66
    v_or3_b32 v13, v13, v67, v68
    v_or3_b32 v13, v13, v69, v70
    v_and_b32 v13, s71, v13
    v_and_or_b32 v13, v71, s71, v13
    v_cmp_ne_u32 vcc, 0, v13
    s_barrier
    s_cbranch_vccnz L_attn_kernel_slow_35
L_attn_kernel_ret_36:
    s_waitcnt lgkmcnt(2)
    v_mfma_f32_16x16x32_bf16 a[0:3], v[92:95], v[64:67], a[0:3]
    ds_read_b128 v[148:151], v7 offset:30720
    v_mfma_f32_16x16x32_bf16 a[4:7], v[92:95], v[68:71], a[4:7]
    ds_read_b128 v[152:155], v7 offset:31744
    s_add_u32 m0, s76, 98304
    s_mov_b32 s68, 256
    v_mfma_f32_16x16x32_bf16 a[8:11], v[96:99], v[64:67], a[8:11]
    buffer_load_dwordx4 v220, s[72:75], s68 offen lds
    v_mfma_f32_16x16x32_bf16 a[12:15], v[96:99], v[68:71], a[12:15]
    s_add_u32 m0, s76, 99328
    s_mov_b32 s68, 7424
    v_mfma_f32_16x16x32_bf16 a[16:19], v[100:103], v[64:67], a[16:19]
    buffer_load_dwordx4 v220, s[72:75], s68 offen lds
    v_mfma_f32_16x16x32_bf16 a[20:23], v[100:103], v[68:71], a[20:23]
    s_add_u32 m0, s76, 100352
    s_mov_b32 s68, 14592
    v_mfma_f32_16x16x32_bf16 a[24:27], v[104:107], v[64:67], a[24:27]
    buffer_load_dwordx4 v220, s[72:75], s68 offen lds
    v_mfma_f32_16x16x32_bf16 a[28:31], v[104:107], v[68:71], a[28:31]
    s_add_u32 m0, s76, 101376
    s_mov_b32 s68, 21760
    v_mfma_f32_16x16x32_bf16 a[32:35], v[108:111], v[64:67], a[32:35]
    buffer_load_dwordx4 v220, s[72:75], s68 offen lds
    v_mfma_f32_16x16x32_bf16 a[36:39], v[108:111], v[68:71], a[36:39]
    s_add_u32 m0, s76, 102400
    s_mov_b32 s68, 28928
    v_mfma_f32_16x16x32_bf16 a[40:43], v[112:115], v[64:67], a[40:43]
    buffer_load_dwordx4 v220, s[72:75], s68 offen lds
    v_mfma_f32_16x16x32_bf16 a[44:47], v[112:115], v[68:71], a[44:47]
    s_add_u32 m0, s76, 103424
    s_mov_b32 s68, 36096
    v_mfma_f32_16x16x32_bf16 v[80:83], v[88:91], v[64:67], v[80:83]
    buffer_load_dwordx4 v220, s[72:75], s68 offen lds
    v_mfma_f32_16x16x32_bf16 a[48:51], v[116:119], v[64:67], a[48:51]
    s_add_u32 m0, s76, 104448
    s_mov_b32 s68, 43264
    v_mfma_f32_16x16x32_bf16 a[52:55], v[116:119], v[68:71], a[52:55]
    buffer_load_dwordx4 v220, s[72:75], s68 offen lds
    v_mfma_f32_16x16x32_bf16 a[56:59], v[120:123], v[64:67], a[56:59]
    s_add_u32 m0, s76, 105472
    s_mov_b32 s68, 50432
    v_mfma_f32_16x16x32_bf16 a[60:63], v[120:123], v[68:71], a[60:63]
    buffer_load_dwordx4 v220, s[72:75], s68 offen lds
    v_mfma_f32_16x16x32_bf16 a[64:67], v[124:127], v[64:67], a[64:67]
    s_add_u32 m0, s76, 131072
    s_mov_b32 s68, 384
    v_mfma_f32_16x16x32_bf16 a[68:71], v[124:127], v[68:71], a[68:71]
    buffer_load_dwordx4 v220, s[72:75], s68 offen lds
    v_mfma_f32_16x16x32_bf16 a[72:75], v[128:131], v[64:67], a[72:75]
    s_add_u32 m0, s76, 132096
    s_mov_b32 s68, 7552
    v_mfma_f32_16x16x32_bf16 a[76:79], v[128:131], v[68:71], a[76:79]
    buffer_load_dwordx4 v220, s[72:75], s68 offen lds
    v_mfma_f32_16x16x32_bf16 v[84:87], v[88:91], v[68:71], v[84:87]
    s_add_u32 m0, s76, 133120
    s_mov_b32 s68, 14720
    v_mfma_f32_16x16x32_bf16 a[80:83], v[132:135], v[64:67], a[80:83]
    buffer_load_dwordx4 v220, s[72:75], s68 offen lds
    v_mfma_f32_16x16x32_bf16 a[84:87], v[132:135], v[68:71], a[84:87]
    s_add_u32 m0, s76, 134144
    s_mov_b32 s68, 21888
    v_mfma_f32_16x16x32_bf16 a[88:91], v[136:139], v[64:67], a[88:91]
    buffer_load_dwordx4 v220, s[72:75], s68 offen lds
    v_mfma_f32_16x16x32_bf16 a[92:95], v[136:139], v[68:71], a[92:95]
    s_add_u32 m0, s76, 135168
    s_mov_b32 s68, 29056
    s_waitcnt lgkmcnt(0)
    v_mfma_f32_16x16x32_bf16 a[96:99], v[140:143], v[64:67], a[96:99]
    buffer_load_dwordx4 v220, s[72:75], s68 offen lds
    v_mfma_f32_16x16x32_bf16 a[100:103], v[140:143], v[68:71], a[100:103]
    s_add_u32 m0, s76, 136192
    s_mov_b32 s68, 36224
    v_mfma_f32_16x16x32_bf16 a[104:107], v[144:147], v[64:67], a[104:107]
    buffer_load_dwordx4 v220, s[72:75], s68 offen lds
    v_mfma_f32_16x16x32_bf16 a[108:111], v[144:147], v[68:71], a[108:111]
    s_add_u32 m0, s76, 137216
    s_mov_b32 s68, 43392
    v_mfma_f32_16x16x32_bf16 a[112:115], v[148:151], v[64:67], a[112:115]
    buffer_load_dwordx4 v220, s[72:75], s68 offen lds
    v_mfma_f32_16x16x32_bf16 a[116:119], v[148:151], v[68:71], a[116:119]
    s_add_u32 m0, s76, 138240
    s_mov_b32 s68, 50560
    v_mfma_f32_16x16x32_bf16 a[120:123], v[152:155], v[64:67], a[120:123]
    buffer_load_dwordx4 v220, s[72:75], s68 offen lds
    v_mfma_f32_16x16x32_bf16 a[124:127], v[152:155], v[68:71], a[124:127]
    s_xor_b32 s42, s42, 0x8000
    s_xor_b32 s43, s43, 0x8000
    v_xor_b32 v7, 0x8000, v7
    v_xor_b32 v6, 0x8000, v6
    s_waitcnt vmcnt(16) lgkmcnt(0)
    s_branch L_attn_kernel_join_34
L_attn_kernel_light_33:
    s_nop 0
    s_barrier
L_attn_kernel_ret_38:
    s_waitcnt lgkmcnt(2)
    s_add_u32 m0, s76, 98304
    s_mov_b32 s68, 256
    buffer_load_dwordx4 v220, s[72:75], s68 offen lds
    s_add_u32 m0, s76, 99328
    s_mov_b32 s68, 7424
    buffer_load_dwordx4 v220, s[72:75], s68 offen lds
    s_add_u32 m0, s76, 100352
    s_mov_b32 s68, 14592
    buffer_load_dwordx4 v220, s[72:75], s68 offen lds
    s_add_u32 m0, s76, 101376
    s_mov_b32 s68, 21760
    buffer_load_dwordx4 v220, s[72:75], s68 offen lds
    s_add_u32 m0, s76, 102400
    s_mov_b32 s68, 28928
    buffer_load_dwordx4 v220, s[72:75], s68 offen lds
    s_add_u32 m0, s76, 103424
    s_mov_b32 s68, 36096
    buffer_load_dwordx4 v220, s[72:75], s68 offen lds
    s_add_u32 m0, s76, 104448
    s_mov_b32 s68, 43264
    buffer_load_dwordx4 v220, s[72:75], s68 offen lds
    s_add_u32 m0, s76, 105472
    s_mov_b32 s68, 50432
    buffer_load_dwordx4 v220, s[72:75], s68 offen lds
    s_add_u32 m0, s76, 131072
    s_mov_b32 s68, 384
    buffer_load_dwordx4 v220, s[72:75], s68 offen lds
    s_add_u32 m0, s76, 132096
    s_mov_b32 s68, 7552
    buffer_load_dwordx4 v220, s[72:75], s68 offen lds
    s_add_u32 m0, s76, 133120
    s_mov_b32 s68, 14720
    buffer_load_dwordx4 v220, s[72:75], s68 offen lds
    s_add_u32 m0, s76, 134144
    s_mov_b32 s68, 21888
    buffer_load_dwordx4 v220, s[72:75], s68 offen lds
    s_add_u32 m0, s76, 135168
    s_mov_b32 s68, 29056
    s_waitcnt lgkmcnt(0)
    buffer_load_dwordx4 v220, s[72:75], s68 offen lds
    s_add_u32 m0, s76, 136192
    s_mov_b32 s68, 36224
    buffer_load_dwordx4 v220, s[72:75], s68 offen lds
    s_add_u32 m0, s76, 137216
    s_mov_b32 s68, 43392
    buffer_load_dwordx4 v220, s[72:75], s68 offen lds
    s_add_u32 m0, s76, 138240
    s_mov_b32 s68, 50560
    buffer_load_dwordx4 v220, s[72:75], s68 offen lds
    s_xor_b32 s42, s42, 0x8000
    s_xor_b32 s43, s43, 0x8000
    s_waitcnt vmcnt(16) lgkmcnt(0)
L_attn_kernel_join_34:
    s_cmp_eq_u32 s35, 0
    s_cbranch_scc1 L_attn_merge
    v_rcp_f32 v236, v80
    v_rcp_f32 v237, v84
    v_accvgpr_read_b32 v240, a0
    v_accvgpr_read_b32 v241, a1
    v_accvgpr_read_b32 v242, a2
    v_accvgpr_read_b32 v243, a3
    v_accvgpr_read_b32 v244, a8
    v_accvgpr_read_b32 v245, a9
    v_accvgpr_read_b32 v246, a10
    v_accvgpr_read_b32 v247, a11
    v_mul_f32 v240, v240, v236
    v_mul_f32 v241, v241, v236
    v_mul_f32 v242, v242, v236
    v_mul_f32 v243, v243, v236
    v_mul_f32 v244, v244, v236
    v_mul_f32 v245, v245, v236
    v_mul_f32 v246, v246, v236
    v_mul_f32 v247, v247, v236
    v_cvt_pk_bf16_f32 v92, v240, v241
    v_cvt_pk_bf16_f32 v93, v242, v243
    v_cvt_pk_bf16_f32 v94, v244, v245
    v_cvt_pk_bf16_f32 v95, v246, v247
    v_accvgpr_read_b32 v248, a4
    v_accvgpr_read_b32 v249, a5
    v_accvgpr_read_b32 v250, a6
    v_accvgpr_read_b32 v251, a7
    v_accvgpr_read_b32 v252, a12
    v_accvgpr_read_b32 v253, a13
    v_accvgpr_read_b32 v254, a14
    v_accvgpr_read_b32 v255, a15
    v_mul_f32 v248, v248, v237
    v_mul_f32 v249, v249, v237
    v_mul_f32 v250, v250, v237
    v_mul_f32 v251, v251, v237
    v_mul_f32 v252, v252, v237
    v_mul_f32 v253, v253, v237
    v_mul_f32 v254, v254, v237
    v_mul_f32 v255, v255, v237
    v_cvt_pk_bf16_f32 v124, v248, v249
    v_cvt_pk_bf16_f32 v125, v250, v251
    v_cvt_pk_bf16_f32 v126, v252, v253
    v_cvt_pk_bf16_f32 v127, v254, v255
    s_barrier
    v_add_u32 v221, 32768, v221
    v_add_u32 v222, 32768, v222
    v_add_u32 v223, 32768, v223
    v_add_u32 v224, 32768, v224
    ds_read_b64_tr_b16 v[16:17], v221 offset:0
    ds_read_b64_tr_b16 v[18:19], v221 offset:2048
    ds_read_b64_tr_b16 v[20:21], v222 offset:0
    ds_read_b64_tr_b16 v[22:23], v222 offset:2048
    ds_read_b64_tr_b16 v[24:25], v223 offset:0
    ds_read_b64_tr_b16 v[26:27], v223 offset:2048
    ds_read_b64_tr_b16 v[28:29], v224 offset:0
    ds_read_b64_tr_b16 v[30:31], v224 offset:2048
    ds_read_b64_tr_b16 v[32:33], v221 offset:4096
    ds_read_b64_tr_b16 v[34:35], v221 offset:6144
    ds_read_b64_tr_b16 v[36:37], v222 offset:4096
    ds_read_b64_tr_b16 v[38:39], v222 offset:6144
    s_waitcnt lgkmcnt(8)
    v_mfma_f32_16x16x32_bf16 a[128:131], v[16:19], v[92:95], 0
    ds_read_b64_tr_b16 v[40:41], v223 offset:4096
    v_accvgpr_read_b32 v240, a16
    v_accvgpr_read_b32 v241, a17
    v_accvgpr_read_b32 v242, a18
    v_accvgpr_read_b32 v243, a19
    v_accvgpr_read_b32 v244, a24
    v_mfma_f32_16x16x32_bf16 a[132:135], v[16:19], v[124:127], 0
    ds_read_b64_tr_b16 v[42:43], v223 offset:6144
    v_accvgpr_read_b32 v245, a25
    v_accvgpr_read_b32 v246, a26
    v_accvgpr_read_b32 v247, a27
    v_mul_f32 v240, v240, v236
    v_mul_f32 v241, v241, v236
    v_mfma_f32_16x16x32_bf16 a[136:139], v[20:23], v[92:95], 0
    ds_read_b64_tr_b16 v[44:45], v224 offset:4096
    v_mul_f32 v242, v242, v236
    v_mul_f32 v243, v243, v236
    v_mul_f32 v244, v244, v236
    v_mul_f32 v245, v245, v236
    v_mul_f32_e64 v246, v246, v236
    v_mfma_f32_16x16x32_bf16 a[140:143], v[20:23], v[124:127], 0
    ds_read_b64_tr_b16 v[46:47], v224 offset:6144
    v_mul_f32_e64 v247, v247, v236
    v_cvt_pk_bf16_f32 v96, v240, v241
    v_cvt_pk_bf16_f32 v97, v242, v243
    v_cvt_pk_bf16_f32 v98, v244, v245
    v_cvt_pk_bf16_f32 v99, v246, v247
    s_waitcnt lgkmcnt(8)
    v_mfma_f32_16x16x32_bf16 a[144:147], v[24:27], v[92:95], 0
    ds_read_b64_tr_b16 v[16:17], v221 offset:8192
    v_accvgpr_read_b32 v248, a20
    v_accvgpr_read_b32 v249, a21
    v_accvgpr_read_b32 v250, a22
    v_accvgpr_read_b32 v251, a23
    v_accvgpr_read_b32 v252, a28
    v_mfma_f32_16x16x32_bf16 a[148:151], v[24:27], v[124:127], 0
    ds_read_b64_tr_b16 v[18:19], v221 offset:10240
    v_accvgpr_read_b32 v253, a29
    v_accvgpr_read_b32 v254, a30
    v_accvgpr_read_b32 v255, a31
    v_mul_f32 v248, v248, v237
    v_mul_f32_e64 v249, v249, v237
    v_mfma_f32_16x16x32_bf16 a[152:155], v[28:31], v[92:95], 0
    ds_read_b64_tr_b16 v[20:21], v222 offset:8192
    v_mul_f32 v250, v250, v237
    v_mul_f32 v251, v251, v237
    v_mul_f32 v252, v252, v237
    v_mul_f32 v253, v253, v237
    v_mul_f32_e64 v254, v254, v237
    v_mfma_f32_16x16x32_bf16 a[156:159], v[28:31], v[124:127], 0
    ds_read_b64_tr_b16 v[22:23], v222 offset:10240
    v_mul_f32_e64 v255, v255, v237
    v_cvt_pk_bf16_f32 v128, v248, v249
    v_cvt_pk_bf16_f32 v129, v250, v251
    v_cvt_pk_bf16_f32 v130, v252, v253
    v_cvt_pk_bf16_f32 v131, v254, v255
    s_waitcnt lgkmcnt(8)
    v_mfma_f32_16x16x32_bf16 a[128:131], v[32:35], v[96:99], a[128:131]
    ds_read_b64_tr_b16 v[24:25], v223 offset:8192
    v_accvgpr_read_b32 v240, a32
    v_accvgpr_read_b32 v241, a33
    v_accvgpr_read_b32 v242, a34
    v_accvgpr_read_b32 v243, a35
    v_accvgpr_read_b32 v244, a40
    v_mfma_f32_16x16x32_bf16 a[132:135], v[32:35], v[128:131], a[132:135]
    ds_read_b64_tr_b16 v[26:27], v223 offset:10240
    v_accvgpr_read_b32 v245, a41
    v_accvgpr_read_b32 v246, a42
    v_accvgpr_read_b32 v247, a43
    v_mul_f32 v240, v240, v236
    v_mul_f32_e64 v241, v241, v236
    v_mfma_f32_16x16x32_bf16 a[136:139], v[36:39], v[96:99], a[136:139]
    ds_read_b64_tr_b16 v[28:29], v224 offset:8192
    v_mul_f32 v242, v242, v236
    v_mul_f32 v243, v243, v236
    v_mul_f32 v244, v244, v236
    v_mul_f32 v245, v245, v236
    v_mul_f32_e64 v246, v246, v236
    v_mfma_f32_16x16x32_bf16 a[140:143], v[36:39], v[128:131], a[140:143]
    ds_read_b64_tr_b16 v[30:31], v224 offset:10240
    v_mul_f32_e64 v247, v247, v236
    v_cvt_pk_bf16_f32 v100, v240, v241
    v_cvt_pk_bf16_f32 v101, v242, v243
    v_cvt_pk_bf16_f32 v102, v244, v245
    v_cvt_pk_bf16_f32 v103, v246, v247
    s_waitcnt lgkmcnt(8)
    v_mfma_f32_16x16x32_bf16 a[144:147], v[40:43], v[96:99], a[144:147]
    ds_read_b64_tr_b16 v[32:33], v221 offset:12288
    v_accvgpr_read_b32 v248, a36
    v_accvgpr_read_b32 v249, a37
    v_accvgpr_read_b32 v250, a38
    v_accvgpr_read_b32 v251, a39
    v_accvgpr_read_b32 v252, a44
    v_mfma_f32_16x16x32_bf16 a[148:151], v[40:43], v[128:131], a[148:151]
    ds_read_b64_tr_b16 v[34:35], v221 offset:14336
    v_accvgpr_read_b32 v253, a45
    v_accvgpr_read_b32 v254, a46
    v_accvgpr_read_b32 v255, a47
    v_mul_f32 v248, v248, v237
    v_mul_f32_e64 v249, v249, v237
    v_mfma_f32_16x16x32_bf16 a[152:155], v[44:47], v[96:99], a[152:155]
    ds_read_b64_tr_b16 v[36:37], v222 offset:12288
    v_mul_f32 v250, v250, v237
    v_mul_f32 v251, v251, v237
    v_mul_f32 v252, v252, v237
    v_mul_f32 v253, v253, v237
    v_mul_f32_e64 v254, v254, v237
    v_mfma_f32_16x16x32_bf16 a[156:159], v[44:47], v[128:131], a[156:159]
    ds_read_b64_tr_b16 v[38:39], v222 offset:14336
    v_mul_f32_e64 v255, v255, v237
    v_cvt_pk_bf16_f32 v132, v248, v249
    v_cvt_pk_bf16_f32 v133, v250, v251
    v_cvt_pk_bf16_f32 v134, v252, v253
    v_cvt_pk_bf16_f32 v135, v254, v255
    s_waitcnt lgkmcnt(8)
    v_mfma_f32_16x16x32_bf16 a[128:131], v[16:19], v[100:103], a[128:131]
    ds_read_b64_tr_b16 v[40:41], v223 offset:12288
    v_accvgpr_read_b32 v240, a48
    v_accvgpr_read_b32 v241, a49
    v_accvgpr_read_b32 v242, a50
    v_accvgpr_read_b32 v243, a51
    v_accvgpr_read_b32 v244, a56
    v_mfma_f32_16x16x32_bf16 a[132:135], v[16:19], v[132:135], a[132:135]
    ds_read_b64_tr_b16 v[42:43], v223 offset:14336
    v_accvgpr_read_b32 v245, a57
    v_accvgpr_read_b32 v246, a58
    v_accvgpr_read_b32 v247, a59
    v_mul_f32 v240, v240, v236
    v_mul_f32_e64 v241, v241, v236
    v_mfma_f32_16x16x32_bf16 a[136:139], v[20:23], v[100:103], a[136:139]
    ds_read_b64_tr_b16 v[44:45], v224 offset:12288
    s_add_u32 m0, s76, 65536
    s_mov_b32 s68, 512
    buffer_load_dwordx4 v220, s[72:75], s68 offen lds
    v_mul_f32 v242, v242, v236
    v_mul_f32 v243, v243, v236
    v_mul_f32 v244, v244, v236
    v_mul_f32 v245, v245, v236
    v_mul_f32_e64 v246, v246, v236
    v_mfma_f32_16x16x32_bf16 a[140:143], v[20:23], v[132:135], a[140:143]
    ds_read_b64_tr_b16 v[46:47], v224 offset:14336
    v_mul_f32_e64 v247, v247, v236
    v_cvt_pk_bf16_f32 v104, v240, v241
    v_cvt_pk_bf16_f32 v105, v242, v243
    v_cvt_pk_bf16_f32 v106, v244, v245
    v_cvt_pk_bf16_f32 v107, v246, v247
    s_waitcnt lgkmcnt(8)
    v_mfma_f32_16x16x32_bf16 a[144:147], v[24:27], v[100:103], a[144:147]
    ds_read_b64_tr_b16 v[16:17], v221 offset:16384
    v_accvgpr_read_b32 v248, a52
    v_accvgpr_read_b32 v249, a53
    v_accvgpr_read_b32 v250, a54
    v_accvgpr_read_b32 v251, a55
    v_accvgpr_read_b32 v252, a60
    v_mfma_f32_16x16x32_bf16 a[148:151], v[24:27], v[132:135], a[148:151]
    ds_read_b64_tr_b16 v[18:19], v221 offset:18432
    v_accvgpr_read_b32 v253, a61
    v_accvgpr_read_b32 v254, a62
    v_accvgpr_read_b32 v255, a63
    v_mul_f32 v248, v248, v237
    v_mul_f32_e64 v249, v249, v237
    v_mfma_f32_16x16x32_bf16 a[152:155], v[28:31], v[100:103], a[152:155]
    ds_read_b64_tr_b16 v[20:21], v222 offset:16384
    s_add_u32 m0, s76, 66560
    s_mov_b32 s68, 7680
    buffer_load_dwordx4 v220, s[72:75], s68 offen lds
    v_mul_f32 v250, v250, v237
    v_mul_f32 v251, v251, v237
    v_mul_f32 v252, v252, v237
    v_mul_f32 v253, v253, v237
    v_mul_f32_e64 v254, v254, v237
    v_mfma_f32_16x16x32_bf16 a[156:159], v[28:31], v[132:135], a[156:159]
    ds_read_b64_tr_b16 v[22:23], v222 offset:18432
    v_mul_f32_e64 v255, v255, v237
    v_cvt_pk_bf16_f32 v136, v248, v249
    v_cvt_pk_bf16_f32 v137, v250, v251
    v_cvt_pk_bf16_f32 v138, v252, v253
    v_cvt_pk_bf16_f32 v139, v254, v255
    s_waitcnt lgkmcnt(8)
    v_mfma_f32_16x16x32_bf16 a[128:131], v[32:35], v[104:107], a[128:131]
    ds_read_b64_tr_b16 v[24:25], v223 offset:16384
    v_accvgpr_read_b32 v240, a64
    v_accvgpr_read_b32 v241, a65
    v_accvgpr_read_b32 v242, a66
    v_accvgpr_read_b32 v243, a67
    v_accvgpr_read_b32 v244, a72
    v_mfma_f32_16x16x32_bf16 a[132:135], v[32:35], v[136:139], a[132:135]
    ds_read_b64_tr_b16 v[26:27], v223 offset:18432
    v_accvgpr_read_b32 v245, a73
    v_accvgpr_read_b32 v246, a74
    v_accvgpr_read_b32 v247, a75
    v_mul_f32 v240, v240, v236
    v_mul_f32_e64 v241, v241, v236
    v_mfma_f32_16x16x32_bf16 a[136:139], v[36:39], v[104:107], a[136:139]
    ds_read_b64_tr_b16 v[28:29], v224 offset:16384
    s_add_u32 m0, s76, 67584
    s_mov_b32 s68, 14848
    buffer_load_dwordx4 v220, s[72:75], s68 offen lds
    v_mul_f32 v242, v242, v236
    v_mul_f32 v243, v243, v236
    v_mul_f32 v244, v244, v236
    v_mul_f32 v245, v245, v236
    v_mul_f32_e64 v246, v246, v236
    v_mfma_f32_16x16x32_bf16 a[140:143], v[36:39], v[136:139], a[140:143]
    ds_read_b64_tr_b16 v[30:31], v224 offset:18432
    v_mul_f32_e64 v247, v247, v236
    v_cvt_pk_bf16_f32 v108, v240, v241
    v_cvt_pk_bf16_f32 v109, v242, v243
    v_cvt_pk_bf16_f32 v110, v244, v245
    v_cvt_pk_bf16_f32 v111, v246, v247
    s_waitcnt lgkmcnt(8)
    v_mfma_f32_16x16x32_bf16 a[144:147], v[40:43], v[104:107], a[144:147]
    ds_read_b64_tr_b16 v[32:33], v221 offset:20480
    v_accvgpr_read_b32 v248, a68
    v_accvgpr_read_b32 v249, a69
    v_accvgpr_read_b32 v250, a70
    v_accvgpr_read_b32 v251, a71
    v_accvgpr_read_b32 v252, a76
    v_mfma_f32_16x16x32_bf16 a[148:151], v[40:43], v[136:139], a[148:151]
    ds_read_b64_tr_b16 v[34:35], v221 offset:22528
    v_accvgpr_read_b32 v253, a77
    v_accvgpr_read_b32 v254, a78
    v_accvgpr_read_b32 v255, a79
    v_mul_f32 v248, v248, v237
    v_mul_f32_e64 v249, v249, v237
    v_mfma_f32_16x16x32_bf16 a[152:155], v[44:47], v[104:107], a[152:155]
    ds_read_b64_tr_b16 v[36:37], v222 offset:20480
    s_add_u32 m0, s76, 68608
    s_mov_b32 s68, 22016
    buffer_load_dwordx4 v220, s[72:75], s68 offen lds
    v_mul_f32 v250, v250, v237
    v_mul_f32 v251, v251, v237
    v_mul_f32 v252, v252, v237
    v_mul_f32 v253, v253, v237
    v_mul_f32_e64 v254, v254, v237
    v_mfma_f32_16x16x32_bf16 a[156:159], v[44:47], v[136:139], a[156:159]
    ds_read_b64_tr_b16 v[38:39], v222 offset:22528
    v_mul_f32_e64 v255, v255, v237
    v_cvt_pk_bf16_f32 v140, v248, v249
    v_cvt_pk_bf16_f32 v141, v250, v251
    v_cvt_pk_bf16_f32 v142, v252, v253
    v_cvt_pk_bf16_f32 v143, v254, v255
    s_waitcnt lgkmcnt(8)
    v_mfma_f32_16x16x32_bf16 a[128:131], v[16:19], v[108:111], a[128:131]
    ds_read_b64_tr_b16 v[40:41], v223 offset:20480
    v_accvgpr_read_b32 v240, a80
    v_accvgpr_read_b32 v241, a81
    v_accvgpr_read_b32 v242, a82
    v_accvgpr_read_b32 v243, a83
    v_accvgpr_read_b32 v244, a88
    v_mfma_f32_16x16x32_bf16 a[132:135], v[16:19], v[140:143], a[132:135]
    ds_read_b64_tr_b16 v[42:43], v223 offset:22528
    v_accvgpr_read_b32 v245, a89
    v_accvgpr_read_b32 v246, a90
    v_accvgpr_read_b32 v247, a91
    v_mul_f32 v240, v240, v236
    v_mul_f32_e64 v241, v241, v236
    v_mfma_f32_16x16x32_bf16 a[136:139], v[20:23], v[108:111], a[136:139]
    ds_read_b64_tr_b16 v[44:45], v224 offset:20480
    s_add_u32 m0, s76, 69632
    s_mov_b32 s68, 29184
    buffer_load_dwordx4 v220, s[72:75], s68 offen lds
    v_mul_f32 v242, v242, v236
    v_mul_f32 v243, v243, v236
    v_mul_f32 v244, v244, v236
    v_mul_f32 v245, v245, v236
    v_mul_f32_e64 v246, v246, v236
    v_mfma_f32_16x16x32_bf16 a[140:143], v[20:23], v[140:143], a[140:143]
    ds_read_b64_tr_b16 v[46:47], v224 offset:22528
    v_mul_f32_e64 v247, v247, v236
    v_cvt_pk_bf16_f32 v112, v240, v241
    v_cvt_pk_bf16_f32 v113, v242, v243
    v_cvt_pk_bf16_f32 v114, v244, v245
    v_cvt_pk_bf16_f32 v115, v246, v247
    s_waitcnt lgkmcnt(8)
    v_mfma_f32_16x16x32_bf16 a[144:147], v[24:27], v[108:111], a[144:147]
    ds_read_b64_tr_b16 v[16:17], v221 offset:24576
    v_accvgpr_read_b32 v248, a84
    v_accvgpr_read_b32 v249, a85
    v_accvgpr_read_b32 v250, a86
    v_accvgpr_read_b32 v251, a87
    v_accvgpr_read_b32 v252, a92
    v_mfma_f32_16x16x32_bf16 a[148:151], v[24:27], v[140:143], a[148:151]
    ds_read_b64_tr_b16 v[18:19], v221 offset:26624
    v_accvgpr_read_b32 v253, a93
    v_accvgpr_read_b32 v254, a94
    v_accvgpr_read_b32 v255, a95
    v_mul_f32 v248, v248, v237
    v_mul_f32_e64 v249, v249, v237
    v_mfma_f32_16x16x32_bf16 a[152:155], v[28:31], v[108:111], a[152:155]
    ds_read_b64_tr_b16 v[20:21], v222 offset:24576
    s_add_u32 m0, s76, 70656
    s_mov_b32 s68, 36352
    buffer_load_dwordx4 v220, s[72:75], s68 offen lds
    v_mul_f32 v250, v250, v237
    v_mul_f32 v251, v251, v237
    v_mul_f32 v252, v252, v237
    v_mul_f32 v253, v253, v237
    v_mul_f32_e64 v254, v254, v237
    v_mfma_f32_16x16x32_bf16 a[156:159], v[28:31], v[140:143], a[156:159]
    ds_read_b64_tr_b16 v[22:23], v222 offset:26624
    v_mul_f32_e64 v255, v255, v237
    v_cvt_pk_bf16_f32 v144, v248, v249
    v_cvt_pk_bf16_f32 v145, v250, v251
    v_cvt_pk_bf16_f32 v146, v252, v253
    v_cvt_pk_bf16_f32 v147, v254, v255
    s_waitcnt lgkmcnt(8)
    v_mfma_f32_16x16x32_bf16 a[128:131], v[32:35], v[112:115], a[128:131]
    ds_read_b64_tr_b16 v[24:25], v223 offset:24576
    v_accvgpr_read_b32 v240, a96
    v_accvgpr_read_b32 v241, a97
    v_accvgpr_read_b32 v242, a98
    v_accvgpr_read_b32 v243, a99
    v_accvgpr_read_b32 v244, a104
    v_mfma_f32_16x16x32_bf16 a[132:135], v[32:35], v[144:147], a[132:135]
    ds_read_b64_tr_b16 v[26:27], v223 offset:26624
    v_accvgpr_read_b32 v245, a105
    v_accvgpr_read_b32 v246, a106
    v_accvgpr_read_b32 v247, a107
    v_mul_f32 v240, v240, v236
    v_mul_f32_e64 v241, v241, v236
    v_mfma_f32_16x16x32_bf16 a[136:139], v[36:39], v[112:115], a[136:139]
    ds_read_b64_tr_b16 v[28:29], v224 offset:24576
    s_add_u32 m0, s76, 71680
    s_mov_b32 s68, 43520
    buffer_load_dwordx4 v220, s[72:75], s68 offen lds
    v_mul_f32 v242, v242, v236
    v_mul_f32 v243, v243, v236
    v_mul_f32 v244, v244, v236
    v_mul_f32 v245, v245, v236
    v_mul_f32_e64 v246, v246, v236
    v_mfma_f32_16x16x32_bf16 a[140:143], v[36:39], v[144:147], a[140:143]
    ds_read_b64_tr_b16 v[30:31], v224 offset:26624
    v_mul_f32_e64 v247, v247, v236
    v_cvt_pk_bf16_f32 v116, v240, v241
    v_cvt_pk_bf16_f32 v117, v242, v243
    v_cvt_pk_bf16_f32 v118, v244, v245
    v_cvt_pk_bf16_f32 v119, v246, v247
    s_waitcnt lgkmcnt(8)
    v_mfma_f32_16x16x32_bf16 a[144:147], v[40:43], v[112:115], a[144:147]
    ds_read_b64_tr_b16 v[32:33], v221 offset:28672
    v_accvgpr_read_b32 v248, a100
    v_accvgpr_read_b32 v249, a101
    v_accvgpr_read_b32 v250, a102
    v_accvgpr_read_b32 v251, a103
    v_accvgpr_read_b32 v252, a108
    v_mfma_f32_16x16x32_bf16 a[148:151], v[40:43], v[144:147], a[148:151]
    ds_read_b64_tr_b16 v[34:35], v221 offset:30720
    v_accvgpr_read_b32 v253, a109
    v_accvgpr_read_b32 v254, a110
    v_accvgpr_read_b32 v255, a111
    v_mul_f32 v248, v248, v237
    v_mul_f32_e64 v249, v249, v237
    v_mfma_f32_16x16x32_bf16 a[152:155], v[44:47], v[112:115], a[152:155]
    ds_read_b64_tr_b16 v[36:37], v222 offset:28672
    s_add_u32 m0, s76, 72704
    s_mov_b32 s68, 50688
    buffer_load_dwordx4 v220, s[72:75], s68 offen lds
    v_mul_f32 v250, v250, v237
    v_mul_f32 v251, v251, v237
    v_mul_f32 v252, v252, v237
    v_mul_f32 v253, v253, v237
    v_mul_f32_e64 v254, v254, v237
    v_mfma_f32_16x16x32_bf16 a[156:159], v[44:47], v[144:147], a[156:159]
    ds_read_b64_tr_b16 v[38:39], v222 offset:30720
    v_mul_f32_e64 v255, v255, v237
    v_cvt_pk_bf16_f32 v148, v248, v249
    v_cvt_pk_bf16_f32 v149, v250, v251
    v_cvt_pk_bf16_f32 v150, v252, v253
    v_cvt_pk_bf16_f32 v151, v254, v255
    s_waitcnt lgkmcnt(8)
    v_mfma_f32_16x16x32_bf16 a[128:131], v[16:19], v[116:119], a[128:131]
    ds_read_b64_tr_b16 v[40:41], v223 offset:28672
    v_accvgpr_read_b32 v240, a112
    v_accvgpr_read_b32 v241, a113
    v_accvgpr_read_b32 v242, a114
    v_accvgpr_read_b32 v243, a115
    v_accvgpr_read_b32 v244, a120
    v_mfma_f32_16x16x32_bf16 a[132:135], v[16:19], v[148:151], a[132:135]
    ds_read_b64_tr_b16 v[42:43], v223 offset:30720
    v_accvgpr_read_b32 v245, a121
    v_accvgpr_read_b32 v246, a122
    v_accvgpr_read_b32 v247, a123
    v_mul_f32 v240, v240, v236
    v_mul_f32_e64 v241, v241, v236
    v_mfma_f32_16x16x32_bf16 a[136:139], v[20:23], v[116:119], a[136:139]
    ds_read_b64_tr_b16 v[44:45], v224 offset:28672
    v_mul_f32 v242, v242, v236
    v_mul_f32 v243, v243, v236
    v_mul_f32 v244, v244, v236
    v_mul_f32 v245, v245, v236
    v_mul_f32_e64 v246, v246, v236
    v_mfma_f32_16x16x32_bf16 a[140:143], v[20:23], v[148:151], a[140:143]
    ds_read_b64_tr_b16 v[46:47], v224 offset:30720
    v_mul_f32_e64 v247, v247, v236
    v_cvt_pk_bf16_f32 v120, v240, v241
    v_cvt_pk_bf16_f32 v121, v242, v243
    v_cvt_pk_bf16_f32 v122, v244, v245
    v_cvt_pk_bf16_f32 v123, v246, v247
    v_add_u32 v221, 4294934528, v221
    v_add_u32 v222, 4294934528, v222
    v_add_u32 v223, 4294934528, v223
    v_add_u32 v224, 4294934528, v224
    s_waitcnt lgkmcnt(8)
    v_mfma_f32_16x16x32_bf16 a[144:147], v[24:27], v[116:119], a[144:147]
    ds_read_b64_tr_b16 v[16:17], v221 offset:0
    v_accvgpr_read_b32 v248, a116
    v_accvgpr_read_b32 v249, a117
    v_accvgpr_read_b32 v250, a118
    v_accvgpr_read_b32 v251, a119
    v_accvgpr_read_b32 v252, a124
    v_mfma_f32_16x16x32_bf16 a[148:151], v[24:27], v[148:151], a[148:151]
    ds_read_b64_tr_b16 v[18:19], v221 offset:2048
    v_accvgpr_read_b32 v253, a125
    v_accvgpr_read_b32 v254, a126
    v_accvgpr_read_b32 v255, a127
    v_mul_f32 v248, v248, v237
    v_mul_f32_e64 v249, v249, v237
    v_mfma_f32_16x16x32_bf16 a[152:155], v[28:31], v[116:119], a[152:155]
    ds_read_b64_tr_b16 v[20:21], v222 offset:0
    v_mul_f32 v250, v250, v237
    v_mul_f32 v251, v251, v237
    v_mul_f32 v252, v252, v237
    v_mul_f32 v253, v253, v237
    v_mul_f32_e64 v254, v254, v237
    v_mfma_f32_16x16x32_bf16 a[156:159], v[28:31], v[148:151], a[156:159]
    ds_read_b64_tr_b16 v[22:23], v222 offset:2048
    v_mul_f32_e64 v255, v255, v237
    v_cvt_pk_bf16_f32 v152, v248, v249
    v_cvt_pk_bf16_f32 v153, v250, v251
    v_cvt_pk_bf16_f32 v154, v252, v253
    v_cvt_pk_bf16_f32 v155, v254, v255
    s_waitcnt lgkmcnt(8)
    v_mfma_f32_16x16x32_bf16 a[128:131], v[32:35], v[120:123], a[128:131]
    ds_read_b64_tr_b16 v[24:25], v223 offset:0
    v_mfma_f32_16x16x32_bf16 a[132:135], v[32:35], v[152:155], a[132:135]
    ds_read_b64_tr_b16 v[26:27], v223 offset:2048
    v_mfma_f32_16x16x32_bf16 a[136:139], v[36:39], v[120:123], a[136:139]
    ds_read_b64_tr_b16 v[28:29], v224 offset:0
    v_mfma_f32_16x16x32_bf16 a[140:143], v[36:39], v[152:155], a[140:143]
    ds_read_b64_tr_b16 v[30:31], v224 offset:2048
    s_waitcnt lgkmcnt(8)
    v_mfma_f32_16x16x32_bf16 a[144:147], v[40:43], v[120:123], a[144:147]
    ds_read_b64_tr_b16 v[32:33], v221 offset:4096
    v_mfma_f32_16x16x32_bf16 a[148:151], v[40:43], v[152:155], a[148:151]
    ds_read_b64_tr_b16 v[34:35], v221 offset:6144
    v_mfma_f32_16x16x32_bf16 a[152:155], v[44:47], v[120:123], a[152:155]
    ds_read_b64_tr_b16 v[36:37], v222 offset:4096
    v_mfma_f32_16x16x32_bf16 a[156:159], v[44:47], v[152:155], a[156:159]
    ds_read_b64_tr_b16 v[38:39], v222 offset:6144
    s_waitcnt lgkmcnt(8)
    v_mfma_f32_16x16x32_bf16 a[160:163], v[16:19], v[92:95], 0
    ds_read_b64_tr_b16 v[40:41], v223 offset:4096
    v_mfma_f32_16x16x32_bf16 a[164:167], v[16:19], v[124:127], 0
    ds_read_b64_tr_b16 v[42:43], v223 offset:6144
    v_mfma_f32_16x16x32_bf16 a[168:171], v[20:23], v[92:95], 0
    ds_read_b64_tr_b16 v[44:45], v224 offset:4096
    v_mfma_f32_16x16x32_bf16 a[172:175], v[20:23], v[124:127], 0
    ds_read_b64_tr_b16 v[46:47], v224 offset:6144
    s_waitcnt lgkmcnt(8)
    v_mfma_f32_16x16x32_bf16 a[176:179], v[24:27], v[92:95], 0
    ds_read_b64_tr_b16 v[16:17], v221 offset:8192
    v_mfma_f32_16x16x32_bf16 a[180:183], v[24:27], v[124:127], 0
    ds_read_b64_tr_b16 v[18:19], v221 offset:10240
    v_mfma_f32_16x16x32_bf16 a[184:187], v[28:31], v[92:95], 0
    ds_read_b64_tr_b16 v[20:21], v222 offset:8192
    v_mfma_f32_16x16x32_bf16 a[188:191], v[28:31], v[124:127], 0
    ds_read_b64_tr_b16 v[22:23], v222 offset:10240
    s_waitcnt lgkmcnt(8)
    v_mfma_f32_16x16x32_bf16 a[160:163], v[32:35], v[96:99], a[160:163]
    ds_read_b64_tr_b16 v[24:25], v223 offset:8192
    v_accvgpr_read_b32 v156, a128
    v_mfma_f32_16x16x32_bf16 a[164:167], v[32:35], v[128:131], a[164:167]
    ds_read_b64_tr_b16 v[26:27], v223 offset:10240
    v_accvgpr_read_b32 v157, a129
    v_mfma_f32_16x16x32_bf16 a[168:171], v[36:39], v[96:99], a[168:171]
    ds_read_b64_tr_b16 v[28:29], v224 offset:8192
    v_accvgpr_read_b32 v158, a130
    v_mfma_f32_16x16x32_bf16 a[172:175], v[36:39], v[128:131], a[172:175]
    ds_read_b64_tr_b16 v[30:31], v224 offset:10240
    v_accvgpr_read_b32 v159, a131
    s_waitcnt lgkmcnt(8)
    v_mfma_f32_16x16x32_bf16 a[176:179], v[40:43], v[96:99], a[176:179]
    ds_read_b64_tr_b16 v[32:33], v221 offset:12288
    v_accvgpr_read_b32 v160, a136
    v_mfma_f32_16x16x32_bf16 a[180:183], v[40:43], v[128:131], a[180:183]
    ds_read_b64_tr_b16 v[34:35], v221 offset:14336
    v_accvgpr_read_b32 v161, a137
    v_mfma_f32_16x16x32_bf16 a[184:187], v[44:47], v[96:99], a[184:187]
    ds_read_b64_tr_b16 v[36:37], v222 offset:12288
    v_accvgpr_read_b32 v162, a138
    v_mfma_f32_16x16x32_bf16 a[188:191], v[44:47], v[128:131], a[188:191]
    ds_read_b64_tr_b16 v[38:39], v222 offset:14336
    v_accvgpr_read_b32 v163, a139
    s_waitcnt lgkmcnt(8)
    v_mfma_f32_16x16x32_bf16 a[160:163], v[16:19], v[100:103], a[160:163]
    ds_read_b64_tr_b16 v[40:41], v223 offset:12288
    v_cvt_pk_bf16_f32 v164, v156, v157
    v_mfma_f32_16x16x32_bf16 a[164:167], v[16:19], v[132:135], a[164:167]
    ds_read_b64_tr_b16 v[42:43], v223 offset:14336
    v_cvt_pk_bf16_f32 v165, v158, v159
    v_mfma_f32_16x16x32_bf16 a[168:171], v[20:23], v[100:103], a[168:171]
    ds_read_b64_tr_b16 v[44:45], v224 offset:12288
    v_cvt_pk_bf16_f32 v166, v160, v161
    v_mfma_f32_16x16x32_bf16 a[172:175], v[20:23], v[132:135], a[172:175]
    ds_read_b64_tr_b16 v[46:47], v224 offset:14336
    v_cvt_pk_bf16_f32 v167, v162, v163
    s_waitcnt lgkmcnt(8)
    v_mfma_f32_16x16x32_bf16 a[176:179], v[24:27], v[100:103], a[176:179]
    ds_read_b64_tr_b16 v[16:17], v221 offset:16384
    s_mov_b32 s6, 0
    v_mfma_f32_16x16x32_bf16 a[180:183], v[24:27], v[132:135], a[180:183]
    ds_read_b64_tr_b16 v[18:19], v221 offset:18432
    buffer_store_dwordx4 v[164:167], v12, s[20:23], s6 offen sc1
    v_mfma_f32_16x16x32_bf16 a[184:187], v[28:31], v[100:103], a[184:187]
    ds_read_b64_tr_b16 v[20:21], v222 offset:16384
    v_accvgpr_read_b32 v168, a132
    v_mfma_f32_16x16x32_bf16 a[188:191], v[28:31], v[132:135], a[188:191]
    ds_read_b64_tr_b16 v[22:23], v222 offset:18432
    v_accvgpr_read_b32 v169, a133
    s_waitcnt lgkmcnt(8)
    v_mfma_f32_16x16x32_bf16 a[160:163], v[32:35], v[104:107], a[160:163]
    ds_read_b64_tr_b16 v[24:25], v223 offset:16384
    v_accvgpr_read_b32 v170, a134
    v_mfma_f32_16x16x32_bf16 a[164:167], v[32:35], v[136:139], a[164:167]
    ds_read_b64_tr_b16 v[26:27], v223 offset:18432
    v_accvgpr_read_b32 v171, a135
    v_mfma_f32_16x16x32_bf16 a[168:171], v[36:39], v[104:107], a[168:171]
    ds_read_b64_tr_b16 v[28:29], v224 offset:16384
    v_accvgpr_read_b32 v172, a140
    v_mfma_f32_16x16x32_bf16 a[172:175], v[36:39], v[136:139], a[172:175]
    ds_read_b64_tr_b16 v[30:31], v224 offset:18432
    v_accvgpr_read_b32 v173, a141
    s_waitcnt lgkmcnt(8)
    v_mfma_f32_16x16x32_bf16 a[176:179], v[40:43], v[104:107], a[176:179]
    ds_read_b64_tr_b16 v[32:33], v221 offset:20480
    v_accvgpr_read_b32 v174, a142
    v_mfma_f32_16x16x32_bf16 a[180:183], v[40:43], v[136:139], a[180:183]
    ds_read_b64_tr_b16 v[34:35], v221 offset:22528
    v_accvgpr_read_b32 v175, a143
    v_mfma_f32_16x16x32_bf16 a[184:187], v[44:47], v[104:107], a[184:187]
    ds_read_b64_tr_b16 v[36:37], v222 offset:20480
    v_cvt_pk_bf16_f32 v176, v168, v169
    v_mfma_f32_16x16x32_bf16 a[188:191], v[44:47], v[136:139], a[188:191]
    ds_read_b64_tr_b16 v[38:39], v222 offset:22528
    v_cvt_pk_bf16_f32 v177, v170, v171
    s_waitcnt lgkmcnt(8)
    v_mfma_f32_16x16x32_bf16 a[160:163], v[16:19], v[108:111], a[160:163]
    ds_read_b64_tr_b16 v[40:41], v223 offset:20480
    v_cvt_pk_bf16_f32 v178, v172, v173
    v_mfma_f32_16x16x32_bf16 a[164:167], v[16:19], v[140:143], a[164:167]
    ds_read_b64_tr_b16 v[42:43], v223 offset:22528
    v_cvt_pk_bf16_f32 v179, v174, v175
    v_mfma_f32_16x16x32_bf16 a[168:171], v[20:23], v[108:111], a[168:171]
    ds_read_b64_tr_b16 v[44:45], v224 offset:20480
    s_mov_b32 s6, 229376
    v_mfma_f32_16x16x32_bf16 a[172:175], v[20:23], v[140:143], a[172:175]
    ds_read_b64_tr_b16 v[46:47], v224 offset:22528
    buffer_store_dwordx4 v[176:179], v12, s[20:23], s6 offen sc1
    s_waitcnt lgkmcnt(8)
    v_mfma_f32_16x16x32_bf16 a[176:179], v[24:27], v[108:111], a[176:179]
    ds_read_b64_tr_b16 v[16:17], v221 offset:24576
    v_accvgpr_read_b32 v180, a144
    v_mfma_f32_16x16x32_bf16 a[180:183], v[24:27], v[140:143], a[180:183]
    ds_read_b64_tr_b16 v[18:19], v221 offset:26624
    v_accvgpr_read_b32 v181, a145
    v_mfma_f32_16x16x32_bf16 a[184:187], v[28:31], v[108:111], a[184:187]
    ds_read_b64_tr_b16 v[20:21], v222 offset:24576
    v_accvgpr_read_b32 v182, a146
    v_mfma_f32_16x16x32_bf16 a[188:191], v[28:31], v[140:143], a[188:191]
    ds_read_b64_tr_b16 v[22:23], v222 offset:26624
    v_accvgpr_read_b32 v183, a147
    s_waitcnt lgkmcnt(8)
    v_mfma_f32_16x16x32_bf16 a[160:163], v[32:35], v[112:115], a[160:163]
    ds_read_b64_tr_b16 v[24:25], v223 offset:24576
    v_accvgpr_read_b32 v184, a152
    v_mfma_f32_16x16x32_bf16 a[164:167], v[32:35], v[144:147], a[164:167]
    ds_read_b64_tr_b16 v[26:27], v223 offset:26624
    v_accvgpr_read_b32 v185, a153
    v_mfma_f32_16x16x32_bf16 a[168:171], v[36:39], v[112:115], a[168:171]
    ds_read_b64_tr_b16 v[28:29], v224 offset:24576
    v_accvgpr_read_b32 v186, a154
    v_mfma_f32_16x16x32_bf16 a[172:175], v[36:39], v[144:147], a[172:175]
    ds_read_b64_tr_b16 v[30:31], v224 offset:26624
    v_accvgpr_read_b32 v187, a155
    s_waitcnt lgkmcnt(8)
    v_mfma_f32_16x16x32_bf16 a[176:179], v[40:43], v[112:115], a[176:179]
    ds_read_b64_tr_b16 v[32:33], v221 offset:28672
    v_cvt_pk_bf16_f32 v188, v180, v181
    v_mfma_f32_16x16x32_bf16 a[180:183], v[40:43], v[144:147], a[180:183]
    ds_read_b64_tr_b16 v[34:35], v221 offset:30720
    v_cvt_pk_bf16_f32 v189, v182, v183
    v_mfma_f32_16x16x32_bf16 a[184:187], v[44:47], v[112:115], a[184:187]
    ds_read_b64_tr_b16 v[36:37], v222 offset:28672
    v_cvt_pk_bf16_f32 v190, v184, v185
    v_mfma_f32_16x16x32_bf16 a[188:191], v[44:47], v[144:147], a[188:191]
    ds_read_b64_tr_b16 v[38:39], v222 offset:30720
    v_cvt_pk_bf16_f32 v191, v186, v187
    s_waitcnt lgkmcnt(8)
    v_mfma_f32_16x16x32_bf16 a[160:163], v[16:19], v[116:119], a[160:163]
    ds_read_b64_tr_b16 v[40:41], v223 offset:28672
    s_mov_b32 s6, 16384
    v_mfma_f32_16x16x32_bf16 a[164:167], v[16:19], v[148:151], a[164:167]
    ds_read_b64_tr_b16 v[42:43], v223 offset:30720
    buffer_store_dwordx4 v[188:191], v12, s[20:23], s6 offen sc1
    v_mfma_f32_16x16x32_bf16 a[168:171], v[20:23], v[116:119], a[168:171]
    ds_read_b64_tr_b16 v[44:45], v224 offset:28672
    v_accvgpr_read_b32 v192, a148
    v_mfma_f32_16x16x32_bf16 a[172:175], v[20:23], v[148:151], a[172:175]
    ds_read_b64_tr_b16 v[46:47], v224 offset:30720
    v_accvgpr_read_b32 v193, a149
    s_waitcnt vmcnt(3) lgkmcnt(0)
    s_barrier
    v_add_u32 v221, 98304, v221
    v_add_u32 v222, 98304, v222
    v_add_u32 v223, 98304, v223
    v_add_u32 v224, 98304, v224
    s_waitcnt lgkmcnt(8)
    v_mfma_f32_16x16x32_bf16 a[176:179], v[24:27], v[116:119], a[176:179]
    ds_read_b64_tr_b16 v[16:17], v221 offset:0
    v_accvgpr_read_b32 v194, a150
    v_mfma_f32_16x16x32_bf16 a[180:183], v[24:27], v[148:151], a[180:183]
    ds_read_b64_tr_b16 v[18:19], v221 offset:2048
    v_accvgpr_read_b32 v195, a151
    v_mfma_f32_16x16x32_bf16 a[184:187], v[28:31], v[116:119], a[184:187]
    ds_read_b64_tr_b16 v[20:21], v222 offset:0
    s_add_u32 m0, s76, 32768
    s_mov_b32 s68, 640
    buffer_load_dwordx4 v220, s[72:75], s68 offen lds
    v_accvgpr_read_b32 v196, a156
    v_mfma_f32_16x16x32_bf16 a[188:191], v[28:31], v[148:151], a[188:191]
    ds_read_b64_tr_b16 v[22:23], v222 offset:2048
    v_accvgpr_read_b32 v197, a157
    s_waitcnt lgkmcnt(8)
    v_mfma_f32_16x16x32_bf16 a[160:163], v[32:35], v[120:123], a[160:163]
    ds_read_b64_tr_b16 v[24:25], v223 offset:0
    v_accvgpr_read_b32 v198, a158
    v_mfma_f32_16x16x32_bf16 a[164:167], v[32:35], v[152:155], a[164:167]
    ds_read_b64_tr_b16 v[26:27], v223 offset:2048
    v_accvgpr_read_b32 v199, a159
    v_mfma_f32_16x16x32_bf16 a[168:171], v[36:39], v[120:123], a[168:171]
    ds_read_b64_tr_b16 v[28:29], v224 offset:0
    s_add_u32 m0, s76, 33792
    s_mov_b32 s68, 7808
    buffer_load_dwordx4 v220, s[72:75], s68 offen lds
    v_cvt_pk_bf16_f32 v200, v192, v193
    v_mfma_f32_16x16x32_bf16 a[172:175], v[36:39], v[152:155], a[172:175]
    ds_read_b64_tr_b16 v[30:31], v224 offset:2048
    v_cvt_pk_bf16_f32 v201, v194, v195
    s_waitcnt lgkmcnt(8)
    v_mfma_f32_16x16x32_bf16 a[176:179], v[40:43], v[120:123], a[176:179]
    ds_read_b64_tr_b16 v[32:33], v221 offset:4096
    v_cvt_pk_bf16_f32 v202, v196, v197
    v_mfma_f32_16x16x32_bf16 a[180:183], v[40:43], v[152:155], a[180:183]
    ds_read_b64_tr_b16 v[34:35], v221 offset:6144
    v_cvt_pk_bf16_f32 v203, v198, v199
    v_mfma_f32_16x16x32_bf16 a[184:187], v[44:47], v[120:123], a[184:187]
    ds_read_b64_tr_b16 v[36:37], v222 offset:4096
    s_add_u32 m0, s76, 34816
    s_mov_b32 s68, 14976
    buffer_load_dwordx4 v220, s[72:75], s68 offen lds
    s_mov_b32 s6, 245760
    v_mfma_f32_16x16x32_bf16 a[188:191], v[44:47], v[152:155], a[188:191]
    ds_read_b64_tr_b16 v[38:39], v222 offset:6144
    buffer_store_dwordx4 v[200:203], v12, s[20:23], s6 offen sc1
    s_waitcnt lgkmcnt(8)
    v_mfma_f32_16x16x32_bf16 a[128:131], v[16:19], v[92:95], 0
    ds_read_b64_tr_b16 v[40:41], v223 offset:4096
    v_mfma_f32_16x16x32_bf16 a[132:135], v[16:19], v[124:127], 0
    ds_read_b64_tr_b16 v[42:43], v223 offset:6144
    v_mfma_f32_16x16x32_bf16 a[136:139], v[20:23], v[92:95], 0
    ds_read_b64_tr_b16 v[44:45], v224 offset:4096
    s_add_u32 m0, s76, 35840
    s_mov_b32 s68, 22144
    buffer_load_dwordx4 v220, s[72:75], s68 offen lds
    v_mfma_f32_16x16x32_bf16 a[140:143], v[20:23], v[124:127], 0
    ds_read_b64_tr_b16 v[46:47], v224 offset:6144
    s_waitcnt lgkmcnt(8)
    v_mfma_f32_16x16x32_bf16 a[144:147], v[24:27], v[92:95], 0
    ds_read_b64_tr_b16 v[16:17], v221 offset:8192
    v_mfma_f32_16x16x32_bf16 a[148:151], v[24:27], v[124:127], 0
    ds_read_b64_tr_b16 v[18:19], v221 offset:10240
    v_mfma_f32_16x16x32_bf16 a[152:155], v[28:31], v[92:95], 0
    ds_read_b64_tr_b16 v[20:21], v222 offset:8192
    s_add_u32 m0, s76, 36864
    s_mov_b32 s68, 29312
    buffer_load_dwordx4 v220, s[72:75], s68 offen lds
    v_mfma_f32_16x16x32_bf16 a[156:159], v[28:31], v[124:127], 0
    ds_read_b64_tr_b16 v[22:23], v222 offset:10240
    s_waitcnt lgkmcnt(8)
    v_mfma_f32_16x16x32_bf16 a[128:131], v[32:35], v[96:99], a[128:131]
    ds_read_b64_tr_b16 v[24:25], v223 offset:8192
    v_accvgpr_read_b32 v156, a160
    v_mfma_f32_16x16x32_bf16 a[132:135], v[32:35], v[128:131], a[132:135]
    ds_read_b64_tr_b16 v[26:27], v223 offset:10240
    v_accvgpr_read_b32 v157, a161
    v_mfma_f32_16x16x32_bf16 a[136:139], v[36:39], v[96:99], a[136:139]
    ds_read_b64_tr_b16 v[28:29], v224 offset:8192
    s_add_u32 m0, s76, 37888
    s_mov_b32 s68, 36480
    buffer_load_dwordx4 v220, s[72:75], s68 offen lds
    v_accvgpr_read_b32 v158, a162
    v_mfma_f32_16x16x32_bf16 a[140:143], v[36:39], v[128:131], a[140:143]
    ds_read_b64_tr_b16 v[30:31], v224 offset:10240
    v_accvgpr_read_b32 v159, a163
    s_waitcnt lgkmcnt(8)
    v_mfma_f32_16x16x32_bf16 a[144:147], v[40:43], v[96:99], a[144:147]
    ds_read_b64_tr_b16 v[32:33], v221 offset:12288
    v_accvgpr_read_b32 v160, a168
    v_mfma_f32_16x16x32_bf16 a[148:151], v[40:43], v[128:131], a[148:151]
    ds_read_b64_tr_b16 v[34:35], v221 offset:14336
    v_accvgpr_read_b32 v161, a169
    v_mfma_f32_16x16x32_bf16 a[152:155], v[44:47], v[96:99], a[152:155]
    ds_read_b64_tr_b16 v[36:37], v222 offset:12288
    s_add_u32 m0, s76, 38912
    s_mov_b32 s68, 43648
    buffer_load_dwordx4 v220, s[72:75], s68 offen lds
    v_accvgpr_read_b32 v162, a170
    v_mfma_f32_16x16x32_bf16 a[156:159], v[44:47], v[128:131], a[156:159]
    ds_read_b64_tr_b16 v[38:39], v222 offset:14336
    v_accvgpr_read_b32 v163, a171
    s_waitcnt lgkmcnt(8)
    v_mfma_f32_16x16x32_bf16 a[128:131], v[16:19], v[100:103], a[128:131]
    ds_read_b64_tr_b16 v[40:41], v223 offset:12288
    v_cvt_pk_bf16_f32 v164, v156, v157
    v_mfma_f32_16x16x32_bf16 a[132:135], v[16:19], v[132:135], a[132:135]
    ds_read_b64_tr_b16 v[42:43], v223 offset:14336
    v_cvt_pk_bf16_f32 v165, v158, v159
    v_mfma_f32_16x16x32_bf16 a[136:139], v[20:23], v[100:103], a[136:139]
    ds_read_b64_tr_b16 v[44:45], v224 offset:12288
    s_add_u32 m0, s76, 39936
    s_mov_b32 s68, 50816
    buffer_load_dwordx4 v220, s[72:75], s68 offen lds
    v_cvt_pk_bf16_f32 v166, v160, v161
    v_mfma_f32_16x16x32_bf16 a[140:143], v[20:23], v[132:135], a[140:143]
    ds_read_b64_tr_b16 v[46:47], v224 offset:14336
    v_cvt_pk_bf16_f32 v167, v162, v163
    s_waitcnt lgkmcnt(8)
    v_mfma_f32_16x16x32_bf16 a[144:147], v[24:27], v[100:103], a[144:147]
    ds_read_b64_tr_b16 v[16:17], v221 offset:16384
    s_mov_b32 s6, 32768
    v_mfma_f32_16x16x32_bf16 a[148:151], v[24:27], v[132:135], a[148:151]
    ds_read_b64_tr_b16 v[18:19], v221 offset:18432
    buffer_store_dwordx4 v[164:167], v12, s[20:23], s6 offen sc1
    v_mfma_f32_16x16x32_bf16 a[152:155], v[28:31], v[100:103], a[152:155]
    ds_read_b64_tr_b16 v[20:21], v222 offset:16384
    s_add_u32 m0, s76, 0
    s_mov_b32 s68, 768
    buffer_load_dwordx4 v220, s[72:75], s68 offen lds
    v_accvgpr_read_b32 v168, a164
    v_mfma_f32_16x16x32_bf16 a[156:159], v[28:31], v[132:135], a[156:159]
    ds_read_b64_tr_b16 v[22:23], v222 offset:18432
    v_accvgpr_read_b32 v169, a165
    s_waitcnt lgkmcnt(8)
    v_mfma_f32_16x16x32_bf16 a[128:131], v[32:35], v[104:107], a[128:131]
    ds_read_b64_tr_b16 v[24:25], v223 offset:16384
    v_accvgpr_read_b32 v170, a166
    v_mfma_f32_16x16x32_bf16 a[132:135], v[32:35], v[136:139], a[132:135]
    ds_read_b64_tr_b16 v[26:27], v223 offset:18432
    v_accvgpr_read_b32 v171, a167
    v_mfma_f32_16x16x32_bf16 a[136:139], v[36:39], v[104:107], a[136:139]
    ds_read_b64_tr_b16 v[28:29], v224 offset:16384
    s_add_u32 m0, s76, 1024
    s_mov_b32 s68, 7936
    buffer_load_dwordx4 v220, s[72:75], s68 offen lds
    v_accvgpr_read_b32 v172, a172
    v_mfma_f32_16x16x32_bf16 a[140:143], v[36:39], v[136:139], a[140:143]
    ds_read_b64_tr_b16 v[30:31], v224 offset:18432
    v_accvgpr_read_b32 v173, a173
    s_waitcnt lgkmcnt(8)
    v_mfma_f32_16x16x32_bf16 a[144:147], v[40:43], v[104:107], a[144:147]
    ds_read_b64_tr_b16 v[32:33], v221 offset:20480
    v_accvgpr_read_b32 v174, a174
    v_mfma_f32_16x16x32_bf16 a[148:151], v[40:43], v[136:139], a[148:151]
    ds_read_b64_tr_b16 v[34:35], v221 offset:22528
    v_accvgpr_read_b32 v175, a175
    v_mfma_f32_16x16x32_bf16 a[152:155], v[44:47], v[104:107], a[152:155]
    ds_read_b64_tr_b16 v[36:37], v222 offset:20480
    s_add_u32 m0, s76, 2048
    s_mov_b32 s68, 15104
    buffer_load_dwordx4 v220, s[72:75], s68 offen lds
    v_cvt_pk_bf16_f32 v176, v168, v169
    v_mfma_f32_16x16x32_bf16 a[156:159], v[44:47], v[136:139], a[156:159]
    ds_read_b64_tr_b16 v[38:39], v222 offset:22528
    v_cvt_pk_bf16_f32 v177, v170, v171
    s_waitcnt lgkmcnt(8)
    v_mfma_f32_16x16x32_bf16 a[128:131], v[16:19], v[108:111], a[128:131]
    ds_read_b64_tr_b16 v[40:41], v223 offset:20480
    v_cvt_pk_bf16_f32 v178, v172, v173
    v_mfma_f32_16x16x32_bf16 a[132:135], v[16:19], v[140:143], a[132:135]
    ds_read_b64_tr_b16 v[42:43], v223 offset:22528
    v_cvt_pk_bf16_f32 v179, v174, v175
    v_mfma_f32_16x16x32_bf16 a[136:139], v[20:23], v[108:111], a[136:139]
    ds_read_b64_tr_b16 v[44:45], v224 offset:20480
    s_add_u32 m0, s76, 3072
    s_mov_b32 s68, 22272
    buffer_load_dwordx4 v220, s[72:75], s68 offen lds
    s_mov_b32 s6, 262144
    v_mfma_f32_16x16x32_bf16 a[140:143], v[20:23], v[140:143], a[140:143]
    ds_read_b64_tr_b16 v[46:47], v224 offset:22528
    buffer_store_dwordx4 v[176:179], v12, s[20:23], s6 offen sc1
    s_waitcnt lgkmcnt(8)
    v_mfma_f32_16x16x32_bf16 a[144:147], v[24:27], v[108:111], a[144:147]
    ds_read_b64_tr_b16 v[16:17], v221 offset:24576
    v_accvgpr_read_b32 v180, a176
    v_mfma_f32_16x16x32_bf16 a[148:151], v[24:27], v[140:143], a[148:151]
    ds_read_b64_tr_b16 v[18:19], v221 offset:26624
    v_accvgpr_read_b32 v181, a177
    v_mfma_f32_16x16x32_bf16 a[152:155], v[28:31], v[108:111], a[152:155]
    ds_read_b64_tr_b16 v[20:21], v222 offset:24576
    s_add_u32 m0, s76, 4096
    s_mov_b32 s68, 29440
    buffer_load_dwordx4 v220, s[72:75], s68 offen lds
    v_accvgpr_read_b32 v182, a178
    v_mfma_f32_16x16x32_bf16 a[156:159], v[28:31], v[140:143], a[156:159]
    ds_read_b64_tr_b16 v[22:23], v222 offset:26624
    v_accvgpr_read_b32 v183, a179
    s_waitcnt lgkmcnt(8)
    v_mfma_f32_16x16x32_bf16 a[128:131], v[32:35], v[112:115], a[128:131]
    ds_read_b64_tr_b16 v[24:25], v223 offset:24576
    v_accvgpr_read_b32 v184, a184
    v_mfma_f32_16x16x32_bf16 a[132:135], v[32:35], v[144:147], a[132:135]
    ds_read_b64_tr_b16 v[26:27], v223 offset:26624
    v_accvgpr_read_b32 v185, a185
    v_mfma_f32_16x16x32_bf16 a[136:139], v[36:39], v[112:115], a[136:139]
    ds_read_b64_tr_b16 v[28:29], v224 offset:24576
    s_add_u32 m0, s76, 5120
    s_mov_b32 s68, 36608
    buffer_load_dwordx4 v220, s[72:75], s68 offen lds
    v_accvgpr_read_b32 v186, a186
    v_mfma_f32_16x16x32_bf16 a[140:143], v[36:39], v[144:147], a[140:143]
    ds_read_b64_tr_b16 v[30:31], v224 offset:26624
    v_accvgpr_read_b32 v187, a187
    s_waitcnt lgkmcnt(8)
    v_mfma_f32_16x16x32_bf16 a[144:147], v[40:43], v[112:115], a[144:147]
    ds_read_b64_tr_b16 v[32:33], v221 offset:28672
    v_cvt_pk_bf16_f32 v188, v180, v181
    v_mfma_f32_16x16x32_bf16 a[148:151], v[40:43], v[144:147], a[148:151]
    ds_read_b64_tr_b16 v[34:35], v221 offset:30720
    v_cvt_pk_bf16_f32 v189, v182, v183
    v_mfma_f32_16x16x32_bf16 a[152:155], v[44:47], v[112:115], a[152:155]
    ds_read_b64_tr_b16 v[36:37], v222 offset:28672
    s_add_u32 m0, s76, 6144
    s_mov_b32 s68, 43776
    buffer_load_dwordx4 v220, s[72:75], s68 offen lds
    v_cvt_pk_bf16_f32 v190, v184, v185
    v_mfma_f32_16x16x32_bf16 a[156:159], v[44:47], v[144:147], a[156:159]
    ds_read_b64_tr_b16 v[38:39], v222 offset:30720
    v_cvt_pk_bf16_f32 v191, v186, v187
    s_waitcnt lgkmcnt(8)
    v_mfma_f32_16x16x32_bf16 a[128:131], v[16:19], v[116:119], a[128:131]
    ds_read_b64_tr_b16 v[40:41], v223 offset:28672
    s_mov_b32 s6, 49152
    v_mfma_f32_16x16x32_bf16 a[132:135], v[16:19], v[148:151], a[132:135]
    ds_read_b64_tr_b16 v[42:43], v223 offset:30720
    buffer_store_dwordx4 v[188:191], v12, s[20:23], s6 offen sc1
    v_mfma_f32_16x16x32_bf16 a[136:139], v[20:23], v[116:119], a[136:139]
    ds_read_b64_tr_b16 v[44:45], v224 offset:28672
    s_add_u32 m0, s76, 7168
    s_mov_b32 s68, 50944
    buffer_load_dwordx4 v220, s[72:75], s68 offen lds
    v_accvgpr_read_b32 v192, a180
    v_mfma_f32_16x16x32_bf16 a[140:143], v[20:23], v[148:151], a[140:143]
    ds_read_b64_tr_b16 v[46:47], v224 offset:30720
    v_accvgpr_read_b32 v193, a181
    v_add_u32 v221, 32768, v221
    v_add_u32 v222, 32768, v222
    v_add_u32 v223, 32768, v223
    v_add_u32 v224, 32768, v224
    s_waitcnt lgkmcnt(8)
    v_mfma_f32_16x16x32_bf16 a[144:147], v[24:27], v[116:119], a[144:147]
    ds_read_b64_tr_b16 v[16:17], v221 offset:0
    v_accvgpr_read_b32 v194, a182
    v_mfma_f32_16x16x32_bf16 a[148:151], v[24:27], v[148:151], a[148:151]
    ds_read_b64_tr_b16 v[18:19], v221 offset:2048
    v_accvgpr_read_b32 v195, a183
    v_mfma_f32_16x16x32_bf16 a[152:155], v[28:31], v[116:119], a[152:155]
    ds_read_b64_tr_b16 v[20:21], v222 offset:0
    v_accvgpr_read_b32 v196, a188
    v_mfma_f32_16x16x32_bf16 a[156:159], v[28:31], v[148:151], a[156:159]
    ds_read_b64_tr_b16 v[22:23], v222 offset:2048
    v_accvgpr_read_b32 v197, a189
    s_waitcnt lgkmcnt(8)
    v_mfma_f32_16x16x32_bf16 a[128:131], v[32:35], v[120:123], a[128:131]
    ds_read_b64_tr_b16 v[24:25], v223 offset:0
    v_accvgpr_read_b32 v198, a190
    v_mfma_f32_16x16x32_bf16 a[132:135], v[32:35], v[152:155], a[132:135]
    ds_read_b64_tr_b16 v[26:27], v223 offset:2048
    v_accvgpr_read_b32 v199, a191
    v_mfma_f32_16x16x32_bf16 a[136:139], v[36:39], v[120:123], a[136:139]
    ds_read_b64_tr_b16 v[28:29], v224 offset:0
    v_cvt_pk_bf16_f32 v200, v192, v193
    v_mfma_f32_16x16x32_bf16 a[140:143], v[36:39], v[152:155], a[140:143]
    ds_read_b64_tr_b16 v[30:31], v224 offset:2048
    v_cvt_pk_bf16_f32 v201, v194, v195
    s_waitcnt lgkmcnt(8)
    v_mfma_f32_16x16x32_bf16 a[144:147], v[40:43], v[120:123], a[144:147]
    ds_read_b64_tr_b16 v[32:33], v221 offset:4096
    v_cvt_pk_bf16_f32 v202, v196, v197
    v_mfma_f32_16x16x32_bf16 a[148:151], v[40:43], v[152:155], a[148:151]
    ds_read_b64_tr_b16 v[34:35], v221 offset:6144
    v_cvt_pk_bf16_f32 v203, v198, v199
    v_mfma_f32_16x16x32_bf16 a[152:155], v[44:47], v[120:123], a[152:155]
    ds_read_b64_tr_b16 v[36:37], v222 offset:4096
    s_mov_b32 s6, 278528
    v_mfma_f32_16x16x32_bf16 a[156:159], v[44:47], v[152:155], a[156:159]
    ds_read_b64_tr_b16 v[38:39], v222 offset:6144
    buffer_store_dwordx4 v[200:203], v12, s[20:23], s6 offen sc1
    s_waitcnt lgkmcnt(8)
    v_mfma_f32_16x16x32_bf16 a[160:163], v[16:19], v[92:95], 0
    ds_read_b64_tr_b16 v[40:41], v223 offset:4096
    v_mfma_f32_16x16x32_bf16 a[164:167], v[16:19], v[124:127], 0
    ds_read_b64_tr_b16 v[42:43], v223 offset:6144
    v_mfma_f32_16x16x32_bf16 a[168:171], v[20:23], v[92:95], 0
    ds_read_b64_tr_b16 v[44:45], v224 offset:4096
    v_mfma_f32_16x16x32_bf16 a[172:175], v[20:23], v[124:127], 0
    ds_read_b64_tr_b16 v[46:47], v224 offset:6144
    s_waitcnt lgkmcnt(8)
    v_mfma_f32_16x16x32_bf16 a[176:179], v[24:27], v[92:95], 0
    ds_read_b64_tr_b16 v[16:17], v221 offset:8192
    v_mfma_f32_16x16x32_bf16 a[180:183], v[24:27], v[124:127], 0
    ds_read_b64_tr_b16 v[18:19], v221 offset:10240
    v_mfma_f32_16x16x32_bf16 a[184:187], v[28:31], v[92:95], 0
    ds_read_b64_tr_b16 v[20:21], v222 offset:8192
    v_mfma_f32_16x16x32_bf16 a[188:191], v[28:31], v[124:127], 0
    ds_read_b64_tr_b16 v[22:23], v222 offset:10240
    s_waitcnt lgkmcnt(8)
    v_mfma_f32_16x16x32_bf16 a[160:163], v[32:35], v[96:99], a[160:163]
    ds_read_b64_tr_b16 v[24:25], v223 offset:8192
    v_accvgpr_read_b32 v156, a128
    v_mfma_f32_16x16x32_bf16 a[164:167], v[32:35], v[128:131], a[164:167]
    ds_read_b64_tr_b16 v[26:27], v223 offset:10240
    v_accvgpr_read_b32 v157, a129
    v_mfma_f32_16x16x32_bf16 a[168:171], v[36:39], v[96:99], a[168:171]
    ds_read_b64_tr_b16 v[28:29], v224 offset:8192
    v_accvgpr_read_b32 v158, a130
    v_mfma_f32_16x16x32_bf16 a[172:175], v[36:39], v[128:131], a[172:175]
    ds_read_b64_tr_b16 v[30:31], v224 offset:10240
    v_accvgpr_read_b32 v159, a131
    s_waitcnt lgkmcnt(8)
    v_mfma_f32_16x16x32_bf16 a[176:179], v[40:43], v[96:99], a[176:179]
    ds_read_b64_tr_b16 v[32:33], v221 offset:12288
    v_accvgpr_read_b32 v160, a136
    v_mfma_f32_16x16x32_bf16 a[180:183], v[40:43], v[128:131], a[180:183]
    ds_read_b64_tr_b16 v[34:35], v221 offset:14336
    v_accvgpr_read_b32 v161, a137
    v_mfma_f32_16x16x32_bf16 a[184:187], v[44:47], v[96:99], a[184:187]
    ds_read_b64_tr_b16 v[36:37], v222 offset:12288
    v_accvgpr_read_b32 v162, a138
    v_mfma_f32_16x16x32_bf16 a[188:191], v[44:47], v[128:131], a[188:191]
    ds_read_b64_tr_b16 v[38:39], v222 offset:14336
    v_accvgpr_read_b32 v163, a139
    s_waitcnt lgkmcnt(8)
    v_mfma_f32_16x16x32_bf16 a[160:163], v[16:19], v[100:103], a[160:163]
    ds_read_b64_tr_b16 v[40:41], v223 offset:12288
    v_cvt_pk_bf16_f32 v164, v156, v157
    v_mfma_f32_16x16x32_bf16 a[164:167], v[16:19], v[132:135], a[164:167]
    ds_read_b64_tr_b16 v[42:43], v223 offset:14336
    v_cvt_pk_bf16_f32 v165, v158, v159
    v_mfma_f32_16x16x32_bf16 a[168:171], v[20:23], v[100:103], a[168:171]
    ds_read_b64_tr_b16 v[44:45], v224 offset:12288
    v_cvt_pk_bf16_f32 v166, v160, v161
    v_mfma_f32_16x16x32_bf16 a[172:175], v[20:23], v[132:135], a[172:175]
    ds_read_b64_tr_b16 v[46:47], v224 offset:14336
    v_cvt_pk_bf16_f32 v167, v162, v163
    s_waitcnt lgkmcnt(8)
    v_mfma_f32_16x16x32_bf16 a[176:179], v[24:27], v[100:103], a[176:179]
    ds_read_b64_tr_b16 v[16:17], v221 offset:16384
    s_mov_b32 s6, 65536
    v_mfma_f32_16x16x32_bf16 a[180:183], v[24:27], v[132:135], a[180:183]
    ds_read_b64_tr_b16 v[18:19], v221 offset:18432
    buffer_store_dwordx4 v[164:167], v12, s[20:23], s6 offen sc1
    v_mfma_f32_16x16x32_bf16 a[184:187], v[28:31], v[100:103], a[184:187]
    ds_read_b64_tr_b16 v[20:21], v222 offset:16384
    v_accvgpr_read_b32 v168, a132
    v_mfma_f32_16x16x32_bf16 a[188:191], v[28:31], v[132:135], a[188:191]
    ds_read_b64_tr_b16 v[22:23], v222 offset:18432
    v_accvgpr_read_b32 v169, a133
    s_waitcnt lgkmcnt(8)
    v_mfma_f32_16x16x32_bf16 a[160:163], v[32:35], v[104:107], a[160:163]
    ds_read_b64_tr_b16 v[24:25], v223 offset:16384
    v_accvgpr_read_b32 v170, a134
    v_mfma_f32_16x16x32_bf16 a[164:167], v[32:35], v[136:139], a[164:167]
    ds_read_b64_tr_b16 v[26:27], v223 offset:18432
    v_accvgpr_read_b32 v171, a135
    v_mfma_f32_16x16x32_bf16 a[168:171], v[36:39], v[104:107], a[168:171]
    ds_read_b64_tr_b16 v[28:29], v224 offset:16384
    v_accvgpr_read_b32 v172, a140
    v_mfma_f32_16x16x32_bf16 a[172:175], v[36:39], v[136:139], a[172:175]
    ds_read_b64_tr_b16 v[30:31], v224 offset:18432
    v_accvgpr_read_b32 v173, a141
    s_waitcnt lgkmcnt(8)
    v_mfma_f32_16x16x32_bf16 a[176:179], v[40:43], v[104:107], a[176:179]
    ds_read_b64_tr_b16 v[32:33], v221 offset:20480
    v_accvgpr_read_b32 v174, a142
    v_mfma_f32_16x16x32_bf16 a[180:183], v[40:43], v[136:139], a[180:183]
    ds_read_b64_tr_b16 v[34:35], v221 offset:22528
    v_accvgpr_read_b32 v175, a143
    v_mfma_f32_16x16x32_bf16 a[184:187], v[44:47], v[104:107], a[184:187]
    ds_read_b64_tr_b16 v[36:37], v222 offset:20480
    v_cvt_pk_bf16_f32 v176, v168, v169
    v_mfma_f32_16x16x32_bf16 a[188:191], v[44:47], v[136:139], a[188:191]
    ds_read_b64_tr_b16 v[38:39], v222 offset:22528
    v_cvt_pk_bf16_f32 v177, v170, v171
    s_waitcnt lgkmcnt(8)
    v_mfma_f32_16x16x32_bf16 a[160:163], v[16:19], v[108:111], a[160:163]
    ds_read_b64_tr_b16 v[40:41], v223 offset:20480
    v_cvt_pk_bf16_f32 v178, v172, v173
    v_mfma_f32_16x16x32_bf16 a[164:167], v[16:19], v[140:143], a[164:167]
    ds_read_b64_tr_b16 v[42:43], v223 offset:22528
    v_cvt_pk_bf16_f32 v179, v174, v175
    v_mfma_f32_16x16x32_bf16 a[168:171], v[20:23], v[108:111], a[168:171]
    ds_read_b64_tr_b16 v[44:45], v224 offset:20480
    s_mov_b32 s6, 294912
    v_mfma_f32_16x16x32_bf16 a[172:175], v[20:23], v[140:143], a[172:175]
    ds_read_b64_tr_b16 v[46:47], v224 offset:22528
    buffer_store_dwordx4 v[176:179], v12, s[20:23], s6 offen sc1
    s_waitcnt lgkmcnt(8)
    v_mfma_f32_16x16x32_bf16 a[176:179], v[24:27], v[108:111], a[176:179]
    ds_read_b64_tr_b16 v[16:17], v221 offset:24576
    v_accvgpr_read_b32 v180, a144
    v_mfma_f32_16x16x32_bf16 a[180:183], v[24:27], v[140:143], a[180:183]
    ds_read_b64_tr_b16 v[18:19], v221 offset:26624
    v_accvgpr_read_b32 v181, a145
    v_mfma_f32_16x16x32_bf16 a[184:187], v[28:31], v[108:111], a[184:187]
    ds_read_b64_tr_b16 v[20:21], v222 offset:24576
    v_accvgpr_read_b32 v182, a146
    v_mfma_f32_16x16x32_bf16 a[188:191], v[28:31], v[140:143], a[188:191]
    ds_read_b64_tr_b16 v[22:23], v222 offset:26624
    v_accvgpr_read_b32 v183, a147
    s_waitcnt lgkmcnt(8)
    v_mfma_f32_16x16x32_bf16 a[160:163], v[32:35], v[112:115], a[160:163]
    ds_read_b64_tr_b16 v[24:25], v223 offset:24576
    v_accvgpr_read_b32 v184, a152
    v_mfma_f32_16x16x32_bf16 a[164:167], v[32:35], v[144:147], a[164:167]
    ds_read_b64_tr_b16 v[26:27], v223 offset:26624
    v_accvgpr_read_b32 v185, a153
    v_mfma_f32_16x16x32_bf16 a[168:171], v[36:39], v[112:115], a[168:171]
    ds_read_b64_tr_b16 v[28:29], v224 offset:24576
    v_accvgpr_read_b32 v186, a154
    v_mfma_f32_16x16x32_bf16 a[172:175], v[36:39], v[144:147], a[172:175]
    ds_read_b64_tr_b16 v[30:31], v224 offset:26624
    v_accvgpr_read_b32 v187, a155
    s_waitcnt lgkmcnt(8)
    v_mfma_f32_16x16x32_bf16 a[176:179], v[40:43], v[112:115], a[176:179]
    ds_read_b64_tr_b16 v[32:33], v221 offset:28672
    v_cvt_pk_bf16_f32 v188, v180, v181
    v_mfma_f32_16x16x32_bf16 a[180:183], v[40:43], v[144:147], a[180:183]
    ds_read_b64_tr_b16 v[34:35], v221 offset:30720
    v_cvt_pk_bf16_f32 v189, v182, v183
    v_mfma_f32_16x16x32_bf16 a[184:187], v[44:47], v[112:115], a[184:187]
    ds_read_b64_tr_b16 v[36:37], v222 offset:28672
    v_cvt_pk_bf16_f32 v190, v184, v185
    v_mfma_f32_16x16x32_bf16 a[188:191], v[44:47], v[144:147], a[188:191]
    ds_read_b64_tr_b16 v[38:39], v222 offset:30720
    v_cvt_pk_bf16_f32 v191, v186, v187
    s_waitcnt lgkmcnt(8)
    v_mfma_f32_16x16x32_bf16 a[160:163], v[16:19], v[116:119], a[160:163]
    ds_read_b64_tr_b16 v[40:41], v223 offset:28672
    s_mov_b32 s6, 81920
    v_mfma_f32_16x16x32_bf16 a[164:167], v[16:19], v[148:151], a[164:167]
    ds_read_b64_tr_b16 v[42:43], v223 offset:30720
    buffer_store_dwordx4 v[188:191], v12, s[20:23], s6 offen sc1
    v_mfma_f32_16x16x32_bf16 a[168:171], v[20:23], v[116:119], a[168:171]
    ds_read_b64_tr_b16 v[44:45], v224 offset:28672
    v_accvgpr_read_b32 v192, a148
    v_mfma_f32_16x16x32_bf16 a[172:175], v[20:23], v[148:151], a[172:175]
    ds_read_b64_tr_b16 v[46:47], v224 offset:30720
    v_accvgpr_read_b32 v193, a149
    v_add_u32 v221, 4294901760, v221
    v_add_u32 v222, 4294901760, v222
    v_add_u32 v223, 4294901760, v223
    v_add_u32 v224, 4294901760, v224
    s_waitcnt lgkmcnt(8)
    v_mfma_f32_16x16x32_bf16 a[176:179], v[24:27], v[116:119], a[176:179]
    ds_read_b64_tr_b16 v[16:17], v221 offset:0
    v_accvgpr_read_b32 v194, a150
    v_mfma_f32_16x16x32_bf16 a[180:183], v[24:27], v[148:151], a[180:183]
    ds_read_b64_tr_b16 v[18:19], v221 offset:2048
    v_accvgpr_read_b32 v195, a151
    v_mfma_f32_16x16x32_bf16 a[184:187], v[28:31], v[116:119], a[184:187]
    ds_read_b64_tr_b16 v[20:21], v222 offset:0
    v_accvgpr_read_b32 v196, a156
    v_mfma_f32_16x16x32_bf16 a[188:191], v[28:31], v[148:151], a[188:191]
    ds_read_b64_tr_b16 v[22:23], v222 offset:2048
    v_accvgpr_read_b32 v197, a157
    s_waitcnt lgkmcnt(8)
    v_mfma_f32_16x16x32_bf16 a[160:163], v[32:35], v[120:123], a[160:163]
    ds_read_b64_tr_b16 v[24:25], v223 offset:0
    v_accvgpr_read_b32 v198, a158
    v_mfma_f32_16x16x32_bf16 a[164:167], v[32:35], v[152:155], a[164:167]
    ds_read_b64_tr_b16 v[26:27], v223 offset:2048
    v_accvgpr_read_b32 v199, a159
    v_mfma_f32_16x16x32_bf16 a[168:171], v[36:39], v[120:123], a[168:171]
    ds_read_b64_tr_b16 v[28:29], v224 offset:0
    v_cvt_pk_bf16_f32 v200, v192, v193
    v_mfma_f32_16x16x32_bf16 a[172:175], v[36:39], v[152:155], a[172:175]
    ds_read_b64_tr_b16 v[30:31], v224 offset:2048
    v_cvt_pk_bf16_f32 v201, v194, v195
    s_waitcnt lgkmcnt(8)
    v_mfma_f32_16x16x32_bf16 a[176:179], v[40:43], v[120:123], a[176:179]
    ds_read_b64_tr_b16 v[32:33], v221 offset:4096
    v_cvt_pk_bf16_f32 v202, v196, v197
    v_mfma_f32_16x16x32_bf16 a[180:183], v[40:43], v[152:155], a[180:183]
    ds_read_b64_tr_b16 v[34:35], v221 offset:6144
    v_cvt_pk_bf16_f32 v203, v198, v199
    v_mfma_f32_16x16x32_bf16 a[184:187], v[44:47], v[120:123], a[184:187]
    ds_read_b64_tr_b16 v[36:37], v222 offset:4096
    s_mov_b32 s6, 311296
    v_mfma_f32_16x16x32_bf16 a[188:191], v[44:47], v[152:155], a[188:191]
    ds_read_b64_tr_b16 v[38:39], v222 offset:6144
    buffer_store_dwordx4 v[200:203], v12, s[20:23], s6 offen sc1
    s_waitcnt lgkmcnt(8)
    v_mfma_f32_16x16x32_bf16 a[128:131], v[16:19], v[92:95], 0
    ds_read_b64_tr_b16 v[40:41], v223 offset:4096
    v_mfma_f32_16x16x32_bf16 a[132:135], v[16:19], v[124:127], 0
    ds_read_b64_tr_b16 v[42:43], v223 offset:6144
    v_mfma_f32_16x16x32_bf16 a[136:139], v[20:23], v[92:95], 0
    ds_read_b64_tr_b16 v[44:45], v224 offset:4096
    v_mfma_f32_16x16x32_bf16 a[140:143], v[20:23], v[124:127], 0
    ds_read_b64_tr_b16 v[46:47], v224 offset:6144
    s_waitcnt lgkmcnt(8)
    v_mfma_f32_16x16x32_bf16 a[144:147], v[24:27], v[92:95], 0
    ds_read_b64_tr_b16 v[16:17], v221 offset:8192
    v_mfma_f32_16x16x32_bf16 a[148:151], v[24:27], v[124:127], 0
    ds_read_b64_tr_b16 v[18:19], v221 offset:10240
    v_mfma_f32_16x16x32_bf16 a[152:155], v[28:31], v[92:95], 0
    ds_read_b64_tr_b16 v[20:21], v222 offset:8192
    v_mfma_f32_16x16x32_bf16 a[156:159], v[28:31], v[124:127], 0
    ds_read_b64_tr_b16 v[22:23], v222 offset:10240
    s_waitcnt lgkmcnt(8)
    v_mfma_f32_16x16x32_bf16 a[128:131], v[32:35], v[96:99], a[128:131]
    ds_read_b64_tr_b16 v[24:25], v223 offset:8192
    v_accvgpr_read_b32 v156, a160
    v_mfma_f32_16x16x32_bf16 a[132:135], v[32:35], v[128:131], a[132:135]
    ds_read_b64_tr_b16 v[26:27], v223 offset:10240
    v_accvgpr_read_b32 v157, a161
    v_mfma_f32_16x16x32_bf16 a[136:139], v[36:39], v[96:99], a[136:139]
    ds_read_b64_tr_b16 v[28:29], v224 offset:8192
    v_accvgpr_read_b32 v158, a162
    v_mfma_f32_16x16x32_bf16 a[140:143], v[36:39], v[128:131], a[140:143]
    ds_read_b64_tr_b16 v[30:31], v224 offset:10240
    v_accvgpr_read_b32 v159, a163
    s_waitcnt lgkmcnt(8)
    v_mfma_f32_16x16x32_bf16 a[144:147], v[40:43], v[96:99], a[144:147]
    ds_read_b64_tr_b16 v[32:33], v221 offset:12288
    v_accvgpr_read_b32 v160, a168
    v_mfma_f32_16x16x32_bf16 a[148:151], v[40:43], v[128:131], a[148:151]
    ds_read_b64_tr_b16 v[34:35], v221 offset:14336
    v_accvgpr_read_b32 v161, a169
    v_mfma_f32_16x16x32_bf16 a[152:155], v[44:47], v[96:99], a[152:155]
    ds_read_b64_tr_b16 v[36:37], v222 offset:12288
    v_accvgpr_read_b32 v162, a170
    v_mfma_f32_16x16x32_bf16 a[156:159], v[44:47], v[128:131], a[156:159]
    ds_read_b64_tr_b16 v[38:39], v222 offset:14336
    v_accvgpr_read_b32 v163, a171
    s_waitcnt lgkmcnt(8)
    v_mfma_f32_16x16x32_bf16 a[128:131], v[16:19], v[100:103], a[128:131]
    ds_read_b64_tr_b16 v[40:41], v223 offset:12288
    v_cvt_pk_bf16_f32 v164, v156, v157
    v_mfma_f32_16x16x32_bf16 a[132:135], v[16:19], v[132:135], a[132:135]
    ds_read_b64_tr_b16 v[42:43], v223 offset:14336
    v_cvt_pk_bf16_f32 v165, v158, v159
    v_mfma_f32_16x16x32_bf16 a[136:139], v[20:23], v[100:103], a[136:139]
    ds_read_b64_tr_b16 v[44:45], v224 offset:12288
    v_cvt_pk_bf16_f32 v166, v160, v161
    v_mfma_f32_16x16x32_bf16 a[140:143], v[20:23], v[132:135], a[140:143]
    ds_read_b64_tr_b16 v[46:47], v224 offset:14336
    v_cvt_pk_bf16_f32 v167, v162, v163
    s_waitcnt lgkmcnt(8)
    v_mfma_f32_16x16x32_bf16 a[144:147], v[24:27], v[100:103], a[144:147]
    ds_read_b64_tr_b16 v[16:17], v221 offset:16384
    s_mov_b32 s6, 98304
    v_mfma_f32_16x16x32_bf16 a[148:151], v[24:27], v[132:135], a[148:151]
    ds_read_b64_tr_b16 v[18:19], v221 offset:18432
    buffer_store_dwordx4 v[164:167], v12, s[20:23], s6 offen sc1
    v_mfma_f32_16x16x32_bf16 a[152:155], v[28:31], v[100:103], a[152:155]
    ds_read_b64_tr_b16 v[20:21], v222 offset:16384
    v_accvgpr_read_b32 v168, a164
    v_mfma_f32_16x16x32_bf16 a[156:159], v[28:31], v[132:135], a[156:159]
    ds_read_b64_tr_b16 v[22:23], v222 offset:18432
    v_accvgpr_read_b32 v169, a165
    s_waitcnt lgkmcnt(8)
    v_mfma_f32_16x16x32_bf16 a[128:131], v[32:35], v[104:107], a[128:131]
    ds_read_b64_tr_b16 v[24:25], v223 offset:16384
    v_accvgpr_read_b32 v170, a166
    v_mfma_f32_16x16x32_bf16 a[132:135], v[32:35], v[136:139], a[132:135]
    ds_read_b64_tr_b16 v[26:27], v223 offset:18432
    v_accvgpr_read_b32 v171, a167
    v_mfma_f32_16x16x32_bf16 a[136:139], v[36:39], v[104:107], a[136:139]
    ds_read_b64_tr_b16 v[28:29], v224 offset:16384
    v_accvgpr_read_b32 v172, a172
    v_mfma_f32_16x16x32_bf16 a[140:143], v[36:39], v[136:139], a[140:143]
    ds_read_b64_tr_b16 v[30:31], v224 offset:18432
    v_accvgpr_read_b32 v173, a173
    s_waitcnt lgkmcnt(8)
    v_mfma_f32_16x16x32_bf16 a[144:147], v[40:43], v[104:107], a[144:147]
    ds_read_b64_tr_b16 v[32:33], v221 offset:20480
    v_accvgpr_read_b32 v174, a174
    v_mfma_f32_16x16x32_bf16 a[148:151], v[40:43], v[136:139], a[148:151]
    ds_read_b64_tr_b16 v[34:35], v221 offset:22528
    v_accvgpr_read_b32 v175, a175
    v_mfma_f32_16x16x32_bf16 a[152:155], v[44:47], v[104:107], a[152:155]
    ds_read_b64_tr_b16 v[36:37], v222 offset:20480
    v_cvt_pk_bf16_f32 v176, v168, v169
    v_mfma_f32_16x16x32_bf16 a[156:159], v[44:47], v[136:139], a[156:159]
    ds_read_b64_tr_b16 v[38:39], v222 offset:22528
    v_cvt_pk_bf16_f32 v177, v170, v171
    s_waitcnt lgkmcnt(8)
    v_mfma_f32_16x16x32_bf16 a[128:131], v[16:19], v[108:111], a[128:131]
    ds_read_b64_tr_b16 v[40:41], v223 offset:20480
    v_cvt_pk_bf16_f32 v178, v172, v173
    v_mfma_f32_16x16x32_bf16 a[132:135], v[16:19], v[140:143], a[132:135]
    ds_read_b64_tr_b16 v[42:43], v223 offset:22528
    v_cvt_pk_bf16_f32 v179, v174, v175
    v_mfma_f32_16x16x32_bf16 a[136:139], v[20:23], v[108:111], a[136:139]
    ds_read_b64_tr_b16 v[44:45], v224 offset:20480
    s_mov_b32 s6, 327680
    v_mfma_f32_16x16x32_bf16 a[140:143], v[20:23], v[140:143], a[140:143]
    ds_read_b64_tr_b16 v[46:47], v224 offset:22528
    buffer_store_dwordx4 v[176:179], v12, s[20:23], s6 offen sc1
    s_waitcnt lgkmcnt(8)
    v_mfma_f32_16x16x32_bf16 a[144:147], v[24:27], v[108:111], a[144:147]
    ds_read_b64_tr_b16 v[16:17], v221 offset:24576
    v_accvgpr_read_b32 v180, a176
    v_mfma_f32_16x16x32_bf16 a[148:151], v[24:27], v[140:143], a[148:151]
    ds_read_b64_tr_b16 v[18:19], v221 offset:26624
    v_accvgpr_read_b32 v181, a177
    v_mfma_f32_16x16x32_bf16 a[152:155], v[28:31], v[108:111], a[152:155]
    ds_read_b64_tr_b16 v[20:21], v222 offset:24576
    v_accvgpr_read_b32 v182, a178
    v_mfma_f32_16x16x32_bf16 a[156:159], v[28:31], v[140:143], a[156:159]
    ds_read_b64_tr_b16 v[22:23], v222 offset:26624
    v_accvgpr_read_b32 v183, a179
    s_waitcnt lgkmcnt(8)
    v_mfma_f32_16x16x32_bf16 a[128:131], v[32:35], v[112:115], a[128:131]
    ds_read_b64_tr_b16 v[24:25], v223 offset:24576
    v_accvgpr_read_b32 v184, a184
    v_mfma_f32_16x16x32_bf16 a[132:135], v[32:35], v[144:147], a[132:135]
    ds_read_b64_tr_b16 v[26:27], v223 offset:26624
    v_accvgpr_read_b32 v185, a185
    v_mfma_f32_16x16x32_bf16 a[136:139], v[36:39], v[112:115], a[136:139]
    ds_read_b64_tr_b16 v[28:29], v224 offset:24576
    v_accvgpr_read_b32 v186, a186
    v_mfma_f32_16x16x32_bf16 a[140:143], v[36:39], v[144:147], a[140:143]
    ds_read_b64_tr_b16 v[30:31], v224 offset:26624
    v_accvgpr_read_b32 v187, a187
    s_waitcnt lgkmcnt(8)
    v_mfma_f32_16x16x32_bf16 a[144:147], v[40:43], v[112:115], a[144:147]
    ds_read_b64_tr_b16 v[32:33], v221 offset:28672
    v_cvt_pk_bf16_f32 v188, v180, v181
    v_mfma_f32_16x16x32_bf16 a[148:151], v[40:43], v[144:147], a[148:151]
    ds_read_b64_tr_b16 v[34:35], v221 offset:30720
    v_cvt_pk_bf16_f32 v189, v182, v183
    v_mfma_f32_16x16x32_bf16 a[152:155], v[44:47], v[112:115], a[152:155]
    ds_read_b64_tr_b16 v[36:37], v222 offset:28672
    v_cvt_pk_bf16_f32 v190, v184, v185
    v_mfma_f32_16x16x32_bf16 a[156:159], v[44:47], v[144:147], a[156:159]
    ds_read_b64_tr_b16 v[38:39], v222 offset:30720
    v_cvt_pk_bf16_f32 v191, v186, v187
    s_waitcnt lgkmcnt(8)
    v_mfma_f32_16x16x32_bf16 a[128:131], v[16:19], v[116:119], a[128:131]
    ds_read_b64_tr_b16 v[40:41], v223 offset:28672
    s_mov_b32 s6, 114688
    v_mfma_f32_16x16x32_bf16 a[132:135], v[16:19], v[148:151], a[132:135]
    ds_read_b64_tr_b16 v[42:43], v223 offset:30720
    buffer_store_dwordx4 v[188:191], v12, s[20:23], s6 offen sc1
    v_mfma_f32_16x16x32_bf16 a[136:139], v[20:23], v[116:119], a[136:139]
    ds_read_b64_tr_b16 v[44:45], v224 offset:28672
    v_accvgpr_read_b32 v192, a180
    v_mfma_f32_16x16x32_bf16 a[140:143], v[20:23], v[148:151], a[140:143]
    ds_read_b64_tr_b16 v[46:47], v224 offset:30720
    v_accvgpr_read_b32 v193, a181
    s_waitcnt vmcnt(8) lgkmcnt(0)
    s_barrier
    v_add_u32 v221, 4294934528, v221
    v_add_u32 v222, 4294934528, v222
    v_add_u32 v223, 4294934528, v223
    v_add_u32 v224, 4294934528, v224
    s_waitcnt lgkmcnt(8)
    v_mfma_f32_16x16x32_bf16 a[144:147], v[24:27], v[116:119], a[144:147]
    ds_read_b64_tr_b16 v[16:17], v221 offset:0
    v_accvgpr_read_b32 v194, a182
    v_mfma_f32_16x16x32_bf16 a[148:151], v[24:27], v[148:151], a[148:151]
    ds_read_b64_tr_b16 v[18:19], v221 offset:2048
    v_accvgpr_read_b32 v195, a183
    v_mfma_f32_16x16x32_bf16 a[152:155], v[28:31], v[116:119], a[152:155]
    ds_read_b64_tr_b16 v[20:21], v222 offset:0
    v_accvgpr_read_b32 v196, a188
    v_mfma_f32_16x16x32_bf16 a[156:159], v[28:31], v[148:151], a[156:159]
    ds_read_b64_tr_b16 v[22:23], v222 offset:2048
    v_accvgpr_read_b32 v197, a189
    s_waitcnt lgkmcnt(8)
    v_mfma_f32_16x16x32_bf16 a[128:131], v[32:35], v[120:123], a[128:131]
    ds_read_b64_tr_b16 v[24:25], v223 offset:0
    v_accvgpr_read_b32 v198, a190
    v_mfma_f32_16x16x32_bf16 a[132:135], v[32:35], v[152:155], a[132:135]
    ds_read_b64_tr_b16 v[26:27], v223 offset:2048
    v_accvgpr_read_b32 v199, a191
    v_mfma_f32_16x16x32_bf16 a[136:139], v[36:39], v[120:123], a[136:139]
    ds_read_b64_tr_b16 v[28:29], v224 offset:0
    v_cvt_pk_bf16_f32 v200, v192, v193
    v_mfma_f32_16x16x32_bf16 a[140:143], v[36:39], v[152:155], a[140:143]
    ds_read_b64_tr_b16 v[30:31], v224 offset:2048
    v_cvt_pk_bf16_f32 v201, v194, v195
    s_waitcnt lgkmcnt(8)
    v_mfma_f32_16x16x32_bf16 a[144:147], v[40:43], v[120:123], a[144:147]
    ds_read_b64_tr_b16 v[32:33], v221 offset:4096
    v_cvt_pk_bf16_f32 v202, v196, v197
    v_mfma_f32_16x16x32_bf16 a[148:151], v[40:43], v[152:155], a[148:151]
    ds_read_b64_tr_b16 v[34:35], v221 offset:6144
    v_cvt_pk_bf16_f32 v203, v198, v199
    v_mfma_f32_16x16x32_bf16 a[152:155], v[44:47], v[120:123], a[152:155]
    ds_read_b64_tr_b16 v[36:37], v222 offset:4096
    s_mov_b32 s6, 344064
    v_mfma_f32_16x16x32_bf16 a[156:159], v[44:47], v[152:155], a[156:159]
    ds_read_b64_tr_b16 v[38:39], v222 offset:6144
    buffer_store_dwordx4 v[200:203], v12, s[20:23], s6 offen sc1
    s_waitcnt lgkmcnt(8)
    v_mfma_f32_16x16x32_bf16 a[160:163], v[16:19], v[92:95], 0
    ds_read_b64_tr_b16 v[40:41], v223 offset:4096
    v_mfma_f32_16x16x32_bf16 a[164:167], v[16:19], v[124:127], 0
    ds_read_b64_tr_b16 v[42:43], v223 offset:6144
    v_mfma_f32_16x16x32_bf16 a[168:171], v[20:23], v[92:95], 0
    ds_read_b64_tr_b16 v[44:45], v224 offset:4096
    v_mfma_f32_16x16x32_bf16 a[172:175], v[20:23], v[124:127], 0
    ds_read_b64_tr_b16 v[46:47], v224 offset:6144
    s_waitcnt lgkmcnt(8)
    v_mfma_f32_16x16x32_bf16 a[176:179], v[24:27], v[92:95], 0
    ds_read_b64_tr_b16 v[16:17], v221 offset:8192
    v_mfma_f32_16x16x32_bf16 a[180:183], v[24:27], v[124:127], 0
    ds_read_b64_tr_b16 v[18:19], v221 offset:10240
    v_mfma_f32_16x16x32_bf16 a[184:187], v[28:31], v[92:95], 0
    ds_read_b64_tr_b16 v[20:21], v222 offset:8192
    v_mfma_f32_16x16x32_bf16 a[188:191], v[28:31], v[124:127], 0
    ds_read_b64_tr_b16 v[22:23], v222 offset:10240
    s_waitcnt lgkmcnt(8)
    v_mfma_f32_16x16x32_bf16 a[160:163], v[32:35], v[96:99], a[160:163]
    ds_read_b64_tr_b16 v[24:25], v223 offset:8192
    v_accvgpr_read_b32 v156, a128
    v_mfma_f32_16x16x32_bf16 a[164:167], v[32:35], v[128:131], a[164:167]
    ds_read_b64_tr_b16 v[26:27], v223 offset:10240
    v_accvgpr_read_b32 v157, a129
    v_mfma_f32_16x16x32_bf16 a[168:171], v[36:39], v[96:99], a[168:171]
    ds_read_b64_tr_b16 v[28:29], v224 offset:8192
    v_accvgpr_read_b32 v158, a130
    v_mfma_f32_16x16x32_bf16 a[172:175], v[36:39], v[128:131], a[172:175]
    ds_read_b64_tr_b16 v[30:31], v224 offset:10240
    v_accvgpr_read_b32 v159, a131
    s_waitcnt lgkmcnt(8)
    v_mfma_f32_16x16x32_bf16 a[176:179], v[40:43], v[96:99], a[176:179]
    ds_read_b64_tr_b16 v[32:33], v221 offset:12288
    v_accvgpr_read_b32 v160, a136
    v_mfma_f32_16x16x32_bf16 a[180:183], v[40:43], v[128:131], a[180:183]
    ds_read_b64_tr_b16 v[34:35], v221 offset:14336
    v_accvgpr_read_b32 v161, a137
    v_mfma_f32_16x16x32_bf16 a[184:187], v[44:47], v[96:99], a[184:187]
    ds_read_b64_tr_b16 v[36:37], v222 offset:12288
    v_accvgpr_read_b32 v162, a138
    v_mfma_f32_16x16x32_bf16 a[188:191], v[44:47], v[128:131], a[188:191]
    ds_read_b64_tr_b16 v[38:39], v222 offset:14336
    v_accvgpr_read_b32 v163, a139
    s_waitcnt lgkmcnt(8)
    v_mfma_f32_16x16x32_bf16 a[160:163], v[16:19], v[100:103], a[160:163]
    ds_read_b64_tr_b16 v[40:41], v223 offset:12288
    v_cvt_pk_bf16_f32 v164, v156, v157
    v_mfma_f32_16x16x32_bf16 a[164:167], v[16:19], v[132:135], a[164:167]
    ds_read_b64_tr_b16 v[42:43], v223 offset:14336
    v_cvt_pk_bf16_f32 v165, v158, v159
    v_mfma_f32_16x16x32_bf16 a[168:171], v[20:23], v[100:103], a[168:171]
    ds_read_b64_tr_b16 v[44:45], v224 offset:12288
    v_cvt_pk_bf16_f32 v166, v160, v161
    v_mfma_f32_16x16x32_bf16 a[172:175], v[20:23], v[132:135], a[172:175]
    ds_read_b64_tr_b16 v[46:47], v224 offset:14336
    v_cvt_pk_bf16_f32 v167, v162, v163
    s_waitcnt lgkmcnt(8)
    v_mfma_f32_16x16x32_bf16 a[176:179], v[24:27], v[100:103], a[176:179]
    ds_read_b64_tr_b16 v[16:17], v221 offset:16384
    s_mov_b32 s6, 131072
    v_mfma_f32_16x16x32_bf16 a[180:183], v[24:27], v[132:135], a[180:183]
    ds_read_b64_tr_b16 v[18:19], v221 offset:18432
    buffer_store_dwordx4 v[164:167], v12, s[20:23], s6 offen sc1
    v_mfma_f32_16x16x32_bf16 a[184:187], v[28:31], v[100:103], a[184:187]
    ds_read_b64_tr_b16 v[20:21], v222 offset:16384
    v_accvgpr_read_b32 v168, a132
    v_mfma_f32_16x16x32_bf16 a[188:191], v[28:31], v[132:135], a[188:191]
    ds_read_b64_tr_b16 v[22:23], v222 offset:18432
    v_accvgpr_read_b32 v169, a133
    s_waitcnt lgkmcnt(8)
    v_mfma_f32_16x16x32_bf16 a[160:163], v[32:35], v[104:107], a[160:163]
    ds_read_b64_tr_b16 v[24:25], v223 offset:16384
    v_accvgpr_read_b32 v170, a134
    v_mfma_f32_16x16x32_bf16 a[164:167], v[32:35], v[136:139], a[164:167]
    ds_read_b64_tr_b16 v[26:27], v223 offset:18432
    v_accvgpr_read_b32 v171, a135
    v_mfma_f32_16x16x32_bf16 a[168:171], v[36:39], v[104:107], a[168:171]
    ds_read_b64_tr_b16 v[28:29], v224 offset:16384
    v_accvgpr_read_b32 v172, a140
    v_mfma_f32_16x16x32_bf16 a[172:175], v[36:39], v[136:139], a[172:175]
    ds_read_b64_tr_b16 v[30:31], v224 offset:18432
    v_accvgpr_read_b32 v173, a141
    s_waitcnt lgkmcnt(8)
    v_mfma_f32_16x16x32_bf16 a[176:179], v[40:43], v[104:107], a[176:179]
    ds_read_b64_tr_b16 v[32:33], v221 offset:20480
    v_accvgpr_read_b32 v174, a142
    v_mfma_f32_16x16x32_bf16 a[180:183], v[40:43], v[136:139], a[180:183]
    ds_read_b64_tr_b16 v[34:35], v221 offset:22528
    v_accvgpr_read_b32 v175, a143
    v_mfma_f32_16x16x32_bf16 a[184:187], v[44:47], v[104:107], a[184:187]
    ds_read_b64_tr_b16 v[36:37], v222 offset:20480
    v_cvt_pk_bf16_f32 v176, v168, v169
    v_mfma_f32_16x16x32_bf16 a[188:191], v[44:47], v[136:139], a[188:191]
    ds_read_b64_tr_b16 v[38:39], v222 offset:22528
    v_cvt_pk_bf16_f32 v177, v170, v171
    s_waitcnt lgkmcnt(8)
    v_mfma_f32_16x16x32_bf16 a[160:163], v[16:19], v[108:111], a[160:163]
    ds_read_b64_tr_b16 v[40:41], v223 offset:20480
    v_cvt_pk_bf16_f32 v178, v172, v173
    v_mfma_f32_16x16x32_bf16 a[164:167], v[16:19], v[140:143], a[164:167]
    ds_read_b64_tr_b16 v[42:43], v223 offset:22528
    v_cvt_pk_bf16_f32 v179, v174, v175
    v_mfma_f32_16x16x32_bf16 a[168:171], v[20:23], v[108:111], a[168:171]
    ds_read_b64_tr_b16 v[44:45], v224 offset:20480
    s_mov_b32 s6, 360448
    v_mfma_f32_16x16x32_bf16 a[172:175], v[20:23], v[140:143], a[172:175]
    ds_read_b64_tr_b16 v[46:47], v224 offset:22528
    buffer_store_dwordx4 v[176:179], v12, s[20:23], s6 offen sc1
    s_waitcnt lgkmcnt(8)
    v_mfma_f32_16x16x32_bf16 a[176:179], v[24:27], v[108:111], a[176:179]
    ds_read_b64_tr_b16 v[16:17], v221 offset:24576
    v_accvgpr_read_b32 v180, a144
    v_mfma_f32_16x16x32_bf16 a[180:183], v[24:27], v[140:143], a[180:183]
    ds_read_b64_tr_b16 v[18:19], v221 offset:26624
    v_accvgpr_read_b32 v181, a145
    v_mfma_f32_16x16x32_bf16 a[184:187], v[28:31], v[108:111], a[184:187]
    ds_read_b64_tr_b16 v[20:21], v222 offset:24576
    v_accvgpr_read_b32 v182, a146
    v_mfma_f32_16x16x32_bf16 a[188:191], v[28:31], v[140:143], a[188:191]
    ds_read_b64_tr_b16 v[22:23], v222 offset:26624
    v_accvgpr_read_b32 v183, a147
    s_waitcnt lgkmcnt(8)
    v_mfma_f32_16x16x32_bf16 a[160:163], v[32:35], v[112:115], a[160:163]
    ds_read_b64_tr_b16 v[24:25], v223 offset:24576
    v_accvgpr_read_b32 v184, a152
    v_mfma_f32_16x16x32_bf16 a[164:167], v[32:35], v[144:147], a[164:167]
    ds_read_b64_tr_b16 v[26:27], v223 offset:26624
    v_accvgpr_read_b32 v185, a153
    v_mfma_f32_16x16x32_bf16 a[168:171], v[36:39], v[112:115], a[168:171]
    ds_read_b64_tr_b16 v[28:29], v224 offset:24576
    v_accvgpr_read_b32 v186, a154
    v_mfma_f32_16x16x32_bf16 a[172:175], v[36:39], v[144:147], a[172:175]
    ds_read_b64_tr_b16 v[30:31], v224 offset:26624
    v_accvgpr_read_b32 v187, a155
    s_waitcnt lgkmcnt(8)
    v_mfma_f32_16x16x32_bf16 a[176:179], v[40:43], v[112:115], a[176:179]
    ds_read_b64_tr_b16 v[32:33], v221 offset:28672
    v_cvt_pk_bf16_f32 v188, v180, v181
    v_mfma_f32_16x16x32_bf16 a[180:183], v[40:43], v[144:147], a[180:183]
    ds_read_b64_tr_b16 v[34:35], v221 offset:30720
    v_cvt_pk_bf16_f32 v189, v182, v183
    v_mfma_f32_16x16x32_bf16 a[184:187], v[44:47], v[112:115], a[184:187]
    ds_read_b64_tr_b16 v[36:37], v222 offset:28672
    v_cvt_pk_bf16_f32 v190, v184, v185
    v_mfma_f32_16x16x32_bf16 a[188:191], v[44:47], v[144:147], a[188:191]
    ds_read_b64_tr_b16 v[38:39], v222 offset:30720
    v_cvt_pk_bf16_f32 v191, v186, v187
    s_waitcnt lgkmcnt(8)
    v_mfma_f32_16x16x32_bf16 a[160:163], v[16:19], v[116:119], a[160:163]
    ds_read_b64_tr_b16 v[40:41], v223 offset:28672
    s_mov_b32 s6, 147456
    v_mfma_f32_16x16x32_bf16 a[164:167], v[16:19], v[148:151], a[164:167]
    ds_read_b64_tr_b16 v[42:43], v223 offset:30720
    buffer_store_dwordx4 v[188:191], v12, s[20:23], s6 offen sc1
    v_mfma_f32_16x16x32_bf16 a[168:171], v[20:23], v[116:119], a[168:171]
    ds_read_b64_tr_b16 v[44:45], v224 offset:28672
    v_accvgpr_read_b32 v192, a148
    v_mfma_f32_16x16x32_bf16 a[172:175], v[20:23], v[148:151], a[172:175]
    ds_read_b64_tr_b16 v[46:47], v224 offset:30720
    v_accvgpr_read_b32 v193, a149
    v_add_u32 v221, 4294934528, v221
    v_add_u32 v222, 4294934528, v222
    v_add_u32 v223, 4294934528, v223
    v_add_u32 v224, 4294934528, v224
    s_waitcnt lgkmcnt(8)
    v_mfma_f32_16x16x32_bf16 a[176:179], v[24:27], v[116:119], a[176:179]
    ds_read_b64_tr_b16 v[16:17], v221 offset:0
    v_accvgpr_read_b32 v194, a150
    v_mfma_f32_16x16x32_bf16 a[180:183], v[24:27], v[148:151], a[180:183]
    ds_read_b64_tr_b16 v[18:19], v221 offset:2048
    v_accvgpr_read_b32 v195, a151
    v_mfma_f32_16x16x32_bf16 a[184:187], v[28:31], v[116:119], a[184:187]
    ds_read_b64_tr_b16 v[20:21], v222 offset:0
    v_accvgpr_read_b32 v196, a156
    v_mfma_f32_16x16x32_bf16 a[188:191], v[28:31], v[148:151], a[188:191]
    ds_read_b64_tr_b16 v[22:23], v222 offset:2048
    v_accvgpr_read_b32 v197, a157
    s_waitcnt lgkmcnt(8)
    v_mfma_f32_16x16x32_bf16 a[160:163], v[32:35], v[120:123], a[160:163]
    ds_read_b64_tr_b16 v[24:25], v223 offset:0
    v_accvgpr_read_b32 v198, a158
    v_mfma_f32_16x16x32_bf16 a[164:167], v[32:35], v[152:155], a[164:167]
    ds_read_b64_tr_b16 v[26:27], v223 offset:2048
    v_accvgpr_read_b32 v199, a159
    v_mfma_f32_16x16x32_bf16 a[168:171], v[36:39], v[120:123], a[168:171]
    ds_read_b64_tr_b16 v[28:29], v224 offset:0
    v_cvt_pk_bf16_f32 v200, v192, v193
    v_mfma_f32_16x16x32_bf16 a[172:175], v[36:39], v[152:155], a[172:175]
    ds_read_b64_tr_b16 v[30:31], v224 offset:2048
    v_cvt_pk_bf16_f32 v201, v194, v195
    s_waitcnt lgkmcnt(8)
    v_mfma_f32_16x16x32_bf16 a[176:179], v[40:43], v[120:123], a[176:179]
    ds_read_b64_tr_b16 v[32:33], v221 offset:4096
    v_cvt_pk_bf16_f32 v202, v196, v197
    v_mfma_f32_16x16x32_bf16 a[180:183], v[40:43], v[152:155], a[180:183]
    ds_read_b64_tr_b16 v[34:35], v221 offset:6144
    v_cvt_pk_bf16_f32 v203, v198, v199
    v_mfma_f32_16x16x32_bf16 a[184:187], v[44:47], v[120:123], a[184:187]
    ds_read_b64_tr_b16 v[36:37], v222 offset:4096
    s_mov_b32 s6, 376832
    v_mfma_f32_16x16x32_bf16 a[188:191], v[44:47], v[152:155], a[188:191]
    ds_read_b64_tr_b16 v[38:39], v222 offset:6144
    buffer_store_dwordx4 v[200:203], v12, s[20:23], s6 offen sc1
    s_waitcnt lgkmcnt(8)
    v_mfma_f32_16x16x32_bf16 a[128:131], v[16:19], v[92:95], 0
    ds_read_b64_tr_b16 v[40:41], v223 offset:4096
    v_mfma_f32_16x16x32_bf16 a[132:135], v[16:19], v[124:127], 0
    ds_read_b64_tr_b16 v[42:43], v223 offset:6144
    v_mfma_f32_16x16x32_bf16 a[136:139], v[20:23], v[92:95], 0
    ds_read_b64_tr_b16 v[44:45], v224 offset:4096
    v_mfma_f32_16x16x32_bf16 a[140:143], v[20:23], v[124:127], 0
    ds_read_b64_tr_b16 v[46:47], v224 offset:6144
    s_waitcnt lgkmcnt(8)
    v_mfma_f32_16x16x32_bf16 a[144:147], v[24:27], v[92:95], 0
    ds_read_b64_tr_b16 v[16:17], v221 offset:8192
    v_mfma_f32_16x16x32_bf16 a[148:151], v[24:27], v[124:127], 0
    ds_read_b64_tr_b16 v[18:19], v221 offset:10240
    v_mfma_f32_16x16x32_bf16 a[152:155], v[28:31], v[92:95], 0
    ds_read_b64_tr_b16 v[20:21], v222 offset:8192
    v_mfma_f32_16x16x32_bf16 a[156:159], v[28:31], v[124:127], 0
    ds_read_b64_tr_b16 v[22:23], v222 offset:10240
    s_waitcnt lgkmcnt(8)
    v_mfma_f32_16x16x32_bf16 a[128:131], v[32:35], v[96:99], a[128:131]
    ds_read_b64_tr_b16 v[24:25], v223 offset:8192
    v_accvgpr_read_b32 v156, a160
    v_mfma_f32_16x16x32_bf16 a[132:135], v[32:35], v[128:131], a[132:135]
    ds_read_b64_tr_b16 v[26:27], v223 offset:10240
    v_accvgpr_read_b32 v157, a161
    v_mfma_f32_16x16x32_bf16 a[136:139], v[36:39], v[96:99], a[136:139]
    ds_read_b64_tr_b16 v[28:29], v224 offset:8192
    v_accvgpr_read_b32 v158, a162
    v_mfma_f32_16x16x32_bf16 a[140:143], v[36:39], v[128:131], a[140:143]
    ds_read_b64_tr_b16 v[30:31], v224 offset:10240
    v_accvgpr_read_b32 v159, a163
    s_waitcnt lgkmcnt(8)
    v_mfma_f32_16x16x32_bf16 a[144:147], v[40:43], v[96:99], a[144:147]
    ds_read_b64_tr_b16 v[32:33], v221 offset:12288
    v_accvgpr_read_b32 v160, a168
    v_mfma_f32_16x16x32_bf16 a[148:151], v[40:43], v[128:131], a[148:151]
    ds_read_b64_tr_b16 v[34:35], v221 offset:14336
    v_accvgpr_read_b32 v161, a169
    v_mfma_f32_16x16x32_bf16 a[152:155], v[44:47], v[96:99], a[152:155]
    ds_read_b64_tr_b16 v[36:37], v222 offset:12288
    v_accvgpr_read_b32 v162, a170
    v_mfma_f32_16x16x32_bf16 a[156:159], v[44:47], v[128:131], a[156:159]
    ds_read_b64_tr_b16 v[38:39], v222 offset:14336
    v_accvgpr_read_b32 v163, a171
    s_waitcnt lgkmcnt(8)
    v_mfma_f32_16x16x32_bf16 a[128:131], v[16:19], v[100:103], a[128:131]
    ds_read_b64_tr_b16 v[40:41], v223 offset:12288
    v_cvt_pk_bf16_f32 v164, v156, v157
    v_mfma_f32_16x16x32_bf16 a[132:135], v[16:19], v[132:135], a[132:135]
    ds_read_b64_tr_b16 v[42:43], v223 offset:14336
    v_cvt_pk_bf16_f32 v165, v158, v159
    v_mfma_f32_16x16x32_bf16 a[136:139], v[20:23], v[100:103], a[136:139]
    ds_read_b64_tr_b16 v[44:45], v224 offset:12288
    v_cvt_pk_bf16_f32 v166, v160, v161
    v_mfma_f32_16x16x32_bf16 a[140:143], v[20:23], v[132:135], a[140:143]
    ds_read_b64_tr_b16 v[46:47], v224 offset:14336
    v_cvt_pk_bf16_f32 v167, v162, v163
    s_waitcnt lgkmcnt(8)
    v_mfma_f32_16x16x32_bf16 a[144:147], v[24:27], v[100:103], a[144:147]
    ds_read_b64_tr_b16 v[16:17], v221 offset:16384
    s_mov_b32 s6, 163840
    v_mfma_f32_16x16x32_bf16 a[148:151], v[24:27], v[132:135], a[148:151]
    ds_read_b64_tr_b16 v[18:19], v221 offset:18432
    buffer_store_dwordx4 v[164:167], v12, s[20:23], s6 offen sc1
    v_mfma_f32_16x16x32_bf16 a[152:155], v[28:31], v[100:103], a[152:155]
    ds_read_b64_tr_b16 v[20:21], v222 offset:16384
    v_accvgpr_read_b32 v168, a164
    v_mfma_f32_16x16x32_bf16 a[156:159], v[28:31], v[132:135], a[156:159]
    ds_read_b64_tr_b16 v[22:23], v222 offset:18432
    v_accvgpr_read_b32 v169, a165
    s_waitcnt lgkmcnt(8)
    v_mfma_f32_16x16x32_bf16 a[128:131], v[32:35], v[104:107], a[128:131]
    ds_read_b64_tr_b16 v[24:25], v223 offset:16384
    v_accvgpr_read_b32 v170, a166
    v_mfma_f32_16x16x32_bf16 a[132:135], v[32:35], v[136:139], a[132:135]
    ds_read_b64_tr_b16 v[26:27], v223 offset:18432
    v_accvgpr_read_b32 v171, a167
    v_mfma_f32_16x16x32_bf16 a[136:139], v[36:39], v[104:107], a[136:139]
    ds_read_b64_tr_b16 v[28:29], v224 offset:16384
    v_accvgpr_read_b32 v172, a172
    v_mfma_f32_16x16x32_bf16 a[140:143], v[36:39], v[136:139], a[140:143]
    ds_read_b64_tr_b16 v[30:31], v224 offset:18432
    v_accvgpr_read_b32 v173, a173
    s_waitcnt lgkmcnt(8)
    v_mfma_f32_16x16x32_bf16 a[144:147], v[40:43], v[104:107], a[144:147]
    ds_read_b64_tr_b16 v[32:33], v221 offset:20480
    v_accvgpr_read_b32 v174, a174
    v_mfma_f32_16x16x32_bf16 a[148:151], v[40:43], v[136:139], a[148:151]
    ds_read_b64_tr_b16 v[34:35], v221 offset:22528
    v_accvgpr_read_b32 v175, a175
    v_mfma_f32_16x16x32_bf16 a[152:155], v[44:47], v[104:107], a[152:155]
    ds_read_b64_tr_b16 v[36:37], v222 offset:20480
    v_cvt_pk_bf16_f32 v176, v168, v169
    v_mfma_f32_16x16x32_bf16 a[156:159], v[44:47], v[136:139], a[156:159]
    ds_read_b64_tr_b16 v[38:39], v222 offset:22528
    v_cvt_pk_bf16_f32 v177, v170, v171
    s_waitcnt lgkmcnt(8)
    v_mfma_f32_16x16x32_bf16 a[128:131], v[16:19], v[108:111], a[128:131]
    ds_read_b64_tr_b16 v[40:41], v223 offset:20480
    v_cvt_pk_bf16_f32 v178, v172, v173
    v_mfma_f32_16x16x32_bf16 a[132:135], v[16:19], v[140:143], a[132:135]
    ds_read_b64_tr_b16 v[42:43], v223 offset:22528
    v_cvt_pk_bf16_f32 v179, v174, v175
    v_mfma_f32_16x16x32_bf16 a[136:139], v[20:23], v[108:111], a[136:139]
    ds_read_b64_tr_b16 v[44:45], v224 offset:20480
    s_mov_b32 s6, 393216
    v_mfma_f32_16x16x32_bf16 a[140:143], v[20:23], v[140:143], a[140:143]
    ds_read_b64_tr_b16 v[46:47], v224 offset:22528
    buffer_store_dwordx4 v[176:179], v12, s[20:23], s6 offen sc1
    s_waitcnt lgkmcnt(8)
    v_mfma_f32_16x16x32_bf16 a[144:147], v[24:27], v[108:111], a[144:147]
    ds_read_b64_tr_b16 v[16:17], v221 offset:24576
    v_accvgpr_read_b32 v180, a176
    v_mfma_f32_16x16x32_bf16 a[148:151], v[24:27], v[140:143], a[148:151]
    ds_read_b64_tr_b16 v[18:19], v221 offset:26624
    v_accvgpr_read_b32 v181, a177
    v_mfma_f32_16x16x32_bf16 a[152:155], v[28:31], v[108:111], a[152:155]
    ds_read_b64_tr_b16 v[20:21], v222 offset:24576
    v_accvgpr_read_b32 v182, a178
    v_mfma_f32_16x16x32_bf16 a[156:159], v[28:31], v[140:143], a[156:159]
    ds_read_b64_tr_b16 v[22:23], v222 offset:26624
    v_accvgpr_read_b32 v183, a179
    s_waitcnt lgkmcnt(8)
    v_mfma_f32_16x16x32_bf16 a[128:131], v[32:35], v[112:115], a[128:131]
    ds_read_b64_tr_b16 v[24:25], v223 offset:24576
    v_accvgpr_read_b32 v184, a184
    v_mfma_f32_16x16x32_bf16 a[132:135], v[32:35], v[144:147], a[132:135]
    ds_read_b64_tr_b16 v[26:27], v223 offset:26624
    v_accvgpr_read_b32 v185, a185
    v_mfma_f32_16x16x32_bf16 a[136:139], v[36:39], v[112:115], a[136:139]
    ds_read_b64_tr_b16 v[28:29], v224 offset:24576
    v_accvgpr_read_b32 v186, a186
    v_mfma_f32_16x16x32_bf16 a[140:143], v[36:39], v[144:147], a[140:143]
    ds_read_b64_tr_b16 v[30:31], v224 offset:26624
    v_accvgpr_read_b32 v187, a187
    s_waitcnt lgkmcnt(8)
    v_mfma_f32_16x16x32_bf16 a[144:147], v[40:43], v[112:115], a[144:147]
    ds_read_b64_tr_b16 v[32:33], v221 offset:28672
    v_cvt_pk_bf16_f32 v188, v180, v181
    v_mfma_f32_16x16x32_bf16 a[148:151], v[40:43], v[144:147], a[148:151]
    ds_read_b64_tr_b16 v[34:35], v221 offset:30720
    v_cvt_pk_bf16_f32 v189, v182, v183
    v_mfma_f32_16x16x32_bf16 a[152:155], v[44:47], v[112:115], a[152:155]
    ds_read_b64_tr_b16 v[36:37], v222 offset:28672
    v_cvt_pk_bf16_f32 v190, v184, v185
    v_mfma_f32_16x16x32_bf16 a[156:159], v[44:47], v[144:147], a[156:159]
    ds_read_b64_tr_b16 v[38:39], v222 offset:30720
    v_cvt_pk_bf16_f32 v191, v186, v187
    s_waitcnt lgkmcnt(8)
    v_mfma_f32_16x16x32_bf16 a[128:131], v[16:19], v[116:119], a[128:131]
    ds_read_b64_tr_b16 v[40:41], v223 offset:28672
    s_mov_b32 s6, 180224
    v_mfma_f32_16x16x32_bf16 a[132:135], v[16:19], v[148:151], a[132:135]
    ds_read_b64_tr_b16 v[42:43], v223 offset:30720
    buffer_store_dwordx4 v[188:191], v12, s[20:23], s6 offen sc1
    v_mfma_f32_16x16x32_bf16 a[136:139], v[20:23], v[116:119], a[136:139]
    ds_read_b64_tr_b16 v[44:45], v224 offset:28672
    v_accvgpr_read_b32 v192, a180
    v_mfma_f32_16x16x32_bf16 a[140:143], v[20:23], v[148:151], a[140:143]
    ds_read_b64_tr_b16 v[46:47], v224 offset:30720
    v_accvgpr_read_b32 v193, a181
    s_waitcnt lgkmcnt(8)
    v_mfma_f32_16x16x32_bf16 a[144:147], v[24:27], v[116:119], a[144:147]
    v_accvgpr_read_b32 v194, a182
    v_mfma_f32_16x16x32_bf16 a[148:151], v[24:27], v[148:151], a[148:151]
    v_accvgpr_read_b32 v195, a183
    v_mfma_f32_16x16x32_bf16 a[152:155], v[28:31], v[116:119], a[152:155]
    v_accvgpr_read_b32 v196, a188
    v_mfma_f32_16x16x32_bf16 a[156:159], v[28:31], v[148:151], a[156:159]
    v_accvgpr_read_b32 v197, a189
    s_waitcnt lgkmcnt(4)
    v_mfma_f32_16x16x32_bf16 a[128:131], v[32:35], v[120:123], a[128:131]
    v_accvgpr_read_b32 v198, a190
    v_mfma_f32_16x16x32_bf16 a[132:135], v[32:35], v[152:155], a[132:135]
    v_accvgpr_read_b32 v199, a191
    v_mfma_f32_16x16x32_bf16 a[136:139], v[36:39], v[120:123], a[136:139]
    v_cvt_pk_bf16_f32 v200, v192, v193
    v_mfma_f32_16x16x32_bf16 a[140:143], v[36:39], v[152:155], a[140:143]
    v_cvt_pk_bf16_f32 v201, v194, v195
    s_waitcnt lgkmcnt(0)
    v_mfma_f32_16x16x32_bf16 a[144:147], v[40:43], v[120:123], a[144:147]
    v_cvt_pk_bf16_f32 v202, v196, v197
    v_mfma_f32_16x16x32_bf16 a[148:151], v[40:43], v[152:155], a[148:151]
    v_cvt_pk_bf16_f32 v203, v198, v199
    v_mfma_f32_16x16x32_bf16 a[152:155], v[44:47], v[120:123], a[152:155]
    s_mov_b32 s6, 409600
    v_mfma_f32_16x16x32_bf16 a[156:159], v[44:47], v[152:155], a[156:159]
    buffer_store_dwordx4 v[200:203], v12, s[20:23], s6 offen sc1
    s_nop 7
    v_accvgpr_read_b32 v156, a128
    v_accvgpr_read_b32 v157, a129
    v_accvgpr_read_b32 v158, a130
    v_accvgpr_read_b32 v159, a131
    v_accvgpr_read_b32 v160, a136
    v_accvgpr_read_b32 v161, a137
    v_accvgpr_read_b32 v162, a138
    v_accvgpr_read_b32 v163, a139
    v_cvt_pk_bf16_f32 v164, v156, v157
    v_cvt_pk_bf16_f32 v165, v158, v159
    v_cvt_pk_bf16_f32 v166, v160, v161
    v_cvt_pk_bf16_f32 v167, v162, v163
    s_mov_b32 s6, 196608
    buffer_store_dwordx4 v[164:167], v12, s[20:23], s6 offen sc1
    v_accvgpr_read_b32 v168, a132
    v_accvgpr_read_b32 v169, a133
    v_accvgpr_read_b32 v170, a134
    v_accvgpr_read_b32 v171, a135
    v_accvgpr_read_b32 v172, a140
    v_accvgpr_read_b32 v173, a141
    v_accvgpr_read_b32 v174, a142
    v_accvgpr_read_b32 v175, a143
    v_cvt_pk_bf16_f32 v176, v168, v169
    v_cvt_pk_bf16_f32 v177, v170, v171
    v_cvt_pk_bf16_f32 v178, v172, v173
    v_cvt_pk_bf16_f32 v179, v174, v175
    s_mov_b32 s6, 425984
    buffer_store_dwordx4 v[176:179], v12, s[20:23], s6 offen sc1
    v_accvgpr_read_b32 v180, a144
    v_accvgpr_read_b32 v181, a145
    v_accvgpr_read_b32 v182, a146
    v_accvgpr_read_b32 v183, a147
    v_accvgpr_read_b32 v184, a152
    v_accvgpr_read_b32 v185, a153
    v_accvgpr_read_b32 v186, a154
    v_accvgpr_read_b32 v187, a155
    v_cvt_pk_bf16_f32 v188, v180, v181
    v_cvt_pk_bf16_f32 v189, v182, v183
    v_cvt_pk_bf16_f32 v190, v184, v185
    v_cvt_pk_bf16_f32 v191, v186, v187
    s_mov_b32 s6, 212992
    buffer_store_dwordx4 v[188:191], v12, s[20:23], s6 offen sc1
    v_accvgpr_read_b32 v192, a148
    v_accvgpr_read_b32 v193, a149
    v_accvgpr_read_b32 v194, a150
    v_accvgpr_read_b32 v195, a151
    v_accvgpr_read_b32 v196, a156
    v_accvgpr_read_b32 v197, a157
    v_accvgpr_read_b32 v198, a158
    v_accvgpr_read_b32 v199, a159
    v_cvt_pk_bf16_f32 v200, v192, v193
    v_cvt_pk_bf16_f32 v201, v194, v195
    v_cvt_pk_bf16_f32 v202, v196, v197
    v_cvt_pk_bf16_f32 v203, v198, v199
    s_mov_b32 s6, 442368
    buffer_store_dwordx4 v[200:203], v12, s[20:23], s6 offen sc1
    s_endpgm
L_attn_merge:
    s_cmp_lg_u32 s77, 0
    s_cbranch_scc1 L_attn_havep
L_attn_poll:
    buffer_load_ushort v2, v255, s[28:31], 0 offen sc1
    s_waitcnt vmcnt(0)
    v_readfirstlane_b32 s6, v2
    s_nop 3
    s_cmp_eq_u32 s6, 0
    s_cbranch_scc1 L_attn_poll
    s_mov_b32 s6, 16384
    buffer_load_dwordx4 v[232:235], v12, s[24:27], s6 offen sc1
    s_mov_b32 s6, 0
    buffer_load_dwordx4 v[156:159], v12, s[24:27], s6 offen offset:0 sc1
    buffer_load_dwordx4 v[160:163], v12, s[24:27], s6 offen offset:1024 sc1
    buffer_load_dwordx4 v[164:167], v12, s[24:27], s6 offen offset:2048 sc1
    buffer_load_dwordx4 v[168:171], v12, s[24:27], s6 offen offset:3072 sc1
    s_mov_b32 s6, 4096
    buffer_load_dwordx4 v[172:175], v12, s[24:27], s6 offen offset:0 sc1
    buffer_load_dwordx4 v[176:179], v12, s[24:27], s6 offen offset:1024 sc1
    buffer_load_dwordx4 v[180:183], v12, s[24:27], s6 offen offset:2048 sc1
    buffer_load_dwordx4 v[184:187], v12, s[24:27], s6 offen offset:3072 sc1
    s_mov_b32 s6, 8192
    buffer_load_dwordx4 v[188:191], v12, s[24:27], s6 offen offset:0 sc1
    buffer_load_dwordx4 v[192:195], v12, s[24:27], s6 offen offset:1024 sc1
    buffer_load_dwordx4 v[196:199], v12, s[24:27], s6 offen offset:2048 sc1
    buffer_load_dwordx4 v[200:203], v12, s[24:27], s6 offen offset:3072 sc1
    s_mov_b32 s6, 12288
    buffer_load_dwordx4 v[204:207], v12, s[24:27], s6 offen offset:0 sc1
    buffer_load_dwordx4 v[208:211], v12, s[24:27], s6 offen offset:1024 sc1
    buffer_load_dwordx4 v[212:215], v12, s[24:27], s6 offen offset:2048 sc1
    buffer_load_dwordx4 v[216:219], v12, s[24:27], s6 offen offset:3072 sc1
    s_waitcnt vmcnt(0)
L_attn_havep:
    v_min_f32 v2, v72, v232
    v_sub_f32 v3, v2, v72
    v_sub_f32 v4, v2, v232
    v_exp_f32 v3, v3
    v_exp_f32 v4, v4
    s_nop 0
    v_mul_f32 v2, v3, v80
    v_fmac_f32 v2, v4, v234
    v_rcp_f32 v2, v2
    s_nop 0
    v_mul_f32 v236, v3, v2
    v_mul_f32 v238, v4, v2
    v_min_f32 v2, v76, v233
    v_sub_f32 v3, v2, v76
    v_sub_f32 v4, v2, v233
    v_exp_f32 v3, v3
    v_exp_f32 v4, v4
    s_nop 0
    v_mul_f32 v2, v3, v84
    v_fmac_f32 v2, v4, v235
    v_rcp_f32 v2, v2
    s_nop 0
    v_mul_f32 v237, v3, v2
    v_mul_f32_e64 v239, v4, v2
    v_accvgpr_read_b32 v240, a0
    v_accvgpr_read_b32 v241, a1
    v_accvgpr_read_b32 v242, a2
    v_accvgpr_read_b32 v243, a3
    v_accvgpr_read_b32 v244, a8
    v_accvgpr_read_b32 v245, a9
    v_accvgpr_read_b32 v246, a10
    v_accvgpr_read_b32 v247, a11
    v_mul_f32 v240, v240, v236
    v_mul_f32 v241, v241, v236
    v_mul_f32 v242, v242, v236
    v_mul_f32 v243, v243, v236
    v_mul_f32 v244, v244, v236
    v_mul_f32 v245, v245, v236
    v_mul_f32 v246, v246, v236
    v_mul_f32 v247, v247, v236
    v_lshlrev_b32_e64 v48, 16, v156
    v_and_b32 v49, 0xffff0000, v156
    v_lshlrev_b32_e64 v50, 16, v157
    v_and_b32 v51, 0xffff0000, v157
    v_fmac_f32 v240, v48, v238
    v_fmac_f32 v241, v49, v238
    v_fmac_f32 v242, v50, v238
    v_fmac_f32 v243, v51, v238
    v_lshlrev_b32_e64 v48, 16, v160
    v_and_b32 v49, 0xffff0000, v160
    v_lshlrev_b32_e64 v50, 16, v161
    v_and_b32 v51, 0xffff0000, v161
    v_fmac_f32 v244, v48, v238
    v_fmac_f32 v245, v49, v238
    v_fmac_f32 v246, v50, v238
    v_fmac_f32 v247, v51, v238
    v_cvt_pk_bf16_f32 v92, v240, v241
    v_cvt_pk_bf16_f32 v93, v242, v243
    v_cvt_pk_bf16_f32 v94, v244, v245
    v_cvt_pk_bf16_f32 v95, v246, v247
    v_accvgpr_read_b32 v248, a4
    v_accvgpr_read_b32 v249, a5
    v_accvgpr_read_b32 v250, a6
    v_accvgpr_read_b32 v251, a7
    v_accvgpr_read_b32 v252, a12
    v_accvgpr_read_b32 v253, a13
    v_accvgpr_read_b32 v254, a14
    v_accvgpr_read_b32 v255, a15
    v_mul_f32 v248, v248, v237
    v_mul_f32 v249, v249, v237
    v_mul_f32 v250, v250, v237
    v_mul_f32 v251, v251, v237
    v_mul_f32 v252, v252, v237
    v_mul_f32 v253, v253, v237
    v_mul_f32 v254, v254, v237
    v_mul_f32 v255, v255, v237
    v_lshlrev_b32_e64 v48, 16, v158
    v_and_b32 v49, 0xffff0000, v158
    v_lshlrev_b32_e64 v50, 16, v159
    v_and_b32 v51, 0xffff0000, v159
    v_fmac_f32 v248, v48, v239
    v_fmac_f32 v249, v49, v239
    v_fmac_f32 v250, v50, v239
    v_fmac_f32 v251, v51, v239
    v_lshlrev_b32_e64 v48, 16, v162
    v_and_b32 v49, 0xffff0000, v162
    v_lshlrev_b32_e64 v50, 16, v163
    v_and_b32 v51, 0xffff0000, v163
    v_fmac_f32 v252, v48, v239
    v_fmac_f32 v253, v49, v239
    v_fmac_f32 v254, v50, v239
    v_fmac_f32 v255, v51, v239
    v_cvt_pk_bf16_f32 v124, v248, v249
    v_cvt_pk_bf16_f32 v125, v250, v251
    v_cvt_pk_bf16_f32 v126, v252, v253
    v_cvt_pk_bf16_f32 v127, v254, v255
    s_barrier
    v_add_u32 v221, 32768, v221
    v_add_u32 v222, 32768, v222
    v_add_u32 v223, 32768, v223
    v_add_u32 v224, 32768, v224
    ds_read_b64_tr_b16 v[16:17], v221 offset:0
    ds_read_b64_tr_b16 v[18:19], v221 offset:2048
    ds_read_b64_tr_b16 v[20:21], v222 offset:0
    ds_read_b64_tr_b16 v[22:23], v222 offset:2048
    ds_read_b64_tr_b16 v[24:25], v223 offset:0
    ds_read_b64_tr_b16 v[26:27], v223 offset:2048
    ds_read_b64_tr_b16 v[28:29], v224 offset:0
    ds_read_b64_tr_b16 v[30:31], v224 offset:2048
    ds_read_b64_tr_b16 v[32:33], v221 offset:4096
    ds_read_b64_tr_b16 v[34:35], v221 offset:6144
    ds_read_b64_tr_b16 v[36:37], v222 offset:4096
    ds_read_b64_tr_b16 v[38:39], v222 offset:6144
    s_waitcnt lgkmcnt(8)
    v_mfma_f32_16x16x32_bf16 a[128:131], v[16:19], v[92:95], 0
    ds_read_b64_tr_b16 v[40:41], v223 offset:4096
    v_accvgpr_read_b32 v240, a16
    v_accvgpr_read_b32 v241, a17
    v_accvgpr_read_b32 v242, a18
    v_accvgpr_read_b32 v243, a19
    v_accvgpr_read_b32 v244, a24
    v_accvgpr_read_b32 v245, a25
    v_accvgpr_read_b32 v246, a26
    v_accvgpr_read_b32 v247, a27
    v_mul_f32_e64 v240, v240, v236
    v_mfma_f32_16x16x32_bf16 a[132:135], v[16:19], v[124:127], 0
    ds_read_b64_tr_b16 v[42:43], v223 offset:6144
    v_mul_f32 v241, v241, v236
    v_mul_f32 v242, v242, v236
    v_mul_f32 v243, v243, v236
    v_mul_f32 v244, v244, v236
    v_mul_f32 v245, v245, v236
    v_mul_f32 v246, v246, v236
    v_mul_f32 v247, v247, v236
    v_lshlrev_b32 v48, 16, v164
    v_and_b32 v49, 0xffff0000, v164
    v_mfma_f32_16x16x32_bf16 a[136:139], v[20:23], v[92:95], 0
    ds_read_b64_tr_b16 v[44:45], v224 offset:4096
    v_lshlrev_b32_e64 v50, 16, v165
    v_and_b32 v51, 0xffff0000, v165
    v_fmac_f32 v240, v48, v238
    v_fmac_f32 v241, v49, v238
    v_fmac_f32 v242, v50, v238
    v_fmac_f32 v243, v51, v238
    v_lshlrev_b32_e64 v48, 16, v168
    v_and_b32 v49, 0xffff0000, v168
    v_lshlrev_b32_e64 v50, 16, v169
    v_mfma_f32_16x16x32_bf16 a[140:143], v[20:23], v[124:127], 0
    ds_read_b64_tr_b16 v[46:47], v224 offset:6144
    v_and_b32 v51, 0xffff0000, v169
    v_fmac_f32 v244, v48, v238
    v_fmac_f32 v245, v49, v238
    v_fmac_f32 v246, v50, v238
    v_fmac_f32 v247, v51, v238
    v_cvt_pk_bf16_f32 v96, v240, v241
    v_cvt_pk_bf16_f32 v97, v242, v243
    v_cvt_pk_bf16_f32 v98, v244, v245
    v_cvt_pk_bf16_f32 v99, v246, v247
    s_waitcnt lgkmcnt(8)
    v_mfma_f32_16x16x32_bf16 a[144:147], v[24:27], v[92:95], 0
    ds_read_b64_tr_b16 v[16:17], v221 offset:8192
    v_accvgpr_read_b32 v248, a20
    v_accvgpr_read_b32 v249, a21
    v_accvgpr_read_b32 v250, a22
    v_accvgpr_read_b32 v251, a23
    v_accvgpr_read_b32 v252, a28
    v_accvgpr_read_b32 v253, a29
    v_accvgpr_read_b32 v254, a30
    v_accvgpr_read_b32 v255, a31
    v_mul_f32 v248, v248, v237
    v_mfma_f32_16x16x32_bf16 a[148:151], v[24:27], v[124:127], 0
    ds_read_b64_tr_b16 v[18:19], v221 offset:10240
    v_mul_f32 v249, v249, v237
    v_mul_f32 v250, v250, v237
    v_mul_f32 v251, v251, v237
    v_mul_f32 v252, v252, v237
    v_mul_f32 v253, v253, v237
    v_mul_f32 v254, v254, v237
    v_mul_f32 v255, v255, v237
    v_lshlrev_b32 v48, 16, v166
    v_and_b32 v49, 0xffff0000, v166
    v_mfma_f32_16x16x32_bf16 a[152:155], v[28:31], v[92:95], 0
    ds_read_b64_tr_b16 v[20:21], v222 offset:8192
    v_lshlrev_b32_e64 v50, 16, v167
    v_and_b32 v51, 0xffff0000, v167
    v_fmac_f32 v248, v48, v239
    v_fmac_f32 v249, v49, v239
    v_fmac_f32 v250, v50, v239
    v_fmac_f32 v251, v51, v239
    v_lshlrev_b32_e64 v48, 16, v170
    v_and_b32 v49, 0xffff0000, v170
    v_lshlrev_b32_e64 v50, 16, v171
    v_mfma_f32_16x16x32_bf16 a[156:159], v[28:31], v[124:127], 0
    ds_read_b64_tr_b16 v[22:23], v222 offset:10240
    v_and_b32 v51, 0xffff0000, v171
    v_fmac_f32 v252, v48, v239
    v_fmac_f32 v253, v49, v239
    v_fmac_f32 v254, v50, v239
    v_fmac_f32 v255, v51, v239
    v_cvt_pk_bf16_f32 v128, v248, v249
    v_cvt_pk_bf16_f32 v129, v250, v251
    v_cvt_pk_bf16_f32 v130, v252, v253
    v_cvt_pk_bf16_f32 v131, v254, v255
    s_waitcnt lgkmcnt(8)
    v_mfma_f32_16x16x32_bf16 a[128:131], v[32:35], v[96:99], a[128:131]
    ds_read_b64_tr_b16 v[24:25], v223 offset:8192
    v_accvgpr_read_b32 v240, a32
    v_accvgpr_read_b32 v241, a33
    v_accvgpr_read_b32 v242, a34
    v_accvgpr_read_b32 v243, a35
    v_accvgpr_read_b32 v244, a40
    v_accvgpr_read_b32 v245, a41
    v_accvgpr_read_b32 v246, a42
    v_accvgpr_read_b32 v247, a43
    v_mul_f32 v240, v240, v236
    v_mfma_f32_16x16x32_bf16 a[132:135], v[32:35], v[128:131], a[132:135]
    ds_read_b64_tr_b16 v[26:27], v223 offset:10240
    v_mul_f32 v241, v241, v236
    v_mul_f32 v242, v242, v236
    v_mul_f32 v243, v243, v236
    v_mul_f32 v244, v244, v236
    v_mul_f32 v245, v245, v236
    v_mul_f32 v246, v246, v236
    v_mul_f32 v247, v247, v236
    v_lshlrev_b32 v48, 16, v172
    v_and_b32 v49, 0xffff0000, v172
    v_mfma_f32_16x16x32_bf16 a[136:139], v[36:39], v[96:99], a[136:139]
    ds_read_b64_tr_b16 v[28:29], v224 offset:8192
    v_lshlrev_b32_e64 v50, 16, v173
    v_and_b32 v51, 0xffff0000, v173
    v_fmac_f32 v240, v48, v238
    v_fmac_f32 v241, v49, v238
    v_fmac_f32 v242, v50, v238
    v_fmac_f32 v243, v51, v238
    v_lshlrev_b32_e64 v48, 16, v176
    v_and_b32 v49, 0xffff0000, v176
    v_lshlrev_b32_e64 v50, 16, v177
    v_mfma_f32_16x16x32_bf16 a[140:143], v[36:39], v[128:131], a[140:143]
    ds_read_b64_tr_b16 v[30:31], v224 offset:10240
    v_and_b32 v51, 0xffff0000, v177
    v_fmac_f32 v244, v48, v238
    v_fmac_f32 v245, v49, v238
    v_fmac_f32 v246, v50, v238
    v_fmac_f32 v247, v51, v238
    v_cvt_pk_bf16_f32 v100, v240, v241
    v_cvt_pk_bf16_f32 v101, v242, v243
    v_cvt_pk_bf16_f32 v102, v244, v245
    v_cvt_pk_bf16_f32 v103, v246, v247
    s_waitcnt lgkmcnt(8)
    v_mfma_f32_16x16x32_bf16 a[144:147], v[40:43], v[96:99], a[144:147]
    ds_read_b64_tr_b16 v[32:33], v221 offset:12288
    v_accvgpr_read_b32 v248, a36
    v_accvgpr_read_b32 v249, a37
    v_accvgpr_read_b32 v250, a38
    v_accvgpr_read_b32 v251, a39
    v_accvgpr_read_b32 v252, a44
    v_accvgpr_read_b32 v253, a45
    v_accvgpr_read_b32 v254, a46
    v_accvgpr_read_b32 v255, a47
    v_mul_f32 v248, v248, v237
    v_mfma_f32_16x16x32_bf16 a[148:151], v[40:43], v[128:131], a[148:151]
    ds_read_b64_tr_b16 v[34:35], v221 offset:14336
    v_mul_f32 v249, v249, v237
    v_mul_f32 v250, v250, v237
    v_mul_f32 v251, v251, v237
    v_mul_f32 v252, v252, v237
    v_mul_f32 v253, v253, v237
    v_mul_f32 v254, v254, v237
    v_mul_f32 v255, v255, v237
    v_lshlrev_b32 v48, 16, v174
    v_and_b32 v49, 0xffff0000, v174
    v_mfma_f32_16x16x32_bf16 a[152:155], v[44:47], v[96:99], a[152:155]
    ds_read_b64_tr_b16 v[36:37], v222 offset:12288
    v_lshlrev_b32_e64 v50, 16, v175
    v_and_b32 v51, 0xffff0000, v175
    v_fmac_f32 v248, v48, v239
    v_fmac_f32 v249, v49, v239
    v_fmac_f32 v250, v50, v239
    v_fmac_f32 v251, v51, v239
    v_lshlrev_b32_e64 v48, 16, v178
    v_and_b32 v49, 0xffff0000, v178
    v_lshlrev_b32_e64 v50, 16, v179
    v_mfma_f32_16x16x32_bf16 a[156:159], v[44:47], v[128:131], a[156:159]
    ds_read_b64_tr_b16 v[38:39], v222 offset:14336
    v_and_b32 v51, 0xffff0000, v179
    v_fmac_f32 v252, v48, v239
    v_fmac_f32 v253, v49, v239
    v_fmac_f32 v254, v50, v239
    v_fmac_f32 v255, v51, v239
    v_cvt_pk_bf16_f32 v132, v248, v249
    v_cvt_pk_bf16_f32 v133, v250, v251
    v_cvt_pk_bf16_f32 v134, v252, v253
    v_cvt_pk_bf16_f32 v135, v254, v255
    s_waitcnt lgkmcnt(8)
    v_mfma_f32_16x16x32_bf16 a[128:131], v[16:19], v[100:103], a[128:131]
    ds_read_b64_tr_b16 v[40:41], v223 offset:12288
    v_accvgpr_read_b32 v240, a48
    v_accvgpr_read_b32 v241, a49
    v_accvgpr_read_b32 v242, a50
    v_accvgpr_read_b32 v243, a51
    v_accvgpr_read_b32 v244, a56
    v_accvgpr_read_b32 v245, a57
    v_accvgpr_read_b32 v246, a58
    v_accvgpr_read_b32 v247, a59
    v_mul_f32 v240, v240, v236
    v_mfma_f32_16x16x32_bf16 a[132:135], v[16:19], v[132:135], a[132:135]
    ds_read_b64_tr_b16 v[42:43], v223 offset:14336
    v_mul_f32 v241, v241, v236
    v_mul_f32 v242, v242, v236
    v_mul_f32 v243, v243, v236
    v_mul_f32 v244, v244, v236
    v_mul_f32 v245, v245, v236
    v_mul_f32 v246, v246, v236
    v_mul_f32 v247, v247, v236
    v_lshlrev_b32 v48, 16, v180
    v_and_b32 v49, 0xffff0000, v180
    v_mfma_f32_16x16x32_bf16 a[136:139], v[20:23], v[100:103], a[136:139]
    ds_read_b64_tr_b16 v[44:45], v224 offset:12288
    s_add_u32 m0, s76, 65536
    s_mov_b32 s68, 512
    buffer_load_dwordx4 v220, s[72:75], s68 offen lds
    v_lshlrev_b32_e64 v50, 16, v181
    v_and_b32 v51, 0xffff0000, v181
    v_fmac_f32 v240, v48, v238
    v_fmac_f32 v241, v49, v238
    v_fmac_f32 v242, v50, v238
    v_fmac_f32 v243, v51, v238
    v_lshlrev_b32_e64 v48, 16, v184
    v_and_b32 v49, 0xffff0000, v184
    v_lshlrev_b32_e64 v50, 16, v185
    v_mfma_f32_16x16x32_bf16 a[140:143], v[20:23], v[132:135], a[140:143]
    ds_read_b64_tr_b16 v[46:47], v224 offset:14336
    v_and_b32 v51, 0xffff0000, v185
    v_fmac_f32 v244, v48, v238
    v_fmac_f32 v245, v49, v238
    v_fmac_f32 v246, v50, v238
    v_fmac_f32 v247, v51, v238
    v_cvt_pk_bf16_f32 v104, v240, v241
    v_cvt_pk_bf16_f32 v105, v242, v243
    v_cvt_pk_bf16_f32 v106, v244, v245
    v_cvt_pk_bf16_f32 v107, v246, v247
    s_waitcnt lgkmcnt(8)
    v_mfma_f32_16x16x32_bf16 a[144:147], v[24:27], v[100:103], a[144:147]
    ds_read_b64_tr_b16 v[16:17], v221 offset:16384
    v_accvgpr_read_b32 v248, a52
    v_accvgpr_read_b32 v249, a53
    v_accvgpr_read_b32 v250, a54
    v_accvgpr_read_b32 v251, a55
    v_accvgpr_read_b32 v252, a60
    v_accvgpr_read_b32 v253, a61
    v_accvgpr_read_b32 v254, a62
    v_accvgpr_read_b32 v255, a63
    v_mul_f32 v248, v248, v237
    v_mfma_f32_16x16x32_bf16 a[148:151], v[24:27], v[132:135], a[148:151]
    ds_read_b64_tr_b16 v[18:19], v221 offset:18432
    v_mul_f32 v249, v249, v237
    v_mul_f32 v250, v250, v237
    v_mul_f32 v251, v251, v237
    v_mul_f32 v252, v252, v237
    v_mul_f32 v253, v253, v237
    v_mul_f32 v254, v254, v237
    v_mul_f32 v255, v255, v237
    v_lshlrev_b32 v48, 16, v182
    v_and_b32 v49, 0xffff0000, v182
    v_mfma_f32_16x16x32_bf16 a[152:155], v[28:31], v[100:103], a[152:155]
    ds_read_b64_tr_b16 v[20:21], v222 offset:16384
    s_add_u32 m0, s76, 66560
    s_mov_b32 s68, 7680
    buffer_load_dwordx4 v220, s[72:75], s68 offen lds
    v_lshlrev_b32_e64 v50, 16, v183
    v_and_b32 v51, 0xffff0000, v183
    v_fmac_f32 v248, v48, v239
    v_fmac_f32 v249, v49, v239
    v_fmac_f32 v250, v50, v239
    v_fmac_f32 v251, v51, v239
    v_lshlrev_b32_e64 v48, 16, v186
    v_and_b32 v49, 0xffff0000, v186
    v_lshlrev_b32_e64 v50, 16, v187
    v_mfma_f32_16x16x32_bf16 a[156:159], v[28:31], v[132:135], a[156:159]
    ds_read_b64_tr_b16 v[22:23], v222 offset:18432
    v_and_b32 v51, 0xffff0000, v187
    v_fmac_f32 v252, v48, v239
    v_fmac_f32 v253, v49, v239
    v_fmac_f32 v254, v50, v239
    v_fmac_f32 v255, v51, v239
    v_cvt_pk_bf16_f32 v136, v248, v249
    v_cvt_pk_bf16_f32 v137, v250, v251
    v_cvt_pk_bf16_f32 v138, v252, v253
    v_cvt_pk_bf16_f32 v139, v254, v255
    s_waitcnt lgkmcnt(8)
    v_mfma_f32_16x16x32_bf16 a[128:131], v[32:35], v[104:107], a[128:131]
    ds_read_b64_tr_b16 v[24:25], v223 offset:16384
    v_accvgpr_read_b32 v240, a64
    v_accvgpr_read_b32 v241, a65
    v_accvgpr_read_b32 v242, a66
    v_accvgpr_read_b32 v243, a67
    v_accvgpr_read_b32 v244, a72
    v_accvgpr_read_b32 v245, a73
    v_accvgpr_read_b32 v246, a74
    v_accvgpr_read_b32 v247, a75
    v_mul_f32 v240, v240, v236
    v_mfma_f32_16x16x32_bf16 a[132:135], v[32:35], v[136:139], a[132:135]
    ds_read_b64_tr_b16 v[26:27], v223 offset:18432
    v_mul_f32 v241, v241, v236
    v_mul_f32 v242, v242, v236
    v_mul_f32 v243, v243, v236
    v_mul_f32 v244, v244, v236
    v_mul_f32 v245, v245, v236
    v_mul_f32 v246, v246, v236
    v_mul_f32 v247, v247, v236
    v_lshlrev_b32 v48, 16, v188
    v_and_b32 v49, 0xffff0000, v188
    v_mfma_f32_16x16x32_bf16 a[136:139], v[36:39], v[104:107], a[136:139]
    ds_read_b64_tr_b16 v[28:29], v224 offset:16384
    s_add_u32 m0, s76, 67584
    s_mov_b32 s68, 14848
    buffer_load_dwordx4 v220, s[72:75], s68 offen lds
    v_lshlrev_b32_e64 v50, 16, v189
    v_and_b32 v51, 0xffff0000, v189
    v_fmac_f32 v240, v48, v238
    v_fmac_f32 v241, v49, v238
    v_fmac_f32 v242, v50, v238
    v_fmac_f32 v243, v51, v238
    v_lshlrev_b32_e64 v48, 16, v192
    v_and_b32 v49, 0xffff0000, v192
    v_lshlrev_b32_e64 v50, 16, v193
    v_mfma_f32_16x16x32_bf16 a[140:143], v[36:39], v[136:139], a[140:143]
    ds_read_b64_tr_b16 v[30:31], v224 offset:18432
    v_and_b32 v51, 0xffff0000, v193
    v_fmac_f32 v244, v48, v238
    v_fmac_f32 v245, v49, v238
    v_fmac_f32 v246, v50, v238
    v_fmac_f32 v247, v51, v238
    v_cvt_pk_bf16_f32 v108, v240, v241
    v_cvt_pk_bf16_f32 v109, v242, v243
    v_cvt_pk_bf16_f32 v110, v244, v245
    v_cvt_pk_bf16_f32 v111, v246, v247
    s_waitcnt lgkmcnt(8)
    v_mfma_f32_16x16x32_bf16 a[144:147], v[40:43], v[104:107], a[144:147]
    ds_read_b64_tr_b16 v[32:33], v221 offset:20480
    v_accvgpr_read_b32 v248, a68
    v_accvgpr_read_b32 v249, a69
    v_accvgpr_read_b32 v250, a70
    v_accvgpr_read_b32 v251, a71
    v_accvgpr_read_b32 v252, a76
    v_accvgpr_read_b32 v253, a77
    v_accvgpr_read_b32 v254, a78
    v_accvgpr_read_b32 v255, a79
    v_mul_f32 v248, v248, v237
    v_mfma_f32_16x16x32_bf16 a[148:151], v[40:43], v[136:139], a[148:151]
    ds_read_b64_tr_b16 v[34:35], v221 offset:22528
    v_mul_f32 v249, v249, v237
    v_mul_f32 v250, v250, v237
    v_mul_f32 v251, v251, v237
    v_mul_f32 v252, v252, v237
    v_mul_f32 v253, v253, v237
    v_mul_f32 v254, v254, v237
    v_mul_f32 v255, v255, v237
    v_lshlrev_b32 v48, 16, v190
    v_and_b32 v49, 0xffff0000, v190
    v_mfma_f32_16x16x32_bf16 a[152:155], v[44:47], v[104:107], a[152:155]
    ds_read_b64_tr_b16 v[36:37], v222 offset:20480
    s_add_u32 m0, s76, 68608
    s_mov_b32 s68, 22016
    buffer_load_dwordx4 v220, s[72:75], s68 offen lds
    v_lshlrev_b32_e64 v50, 16, v191
    v_and_b32 v51, 0xffff0000, v191
    v_fmac_f32 v248, v48, v239
    v_fmac_f32 v249, v49, v239
    v_fmac_f32 v250, v50, v239
    v_fmac_f32 v251, v51, v239
    v_lshlrev_b32_e64 v48, 16, v194
    v_and_b32 v49, 0xffff0000, v194
    v_lshlrev_b32_e64 v50, 16, v195
    v_mfma_f32_16x16x32_bf16 a[156:159], v[44:47], v[136:139], a[156:159]
    ds_read_b64_tr_b16 v[38:39], v222 offset:22528
    v_and_b32 v51, 0xffff0000, v195
    v_fmac_f32 v252, v48, v239
    v_fmac_f32 v253, v49, v239
    v_fmac_f32 v254, v50, v239
    v_fmac_f32 v255, v51, v239
    v_cvt_pk_bf16_f32 v140, v248, v249
    v_cvt_pk_bf16_f32 v141, v250, v251
    v_cvt_pk_bf16_f32 v142, v252, v253
    v_cvt_pk_bf16_f32 v143, v254, v255
    s_waitcnt lgkmcnt(8)
    v_mfma_f32_16x16x32_bf16 a[128:131], v[16:19], v[108:111], a[128:131]
    ds_read_b64_tr_b16 v[40:41], v223 offset:20480
    v_accvgpr_read_b32 v240, a80
    v_accvgpr_read_b32 v241, a81
    v_accvgpr_read_b32 v242, a82
    v_accvgpr_read_b32 v243, a83
    v_accvgpr_read_b32 v244, a88
    v_accvgpr_read_b32 v245, a89
    v_accvgpr_read_b32 v246, a90
    v_accvgpr_read_b32 v247, a91
    v_mul_f32 v240, v240, v236
    v_mfma_f32_16x16x32_bf16 a[132:135], v[16:19], v[140:143], a[132:135]
    ds_read_b64_tr_b16 v[42:43], v223 offset:22528
    v_mul_f32 v241, v241, v236
    v_mul_f32 v242, v242, v236
    v_mul_f32 v243, v243, v236
    v_mul_f32 v244, v244, v236
    v_mul_f32 v245, v245, v236
    v_mul_f32 v246, v246, v236
    v_mul_f32 v247, v247, v236
    v_lshlrev_b32 v48, 16, v196
    v_and_b32 v49, 0xffff0000, v196
    v_mfma_f32_16x16x32_bf16 a[136:139], v[20:23], v[108:111], a[136:139]
    ds_read_b64_tr_b16 v[44:45], v224 offset:20480
    s_add_u32 m0, s76, 69632
    s_mov_b32 s68, 29184
    buffer_load_dwordx4 v220, s[72:75], s68 offen lds
    v_lshlrev_b32_e64 v50, 16, v197
    v_and_b32 v51, 0xffff0000, v197
    v_fmac_f32 v240, v48, v238
    v_fmac_f32 v241, v49, v238
    v_fmac_f32 v242, v50, v238
    v_fmac_f32 v243, v51, v238
    v_lshlrev_b32_e64 v48, 16, v200
    v_and_b32 v49, 0xffff0000, v200
    v_lshlrev_b32_e64 v50, 16, v201
    v_mfma_f32_16x16x32_bf16 a[140:143], v[20:23], v[140:143], a[140:143]
    ds_read_b64_tr_b16 v[46:47], v224 offset:22528
    v_and_b32 v51, 0xffff0000, v201
    v_fmac_f32 v244, v48, v238
    v_fmac_f32 v245, v49, v238
    v_fmac_f32 v246, v50, v238
    v_fmac_f32 v247, v51, v238
    v_cvt_pk_bf16_f32 v112, v240, v241
    v_cvt_pk_bf16_f32 v113, v242, v243
    v_cvt_pk_bf16_f32 v114, v244, v245
    v_cvt_pk_bf16_f32 v115, v246, v247
    s_waitcnt lgkmcnt(8)
    v_mfma_f32_16x16x32_bf16 a[144:147], v[24:27], v[108:111], a[144:147]
    ds_read_b64_tr_b16 v[16:17], v221 offset:24576
    v_accvgpr_read_b32 v248, a84
    v_accvgpr_read_b32 v249, a85
    v_accvgpr_read_b32 v250, a86
    v_accvgpr_read_b32 v251, a87
    v_accvgpr_read_b32 v252, a92
    v_accvgpr_read_b32 v253, a93
    v_accvgpr_read_b32 v254, a94
    v_accvgpr_read_b32 v255, a95
    v_mul_f32 v248, v248, v237
    v_mfma_f32_16x16x32_bf16 a[148:151], v[24:27], v[140:143], a[148:151]
    ds_read_b64_tr_b16 v[18:19], v221 offset:26624
    v_mul_f32 v249, v249, v237
    v_mul_f32 v250, v250, v237
    v_mul_f32 v251, v251, v237
    v_mul_f32 v252, v252, v237
    v_mul_f32 v253, v253, v237
    v_mul_f32 v254, v254, v237
    v_mul_f32 v255, v255, v237
    v_lshlrev_b32 v48, 16, v198
    v_and_b32 v49, 0xffff0000, v198
    v_mfma_f32_16x16x32_bf16 a[152:155], v[28:31], v[108:111], a[152:155]
    ds_read_b64_tr_b16 v[20:21], v222 offset:24576
    s_add_u32 m0, s76, 70656
    s_mov_b32 s68, 36352
    buffer_load_dwordx4 v220, s[72:75], s68 offen lds
    v_lshlrev_b32_e64 v50, 16, v199
    v_and_b32 v51, 0xffff0000, v199
    v_fmac_f32 v248, v48, v239
    v_fmac_f32 v249, v49, v239
    v_fmac_f32 v250, v50, v239
    v_fmac_f32 v251, v51, v239
    v_lshlrev_b32_e64 v48, 16, v202
    v_and_b32 v49, 0xffff0000, v202
    v_lshlrev_b32_e64 v50, 16, v203
    v_mfma_f32_16x16x32_bf16 a[156:159], v[28:31], v[140:143], a[156:159]
    ds_read_b64_tr_b16 v[22:23], v222 offset:26624
    v_and_b32 v51, 0xffff0000, v203
    v_fmac_f32 v252, v48, v239
    v_fmac_f32 v253, v49, v239
    v_fmac_f32 v254, v50, v239
    v_fmac_f32 v255, v51, v239
    v_cvt_pk_bf16_f32 v144, v248, v249
    v_cvt_pk_bf16_f32 v145, v250, v251
    v_cvt_pk_bf16_f32 v146, v252, v253
    v_cvt_pk_bf16_f32 v147, v254, v255
    s_waitcnt lgkmcnt(8)
    v_mfma_f32_16x16x32_bf16 a[128:131], v[32:35], v[112:115], a[128:131]
    ds_read_b64_tr_b16 v[24:25], v223 offset:24576
    v_accvgpr_read_b32 v240, a96
    v_accvgpr_read_b32 v241, a97
    v_accvgpr_read_b32 v242, a98
    v_accvgpr_read_b32 v243, a99
    v_accvgpr_read_b32 v244, a104
    v_accvgpr_read_b32 v245, a105
    v_accvgpr_read_b32 v246, a106
    v_accvgpr_read_b32 v247, a107
    v_mul_f32 v240, v240, v236
    v_mfma_f32_16x16x32_bf16 a[132:135], v[32:35], v[144:147], a[132:135]
    ds_read_b64_tr_b16 v[26:27], v223 offset:26624
    v_mul_f32 v241, v241, v236
    v_mul_f32 v242, v242, v236
    v_mul_f32 v243, v243, v236
    v_mul_f32 v244, v244, v236
    v_mul_f32 v245, v245, v236
    v_mul_f32 v246, v246, v236
    v_mul_f32 v247, v247, v236
    v_lshlrev_b32 v48, 16, v204
    v_and_b32 v49, 0xffff0000, v204
    v_mfma_f32_16x16x32_bf16 a[136:139], v[36:39], v[112:115], a[136:139]
    ds_read_b64_tr_b16 v[28:29], v224 offset:24576
    s_add_u32 m0, s76, 71680
    s_mov_b32 s68, 43520
    buffer_load_dwordx4 v220, s[72:75], s68 offen lds
    v_lshlrev_b32_e64 v50, 16, v205
    v_and_b32 v51, 0xffff0000, v205
    v_fmac_f32 v240, v48, v238
    v_fmac_f32 v241, v49, v238
    v_fmac_f32 v242, v50, v238
    v_fmac_f32 v243, v51, v238
    v_lshlrev_b32_e64 v48, 16, v208
    v_and_b32 v49, 0xffff0000, v208
    v_lshlrev_b32_e64 v50, 16, v209
    v_mfma_f32_16x16x32_bf16 a[140:143], v[36:39], v[144:147], a[140:143]
    ds_read_b64_tr_b16 v[30:31], v224 offset:26624
    v_and_b32 v51, 0xffff0000, v209
    v_fmac_f32 v244, v48, v238
    v_fmac_f32 v245, v49, v238
    v_fmac_f32 v246, v50, v238
    v_fmac_f32 v247, v51, v238
    v_cvt_pk_bf16_f32 v116, v240, v241
    v_cvt_pk_bf16_f32 v117, v242, v243
    v_cvt_pk_bf16_f32 v118, v244, v245
    v_cvt_pk_bf16_f32 v119, v246, v247
    s_waitcnt lgkmcnt(8)
    v_mfma_f32_16x16x32_bf16 a[144:147], v[40:43], v[112:115], a[144:147]
    ds_read_b64_tr_b16 v[32:33], v221 offset:28672
    v_accvgpr_read_b32 v248, a100
    v_accvgpr_read_b32 v249, a101
    v_accvgpr_read_b32 v250, a102
    v_accvgpr_read_b32 v251, a103
    v_accvgpr_read_b32 v252, a108
    v_accvgpr_read_b32 v253, a109
    v_accvgpr_read_b32 v254, a110
    v_accvgpr_read_b32 v255, a111
    v_mul_f32 v248, v248, v237
    v_mfma_f32_16x16x32_bf16 a[148:151], v[40:43], v[144:147], a[148:151]
    ds_read_b64_tr_b16 v[34:35], v221 offset:30720
    v_mul_f32 v249, v249, v237
    v_mul_f32 v250, v250, v237
    v_mul_f32 v251, v251, v237
    v_mul_f32 v252, v252, v237
    v_mul_f32 v253, v253, v237
    v_mul_f32 v254, v254, v237
    v_mul_f32 v255, v255, v237
    v_lshlrev_b32 v48, 16, v206
    v_and_b32 v49, 0xffff0000, v206
    v_mfma_f32_16x16x32_bf16 a[152:155], v[44:47], v[112:115], a[152:155]
    ds_read_b64_tr_b16 v[36:37], v222 offset:28672
    s_add_u32 m0, s76, 72704
    s_mov_b32 s68, 50688
    buffer_load_dwordx4 v220, s[72:75], s68 offen lds
    v_lshlrev_b32_e64 v50, 16, v207
    v_and_b32 v51, 0xffff0000, v207
    v_fmac_f32 v248, v48, v239
    v_fmac_f32 v249, v49, v239
    v_fmac_f32 v250, v50, v239
    v_fmac_f32 v251, v51, v239
    v_lshlrev_b32_e64 v48, 16, v210
    v_and_b32 v49, 0xffff0000, v210
    v_lshlrev_b32_e64 v50, 16, v211
    v_mfma_f32_16x16x32_bf16 a[156:159], v[44:47], v[144:147], a[156:159]
    ds_read_b64_tr_b16 v[38:39], v222 offset:30720
    v_and_b32 v51, 0xffff0000, v211
    v_fmac_f32 v252, v48, v239
    v_fmac_f32 v253, v49, v239
    v_fmac_f32 v254, v50, v239
    v_fmac_f32 v255, v51, v239
    v_cvt_pk_bf16_f32 v148, v248, v249
    v_cvt_pk_bf16_f32 v149, v250, v251
    v_cvt_pk_bf16_f32 v150, v252, v253
    v_cvt_pk_bf16_f32 v151, v254, v255
    s_waitcnt lgkmcnt(8)
    v_mfma_f32_16x16x32_bf16 a[128:131], v[16:19], v[116:119], a[128:131]
    ds_read_b64_tr_b16 v[40:41], v223 offset:28672
    v_accvgpr_read_b32 v240, a112
    v_accvgpr_read_b32 v241, a113
    v_accvgpr_read_b32 v242, a114
    v_accvgpr_read_b32 v243, a115
    v_accvgpr_read_b32 v244, a120
    v_accvgpr_read_b32 v245, a121
    v_accvgpr_read_b32 v246, a122
    v_accvgpr_read_b32 v247, a123
    v_mul_f32 v240, v240, v236
    v_mfma_f32_16x16x32_bf16 a[132:135], v[16:19], v[148:151], a[132:135]
    ds_read_b64_tr_b16 v[42:43], v223 offset:30720
    v_mul_f32 v241, v241, v236
    v_mul_f32 v242, v242, v236
    v_mul_f32 v243, v243, v236
    v_mul_f32 v244, v244, v236
    v_mul_f32 v245, v245, v236
    v_mul_f32 v246, v246, v236
    v_mul_f32 v247, v247, v236
    v_lshlrev_b32 v48, 16, v212
    v_and_b32 v49, 0xffff0000, v212
    v_mfma_f32_16x16x32_bf16 a[136:139], v[20:23], v[116:119], a[136:139]
    ds_read_b64_tr_b16 v[44:45], v224 offset:28672
    v_lshlrev_b32_e64 v50, 16, v213
    v_and_b32 v51, 0xffff0000, v213
    v_fmac_f32 v240, v48, v238
    v_fmac_f32 v241, v49, v238
    v_fmac_f32 v242, v50, v238
    v_fmac_f32 v243, v51, v238
    v_lshlrev_b32_e64 v48, 16, v216
    v_and_b32 v49, 0xffff0000, v216
    v_lshlrev_b32_e64 v50, 16, v217
    v_mfma_f32_16x16x32_bf16 a[140:143], v[20:23], v[148:151], a[140:143]
    ds_read_b64_tr_b16 v[46:47], v224 offset:30720
    v_and_b32 v51, 0xffff0000, v217
    v_fmac_f32 v244, v48, v238
    v_fmac_f32 v245, v49, v238
    v_fmac_f32 v246, v50, v238
    v_fmac_f32 v247, v51, v238
    v_cvt_pk_bf16_f32 v120, v240, v241
    v_cvt_pk_bf16_f32 v121, v242, v243
    v_cvt_pk_bf16_f32 v122, v244, v245
    v_cvt_pk_bf16_f32 v123, v246, v247
    v_add_u32 v221, 4294934528, v221
    v_add_u32 v222, 4294934528, v222
    v_add_u32 v223, 4294934528, v223
    v_add_u32 v224, 4294934528, v224
    s_waitcnt lgkmcnt(8)
    v_mfma_f32_16x16x32_bf16 a[144:147], v[24:27], v[116:119], a[144:147]
    ds_read_b64_tr_b16 v[16:17], v221 offset:0
    v_accvgpr_read_b32 v248, a116
    v_accvgpr_read_b32 v249, a117
    v_accvgpr_read_b32 v250, a118
    v_accvgpr_read_b32 v251, a119
    v_accvgpr_read_b32 v252, a124
    v_accvgpr_read_b32 v253, a125
    v_accvgpr_read_b32 v254, a126
    v_accvgpr_read_b32 v255, a127
    v_mul_f32 v248, v248, v237
    v_mfma_f32_16x16x32_bf16 a[148:151], v[24:27], v[148:151], a[148:151]
    ds_read_b64_tr_b16 v[18:19], v221 offset:2048
    v_mul_f32 v249, v249, v237
    v_mul_f32 v250, v250, v237
    v_mul_f32 v251, v251, v237
    v_mul_f32 v252, v252, v237
    v_mul_f32 v253, v253, v237
    v_mul_f32 v254, v254, v237
    v_mul_f32 v255, v255, v237
    v_lshlrev_b32 v48, 16, v214
    v_and_b32 v49, 0xffff0000, v214
    v_mfma_f32_16x16x32_bf16 a[152:155], v[28:31], v[116:119], a[152:155]
    ds_read_b64_tr_b16 v[20:21], v222 offset:0
    v_lshlrev_b32_e64 v50, 16, v215
    v_and_b32 v51, 0xffff0000, v215
    v_fmac_f32 v248, v48, v239
    v_fmac_f32 v249, v49, v239
    v_fmac_f32 v250, v50, v239
    v_fmac_f32 v251, v51, v239
    v_lshlrev_b32_e64 v48, 16, v218
    v_and_b32 v49, 0xffff0000, v218
    v_lshlrev_b32_e64 v50, 16, v219
    v_mfma_f32_16x16x32_bf16 a[156:159], v[28:31], v[148:151], a[156:159]
    ds_read_b64_tr_b16 v[22:23], v222 offset:2048
    v_and_b32 v51, 0xffff0000, v219
    v_fmac_f32 v252, v48, v239
    v_fmac_f32 v253, v49, v239
    v_fmac_f32 v254, v50, v239
    v_fmac_f32 v255, v51, v239
    v_cvt_pk_bf16_f32 v152, v248, v249
    v_cvt_pk_bf16_f32 v153, v250, v251
    v_cvt_pk_bf16_f32 v154, v252, v253
    v_cvt_pk_bf16_f32 v155, v254, v255
    s_waitcnt lgkmcnt(8)
    v_mfma_f32_16x16x32_bf16 a[128:131], v[32:35], v[120:123], a[128:131]
    ds_read_b64_tr_b16 v[24:25], v223 offset:0
    v_mfma_f32_16x16x32_bf16 a[132:135], v[32:35], v[152:155], a[132:135]
    ds_read_b64_tr_b16 v[26:27], v223 offset:2048
    v_mfma_f32_16x16x32_bf16 a[136:139], v[36:39], v[120:123], a[136:139]
    ds_read_b64_tr_b16 v[28:29], v224 offset:0
    v_mfma_f32_16x16x32_bf16 a[140:143], v[36:39], v[152:155], a[140:143]
    ds_read_b64_tr_b16 v[30:31], v224 offset:2048
    s_waitcnt lgkmcnt(8)
    v_mfma_f32_16x16x32_bf16 a[144:147], v[40:43], v[120:123], a[144:147]
    ds_read_b64_tr_b16 v[32:33], v221 offset:4096
    v_mfma_f32_16x16x32_bf16 a[148:151], v[40:43], v[152:155], a[148:151]
    ds_read_b64_tr_b16 v[34:35], v221 offset:6144
    v_mfma_f32_16x16x32_bf16 a[152:155], v[44:47], v[120:123], a[152:155]
    ds_read_b64_tr_b16 v[36:37], v222 offset:4096
    v_mfma_f32_16x16x32_bf16 a[156:159], v[44:47], v[152:155], a[156:159]
    ds_read_b64_tr_b16 v[38:39], v222 offset:6144
    s_waitcnt lgkmcnt(8)
    v_mfma_f32_16x16x32_bf16 a[160:163], v[16:19], v[92:95], 0
    ds_read_b64_tr_b16 v[40:41], v223 offset:4096
    v_mfma_f32_16x16x32_bf16 a[164:167], v[16:19], v[124:127], 0
    ds_read_b64_tr_b16 v[42:43], v223 offset:6144
    v_mfma_f32_16x16x32_bf16 a[168:171], v[20:23], v[92:95], 0
    ds_read_b64_tr_b16 v[44:45], v224 offset:4096
    v_mfma_f32_16x16x32_bf16 a[172:175], v[20:23], v[124:127], 0
    ds_read_b64_tr_b16 v[46:47], v224 offset:6144
    s_waitcnt lgkmcnt(8)
    v_mfma_f32_16x16x32_bf16 a[176:179], v[24:27], v[92:95], 0
    ds_read_b64_tr_b16 v[16:17], v221 offset:8192
    v_mfma_f32_16x16x32_bf16 a[180:183], v[24:27], v[124:127], 0
    ds_read_b64_tr_b16 v[18:19], v221 offset:10240
    v_mfma_f32_16x16x32_bf16 a[184:187], v[28:31], v[92:95], 0
    ds_read_b64_tr_b16 v[20:21], v222 offset:8192
    v_mfma_f32_16x16x32_bf16 a[188:191], v[28:31], v[124:127], 0
    ds_read_b64_tr_b16 v[22:23], v222 offset:10240
    s_waitcnt lgkmcnt(8)
    v_mfma_f32_16x16x32_bf16 a[160:163], v[32:35], v[96:99], a[160:163]
    ds_read_b64_tr_b16 v[24:25], v223 offset:8192
    v_accvgpr_read_b32 v156, a128
    v_mfma_f32_16x16x32_bf16 a[164:167], v[32:35], v[128:131], a[164:167]
    ds_read_b64_tr_b16 v[26:27], v223 offset:10240
    v_accvgpr_read_b32 v157, a129
    v_mfma_f32_16x16x32_bf16 a[168:171], v[36:39], v[96:99], a[168:171]
    ds_read_b64_tr_b16 v[28:29], v224 offset:8192
    v_accvgpr_read_b32 v158, a130
    v_mfma_f32_16x16x32_bf16 a[172:175], v[36:39], v[128:131], a[172:175]
    ds_read_b64_tr_b16 v[30:31], v224 offset:10240
    v_accvgpr_read_b32 v159, a131
    s_waitcnt lgkmcnt(8)
    v_mfma_f32_16x16x32_bf16 a[176:179], v[40:43], v[96:99], a[176:179]
    ds_read_b64_tr_b16 v[32:33], v221 offset:12288
    v_accvgpr_read_b32 v160, a136
    v_mfma_f32_16x16x32_bf16 a[180:183], v[40:43], v[128:131], a[180:183]
    ds_read_b64_tr_b16 v[34:35], v221 offset:14336
    v_accvgpr_read_b32 v161, a137
    v_mfma_f32_16x16x32_bf16 a[184:187], v[44:47], v[96:99], a[184:187]
    ds_read_b64_tr_b16 v[36:37], v222 offset:12288
    v_accvgpr_read_b32 v162, a138
    v_mfma_f32_16x16x32_bf16 a[188:191], v[44:47], v[128:131], a[188:191]
    ds_read_b64_tr_b16 v[38:39], v222 offset:14336
    v_accvgpr_read_b32 v163, a139
    s_waitcnt lgkmcnt(8)
    v_mfma_f32_16x16x32_bf16 a[160:163], v[16:19], v[100:103], a[160:163]
    ds_read_b64_tr_b16 v[40:41], v223 offset:12288
    v_cvt_pk_bf16_f32 v164, v156, v157
    v_mfma_f32_16x16x32_bf16 a[164:167], v[16:19], v[132:135], a[164:167]
    ds_read_b64_tr_b16 v[42:43], v223 offset:14336
    v_cvt_pk_bf16_f32 v165, v158, v159
    v_mfma_f32_16x16x32_bf16 a[168:171], v[20:23], v[100:103], a[168:171]
    ds_read_b64_tr_b16 v[44:45], v224 offset:12288
    v_cvt_pk_bf16_f32 v166, v160, v161
    v_mfma_f32_16x16x32_bf16 a[172:175], v[20:23], v[132:135], a[172:175]
    ds_read_b64_tr_b16 v[46:47], v224 offset:14336
    v_cvt_pk_bf16_f32 v167, v162, v163
    s_waitcnt lgkmcnt(8)
    v_mfma_f32_16x16x32_bf16 a[176:179], v[24:27], v[100:103], a[176:179]
    ds_read_b64_tr_b16 v[16:17], v221 offset:16384
    s_mov_b32 s6, 0
    v_mfma_f32_16x16x32_bf16 a[180:183], v[24:27], v[132:135], a[180:183]
    ds_read_b64_tr_b16 v[18:19], v221 offset:18432
    buffer_store_dwordx4 v[164:167], v12, s[20:23], s6 offen sc1
    v_mfma_f32_16x16x32_bf16 a[184:187], v[28:31], v[100:103], a[184:187]
    ds_read_b64_tr_b16 v[20:21], v222 offset:16384
    v_accvgpr_read_b32 v168, a132
    v_mfma_f32_16x16x32_bf16 a[188:191], v[28:31], v[132:135], a[188:191]
    ds_read_b64_tr_b16 v[22:23], v222 offset:18432
    v_accvgpr_read_b32 v169, a133
    s_waitcnt lgkmcnt(8)
    v_mfma_f32_16x16x32_bf16 a[160:163], v[32:35], v[104:107], a[160:163]
    ds_read_b64_tr_b16 v[24:25], v223 offset:16384
    v_accvgpr_read_b32 v170, a134
    v_mfma_f32_16x16x32_bf16 a[164:167], v[32:35], v[136:139], a[164:167]
    ds_read_b64_tr_b16 v[26:27], v223 offset:18432
    v_accvgpr_read_b32 v171, a135
    v_mfma_f32_16x16x32_bf16 a[168:171], v[36:39], v[104:107], a[168:171]
    ds_read_b64_tr_b16 v[28:29], v224 offset:16384
    v_accvgpr_read_b32 v172, a140
    v_mfma_f32_16x16x32_bf16 a[172:175], v[36:39], v[136:139], a[172:175]
    ds_read_b64_tr_b16 v[30:31], v224 offset:18432
    v_accvgpr_read_b32 v173, a141
    s_waitcnt lgkmcnt(8)
    v_mfma_f32_16x16x32_bf16 a[176:179], v[40:43], v[104:107], a[176:179]
    ds_read_b64_tr_b16 v[32:33], v221 offset:20480
    v_accvgpr_read_b32 v174, a142
    v_mfma_f32_16x16x32_bf16 a[180:183], v[40:43], v[136:139], a[180:183]
    ds_read_b64_tr_b16 v[34:35], v221 offset:22528
    v_accvgpr_read_b32 v175, a143
    v_mfma_f32_16x16x32_bf16 a[184:187], v[44:47], v[104:107], a[184:187]
    ds_read_b64_tr_b16 v[36:37], v222 offset:20480
    v_cvt_pk_bf16_f32 v176, v168, v169
    v_mfma_f32_16x16x32_bf16 a[188:191], v[44:47], v[136:139], a[188:191]
    ds_read_b64_tr_b16 v[38:39], v222 offset:22528
    v_cvt_pk_bf16_f32 v177, v170, v171
    s_waitcnt lgkmcnt(8)
    v_mfma_f32_16x16x32_bf16 a[160:163], v[16:19], v[108:111], a[160:163]
    ds_read_b64_tr_b16 v[40:41], v223 offset:20480
    v_cvt_pk_bf16_f32 v178, v172, v173
    v_mfma_f32_16x16x32_bf16 a[164:167], v[16:19], v[140:143], a[164:167]
    ds_read_b64_tr_b16 v[42:43], v223 offset:22528
    v_cvt_pk_bf16_f32 v179, v174, v175
    v_mfma_f32_16x16x32_bf16 a[168:171], v[20:23], v[108:111], a[168:171]
    ds_read_b64_tr_b16 v[44:45], v224 offset:20480
    s_mov_b32 s6, 229376
    v_mfma_f32_16x16x32_bf16 a[172:175], v[20:23], v[140:143], a[172:175]
    ds_read_b64_tr_b16 v[46:47], v224 offset:22528
    buffer_store_dwordx4 v[176:179], v12, s[20:23], s6 offen sc1
    s_waitcnt lgkmcnt(8)
    v_mfma_f32_16x16x32_bf16 a[176:179], v[24:27], v[108:111], a[176:179]
    ds_read_b64_tr_b16 v[16:17], v221 offset:24576
    v_accvgpr_read_b32 v180, a144
    v_mfma_f32_16x16x32_bf16 a[180:183], v[24:27], v[140:143], a[180:183]
    ds_read_b64_tr_b16 v[18:19], v221 offset:26624
    v_accvgpr_read_b32 v181, a145
    v_mfma_f32_16x16x32_bf16 a[184:187], v[28:31], v[108:111], a[184:187]
    ds_read_b64_tr_b16 v[20:21], v222 offset:24576
    v_accvgpr_read_b32 v182, a146
    v_mfma_f32_16x16x32_bf16 a[188:191], v[28:31], v[140:143], a[188:191]
    ds_read_b64_tr_b16 v[22:23], v222 offset:26624
    v_accvgpr_read_b32 v183, a147
    s_waitcnt lgkmcnt(8)
    v_mfma_f32_16x16x32_bf16 a[160:163], v[32:35], v[112:115], a[160:163]
    ds_read_b64_tr_b16 v[24:25], v223 offset:24576
    v_accvgpr_read_b32 v184, a152
    v_mfma_f32_16x16x32_bf16 a[164:167], v[32:35], v[144:147], a[164:167]
    ds_read_b64_tr_b16 v[26:27], v223 offset:26624
    v_accvgpr_read_b32 v185, a153
    v_mfma_f32_16x16x32_bf16 a[168:171], v[36:39], v[112:115], a[168:171]
    ds_read_b64_tr_b16 v[28:29], v224 offset:24576
    v_accvgpr_read_b32 v186, a154
    v_mfma_f32_16x16x32_bf16 a[172:175], v[36:39], v[144:147], a[172:175]
    ds_read_b64_tr_b16 v[30:31], v224 offset:26624
    v_accvgpr_read_b32 v187, a155
    s_waitcnt lgkmcnt(8)
    v_mfma_f32_16x16x32_bf16 a[176:179], v[40:43], v[112:115], a[176:179]
    ds_read_b64_tr_b16 v[32:33], v221 offset:28672
    v_cvt_pk_bf16_f32 v188, v180, v181
    v_mfma_f32_16x16x32_bf16 a[180:183], v[40:43], v[144:147], a[180:183]
    ds_read_b64_tr_b16 v[34:35], v221 offset:30720
    v_cvt_pk_bf16_f32 v189, v182, v183
    v_mfma_f32_16x16x32_bf16 a[184:187], v[44:47], v[112:115], a[184:187]
    ds_read_b64_tr_b16 v[36:37], v222 offset:28672
    v_cvt_pk_bf16_f32 v190, v184, v185
    v_mfma_f32_16x16x32_bf16 a[188:191], v[44:47], v[144:147], a[188:191]
    ds_read_b64_tr_b16 v[38:39], v222 offset:30720
    v_cvt_pk_bf16_f32 v191, v186, v187
    s_waitcnt lgkmcnt(8)
    v_mfma_f32_16x16x32_bf16 a[160:163], v[16:19], v[116:119], a[160:163]
    ds_read_b64_tr_b16 v[40:41], v223 offset:28672
    s_mov_b32 s6, 16384
    v_mfma_f32_16x16x32_bf16 a[164:167], v[16:19], v[148:151], a[164:167]
    ds_read_b64_tr_b16 v[42:43], v223 offset:30720
    buffer_store_dwordx4 v[188:191], v12, s[20:23], s6 offen sc1
    v_mfma_f32_16x16x32_bf16 a[168:171], v[20:23], v[116:119], a[168:171]
    ds_read_b64_tr_b16 v[44:45], v224 offset:28672
    v_accvgpr_read_b32 v192, a148
    v_mfma_f32_16x16x32_bf16 a[172:175], v[20:23], v[148:151], a[172:175]
    ds_read_b64_tr_b16 v[46:47], v224 offset:30720
    v_accvgpr_read_b32 v193, a149
    s_waitcnt vmcnt(3) lgkmcnt(0)
    s_barrier
    v_add_u32 v221, 98304, v221
    v_add_u32 v222, 98304, v222
    v_add_u32 v223, 98304, v223
    v_add_u32 v224, 98304, v224
    s_waitcnt lgkmcnt(8)
    v_mfma_f32_16x16x32_bf16 a[176:179], v[24:27], v[116:119], a[176:179]
    ds_read_b64_tr_b16 v[16:17], v221 offset:0
    v_accvgpr_read_b32 v194, a150
    v_mfma_f32_16x16x32_bf16 a[180:183], v[24:27], v[148:151], a[180:183]
    ds_read_b64_tr_b16 v[18:19], v221 offset:2048
    v_accvgpr_read_b32 v195, a151
    v_mfma_f32_16x16x32_bf16 a[184:187], v[28:31], v[116:119], a[184:187]
    ds_read_b64_tr_b16 v[20:21], v222 offset:0
    s_add_u32 m0, s76, 32768
    s_mov_b32 s68, 640
    buffer_load_dwordx4 v220, s[72:75], s68 offen lds
    v_accvgpr_read_b32 v196, a156
    v_mfma_f32_16x16x32_bf16 a[188:191], v[28:31], v[148:151], a[188:191]
    ds_read_b64_tr_b16 v[22:23], v222 offset:2048
    v_accvgpr_read_b32 v197, a157
    s_waitcnt lgkmcnt(8)
    v_mfma_f32_16x16x32_bf16 a[160:163], v[32:35], v[120:123], a[160:163]
    ds_read_b64_tr_b16 v[24:25], v223 offset:0
    v_accvgpr_read_b32 v198, a158
    v_mfma_f32_16x16x32_bf16 a[164:167], v[32:35], v[152:155], a[164:167]
    ds_read_b64_tr_b16 v[26:27], v223 offset:2048
    v_accvgpr_read_b32 v199, a159
    v_mfma_f32_16x16x32_bf16 a[168:171], v[36:39], v[120:123], a[168:171]
    ds_read_b64_tr_b16 v[28:29], v224 offset:0
    s_add_u32 m0, s76, 33792
    s_mov_b32 s68, 7808
    buffer_load_dwordx4 v220, s[72:75], s68 offen lds
    v_cvt_pk_bf16_f32 v200, v192, v193
    v_mfma_f32_16x16x32_bf16 a[172:175], v[36:39], v[152:155], a[172:175]
    ds_read_b64_tr_b16 v[30:31], v224 offset:2048
    v_cvt_pk_bf16_f32 v201, v194, v195
    s_waitcnt lgkmcnt(8)
    v_mfma_f32_16x16x32_bf16 a[176:179], v[40:43], v[120:123], a[176:179]
    ds_read_b64_tr_b16 v[32:33], v221 offset:4096
    v_cvt_pk_bf16_f32 v202, v196, v197
    v_mfma_f32_16x16x32_bf16 a[180:183], v[40:43], v[152:155], a[180:183]
    ds_read_b64_tr_b16 v[34:35], v221 offset:6144
    v_cvt_pk_bf16_f32 v203, v198, v199
    v_mfma_f32_16x16x32_bf16 a[184:187], v[44:47], v[120:123], a[184:187]
    ds_read_b64_tr_b16 v[36:37], v222 offset:4096
    s_add_u32 m0, s76, 34816
    s_mov_b32 s68, 14976
    buffer_load_dwordx4 v220, s[72:75], s68 offen lds
    s_mov_b32 s6, 245760
    v_mfma_f32_16x16x32_bf16 a[188:191], v[44:47], v[152:155], a[188:191]
    ds_read_b64_tr_b16 v[38:39], v222 offset:6144
    buffer_store_dwordx4 v[200:203], v12, s[20:23], s6 offen sc1
    s_waitcnt lgkmcnt(8)
    v_mfma_f32_16x16x32_bf16 a[128:131], v[16:19], v[92:95], 0
    ds_read_b64_tr_b16 v[40:41], v223 offset:4096
    v_mfma_f32_16x16x32_bf16 a[132:135], v[16:19], v[124:127], 0
    ds_read_b64_tr_b16 v[42:43], v223 offset:6144
    v_mfma_f32_16x16x32_bf16 a[136:139], v[20:23], v[92:95], 0
    ds_read_b64_tr_b16 v[44:45], v224 offset:4096
    s_add_u32 m0, s76, 35840
    s_mov_b32 s68, 22144
    buffer_load_dwordx4 v220, s[72:75], s68 offen lds
    v_mfma_f32_16x16x32_bf16 a[140:143], v[20:23], v[124:127], 0
    ds_read_b64_tr_b16 v[46:47], v224 offset:6144
    s_waitcnt lgkmcnt(8)
    v_mfma_f32_16x16x32_bf16 a[144:147], v[24:27], v[92:95], 0
    ds_read_b64_tr_b16 v[16:17], v221 offset:8192
    v_mfma_f32_16x16x32_bf16 a[148:151], v[24:27], v[124:127], 0
    ds_read_b64_tr_b16 v[18:19], v221 offset:10240
    v_mfma_f32_16x16x32_bf16 a[152:155], v[28:31], v[92:95], 0
    ds_read_b64_tr_b16 v[20:21], v222 offset:8192
    s_add_u32 m0, s76, 36864
    s_mov_b32 s68, 29312
    buffer_load_dwordx4 v220, s[72:75], s68 offen lds
    v_mfma_f32_16x16x32_bf16 a[156:159], v[28:31], v[124:127], 0
    ds_read_b64_tr_b16 v[22:23], v222 offset:10240
    s_waitcnt lgkmcnt(8)
    v_mfma_f32_16x16x32_bf16 a[128:131], v[32:35], v[96:99], a[128:131]
    ds_read_b64_tr_b16 v[24:25], v223 offset:8192
    v_accvgpr_read_b32 v156, a160
    v_mfma_f32_16x16x32_bf16 a[132:135], v[32:35], v[128:131], a[132:135]
    ds_read_b64_tr_b16 v[26:27], v223 offset:10240
    v_accvgpr_read_b32 v157, a161
    v_mfma_f32_16x16x32_bf16 a[136:139], v[36:39], v[96:99], a[136:139]
    ds_read_b64_tr_b16 v[28:29], v224 offset:8192
    s_add_u32 m0, s76, 37888
    s_mov_b32 s68, 36480
    buffer_load_dwordx4 v220, s[72:75], s68 offen lds
    v_accvgpr_read_b32 v158, a162
    v_mfma_f32_16x16x32_bf16 a[140:143], v[36:39], v[128:131], a[140:143]
    ds_read_b64_tr_b16 v[30:31], v224 offset:10240
    v_accvgpr_read_b32 v159, a163
    s_waitcnt lgkmcnt(8)
    v_mfma_f32_16x16x32_bf16 a[144:147], v[40:43], v[96:99], a[144:147]
    ds_read_b64_tr_b16 v[32:33], v221 offset:12288
    v_accvgpr_read_b32 v160, a168
    v_mfma_f32_16x16x32_bf16 a[148:151], v[40:43], v[128:131], a[148:151]
    ds_read_b64_tr_b16 v[34:35], v221 offset:14336
    v_accvgpr_read_b32 v161, a169
    v_mfma_f32_16x16x32_bf16 a[152:155], v[44:47], v[96:99], a[152:155]
    ds_read_b64_tr_b16 v[36:37], v222 offset:12288
    s_add_u32 m0, s76, 38912
    s_mov_b32 s68, 43648
    buffer_load_dwordx4 v220, s[72:75], s68 offen lds
    v_accvgpr_read_b32 v162, a170
    v_mfma_f32_16x16x32_bf16 a[156:159], v[44:47], v[128:131], a[156:159]
    ds_read_b64_tr_b16 v[38:39], v222 offset:14336
    v_accvgpr_read_b32 v163, a171
    s_waitcnt lgkmcnt(8)
    v_mfma_f32_16x16x32_bf16 a[128:131], v[16:19], v[100:103], a[128:131]
    ds_read_b64_tr_b16 v[40:41], v223 offset:12288
    v_cvt_pk_bf16_f32 v164, v156, v157
    v_mfma_f32_16x16x32_bf16 a[132:135], v[16:19], v[132:135], a[132:135]
    ds_read_b64_tr_b16 v[42:43], v223 offset:14336
    v_cvt_pk_bf16_f32 v165, v158, v159
    v_mfma_f32_16x16x32_bf16 a[136:139], v[20:23], v[100:103], a[136:139]
    ds_read_b64_tr_b16 v[44:45], v224 offset:12288
    s_add_u32 m0, s76, 39936
    s_mov_b32 s68, 50816
    buffer_load_dwordx4 v220, s[72:75], s68 offen lds
    v_cvt_pk_bf16_f32 v166, v160, v161
    v_mfma_f32_16x16x32_bf16 a[140:143], v[20:23], v[132:135], a[140:143]
    ds_read_b64_tr_b16 v[46:47], v224 offset:14336
    v_cvt_pk_bf16_f32 v167, v162, v163
    s_waitcnt lgkmcnt(8)
    v_mfma_f32_16x16x32_bf16 a[144:147], v[24:27], v[100:103], a[144:147]
    ds_read_b64_tr_b16 v[16:17], v221 offset:16384
    s_mov_b32 s6, 32768
    v_mfma_f32_16x16x32_bf16 a[148:151], v[24:27], v[132:135], a[148:151]
    ds_read_b64_tr_b16 v[18:19], v221 offset:18432
    buffer_store_dwordx4 v[164:167], v12, s[20:23], s6 offen sc1
    v_mfma_f32_16x16x32_bf16 a[152:155], v[28:31], v[100:103], a[152:155]
    ds_read_b64_tr_b16 v[20:21], v222 offset:16384
    s_add_u32 m0, s76, 0
    s_mov_b32 s68, 768
    buffer_load_dwordx4 v220, s[72:75], s68 offen lds
    v_accvgpr_read_b32 v168, a164
    v_mfma_f32_16x16x32_bf16 a[156:159], v[28:31], v[132:135], a[156:159]
    ds_read_b64_tr_b16 v[22:23], v222 offset:18432
    v_accvgpr_read_b32 v169, a165
    s_waitcnt lgkmcnt(8)
    v_mfma_f32_16x16x32_bf16 a[128:131], v[32:35], v[104:107], a[128:131]
    ds_read_b64_tr_b16 v[24:25], v223 offset:16384
    v_accvgpr_read_b32 v170, a166
    v_mfma_f32_16x16x32_bf16 a[132:135], v[32:35], v[136:139], a[132:135]
    ds_read_b64_tr_b16 v[26:27], v223 offset:18432
    v_accvgpr_read_b32 v171, a167
    v_mfma_f32_16x16x32_bf16 a[136:139], v[36:39], v[104:107], a[136:139]
    ds_read_b64_tr_b16 v[28:29], v224 offset:16384
    s_add_u32 m0, s76, 1024
    s_mov_b32 s68, 7936
    buffer_load_dwordx4 v220, s[72:75], s68 offen lds
    v_accvgpr_read_b32 v172, a172
    v_mfma_f32_16x16x32_bf16 a[140:143], v[36:39], v[136:139], a[140:143]
    ds_read_b64_tr_b16 v[30:31], v224 offset:18432
    v_accvgpr_read_b32 v173, a173
    s_waitcnt lgkmcnt(8)
    v_mfma_f32_16x16x32_bf16 a[144:147], v[40:43], v[104:107], a[144:147]
    ds_read_b64_tr_b16 v[32:33], v221 offset:20480
    v_accvgpr_read_b32 v174, a174
    v_mfma_f32_16x16x32_bf16 a[148:151], v[40:43], v[136:139], a[148:151]
    ds_read_b64_tr_b16 v[34:35], v221 offset:22528
    v_accvgpr_read_b32 v175, a175
    v_mfma_f32_16x16x32_bf16 a[152:155], v[44:47], v[104:107], a[152:155]
    ds_read_b64_tr_b16 v[36:37], v222 offset:20480
    s_add_u32 m0, s76, 2048
    s_mov_b32 s68, 15104
    buffer_load_dwordx4 v220, s[72:75], s68 offen lds
    v_cvt_pk_bf16_f32 v176, v168, v169
    v_mfma_f32_16x16x32_bf16 a[156:159], v[44:47], v[136:139], a[156:159]
    ds_read_b64_tr_b16 v[38:39], v222 offset:22528
    v_cvt_pk_bf16_f32 v177, v170, v171
    s_waitcnt lgkmcnt(8)
    v_mfma_f32_16x16x32_bf16 a[128:131], v[16:19], v[108:111], a[128:131]
    ds_read_b64_tr_b16 v[40:41], v223 offset:20480
    v_cvt_pk_bf16_f32 v178, v172, v173
    v_mfma_f32_16x16x32_bf16 a[132:135], v[16:19], v[140:143], a[132:135]
    ds_read_b64_tr_b16 v[42:43], v223 offset:22528
    v_cvt_pk_bf16_f32 v179, v174, v175
    v_mfma_f32_16x16x32_bf16 a[136:139], v[20:23], v[108:111], a[136:139]
    ds_read_b64_tr_b16 v[44:45], v224 offset:20480
    s_add_u32 m0, s76, 3072
    s_mov_b32 s68, 22272
    buffer_load_dwordx4 v220, s[72:75], s68 offen lds
    s_mov_b32 s6, 262144
    v_mfma_f32_16x16x32_bf16 a[140:143], v[20:23], v[140:143], a[140:143]
    ds_read_b64_tr_b16 v[46:47], v224 offset:22528
    buffer_store_dwordx4 v[176:179], v12, s[20:23], s6 offen sc1
    s_waitcnt lgkmcnt(8)
    v_mfma_f32_16x16x32_bf16 a[144:147], v[24:27], v[108:111], a[144:147]
    ds_read_b64_tr_b16 v[16:17], v221 offset:24576
    v_accvgpr_read_b32 v180, a176
    v_mfma_f32_16x16x32_bf16 a[148:151], v[24:27], v[140:143], a[148:151]
    ds_read_b64_tr_b16 v[18:19], v221 offset:26624
    v_accvgpr_read_b32 v181, a177
    v_mfma_f32_16x16x32_bf16 a[152:155], v[28:31], v[108:111], a[152:155]
    ds_read_b64_tr_b16 v[20:21], v222 offset:24576
    s_add_u32 m0, s76, 4096
    s_mov_b32 s68, 29440
    buffer_load_dwordx4 v220, s[72:75], s68 offen lds
    v_accvgpr_read_b32 v182, a178
    v_mfma_f32_16x16x32_bf16 a[156:159], v[28:31], v[140:143], a[156:159]
    ds_read_b64_tr_b16 v[22:23], v222 offset:26624
    v_accvgpr_read_b32 v183, a179
    s_waitcnt lgkmcnt(8)
    v_mfma_f32_16x16x32_bf16 a[128:131], v[32:35], v[112:115], a[128:131]
    ds_read_b64_tr_b16 v[24:25], v223 offset:24576
    v_accvgpr_read_b32 v184, a184
    v_mfma_f32_16x16x32_bf16 a[132:135], v[32:35], v[144:147], a[132:135]
    ds_read_b64_tr_b16 v[26:27], v223 offset:26624
    v_accvgpr_read_b32 v185, a185
    v_mfma_f32_16x16x32_bf16 a[136:139], v[36:39], v[112:115], a[136:139]
    ds_read_b64_tr_b16 v[28:29], v224 offset:24576
    s_add_u32 m0, s76, 5120
    s_mov_b32 s68, 36608
    buffer_load_dwordx4 v220, s[72:75], s68 offen lds
    v_accvgpr_read_b32 v186, a186
    v_mfma_f32_16x16x32_bf16 a[140:143], v[36:39], v[144:147], a[140:143]
    ds_read_b64_tr_b16 v[30:31], v224 offset:26624
    v_accvgpr_read_b32 v187, a187
    s_waitcnt lgkmcnt(8)
    v_mfma_f32_16x16x32_bf16 a[144:147], v[40:43], v[112:115], a[144:147]
    ds_read_b64_tr_b16 v[32:33], v221 offset:28672
    v_cvt_pk_bf16_f32 v188, v180, v181
    v_mfma_f32_16x16x32_bf16 a[148:151], v[40:43], v[144:147], a[148:151]
    ds_read_b64_tr_b16 v[34:35], v221 offset:30720
    v_cvt_pk_bf16_f32 v189, v182, v183
    v_mfma_f32_16x16x32_bf16 a[152:155], v[44:47], v[112:115], a[152:155]
    ds_read_b64_tr_b16 v[36:37], v222 offset:28672
    s_add_u32 m0, s76, 6144
    s_mov_b32 s68, 43776
    buffer_load_dwordx4 v220, s[72:75], s68 offen lds
    v_cvt_pk_bf16_f32 v190, v184, v185
    v_mfma_f32_16x16x32_bf16 a[156:159], v[44:47], v[144:147], a[156:159]
    ds_read_b64_tr_b16 v[38:39], v222 offset:30720
    v_cvt_pk_bf16_f32 v191, v186, v187
    s_waitcnt lgkmcnt(8)
    v_mfma_f32_16x16x32_bf16 a[128:131], v[16:19], v[116:119], a[128:131]
    ds_read_b64_tr_b16 v[40:41], v223 offset:28672
    s_mov_b32 s6, 49152
    v_mfma_f32_16x16x32_bf16 a[132:135], v[16:19], v[148:151], a[132:135]
    ds_read_b64_tr_b16 v[42:43], v223 offset:30720
    buffer_store_dwordx4 v[188:191], v12, s[20:23], s6 offen sc1
    v_mfma_f32_16x16x32_bf16 a[136:139], v[20:23], v[116:119], a[136:139]
    ds_read_b64_tr_b16 v[44:45], v224 offset:28672
    s_add_u32 m0, s76, 7168
    s_mov_b32 s68, 50944
    buffer_load_dwordx4 v220, s[72:75], s68 offen lds
    v_accvgpr_read_b32 v192, a180
    v_mfma_f32_16x16x32_bf16 a[140:143], v[20:23], v[148:151], a[140:143]
    ds_read_b64_tr_b16 v[46:47], v224 offset:30720
    v_accvgpr_read_b32 v193, a181
    v_add_u32 v221, 32768, v221
    v_add_u32 v222, 32768, v222
    v_add_u32 v223, 32768, v223
    v_add_u32 v224, 32768, v224
    s_waitcnt lgkmcnt(8)
    v_mfma_f32_16x16x32_bf16 a[144:147], v[24:27], v[116:119], a[144:147]
    ds_read_b64_tr_b16 v[16:17], v221 offset:0
    v_accvgpr_read_b32 v194, a182
    v_mfma_f32_16x16x32_bf16 a[148:151], v[24:27], v[148:151], a[148:151]
    ds_read_b64_tr_b16 v[18:19], v221 offset:2048
    v_accvgpr_read_b32 v195, a183
    v_mfma_f32_16x16x32_bf16 a[152:155], v[28:31], v[116:119], a[152:155]
    ds_read_b64_tr_b16 v[20:21], v222 offset:0
    v_accvgpr_read_b32 v196, a188
    v_mfma_f32_16x16x32_bf16 a[156:159], v[28:31], v[148:151], a[156:159]
    ds_read_b64_tr_b16 v[22:23], v222 offset:2048
    v_accvgpr_read_b32 v197, a189
    s_waitcnt lgkmcnt(8)
    v_mfma_f32_16x16x32_bf16 a[128:131], v[32:35], v[120:123], a[128:131]
    ds_read_b64_tr_b16 v[24:25], v223 offset:0
    v_accvgpr_read_b32 v198, a190
    v_mfma_f32_16x16x32_bf16 a[132:135], v[32:35], v[152:155], a[132:135]
    ds_read_b64_tr_b16 v[26:27], v223 offset:2048
    v_accvgpr_read_b32 v199, a191
    v_mfma_f32_16x16x32_bf16 a[136:139], v[36:39], v[120:123], a[136:139]
    ds_read_b64_tr_b16 v[28:29], v224 offset:0
    v_cvt_pk_bf16_f32 v200, v192, v193
    v_mfma_f32_16x16x32_bf16 a[140:143], v[36:39], v[152:155], a[140:143]
    ds_read_b64_tr_b16 v[30:31], v224 offset:2048
    v_cvt_pk_bf16_f32 v201, v194, v195
    s_waitcnt lgkmcnt(8)
    v_mfma_f32_16x16x32_bf16 a[144:147], v[40:43], v[120:123], a[144:147]
    ds_read_b64_tr_b16 v[32:33], v221 offset:4096
    v_cvt_pk_bf16_f32 v202, v196, v197
    v_mfma_f32_16x16x32_bf16 a[148:151], v[40:43], v[152:155], a[148:151]
    ds_read_b64_tr_b16 v[34:35], v221 offset:6144
    v_cvt_pk_bf16_f32 v203, v198, v199
    v_mfma_f32_16x16x32_bf16 a[152:155], v[44:47], v[120:123], a[152:155]
    ds_read_b64_tr_b16 v[36:37], v222 offset:4096
    s_mov_b32 s6, 278528
    v_mfma_f32_16x16x32_bf16 a[156:159], v[44:47], v[152:155], a[156:159]
    ds_read_b64_tr_b16 v[38:39], v222 offset:6144
    buffer_store_dwordx4 v[200:203], v12, s[20:23], s6 offen sc1
    s_waitcnt lgkmcnt(8)
    v_mfma_f32_16x16x32_bf16 a[160:163], v[16:19], v[92:95], 0
    ds_read_b64_tr_b16 v[40:41], v223 offset:4096
    v_mfma_f32_16x16x32_bf16 a[164:167], v[16:19], v[124:127], 0
    ds_read_b64_tr_b16 v[42:43], v223 offset:6144
    v_mfma_f32_16x16x32_bf16 a[168:171], v[20:23], v[92:95], 0
    ds_read_b64_tr_b16 v[44:45], v224 offset:4096
    v_mfma_f32_16x16x32_bf16 a[172:175], v[20:23], v[124:127], 0
    ds_read_b64_tr_b16 v[46:47], v224 offset:6144
    s_waitcnt lgkmcnt(8)
    v_mfma_f32_16x16x32_bf16 a[176:179], v[24:27], v[92:95], 0
    ds_read_b64_tr_b16 v[16:17], v221 offset:8192
    v_mfma_f32_16x16x32_bf16 a[180:183], v[24:27], v[124:127], 0
    ds_read_b64_tr_b16 v[18:19], v221 offset:10240
    v_mfma_f32_16x16x32_bf16 a[184:187], v[28:31], v[92:95], 0
    ds_read_b64_tr_b16 v[20:21], v222 offset:8192
    v_mfma_f32_16x16x32_bf16 a[188:191], v[28:31], v[124:127], 0
    ds_read_b64_tr_b16 v[22:23], v222 offset:10240
    s_waitcnt lgkmcnt(8)
    v_mfma_f32_16x16x32_bf16 a[160:163], v[32:35], v[96:99], a[160:163]
    ds_read_b64_tr_b16 v[24:25], v223 offset:8192
    v_accvgpr_read_b32 v156, a128
    v_mfma_f32_16x16x32_bf16 a[164:167], v[32:35], v[128:131], a[164:167]
    ds_read_b64_tr_b16 v[26:27], v223 offset:10240
    v_accvgpr_read_b32 v157, a129
    v_mfma_f32_16x16x32_bf16 a[168:171], v[36:39], v[96:99], a[168:171]
    ds_read_b64_tr_b16 v[28:29], v224 offset:8192
    v_accvgpr_read_b32 v158, a130
    v_mfma_f32_16x16x32_bf16 a[172:175], v[36:39], v[128:131], a[172:175]
    ds_read_b64_tr_b16 v[30:31], v224 offset:10240
    v_accvgpr_read_b32 v159, a131
    s_waitcnt lgkmcnt(8)
    v_mfma_f32_16x16x32_bf16 a[176:179], v[40:43], v[96:99], a[176:179]
    ds_read_b64_tr_b16 v[32:33], v221 offset:12288
    v_accvgpr_read_b32 v160, a136
    v_mfma_f32_16x16x32_bf16 a[180:183], v[40:43], v[128:131], a[180:183]
    ds_read_b64_tr_b16 v[34:35], v221 offset:14336
    v_accvgpr_read_b32 v161, a137
    v_mfma_f32_16x16x32_bf16 a[184:187], v[44:47], v[96:99], a[184:187]
    ds_read_b64_tr_b16 v[36:37], v222 offset:12288
    v_accvgpr_read_b32 v162, a138
    v_mfma_f32_16x16x32_bf16 a[188:191], v[44:47], v[128:131], a[188:191]
    ds_read_b64_tr_b16 v[38:39], v222 offset:14336
    v_accvgpr_read_b32 v163, a139
    s_waitcnt lgkmcnt(8)
    v_mfma_f32_16x16x32_bf16 a[160:163], v[16:19], v[100:103], a[160:163]
    ds_read_b64_tr_b16 v[40:41], v223 offset:12288
    v_cvt_pk_bf16_f32 v164, v156, v157
    v_mfma_f32_16x16x32_bf16 a[164:167], v[16:19], v[132:135], a[164:167]
    ds_read_b64_tr_b16 v[42:43], v223 offset:14336
    v_cvt_pk_bf16_f32 v165, v158, v159
    v_mfma_f32_16x16x32_bf16 a[168:171], v[20:23], v[100:103], a[168:171]
    ds_read_b64_tr_b16 v[44:45], v224 offset:12288
    v_cvt_pk_bf16_f32 v166, v160, v161
    v_mfma_f32_16x16x32_bf16 a[172:175], v[20:23], v[132:135], a[172:175]
    ds_read_b64_tr_b16 v[46:47], v224 offset:14336
    v_cvt_pk_bf16_f32 v167, v162, v163
    s_waitcnt lgkmcnt(8)
    v_mfma_f32_16x16x32_bf16 a[176:179], v[24:27], v[100:103], a[176:179]
    ds_read_b64_tr_b16 v[16:17], v221 offset:16384
    s_mov_b32 s6, 65536
    v_mfma_f32_16x16x32_bf16 a[180:183], v[24:27], v[132:135], a[180:183]
    ds_read_b64_tr_b16 v[18:19], v221 offset:18432
    buffer_store_dwordx4 v[164:167], v12, s[20:23], s6 offen sc1
    v_mfma_f32_16x16x32_bf16 a[184:187], v[28:31], v[100:103], a[184:187]
    ds_read_b64_tr_b16 v[20:21], v222 offset:16384
    v_accvgpr_read_b32 v168, a132
    v_mfma_f32_16x16x32_bf16 a[188:191], v[28:31], v[132:135], a[188:191]
    ds_read_b64_tr_b16 v[22:23], v222 offset:18432
    v_accvgpr_read_b32 v169, a133
    s_waitcnt lgkmcnt(8)
    v_mfma_f32_16x16x32_bf16 a[160:163], v[32:35], v[104:107], a[160:163]
    ds_read_b64_tr_b16 v[24:25], v223 offset:16384
    v_accvgpr_read_b32 v170, a134
    v_mfma_f32_16x16x32_bf16 a[164:167], v[32:35], v[136:139], a[164:167]
    ds_read_b64_tr_b16 v[26:27], v223 offset:18432
    v_accvgpr_read_b32 v171, a135
    v_mfma_f32_16x16x32_bf16 a[168:171], v[36:39], v[104:107], a[168:171]
    ds_read_b64_tr_b16 v[28:29], v224 offset:16384
    v_accvgpr_read_b32 v172, a140
    v_mfma_f32_16x16x32_bf16 a[172:175], v[36:39], v[136:139], a[172:175]
    ds_read_b64_tr_b16 v[30:31], v224 offset:18432
    v_accvgpr_read_b32 v173, a141
    s_waitcnt lgkmcnt(8)
    v_mfma_f32_16x16x32_bf16 a[176:179], v[40:43], v[104:107], a[176:179]
    ds_read_b64_tr_b16 v[32:33], v221 offset:20480
    v_accvgpr_read_b32 v174, a142
    v_mfma_f32_16x16x32_bf16 a[180:183], v[40:43], v[136:139], a[180:183]
    ds_read_b64_tr_b16 v[34:35], v221 offset:22528
    v_accvgpr_read_b32 v175, a143
    v_mfma_f32_16x16x32_bf16 a[184:187], v[44:47], v[104:107], a[184:187]
    ds_read_b64_tr_b16 v[36:37], v222 offset:20480
    v_cvt_pk_bf16_f32 v176, v168, v169
    v_mfma_f32_16x16x32_bf16 a[188:191], v[44:47], v[136:139], a[188:191]
    ds_read_b64_tr_b16 v[38:39], v222 offset:22528
    v_cvt_pk_bf16_f32 v177, v170, v171
    s_waitcnt lgkmcnt(8)
    v_mfma_f32_16x16x32_bf16 a[160:163], v[16:19], v[108:111], a[160:163]
    ds_read_b64_tr_b16 v[40:41], v223 offset:20480
    v_cvt_pk_bf16_f32 v178, v172, v173
    v_mfma_f32_16x16x32_bf16 a[164:167], v[16:19], v[140:143], a[164:167]
    ds_read_b64_tr_b16 v[42:43], v223 offset:22528
    v_cvt_pk_bf16_f32 v179, v174, v175
    v_mfma_f32_16x16x32_bf16 a[168:171], v[20:23], v[108:111], a[168:171]
    ds_read_b64_tr_b16 v[44:45], v224 offset:20480
    s_mov_b32 s6, 294912
    v_mfma_f32_16x16x32_bf16 a[172:175], v[20:23], v[140:143], a[172:175]
    ds_read_b64_tr_b16 v[46:47], v224 offset:22528
    buffer_store_dwordx4 v[176:179], v12, s[20:23], s6 offen sc1
    s_waitcnt lgkmcnt(8)
    v_mfma_f32_16x16x32_bf16 a[176:179], v[24:27], v[108:111], a[176:179]
    ds_read_b64_tr_b16 v[16:17], v221 offset:24576
    v_accvgpr_read_b32 v180, a144
    v_mfma_f32_16x16x32_bf16 a[180:183], v[24:27], v[140:143], a[180:183]
    ds_read_b64_tr_b16 v[18:19], v221 offset:26624
    v_accvgpr_read_b32 v181, a145
    v_mfma_f32_16x16x32_bf16 a[184:187], v[28:31], v[108:111], a[184:187]
    ds_read_b64_tr_b16 v[20:21], v222 offset:24576
    v_accvgpr_read_b32 v182, a146
    v_mfma_f32_16x16x32_bf16 a[188:191], v[28:31], v[140:143], a[188:191]
    ds_read_b64_tr_b16 v[22:23], v222 offset:26624
    v_accvgpr_read_b32 v183, a147
    s_waitcnt lgkmcnt(8)
    v_mfma_f32_16x16x32_bf16 a[160:163], v[32:35], v[112:115], a[160:163]
    ds_read_b64_tr_b16 v[24:25], v223 offset:24576
    v_accvgpr_read_b32 v184, a152
    v_mfma_f32_16x16x32_bf16 a[164:167], v[32:35], v[144:147], a[164:167]
    ds_read_b64_tr_b16 v[26:27], v223 offset:26624
    v_accvgpr_read_b32 v185, a153
    v_mfma_f32_16x16x32_bf16 a[168:171], v[36:39], v[112:115], a[168:171]
    ds_read_b64_tr_b16 v[28:29], v224 offset:24576
    v_accvgpr_read_b32 v186, a154
    v_mfma_f32_16x16x32_bf16 a[172:175], v[36:39], v[144:147], a[172:175]
    ds_read_b64_tr_b16 v[30:31], v224 offset:26624
    v_accvgpr_read_b32 v187, a155
    s_waitcnt lgkmcnt(8)
    v_mfma_f32_16x16x32_bf16 a[176:179], v[40:43], v[112:115], a[176:179]
    ds_read_b64_tr_b16 v[32:33], v221 offset:28672
    v_cvt_pk_bf16_f32 v188, v180, v181
    v_mfma_f32_16x16x32_bf16 a[180:183], v[40:43], v[144:147], a[180:183]
    ds_read_b64_tr_b16 v[34:35], v221 offset:30720
    v_cvt_pk_bf16_f32 v189, v182, v183
    v_mfma_f32_16x16x32_bf16 a[184:187], v[44:47], v[112:115], a[184:187]
    ds_read_b64_tr_b16 v[36:37], v222 offset:28672
    v_cvt_pk_bf16_f32 v190, v184, v185
    v_mfma_f32_16x16x32_bf16 a[188:191], v[44:47], v[144:147], a[188:191]
    ds_read_b64_tr_b16 v[38:39], v222 offset:30720
    v_cvt_pk_bf16_f32 v191, v186, v187
    s_waitcnt lgkmcnt(8)
    v_mfma_f32_16x16x32_bf16 a[160:163], v[16:19], v[116:119], a[160:163]
    ds_read_b64_tr_b16 v[40:41], v223 offset:28672
    s_mov_b32 s6, 81920
    v_mfma_f32_16x16x32_bf16 a[164:167], v[16:19], v[148:151], a[164:167]
    ds_read_b64_tr_b16 v[42:43], v223 offset:30720
    buffer_store_dwordx4 v[188:191], v12, s[20:23], s6 offen sc1
    v_mfma_f32_16x16x32_bf16 a[168:171], v[20:23], v[116:119], a[168:171]
    ds_read_b64_tr_b16 v[44:45], v224 offset:28672
    v_accvgpr_read_b32 v192, a148
    v_mfma_f32_16x16x32_bf16 a[172:175], v[20:23], v[148:151], a[172:175]
    ds_read_b64_tr_b16 v[46:47], v224 offset:30720
    v_accvgpr_read_b32 v193, a149
    v_add_u32 v221, 4294901760, v221
    v_add_u32 v222, 4294901760, v222
    v_add_u32 v223, 4294901760, v223
    v_add_u32 v224, 4294901760, v224
    s_waitcnt lgkmcnt(8)
    v_mfma_f32_16x16x32_bf16 a[176:179], v[24:27], v[116:119], a[176:179]
    ds_read_b64_tr_b16 v[16:17], v221 offset:0
    v_accvgpr_read_b32 v194, a150
    v_mfma_f32_16x16x32_bf16 a[180:183], v[24:27], v[148:151], a[180:183]
    ds_read_b64_tr_b16 v[18:19], v221 offset:2048
    v_accvgpr_read_b32 v195, a151
    v_mfma_f32_16x16x32_bf16 a[184:187], v[28:31], v[116:119], a[184:187]
    ds_read_b64_tr_b16 v[20:21], v222 offset:0
    v_accvgpr_read_b32 v196, a156
    v_mfma_f32_16x16x32_bf16 a[188:191], v[28:31], v[148:151], a[188:191]
    ds_read_b64_tr_b16 v[22:23], v222 offset:2048
    v_accvgpr_read_b32 v197, a157
    s_waitcnt lgkmcnt(8)
    v_mfma_f32_16x16x32_bf16 a[160:163], v[32:35], v[120:123], a[160:163]
    ds_read_b64_tr_b16 v[24:25], v223 offset:0
    v_accvgpr_read_b32 v198, a158
    v_mfma_f32_16x16x32_bf16 a[164:167], v[32:35], v[152:155], a[164:167]
    ds_read_b64_tr_b16 v[26:27], v223 offset:2048
    v_accvgpr_read_b32 v199, a159
    v_mfma_f32_16x16x32_bf16 a[168:171], v[36:39], v[120:123], a[168:171]
    ds_read_b64_tr_b16 v[28:29], v224 offset:0
    v_cvt_pk_bf16_f32 v200, v192, v193
    v_mfma_f32_16x16x32_bf16 a[172:175], v[36:39], v[152:155], a[172:175]
    ds_read_b64_tr_b16 v[30:31], v224 offset:2048
    v_cvt_pk_bf16_f32 v201, v194, v195
    s_waitcnt lgkmcnt(8)
    v_mfma_f32_16x16x32_bf16 a[176:179], v[40:43], v[120:123], a[176:179]
    ds_read_b64_tr_b16 v[32:33], v221 offset:4096
    v_cvt_pk_bf16_f32 v202, v196, v197
    v_mfma_f32_16x16x32_bf16 a[180:183], v[40:43], v[152:155], a[180:183]
    ds_read_b64_tr_b16 v[34:35], v221 offset:6144
    v_cvt_pk_bf16_f32 v203, v198, v199
    v_mfma_f32_16x16x32_bf16 a[184:187], v[44:47], v[120:123], a[184:187]
    ds_read_b64_tr_b16 v[36:37], v222 offset:4096
    s_mov_b32 s6, 311296
    v_mfma_f32_16x16x32_bf16 a[188:191], v[44:47], v[152:155], a[188:191]
    ds_read_b64_tr_b16 v[38:39], v222 offset:6144
    buffer_store_dwordx4 v[200:203], v12, s[20:23], s6 offen sc1
    s_waitcnt lgkmcnt(8)
    v_mfma_f32_16x16x32_bf16 a[128:131], v[16:19], v[92:95], 0
    ds_read_b64_tr_b16 v[40:41], v223 offset:4096
    v_mfma_f32_16x16x32_bf16 a[132:135], v[16:19], v[124:127], 0
    ds_read_b64_tr_b16 v[42:43], v223 offset:6144
    v_mfma_f32_16x16x32_bf16 a[136:139], v[20:23], v[92:95], 0
    ds_read_b64_tr_b16 v[44:45], v224 offset:4096
    v_mfma_f32_16x16x32_bf16 a[140:143], v[20:23], v[124:127], 0
    ds_read_b64_tr_b16 v[46:47], v224 offset:6144
    s_waitcnt lgkmcnt(8)
    v_mfma_f32_16x16x32_bf16 a[144:147], v[24:27], v[92:95], 0
    ds_read_b64_tr_b16 v[16:17], v221 offset:8192
    v_mfma_f32_16x16x32_bf16 a[148:151], v[24:27], v[124:127], 0
    ds_read_b64_tr_b16 v[18:19], v221 offset:10240
    v_mfma_f32_16x16x32_bf16 a[152:155], v[28:31], v[92:95], 0
    ds_read_b64_tr_b16 v[20:21], v222 offset:8192
    v_mfma_f32_16x16x32_bf16 a[156:159], v[28:31], v[124:127], 0
    ds_read_b64_tr_b16 v[22:23], v222 offset:10240
    s_waitcnt lgkmcnt(8)
    v_mfma_f32_16x16x32_bf16 a[128:131], v[32:35], v[96:99], a[128:131]
    ds_read_b64_tr_b16 v[24:25], v223 offset:8192
    v_accvgpr_read_b32 v156, a160
    v_mfma_f32_16x16x32_bf16 a[132:135], v[32:35], v[128:131], a[132:135]
    ds_read_b64_tr_b16 v[26:27], v223 offset:10240
    v_accvgpr_read_b32 v157, a161
    v_mfma_f32_16x16x32_bf16 a[136:139], v[36:39], v[96:99], a[136:139]
    ds_read_b64_tr_b16 v[28:29], v224 offset:8192
    v_accvgpr_read_b32 v158, a162
    v_mfma_f32_16x16x32_bf16 a[140:143], v[36:39], v[128:131], a[140:143]
    ds_read_b64_tr_b16 v[30:31], v224 offset:10240
    v_accvgpr_read_b32 v159, a163
    s_waitcnt lgkmcnt(8)
    v_mfma_f32_16x16x32_bf16 a[144:147], v[40:43], v[96:99], a[144:147]
    ds_read_b64_tr_b16 v[32:33], v221 offset:12288
    v_accvgpr_read_b32 v160, a168
    v_mfma_f32_16x16x32_bf16 a[148:151], v[40:43], v[128:131], a[148:151]
    ds_read_b64_tr_b16 v[34:35], v221 offset:14336
    v_accvgpr_read_b32 v161, a169
    v_mfma_f32_16x16x32_bf16 a[152:155], v[44:47], v[96:99], a[152:155]
    ds_read_b64_tr_b16 v[36:37], v222 offset:12288
    v_accvgpr_read_b32 v162, a170
    v_mfma_f32_16x16x32_bf16 a[156:159], v[44:47], v[128:131], a[156:159]
    ds_read_b64_tr_b16 v[38:39], v222 offset:14336
    v_accvgpr_read_b32 v163, a171
    s_waitcnt lgkmcnt(8)
    v_mfma_f32_16x16x32_bf16 a[128:131], v[16:19], v[100:103], a[128:131]
    ds_read_b64_tr_b16 v[40:41], v223 offset:12288
    v_cvt_pk_bf16_f32 v164, v156, v157
    v_mfma_f32_16x16x32_bf16 a[132:135], v[16:19], v[132:135], a[132:135]
    ds_read_b64_tr_b16 v[42:43], v223 offset:14336
    v_cvt_pk_bf16_f32 v165, v158, v159
    v_mfma_f32_16x16x32_bf16 a[136:139], v[20:23], v[100:103], a[136:139]
    ds_read_b64_tr_b16 v[44:45], v224 offset:12288
    v_cvt_pk_bf16_f32 v166, v160, v161
    v_mfma_f32_16x16x32_bf16 a[140:143], v[20:23], v[132:135], a[140:143]
    ds_read_b64_tr_b16 v[46:47], v224 offset:14336
    v_cvt_pk_bf16_f32 v167, v162, v163
    s_waitcnt lgkmcnt(8)
    v_mfma_f32_16x16x32_bf16 a[144:147], v[24:27], v[100:103], a[144:147]
    ds_read_b64_tr_b16 v[16:17], v221 offset:16384
    s_mov_b32 s6, 98304
    v_mfma_f32_16x16x32_bf16 a[148:151], v[24:27], v[132:135], a[148:151]
    ds_read_b64_tr_b16 v[18:19], v221 offset:18432
    buffer_store_dwordx4 v[164:167], v12, s[20:23], s6 offen sc1
    v_mfma_f32_16x16x32_bf16 a[152:155], v[28:31], v[100:103], a[152:155]
    ds_read_b64_tr_b16 v[20:21], v222 offset:16384
    v_accvgpr_read_b32 v168, a164
    v_mfma_f32_16x16x32_bf16 a[156:159], v[28:31], v[132:135], a[156:159]
    ds_read_b64_tr_b16 v[22:23], v222 offset:18432
    v_accvgpr_read_b32 v169, a165
    s_waitcnt lgkmcnt(8)
    v_mfma_f32_16x16x32_bf16 a[128:131], v[32:35], v[104:107], a[128:131]
    ds_read_b64_tr_b16 v[24:25], v223 offset:16384
    v_accvgpr_read_b32 v170, a166
    v_mfma_f32_16x16x32_bf16 a[132:135], v[32:35], v[136:139], a[132:135]
    ds_read_b64_tr_b16 v[26:27], v223 offset:18432
    v_accvgpr_read_b32 v171, a167
    v_mfma_f32_16x16x32_bf16 a[136:139], v[36:39], v[104:107], a[136:139]
    ds_read_b64_tr_b16 v[28:29], v224 offset:16384
    v_accvgpr_read_b32 v172, a172
    v_mfma_f32_16x16x32_bf16 a[140:143], v[36:39], v[136:139], a[140:143]
    ds_read_b64_tr_b16 v[30:31], v224 offset:18432
    v_accvgpr_read_b32 v173, a173
    s_waitcnt lgkmcnt(8)
    v_mfma_f32_16x16x32_bf16 a[144:147], v[40:43], v[104:107], a[144:147]
    ds_read_b64_tr_b16 v[32:33], v221 offset:20480
    v_accvgpr_read_b32 v174, a174
    v_mfma_f32_16x16x32_bf16 a[148:151], v[40:43], v[136:139], a[148:151]
    ds_read_b64_tr_b16 v[34:35], v221 offset:22528
    v_accvgpr_read_b32 v175, a175
    v_mfma_f32_16x16x32_bf16 a[152:155], v[44:47], v[104:107], a[152:155]
    ds_read_b64_tr_b16 v[36:37], v222 offset:20480
    v_cvt_pk_bf16_f32 v176, v168, v169
    v_mfma_f32_16x16x32_bf16 a[156:159], v[44:47], v[136:139], a[156:159]
    ds_read_b64_tr_b16 v[38:39], v222 offset:22528
    v_cvt_pk_bf16_f32 v177, v170, v171
    s_waitcnt lgkmcnt(8)
    v_mfma_f32_16x16x32_bf16 a[128:131], v[16:19], v[108:111], a[128:131]
    ds_read_b64_tr_b16 v[40:41], v223 offset:20480
    v_cvt_pk_bf16_f32 v178, v172, v173
    v_mfma_f32_16x16x32_bf16 a[132:135], v[16:19], v[140:143], a[132:135]
    ds_read_b64_tr_b16 v[42:43], v223 offset:22528
    v_cvt_pk_bf16_f32 v179, v174, v175
    v_mfma_f32_16x16x32_bf16 a[136:139], v[20:23], v[108:111], a[136:139]
    ds_read_b64_tr_b16 v[44:45], v224 offset:20480
    s_mov_b32 s6, 327680
    v_mfma_f32_16x16x32_bf16 a[140:143], v[20:23], v[140:143], a[140:143]
    ds_read_b64_tr_b16 v[46:47], v224 offset:22528
    buffer_store_dwordx4 v[176:179], v12, s[20:23], s6 offen sc1
    s_waitcnt lgkmcnt(8)
    v_mfma_f32_16x16x32_bf16 a[144:147], v[24:27], v[108:111], a[144:147]
    ds_read_b64_tr_b16 v[16:17], v221 offset:24576
    v_accvgpr_read_b32 v180, a176
    v_mfma_f32_16x16x32_bf16 a[148:151], v[24:27], v[140:143], a[148:151]
    ds_read_b64_tr_b16 v[18:19], v221 offset:26624
    v_accvgpr_read_b32 v181, a177
    v_mfma_f32_16x16x32_bf16 a[152:155], v[28:31], v[108:111], a[152:155]
    ds_read_b64_tr_b16 v[20:21], v222 offset:24576
    v_accvgpr_read_b32 v182, a178
    v_mfma_f32_16x16x32_bf16 a[156:159], v[28:31], v[140:143], a[156:159]
    ds_read_b64_tr_b16 v[22:23], v222 offset:26624
    v_accvgpr_read_b32 v183, a179
    s_waitcnt lgkmcnt(8)
    v_mfma_f32_16x16x32_bf16 a[128:131], v[32:35], v[112:115], a[128:131]
    ds_read_b64_tr_b16 v[24:25], v223 offset:24576
    v_accvgpr_read_b32 v184, a184
    v_mfma_f32_16x16x32_bf16 a[132:135], v[32:35], v[144:147], a[132:135]
    ds_read_b64_tr_b16 v[26:27], v223 offset:26624
    v_accvgpr_read_b32 v185, a185
    v_mfma_f32_16x16x32_bf16 a[136:139], v[36:39], v[112:115], a[136:139]
    ds_read_b64_tr_b16 v[28:29], v224 offset:24576
    v_accvgpr_read_b32 v186, a186
    v_mfma_f32_16x16x32_bf16 a[140:143], v[36:39], v[144:147], a[140:143]
    ds_read_b64_tr_b16 v[30:31], v224 offset:26624
    v_accvgpr_read_b32 v187, a187
    s_waitcnt lgkmcnt(8)
    v_mfma_f32_16x16x32_bf16 a[144:147], v[40:43], v[112:115], a[144:147]
    ds_read_b64_tr_b16 v[32:33], v221 offset:28672
    v_cvt_pk_bf16_f32 v188, v180, v181
    v_mfma_f32_16x16x32_bf16 a[148:151], v[40:43], v[144:147], a[148:151]
    ds_read_b64_tr_b16 v[34:35], v221 offset:30720
    v_cvt_pk_bf16_f32 v189, v182, v183
    v_mfma_f32_16x16x32_bf16 a[152:155], v[44:47], v[112:115], a[152:155]
    ds_read_b64_tr_b16 v[36:37], v222 offset:28672
    v_cvt_pk_bf16_f32 v190, v184, v185
    v_mfma_f32_16x16x32_bf16 a[156:159], v[44:47], v[144:147], a[156:159]
    ds_read_b64_tr_b16 v[38:39], v222 offset:30720
    v_cvt_pk_bf16_f32 v191, v186, v187
    s_waitcnt lgkmcnt(8)
    v_mfma_f32_16x16x32_bf16 a[128:131], v[16:19], v[116:119], a[128:131]
    ds_read_b64_tr_b16 v[40:41], v223 offset:28672
    s_mov_b32 s6, 114688
    v_mfma_f32_16x16x32_bf16 a[132:135], v[16:19], v[148:151], a[132:135]
    ds_read_b64_tr_b16 v[42:43], v223 offset:30720
    buffer_store_dwordx4 v[188:191], v12, s[20:23], s6 offen sc1
    v_mfma_f32_16x16x32_bf16 a[136:139], v[20:23], v[116:119], a[136:139]
    ds_read_b64_tr_b16 v[44:45], v224 offset:28672
    v_accvgpr_read_b32 v192, a180
    v_mfma_f32_16x16x32_bf16 a[140:143], v[20:23], v[148:151], a[140:143]
    ds_read_b64_tr_b16 v[46:47], v224 offset:30720
    v_accvgpr_read_b32 v193, a181
    s_waitcnt vmcnt(8) lgkmcnt(0)
    s_barrier
    v_add_u32 v221, 4294934528, v221
    v_add_u32 v222, 4294934528, v222
    v_add_u32 v223, 4294934528, v223
    v_add_u32 v224, 4294934528, v224
    s_waitcnt lgkmcnt(8)
    v_mfma_f32_16x16x32_bf16 a[144:147], v[24:27], v[116:119], a[144:147]
    ds_read_b64_tr_b16 v[16:17], v221 offset:0
    v_accvgpr_read_b32 v194, a182
    v_mfma_f32_16x16x32_bf16 a[148:151], v[24:27], v[148:151], a[148:151]
    ds_read_b64_tr_b16 v[18:19], v221 offset:2048
    v_accvgpr_read_b32 v195, a183
    v_mfma_f32_16x16x32_bf16 a[152:155], v[28:31], v[116:119], a[152:155]
    ds_read_b64_tr_b16 v[20:21], v222 offset:0
    v_accvgpr_read_b32 v196, a188
    v_mfma_f32_16x16x32_bf16 a[156:159], v[28:31], v[148:151], a[156:159]
    ds_read_b64_tr_b16 v[22:23], v222 offset:2048
    v_accvgpr_read_b32 v197, a189
    s_waitcnt lgkmcnt(8)
    v_mfma_f32_16x16x32_bf16 a[128:131], v[32:35], v[120:123], a[128:131]
    ds_read_b64_tr_b16 v[24:25], v223 offset:0
    v_accvgpr_read_b32 v198, a190
    v_mfma_f32_16x16x32_bf16 a[132:135], v[32:35], v[152:155], a[132:135]
    ds_read_b64_tr_b16 v[26:27], v223 offset:2048
    v_accvgpr_read_b32 v199, a191
    v_mfma_f32_16x16x32_bf16 a[136:139], v[36:39], v[120:123], a[136:139]
    ds_read_b64_tr_b16 v[28:29], v224 offset:0
    v_cvt_pk_bf16_f32 v200, v192, v193
    v_mfma_f32_16x16x32_bf16 a[140:143], v[36:39], v[152:155], a[140:143]
    ds_read_b64_tr_b16 v[30:31], v224 offset:2048
    v_cvt_pk_bf16_f32 v201, v194, v195
    s_waitcnt lgkmcnt(8)
    v_mfma_f32_16x16x32_bf16 a[144:147], v[40:43], v[120:123], a[144:147]
    ds_read_b64_tr_b16 v[32:33], v221 offset:4096
    v_cvt_pk_bf16_f32 v202, v196, v197
    v_mfma_f32_16x16x32_bf16 a[148:151], v[40:43], v[152:155], a[148:151]
    ds_read_b64_tr_b16 v[34:35], v221 offset:6144
    v_cvt_pk_bf16_f32 v203, v198, v199
    v_mfma_f32_16x16x32_bf16 a[152:155], v[44:47], v[120:123], a[152:155]
    ds_read_b64_tr_b16 v[36:37], v222 offset:4096
    s_mov_b32 s6, 344064
    v_mfma_f32_16x16x32_bf16 a[156:159], v[44:47], v[152:155], a[156:159]
    ds_read_b64_tr_b16 v[38:39], v222 offset:6144
    buffer_store_dwordx4 v[200:203], v12, s[20:23], s6 offen sc1
    s_waitcnt lgkmcnt(8)
    v_mfma_f32_16x16x32_bf16 a[160:163], v[16:19], v[92:95], 0
    ds_read_b64_tr_b16 v[40:41], v223 offset:4096
    v_mfma_f32_16x16x32_bf16 a[164:167], v[16:19], v[124:127], 0
    ds_read_b64_tr_b16 v[42:43], v223 offset:6144
    v_mfma_f32_16x16x32_bf16 a[168:171], v[20:23], v[92:95], 0
    ds_read_b64_tr_b16 v[44:45], v224 offset:4096
    v_mfma_f32_16x16x32_bf16 a[172:175], v[20:23], v[124:127], 0
    ds_read_b64_tr_b16 v[46:47], v224 offset:6144
    s_waitcnt lgkmcnt(8)
    v_mfma_f32_16x16x32_bf16 a[176:179], v[24:27], v[92:95], 0
    ds_read_b64_tr_b16 v[16:17], v221 offset:8192
    v_mfma_f32_16x16x32_bf16 a[180:183], v[24:27], v[124:127], 0
    ds_read_b64_tr_b16 v[18:19], v221 offset:10240
    v_mfma_f32_16x16x32_bf16 a[184:187], v[28:31], v[92:95], 0
    ds_read_b64_tr_b16 v[20:21], v222 offset:8192
    v_mfma_f32_16x16x32_bf16 a[188:191], v[28:31], v[124:127], 0
    ds_read_b64_tr_b16 v[22:23], v222 offset:10240
    s_waitcnt lgkmcnt(8)
    v_mfma_f32_16x16x32_bf16 a[160:163], v[32:35], v[96:99], a[160:163]
    ds_read_b64_tr_b16 v[24:25], v223 offset:8192
    v_accvgpr_read_b32 v156, a128
    v_mfma_f32_16x16x32_bf16 a[164:167], v[32:35], v[128:131], a[164:167]
    ds_read_b64_tr_b16 v[26:27], v223 offset:10240
    v_accvgpr_read_b32 v157, a129
    v_mfma_f32_16x16x32_bf16 a[168:171], v[36:39], v[96:99], a[168:171]
    ds_read_b64_tr_b16 v[28:29], v224 offset:8192
    v_accvgpr_read_b32 v158, a130
    v_mfma_f32_16x16x32_bf16 a[172:175], v[36:39], v[128:131], a[172:175]
    ds_read_b64_tr_b16 v[30:31], v224 offset:10240
    v_accvgpr_read_b32 v159, a131
    s_waitcnt lgkmcnt(8)
    v_mfma_f32_16x16x32_bf16 a[176:179], v[40:43], v[96:99], a[176:179]
    ds_read_b64_tr_b16 v[32:33], v221 offset:12288
    v_accvgpr_read_b32 v160, a136
    v_mfma_f32_16x16x32_bf16 a[180:183], v[40:43], v[128:131], a[180:183]
    ds_read_b64_tr_b16 v[34:35], v221 offset:14336
    v_accvgpr_read_b32 v161, a137
    v_mfma_f32_16x16x32_bf16 a[184:187], v[44:47], v[96:99], a[184:187]
    ds_read_b64_tr_b16 v[36:37], v222 offset:12288
    v_accvgpr_read_b32 v162, a138
    v_mfma_f32_16x16x32_bf16 a[188:191], v[44:47], v[128:131], a[188:191]
    ds_read_b64_tr_b16 v[38:39], v222 offset:14336
    v_accvgpr_read_b32 v163, a139
    s_waitcnt lgkmcnt(8)
    v_mfma_f32_16x16x32_bf16 a[160:163], v[16:19], v[100:103], a[160:163]
    ds_read_b64_tr_b16 v[40:41], v223 offset:12288
    v_cvt_pk_bf16_f32 v164, v156, v157
    v_mfma_f32_16x16x32_bf16 a[164:167], v[16:19], v[132:135], a[164:167]
    ds_read_b64_tr_b16 v[42:43], v223 offset:14336
    v_cvt_pk_bf16_f32 v165, v158, v159
    v_mfma_f32_16x16x32_bf16 a[168:171], v[20:23], v[100:103], a[168:171]
    ds_read_b64_tr_b16 v[44:45], v224 offset:12288
    v_cvt_pk_bf16_f32 v166, v160, v161
    v_mfma_f32_16x16x32_bf16 a[172:175], v[20:23], v[132:135], a[172:175]
    ds_read_b64_tr_b16 v[46:47], v224 offset:14336
    v_cvt_pk_bf16_f32 v167, v162, v163
    s_waitcnt lgkmcnt(8)
    v_mfma_f32_16x16x32_bf16 a[176:179], v[24:27], v[100:103], a[176:179]
    ds_read_b64_tr_b16 v[16:17], v221 offset:16384
    s_mov_b32 s6, 131072
    v_mfma_f32_16x16x32_bf16 a[180:183], v[24:27], v[132:135], a[180:183]
    ds_read_b64_tr_b16 v[18:19], v221 offset:18432
    buffer_store_dwordx4 v[164:167], v12, s[20:23], s6 offen sc1
    v_mfma_f32_16x16x32_bf16 a[184:187], v[28:31], v[100:103], a[184:187]
    ds_read_b64_tr_b16 v[20:21], v222 offset:16384
    v_accvgpr_read_b32 v168, a132
    v_mfma_f32_16x16x32_bf16 a[188:191], v[28:31], v[132:135], a[188:191]
    ds_read_b64_tr_b16 v[22:23], v222 offset:18432
    v_accvgpr_read_b32 v169, a133
    s_waitcnt lgkmcnt(8)
    v_mfma_f32_16x16x32_bf16 a[160:163], v[32:35], v[104:107], a[160:163]
    ds_read_b64_tr_b16 v[24:25], v223 offset:16384
    v_accvgpr_read_b32 v170, a134
    v_mfma_f32_16x16x32_bf16 a[164:167], v[32:35], v[136:139], a[164:167]
    ds_read_b64_tr_b16 v[26:27], v223 offset:18432
    v_accvgpr_read_b32 v171, a135
    v_mfma_f32_16x16x32_bf16 a[168:171], v[36:39], v[104:107], a[168:171]
    ds_read_b64_tr_b16 v[28:29], v224 offset:16384
    v_accvgpr_read_b32 v172, a140
    v_mfma_f32_16x16x32_bf16 a[172:175], v[36:39], v[136:139], a[172:175]
    ds_read_b64_tr_b16 v[30:31], v224 offset:18432
    v_accvgpr_read_b32 v173, a141
    s_waitcnt lgkmcnt(8)
    v_mfma_f32_16x16x32_bf16 a[176:179], v[40:43], v[104:107], a[176:179]
    ds_read_b64_tr_b16 v[32:33], v221 offset:20480
    v_accvgpr_read_b32 v174, a142
    v_mfma_f32_16x16x32_bf16 a[180:183], v[40:43], v[136:139], a[180:183]
    ds_read_b64_tr_b16 v[34:35], v221 offset:22528
    v_accvgpr_read_b32 v175, a143
    v_mfma_f32_16x16x32_bf16 a[184:187], v[44:47], v[104:107], a[184:187]
    ds_read_b64_tr_b16 v[36:37], v222 offset:20480
    v_cvt_pk_bf16_f32 v176, v168, v169
    v_mfma_f32_16x16x32_bf16 a[188:191], v[44:47], v[136:139], a[188:191]
    ds_read_b64_tr_b16 v[38:39], v222 offset:22528
    v_cvt_pk_bf16_f32 v177, v170, v171
    s_waitcnt lgkmcnt(8)
    v_mfma_f32_16x16x32_bf16 a[160:163], v[16:19], v[108:111], a[160:163]
    ds_read_b64_tr_b16 v[40:41], v223 offset:20480
    v_cvt_pk_bf16_f32 v178, v172, v173
    v_mfma_f32_16x16x32_bf16 a[164:167], v[16:19], v[140:143], a[164:167]
    ds_read_b64_tr_b16 v[42:43], v223 offset:22528
    v_cvt_pk_bf16_f32 v179, v174, v175
    v_mfma_f32_16x16x32_bf16 a[168:171], v[20:23], v[108:111], a[168:171]
    ds_read_b64_tr_b16 v[44:45], v224 offset:20480
    s_mov_b32 s6, 360448
    v_mfma_f32_16x16x32_bf16 a[172:175], v[20:23], v[140:143], a[172:175]
    ds_read_b64_tr_b16 v[46:47], v224 offset:22528
    buffer_store_dwordx4 v[176:179], v12, s[20:23], s6 offen sc1
    s_waitcnt lgkmcnt(8)
    v_mfma_f32_16x16x32_bf16 a[176:179], v[24:27], v[108:111], a[176:179]
    ds_read_b64_tr_b16 v[16:17], v221 offset:24576
    v_accvgpr_read_b32 v180, a144
    v_mfma_f32_16x16x32_bf16 a[180:183], v[24:27], v[140:143], a[180:183]
    ds_read_b64_tr_b16 v[18:19], v221 offset:26624
    v_accvgpr_read_b32 v181, a145
    v_mfma_f32_16x16x32_bf16 a[184:187], v[28:31], v[108:111], a[184:187]
    ds_read_b64_tr_b16 v[20:21], v222 offset:24576
    v_accvgpr_read_b32 v182, a146
    v_mfma_f32_16x16x32_bf16 a[188:191], v[28:31], v[140:143], a[188:191]
    ds_read_b64_tr_b16 v[22:23], v222 offset:26624
    v_accvgpr_read_b32 v183, a147
    s_waitcnt lgkmcnt(8)
    v_mfma_f32_16x16x32_bf16 a[160:163], v[32:35], v[112:115], a[160:163]
    ds_read_b64_tr_b16 v[24:25], v223 offset:24576
    v_accvgpr_read_b32 v184, a152
    v_mfma_f32_16x16x32_bf16 a[164:167], v[32:35], v[144:147], a[164:167]
    ds_read_b64_tr_b16 v[26:27], v223 offset:26624
    v_accvgpr_read_b32 v185, a153
    v_mfma_f32_16x16x32_bf16 a[168:171], v[36:39], v[112:115], a[168:171]
    ds_read_b64_tr_b16 v[28:29], v224 offset:24576
    v_accvgpr_read_b32 v186, a154
    v_mfma_f32_16x16x32_bf16 a[172:175], v[36:39], v[144:147], a[172:175]
    ds_read_b64_tr_b16 v[30:31], v224 offset:26624
    v_accvgpr_read_b32 v187, a155
    s_waitcnt lgkmcnt(8)
    v_mfma_f32_16x16x32_bf16 a[176:179], v[40:43], v[112:115], a[176:179]
    ds_read_b64_tr_b16 v[32:33], v221 offset:28672
    v_cvt_pk_bf16_f32 v188, v180, v181
    v_mfma_f32_16x16x32_bf16 a[180:183], v[40:43], v[144:147], a[180:183]
    ds_read_b64_tr_b16 v[34:35], v221 offset:30720
    v_cvt_pk_bf16_f32 v189, v182, v183
    v_mfma_f32_16x16x32_bf16 a[184:187], v[44:47], v[112:115], a[184:187]
    ds_read_b64_tr_b16 v[36:37], v222 offset:28672
    v_cvt_pk_bf16_f32 v190, v184, v185
    v_mfma_f32_16x16x32_bf16 a[188:191], v[44:47], v[144:147], a[188:191]
    ds_read_b64_tr_b16 v[38:39], v222 offset:30720
    v_cvt_pk_bf16_f32 v191, v186, v187
    s_waitcnt lgkmcnt(8)
    v_mfma_f32_16x16x32_bf16 a[160:163], v[16:19], v[116:119], a[160:163]
    ds_read_b64_tr_b16 v[40:41], v223 offset:28672
    s_mov_b32 s6, 147456
    v_mfma_f32_16x16x32_bf16 a[164:167], v[16:19], v[148:151], a[164:167]
    ds_read_b64_tr_b16 v[42:43], v223 offset:30720
    buffer_store_dwordx4 v[188:191], v12, s[20:23], s6 offen sc1
    v_mfma_f32_16x16x32_bf16 a[168:171], v[20:23], v[116:119], a[168:171]
    ds_read_b64_tr_b16 v[44:45], v224 offset:28672
    v_accvgpr_read_b32 v192, a148
    v_mfma_f32_16x16x32_bf16 a[172:175], v[20:23], v[148:151], a[172:175]
    ds_read_b64_tr_b16 v[46:47], v224 offset:30720
    v_accvgpr_read_b32 v193, a149
    v_add_u32 v221, 4294934528, v221
    v_add_u32 v222, 4294934528, v222
    v_add_u32 v223, 4294934528, v223
    v_add_u32 v224, 4294934528, v224
    s_waitcnt lgkmcnt(8)
    v_mfma_f32_16x16x32_bf16 a[176:179], v[24:27], v[116:119], a[176:179]
    ds_read_b64_tr_b16 v[16:17], v221 offset:0
    v_accvgpr_read_b32 v194, a150
    v_mfma_f32_16x16x32_bf16 a[180:183], v[24:27], v[148:151], a[180:183]
    ds_read_b64_tr_b16 v[18:19], v221 offset:2048
    v_accvgpr_read_b32 v195, a151
    v_mfma_f32_16x16x32_bf16 a[184:187], v[28:31], v[116:119], a[184:187]
    ds_read_b64_tr_b16 v[20:21], v222 offset:0
    v_accvgpr_read_b32 v196, a156
    v_mfma_f32_16x16x32_bf16 a[188:191], v[28:31], v[148:151], a[188:191]
    ds_read_b64_tr_b16 v[22:23], v222 offset:2048
    v_accvgpr_read_b32 v197, a157
    s_waitcnt lgkmcnt(8)
    v_mfma_f32_16x16x32_bf16 a[160:163], v[32:35], v[120:123], a[160:163]
    ds_read_b64_tr_b16 v[24:25], v223 offset:0
    v_accvgpr_read_b32 v198, a158
    v_mfma_f32_16x16x32_bf16 a[164:167], v[32:35], v[152:155], a[164:167]
    ds_read_b64_tr_b16 v[26:27], v223 offset:2048
    v_accvgpr_read_b32 v199, a159
    v_mfma_f32_16x16x32_bf16 a[168:171], v[36:39], v[120:123], a[168:171]
    ds_read_b64_tr_b16 v[28:29], v224 offset:0
    v_cvt_pk_bf16_f32 v200, v192, v193
    v_mfma_f32_16x16x32_bf16 a[172:175], v[36:39], v[152:155], a[172:175]
    ds_read_b64_tr_b16 v[30:31], v224 offset:2048
    v_cvt_pk_bf16_f32 v201, v194, v195
    s_waitcnt lgkmcnt(8)
    v_mfma_f32_16x16x32_bf16 a[176:179], v[40:43], v[120:123], a[176:179]
    ds_read_b64_tr_b16 v[32:33], v221 offset:4096
    v_cvt_pk_bf16_f32 v202, v196, v197
    v_mfma_f32_16x16x32_bf16 a[180:183], v[40:43], v[152:155], a[180:183]
    ds_read_b64_tr_b16 v[34:35], v221 offset:6144
    v_cvt_pk_bf16_f32 v203, v198, v199
    v_mfma_f32_16x16x32_bf16 a[184:187], v[44:47], v[120:123], a[184:187]
    ds_read_b64_tr_b16 v[36:37], v222 offset:4096
    s_mov_b32 s6, 376832
    v_mfma_f32_16x16x32_bf16 a[188:191], v[44:47], v[152:155], a[188:191]
    ds_read_b64_tr_b16 v[38:39], v222 offset:6144
    buffer_store_dwordx4 v[200:203], v12, s[20:23], s6 offen sc1
    s_waitcnt lgkmcnt(8)
    v_mfma_f32_16x16x32_bf16 a[128:131], v[16:19], v[92:95], 0
    ds_read_b64_tr_b16 v[40:41], v223 offset:4096
    v_mfma_f32_16x16x32_bf16 a[132:135], v[16:19], v[124:127], 0
    ds_read_b64_tr_b16 v[42:43], v223 offset:6144
    v_mfma_f32_16x16x32_bf16 a[136:139], v[20:23], v[92:95], 0
    ds_read_b64_tr_b16 v[44:45], v224 offset:4096
    v_mfma_f32_16x16x32_bf16 a[140:143], v[20:23], v[124:127], 0
    ds_read_b64_tr_b16 v[46:47], v224 offset:6144
    s_waitcnt lgkmcnt(8)
    v_mfma_f32_16x16x32_bf16 a[144:147], v[24:27], v[92:95], 0
    ds_read_b64_tr_b16 v[16:17], v221 offset:8192
    v_mfma_f32_16x16x32_bf16 a[148:151], v[24:27], v[124:127], 0
    ds_read_b64_tr_b16 v[18:19], v221 offset:10240
    v_mfma_f32_16x16x32_bf16 a[152:155], v[28:31], v[92:95], 0
    ds_read_b64_tr_b16 v[20:21], v222 offset:8192
    v_mfma_f32_16x16x32_bf16 a[156:159], v[28:31], v[124:127], 0
    ds_read_b64_tr_b16 v[22:23], v222 offset:10240
    s_waitcnt lgkmcnt(8)
    v_mfma_f32_16x16x32_bf16 a[128:131], v[32:35], v[96:99], a[128:131]
    ds_read_b64_tr_b16 v[24:25], v223 offset:8192
    v_accvgpr_read_b32 v156, a160
    v_mfma_f32_16x16x32_bf16 a[132:135], v[32:35], v[128:131], a[132:135]
    ds_read_b64_tr_b16 v[26:27], v223 offset:10240
    v_accvgpr_read_b32 v157, a161
    v_mfma_f32_16x16x32_bf16 a[136:139], v[36:39], v[96:99], a[136:139]
    ds_read_b64_tr_b16 v[28:29], v224 offset:8192
    v_accvgpr_read_b32 v158, a162
    v_mfma_f32_16x16x32_bf16 a[140:143], v[36:39], v[128:131], a[140:143]
    ds_read_b64_tr_b16 v[30:31], v224 offset:10240
    v_accvgpr_read_b32 v159, a163
    s_waitcnt lgkmcnt(8)
    v_mfma_f32_16x16x32_bf16 a[144:147], v[40:43], v[96:99], a[144:147]
    ds_read_b64_tr_b16 v[32:33], v221 offset:12288
    v_accvgpr_read_b32 v160, a168
    v_mfma_f32_16x16x32_bf16 a[148:151], v[40:43], v[128:131], a[148:151]
    ds_read_b64_tr_b16 v[34:35], v221 offset:14336
    v_accvgpr_read_b32 v161, a169
    v_mfma_f32_16x16x32_bf16 a[152:155], v[44:47], v[96:99], a[152:155]
    ds_read_b64_tr_b16 v[36:37], v222 offset:12288
    v_accvgpr_read_b32 v162, a170
    v_mfma_f32_16x16x32_bf16 a[156:159], v[44:47], v[128:131], a[156:159]
    ds_read_b64_tr_b16 v[38:39], v222 offset:14336
    v_accvgpr_read_b32 v163, a171
    s_waitcnt lgkmcnt(8)
    v_mfma_f32_16x16x32_bf16 a[128:131], v[16:19], v[100:103], a[128:131]
    ds_read_b64_tr_b16 v[40:41], v223 offset:12288
    v_cvt_pk_bf16_f32 v164, v156, v157
    v_mfma_f32_16x16x32_bf16 a[132:135], v[16:19], v[132:135], a[132:135]
    ds_read_b64_tr_b16 v[42:43], v223 offset:14336
    v_cvt_pk_bf16_f32 v165, v158, v159
    v_mfma_f32_16x16x32_bf16 a[136:139], v[20:23], v[100:103], a[136:139]
    ds_read_b64_tr_b16 v[44:45], v224 offset:12288
    v_cvt_pk_bf16_f32 v166, v160, v161
    v_mfma_f32_16x16x32_bf16 a[140:143], v[20:23], v[132:135], a[140:143]
    ds_read_b64_tr_b16 v[46:47], v224 offset:14336
    v_cvt_pk_bf16_f32 v167, v162, v163
    s_waitcnt lgkmcnt(8)
    v_mfma_f32_16x16x32_bf16 a[144:147], v[24:27], v[100:103], a[144:147]
    ds_read_b64_tr_b16 v[16:17], v221 offset:16384
    s_mov_b32 s6, 163840
    v_mfma_f32_16x16x32_bf16 a[148:151], v[24:27], v[132:135], a[148:151]
    ds_read_b64_tr_b16 v[18:19], v221 offset:18432
    buffer_store_dwordx4 v[164:167], v12, s[20:23], s6 offen sc1
    v_mfma_f32_16x16x32_bf16 a[152:155], v[28:31], v[100:103], a[152:155]
    ds_read_b64_tr_b16 v[20:21], v222 offset:16384
    v_accvgpr_read_b32 v168, a164
    v_mfma_f32_16x16x32_bf16 a[156:159], v[28:31], v[132:135], a[156:159]
    ds_read_b64_tr_b16 v[22:23], v222 offset:18432
    v_accvgpr_read_b32 v169, a165
    s_waitcnt lgkmcnt(8)
    v_mfma_f32_16x16x32_bf16 a[128:131], v[32:35], v[104:107], a[128:131]
    ds_read_b64_tr_b16 v[24:25], v223 offset:16384
    v_accvgpr_read_b32 v170, a166
    v_mfma_f32_16x16x32_bf16 a[132:135], v[32:35], v[136:139], a[132:135]
    ds_read_b64_tr_b16 v[26:27], v223 offset:18432
    v_accvgpr_read_b32 v171, a167
    v_mfma_f32_16x16x32_bf16 a[136:139], v[36:39], v[104:107], a[136:139]
    ds_read_b64_tr_b16 v[28:29], v224 offset:16384
    v_accvgpr_read_b32 v172, a172
    v_mfma_f32_16x16x32_bf16 a[140:143], v[36:39], v[136:139], a[140:143]
    ds_read_b64_tr_b16 v[30:31], v224 offset:18432
    v_accvgpr_read_b32 v173, a173
    s_waitcnt lgkmcnt(8)
    v_mfma_f32_16x16x32_bf16 a[144:147], v[40:43], v[104:107], a[144:147]
    ds_read_b64_tr_b16 v[32:33], v221 offset:20480
    v_accvgpr_read_b32 v174, a174
    v_mfma_f32_16x16x32_bf16 a[148:151], v[40:43], v[136:139], a[148:151]
    ds_read_b64_tr_b16 v[34:35], v221 offset:22528
    v_accvgpr_read_b32 v175, a175
    v_mfma_f32_16x16x32_bf16 a[152:155], v[44:47], v[104:107], a[152:155]
    ds_read_b64_tr_b16 v[36:37], v222 offset:20480
    v_cvt_pk_bf16_f32 v176, v168, v169
    v_mfma_f32_16x16x32_bf16 a[156:159], v[44:47], v[136:139], a[156:159]
    ds_read_b64_tr_b16 v[38:39], v222 offset:22528
    v_cvt_pk_bf16_f32 v177, v170, v171
    s_waitcnt lgkmcnt(8)
    v_mfma_f32_16x16x32_bf16 a[128:131], v[16:19], v[108:111], a[128:131]
    ds_read_b64_tr_b16 v[40:41], v223 offset:20480
    v_cvt_pk_bf16_f32 v178, v172, v173
    v_mfma_f32_16x16x32_bf16 a[132:135], v[16:19], v[140:143], a[132:135]
    ds_read_b64_tr_b16 v[42:43], v223 offset:22528
    v_cvt_pk_bf16_f32 v179, v174, v175
    v_mfma_f32_16x16x32_bf16 a[136:139], v[20:23], v[108:111], a[136:139]
    ds_read_b64_tr_b16 v[44:45], v224 offset:20480
    s_mov_b32 s6, 393216
    v_mfma_f32_16x16x32_bf16 a[140:143], v[20:23], v[140:143], a[140:143]
    ds_read_b64_tr_b16 v[46:47], v224 offset:22528
    buffer_store_dwordx4 v[176:179], v12, s[20:23], s6 offen sc1
    s_waitcnt lgkmcnt(8)
    v_mfma_f32_16x16x32_bf16 a[144:147], v[24:27], v[108:111], a[144:147]
    ds_read_b64_tr_b16 v[16:17], v221 offset:24576
    v_accvgpr_read_b32 v180, a176
    v_mfma_f32_16x16x32_bf16 a[148:151], v[24:27], v[140:143], a[148:151]
    ds_read_b64_tr_b16 v[18:19], v221 offset:26624
    v_accvgpr_read_b32 v181, a177
    v_mfma_f32_16x16x32_bf16 a[152:155], v[28:31], v[108:111], a[152:155]
    ds_read_b64_tr_b16 v[20:21], v222 offset:24576
    v_accvgpr_read_b32 v182, a178
    v_mfma_f32_16x16x32_bf16 a[156:159], v[28:31], v[140:143], a[156:159]
    ds_read_b64_tr_b16 v[22:23], v222 offset:26624
    v_accvgpr_read_b32 v183, a179
    s_waitcnt lgkmcnt(8)
    v_mfma_f32_16x16x32_bf16 a[128:131], v[32:35], v[112:115], a[128:131]
    ds_read_b64_tr_b16 v[24:25], v223 offset:24576
    v_accvgpr_read_b32 v184, a184
    v_mfma_f32_16x16x32_bf16 a[132:135], v[32:35], v[144:147], a[132:135]
    ds_read_b64_tr_b16 v[26:27], v223 offset:26624
    v_accvgpr_read_b32 v185, a185
    v_mfma_f32_16x16x32_bf16 a[136:139], v[36:39], v[112:115], a[136:139]
    ds_read_b64_tr_b16 v[28:29], v224 offset:24576
    v_accvgpr_read_b32 v186, a186
    v_mfma_f32_16x16x32_bf16 a[140:143], v[36:39], v[144:147], a[140:143]
    ds_read_b64_tr_b16 v[30:31], v224 offset:26624
    v_accvgpr_read_b32 v187, a187
    s_waitcnt lgkmcnt(8)
    v_mfma_f32_16x16x32_bf16 a[144:147], v[40:43], v[112:115], a[144:147]
    ds_read_b64_tr_b16 v[32:33], v221 offset:28672
    v_cvt_pk_bf16_f32 v188, v180, v181
    v_mfma_f32_16x16x32_bf16 a[148:151], v[40:43], v[144:147], a[148:151]
    ds_read_b64_tr_b16 v[34:35], v221 offset:30720
    v_cvt_pk_bf16_f32 v189, v182, v183
    v_mfma_f32_16x16x32_bf16 a[152:155], v[44:47], v[112:115], a[152:155]
    ds_read_b64_tr_b16 v[36:37], v222 offset:28672
    v_cvt_pk_bf16_f32 v190, v184, v185
    v_mfma_f32_16x16x32_bf16 a[156:159], v[44:47], v[144:147], a[156:159]
    ds_read_b64_tr_b16 v[38:39], v222 offset:30720
    v_cvt_pk_bf16_f32 v191, v186, v187
    s_waitcnt lgkmcnt(8)
    v_mfma_f32_16x16x32_bf16 a[128:131], v[16:19], v[116:119], a[128:131]
    ds_read_b64_tr_b16 v[40:41], v223 offset:28672
    s_mov_b32 s6, 180224
    v_mfma_f32_16x16x32_bf16 a[132:135], v[16:19], v[148:151], a[132:135]
    ds_read_b64_tr_b16 v[42:43], v223 offset:30720
    buffer_store_dwordx4 v[188:191], v12, s[20:23], s6 offen sc1
    v_mfma_f32_16x16x32_bf16 a[136:139], v[20:23], v[116:119], a[136:139]
    ds_read_b64_tr_b16 v[44:45], v224 offset:28672
    v_accvgpr_read_b32 v192, a180
    v_mfma_f32_16x16x32_bf16 a[140:143], v[20:23], v[148:151], a[140:143]
    ds_read_b64_tr_b16 v[46:47], v224 offset:30720
    v_accvgpr_read_b32 v193, a181
    s_waitcnt lgkmcnt(8)
    v_mfma_f32_16x16x32_bf16 a[144:147], v[24:27], v[116:119], a[144:147]
    v_accvgpr_read_b32 v194, a182
    v_mfma_f32_16x16x32_bf16 a[148:151], v[24:27], v[148:151], a[148:151]
    v_accvgpr_read_b32 v195, a183
    v_mfma_f32_16x16x32_bf16 a[152:155], v[28:31], v[116:119], a[152:155]
    v_accvgpr_read_b32 v196, a188
    v_mfma_f32_16x16x32_bf16 a[156:159], v[28:31], v[148:151], a[156:159]
    v_accvgpr_read_b32 v197, a189
    s_waitcnt lgkmcnt(4)
    v_mfma_f32_16x16x32_bf16 a[128:131], v[32:35], v[120:123], a[128:131]
    v_accvgpr_read_b32 v198, a190
    v_mfma_f32_16x16x32_bf16 a[132:135], v[32:35], v[152:155], a[132:135]
    v_accvgpr_read_b32 v199, a191
    v_mfma_f32_16x16x32_bf16 a[136:139], v[36:39], v[120:123], a[136:139]
    v_cvt_pk_bf16_f32 v200, v192, v193
    v_mfma_f32_16x16x32_bf16 a[140:143], v[36:39], v[152:155], a[140:143]
    v_cvt_pk_bf16_f32 v201, v194, v195
    s_waitcnt lgkmcnt(0)
    v_mfma_f32_16x16x32_bf16 a[144:147], v[40:43], v[120:123], a[144:147]
    v_cvt_pk_bf16_f32 v202, v196, v197
    v_mfma_f32_16x16x32_bf16 a[148:151], v[40:43], v[152:155], a[148:151]
    v_cvt_pk_bf16_f32 v203, v198, v199
    v_mfma_f32_16x16x32_bf16 a[152:155], v[44:47], v[120:123], a[152:155]
    s_mov_b32 s6, 409600
    v_mfma_f32_16x16x32_bf16 a[156:159], v[44:47], v[152:155], a[156:159]
    buffer_store_dwordx4 v[200:203], v12, s[20:23], s6 offen sc1
    s_nop 7
    v_accvgpr_read_b32 v156, a128
    v_accvgpr_read_b32 v157, a129
    v_accvgpr_read_b32 v158, a130
    v_accvgpr_read_b32 v159, a131
    v_accvgpr_read_b32 v160, a136
    v_accvgpr_read_b32 v161, a137
    v_accvgpr_read_b32 v162, a138
    v_accvgpr_read_b32 v163, a139
    v_cvt_pk_bf16_f32 v164, v156, v157
    v_cvt_pk_bf16_f32 v165, v158, v159
    v_cvt_pk_bf16_f32 v166, v160, v161
    v_cvt_pk_bf16_f32 v167, v162, v163
    s_mov_b32 s6, 196608
    buffer_store_dwordx4 v[164:167], v12, s[20:23], s6 offen sc1
    v_accvgpr_read_b32 v168, a132
    v_accvgpr_read_b32 v169, a133
    v_accvgpr_read_b32 v170, a134
    v_accvgpr_read_b32 v171, a135
    v_accvgpr_read_b32 v172, a140
    v_accvgpr_read_b32 v173, a141
    v_accvgpr_read_b32 v174, a142
    v_accvgpr_read_b32 v175, a143
    v_cvt_pk_bf16_f32 v176, v168, v169
    v_cvt_pk_bf16_f32 v177, v170, v171
    v_cvt_pk_bf16_f32 v178, v172, v173
    v_cvt_pk_bf16_f32 v179, v174, v175
    s_mov_b32 s6, 425984
    buffer_store_dwordx4 v[176:179], v12, s[20:23], s6 offen sc1
    v_accvgpr_read_b32 v180, a144
    v_accvgpr_read_b32 v181, a145
    v_accvgpr_read_b32 v182, a146
    v_accvgpr_read_b32 v183, a147
    v_accvgpr_read_b32 v184, a152
    v_accvgpr_read_b32 v185, a153
    v_accvgpr_read_b32 v186, a154
    v_accvgpr_read_b32 v187, a155
    v_cvt_pk_bf16_f32 v188, v180, v181
    v_cvt_pk_bf16_f32 v189, v182, v183
    v_cvt_pk_bf16_f32 v190, v184, v185
    v_cvt_pk_bf16_f32 v191, v186, v187
    s_mov_b32 s6, 212992
    buffer_store_dwordx4 v[188:191], v12, s[20:23], s6 offen sc1
    v_accvgpr_read_b32 v192, a148
    v_accvgpr_read_b32 v193, a149
    v_accvgpr_read_b32 v194, a150
    v_accvgpr_read_b32 v195, a151
    v_accvgpr_read_b32 v196, a156
    v_accvgpr_read_b32 v197, a157
    v_accvgpr_read_b32 v198, a158
    v_accvgpr_read_b32 v199, a159
    v_cvt_pk_bf16_f32 v200, v192, v193
    v_cvt_pk_bf16_f32 v201, v194, v195
    v_cvt_pk_bf16_f32 v202, v196, v197
    v_cvt_pk_bf16_f32 v203, v198, v199
    s_mov_b32 s6, 442368
    buffer_store_dwordx4 v[200:203], v12, s[20:23], s6 offen sc1
    s_endpgm
L_attn_segx:
    s_add_u32 s77, s77, 1
    s_cmp_eq_u32 s77, 2
    s_cbranch_scc1 L_attn_seg2
    s_cmp_eq_u32 s77, 3
    s_cbranch_scc1 L_attn_seg3
    s_cmp_eq_u32 s44, 0
    s_cbranch_scc1 L_attn_segx
    s_sub_u32 s3, s44, 1
    s_mov_b32 s69, 1
    s_branch L_attn_j2loop
L_attn_seg2:
    s_cmp_eq_u32 s51, s69
    s_cbranch_scc0 L_attn_seg2b
    v_mov_b32 v2, 1
    v_mov_b32 v3, s70
    s_mov_b32 s51, 1000
    s_mov_b64 exec, 1
    buffer_store_short v2, v3, s[28:31], 0 offen sc1
    s_mov_b64 exec, -1
L_attn_seg2b:
    s_cmp_le_u32 s44, 2
    s_cbranch_scc1 L_attn_segx
    s_mov_b32 s3, 2
    s_branch L_attn_j2loop
L_attn_seg3:
    s_lshr_b32 s6, s2, 3
    s_and_b32 s6, s6, 15
    s_lshl_b32 s6, s6, 2
    s_add_u32 s6, s6, s32
    s_mul_i32 s6, s6, 3584
    v_min_u32 v2, 27, v1
    v_lshlrev_b32 v2, 7, v2
    buffer_load_dword v227, v2, s[72:75], s6 offen
    s_getpc_b64 s[52:53]
L_attn_kernel_pc_39:
    s_sub_u32 s52, s52, L_attn_kernel_pc_39-L_attn_diag
    s_subb_u32 s53, s53, 0
    s_and_b32 s53, s53, 0xffff
    s_mov_b32 s54, L_text_end-L_attn_diag
    s_mov_b32 s55, 0x00020000
    s_lshr_b32 s56, s2, 3
    s_lshl_b32 s56, s56, 2
    s_add_u32 s56, s56, s32
    s_and_b32 s56, s56, 7
    s_lshl_b32 s56, s56, 13
    v_lshlrev_b32 v2, 7, v1
    buffer_load_dword v227, v2, s[52:55], s56 offen
    s_cmp_eq_u32 s44, 0
    s_cbranch_scc1 L_attn_diag
    s_mov_b32 s3, 0
    s_branch L_attn_j2loop
L_attn_kernel_flag_15:
    v_mov_b32 v2, 1
    v_mov_b32 v3, s70
    s_mov_b32 s51, 1000
    s_mov_b64 exec, 1
    buffer_store_short v2, v3, s[28:31], 0 offen sc1
    s_mov_b64 exec, -1
    s_branch L_attn_kernel_fb_16
L_attn_kernel_flag_21:
    v_mov_b32 v2, 1
    v_mov_b32_e64 v3, s70
    s_mov_b32 s51, 1000
    s_mov_b64 exec, 1
    buffer_store_short v2, v3, s[28:31], 0 offen sc1
    s_mov_b64 exec, -1
    s_branch L_attn_kernel_fb_22
L_attn_kernel_flag_25:
    v_mov_b32 v2, 1
    v_mov_b32_e64 v3, s70
    s_mov_b32 s51, 1000
    s_mov_b64 exec, 1
    buffer_store_short v2, v3, s[28:31], 0 offen sc1
    s_mov_b64 exec, -1
    s_branch L_attn_kernel_fb_26
L_attn_kernel_slow_1:
    s_mov_b32 s50, 0
    s_branch L_attn_slow_01
L_attn_kernel_slow_3:
    s_mov_b32 s50, 1
    s_branch L_attn_slow_11
L_attn_kernel_slow_5:
    s_mov_b32 s50, 2
    s_branch L_attn_slow_01
L_attn_kernel_slow_7:
    s_mov_b32 s50, 3
    s_branch L_attn_slow_10
L_attn_kernel_slow_9:
    s_mov_b32 s50, 4
    s_branch L_attn_slow_01
L_attn_kernel_slow_11:
    s_mov_b32 s50, 5
    s_branch L_attn_slow_11
L_attn_kernel_slow_13:
    s_mov_b32 s50, 6
    s_branch L_attn_slow_01
L_attn_kernel_slow_19:
    s_mov_b32 s50, 7
    s_branch L_attn_slow_11
L_attn_kernel_slow_29:
    s_mov_b32 s50, 8
    s_branch L_attn_slow_01
L_attn_kernel_slow_35:
    s_mov_b32 s50, 9
    s_branch L_attn_slow_10
L_attn_slow_01:
    s_nop 7
    s_nop 3
    v_max3_f32 v2, v16, v17, v18
    v_max3_f32 v2, v2, v19, v24
    v_max3_f32 v2, v2, v25, v26
    v_max_f32 v2, v2, v27
    v_mov_b32 v3, v2
    s_nop 1
    v_permlane16_swap_b32 v2, v3
    s_nop 1
    v_max_f32 v2, v2, v3
    v_mov_b32 v3, v2
    s_nop 1
    v_permlane32_swap_b32 v2, v3
    s_nop 1
    v_max_f32 v2, v2, v3
    v_add_f32 v2, 0x41400000, v2
    v_max_f32 v2, 0, v2
    v_sub_f32 v72, v72, v2
    v_sub_f32 v73, v73, v2
    v_sub_f32 v74, v74, v2
    v_sub_f32 v75, v75, v2
    v_sub_f32 v16, v16, v2
    v_sub_f32 v17, v17, v2
    v_sub_f32 v18, v18, v2
    v_sub_f32 v19, v19, v2
    v_sub_f32 v24, v24, v2
    v_sub_f32 v25, v25, v2
    v_sub_f32 v26, v26, v2
    v_sub_f32 v27, v27, v2
    v_sub_f32 v32, v32, v2
    v_sub_f32 v33, v33, v2
    v_sub_f32 v34, v34, v2
    v_sub_f32 v35, v35, v2
    v_sub_f32 v40, v40, v2
    v_sub_f32 v41, v41, v2
    v_sub_f32 v42, v42, v2
    v_sub_f32 v43, v43, v2
    v_sub_f32 v3, 0, v2
    v_exp_f32 v3, v3
    s_nop 0
    v_mul_f32 v80, v80, v3
    v_mul_f32 v81, v81, v3
    v_mul_f32 v82, v82, v3
    v_mul_f32 v83, v83, v3
    v_accvgpr_read_b32 v48, a0
    v_accvgpr_read_b32 v49, a1
    v_accvgpr_read_b32 v50, a2
    v_accvgpr_read_b32 v51, a3
    v_mul_f32 v48, v48, v3
    v_mul_f32 v49, v49, v3
    v_mul_f32 v50, v50, v3
    v_mul_f32 v51, v51, v3
    v_accvgpr_write_b32 a0, v48
    v_accvgpr_write_b32 a1, v49
    v_accvgpr_write_b32 a2, v50
    v_accvgpr_write_b32 a3, v51
    v_accvgpr_read_b32 v48, a8
    v_accvgpr_read_b32 v49, a9
    v_accvgpr_read_b32 v50, a10
    v_accvgpr_read_b32 v51, a11
    v_mul_f32 v48, v48, v3
    v_mul_f32 v49, v49, v3
    v_mul_f32 v50, v50, v3
    v_mul_f32 v51, v51, v3
    v_accvgpr_write_b32 a8, v48
    v_accvgpr_write_b32 a9, v49
    v_accvgpr_write_b32 a10, v50
    v_accvgpr_write_b32 a11, v51
    v_accvgpr_read_b32 v48, a16
    v_accvgpr_read_b32 v49, a17
    v_accvgpr_read_b32 v50, a18
    v_accvgpr_read_b32 v51, a19
    v_mul_f32 v48, v48, v3
    v_mul_f32 v49, v49, v3
    v_mul_f32 v50, v50, v3
    v_mul_f32 v51, v51, v3
    v_accvgpr_write_b32 a16, v48
    v_accvgpr_write_b32 a17, v49
    v_accvgpr_write_b32 a18, v50
    v_accvgpr_write_b32 a19, v51
    v_accvgpr_read_b32 v48, a24
    v_accvgpr_read_b32 v49, a25
    v_accvgpr_read_b32 v50, a26
    v_accvgpr_read_b32 v51, a27
    v_mul_f32 v48, v48, v3
    v_mul_f32 v49, v49, v3
    v_mul_f32 v50, v50, v3
    v_mul_f32 v51, v51, v3
    v_accvgpr_write_b32 a24, v48
    v_accvgpr_write_b32 a25, v49
    v_accvgpr_write_b32 a26, v50
    v_accvgpr_write_b32 a27, v51
    v_accvgpr_read_b32 v48, a32
    v_accvgpr_read_b32 v49, a33
    v_accvgpr_read_b32 v50, a34
    v_accvgpr_read_b32 v51, a35
    v_mul_f32 v48, v48, v3
    v_mul_f32 v49, v49, v3
    v_mul_f32 v50, v50, v3
    v_mul_f32 v51, v51, v3
    v_accvgpr_write_b32 a32, v48
    v_accvgpr_write_b32 a33, v49
    v_accvgpr_write_b32 a34, v50
    v_accvgpr_write_b32 a35, v51
    v_accvgpr_read_b32 v48, a40
    v_accvgpr_read_b32 v49, a41
    v_accvgpr_read_b32 v50, a42
    v_accvgpr_read_b32 v51, a43
    v_mul_f32 v48, v48, v3
    v_mul_f32 v49, v49, v3
    v_mul_f32 v50, v50, v3
    v_mul_f32 v51, v51, v3
    v_accvgpr_write_b32 a40, v48
    v_accvgpr_write_b32 a41, v49
    v_accvgpr_write_b32 a42, v50
    v_accvgpr_write_b32 a43, v51
    v_accvgpr_read_b32 v48, a48
    v_accvgpr_read_b32 v49, a49
    v_accvgpr_read_b32 v50, a50
    v_accvgpr_read_b32 v51, a51
    v_mul_f32 v48, v48, v3
    v_mul_f32 v49, v49, v3
    v_mul_f32 v50, v50, v3
    v_mul_f32 v51, v51, v3
    v_accvgpr_write_b32 a48, v48
    v_accvgpr_write_b32 a49, v49
    v_accvgpr_write_b32 a50, v50
    v_accvgpr_write_b32 a51, v51
    v_accvgpr_read_b32 v48, a56
    v_accvgpr_read_b32 v49, a57
    v_accvgpr_read_b32 v50, a58
    v_accvgpr_read_b32 v51, a59
    v_mul_f32 v48, v48, v3
    v_mul_f32 v49, v49, v3
    v_mul_f32 v50, v50, v3
    v_mul_f32 v51, v51, v3
    v_accvgpr_write_b32 a56, v48
    v_accvgpr_write_b32 a57, v49
    v_accvgpr_write_b32 a58, v50
    v_accvgpr_write_b32 a59, v51
    v_accvgpr_read_b32 v48, a64
    v_accvgpr_read_b32 v49, a65
    v_accvgpr_read_b32 v50, a66
    v_accvgpr_read_b32 v51, a67
    v_mul_f32 v48, v48, v3
    v_mul_f32 v49, v49, v3
    v_mul_f32 v50, v50, v3
    v_mul_f32 v51, v51, v3
    v_accvgpr_write_b32 a64, v48
    v_accvgpr_write_b32 a65, v49
    v_accvgpr_write_b32 a66, v50
    v_accvgpr_write_b32 a67, v51
    v_accvgpr_read_b32 v48, a72
    v_accvgpr_read_b32 v49, a73
    v_accvgpr_read_b32 v50, a74
    v_accvgpr_read_b32 v51, a75
    v_mul_f32 v48, v48, v3
    v_mul_f32 v49, v49, v3
    v_mul_f32 v50, v50, v3
    v_mul_f32 v51, v51, v3
    v_accvgpr_write_b32 a72, v48
    v_accvgpr_write_b32 a73, v49
    v_accvgpr_write_b32 a74, v50
    v_accvgpr_write_b32 a75, v51
    v_accvgpr_read_b32 v48, a80
    v_accvgpr_read_b32 v49, a81
    v_accvgpr_read_b32 v50, a82
    v_accvgpr_read_b32 v51, a83
    v_mul_f32 v48, v48, v3
    v_mul_f32 v49, v49, v3
    v_mul_f32 v50, v50, v3
    v_mul_f32 v51, v51, v3
    v_accvgpr_write_b32 a80, v48
    v_accvgpr_write_b32 a81, v49
    v_accvgpr_write_b32 a82, v50
    v_accvgpr_write_b32 a83, v51
    v_accvgpr_read_b32 v48, a88
    v_accvgpr_read_b32 v49, a89
    v_accvgpr_read_b32 v50, a90
    v_accvgpr_read_b32 v51, a91
    v_mul_f32 v48, v48, v3
    v_mul_f32 v49, v49, v3
    v_mul_f32 v50, v50, v3
    v_mul_f32 v51, v51, v3
    v_accvgpr_write_b32 a88, v48
    v_accvgpr_write_b32 a89, v49
    v_accvgpr_write_b32 a90, v50
    v_accvgpr_write_b32 a91, v51
    v_accvgpr_read_b32 v48, a96
    v_accvgpr_read_b32 v49, a97
    v_accvgpr_read_b32 v50, a98
    v_accvgpr_read_b32 v51, a99
    v_mul_f32 v48, v48, v3
    v_mul_f32 v49, v49, v3
    v_mul_f32 v50, v50, v3
    v_mul_f32 v51, v51, v3
    v_accvgpr_write_b32 a96, v48
    v_accvgpr_write_b32 a97, v49
    v_accvgpr_write_b32 a98, v50
    v_accvgpr_write_b32 a99, v51
    v_accvgpr_read_b32 v48, a104
    v_accvgpr_read_b32 v49, a105
    v_accvgpr_read_b32 v50, a106
    v_accvgpr_read_b32 v51, a107
    v_mul_f32 v48, v48, v3
    v_mul_f32 v49, v49, v3
    v_mul_f32 v50, v50, v3
    v_mul_f32 v51, v51, v3
    v_accvgpr_write_b32 a104, v48
    v_accvgpr_write_b32 a105, v49
    v_accvgpr_write_b32 a106, v50
    v_accvgpr_write_b32 a107, v51
    v_accvgpr_read_b32 v48, a112
    v_accvgpr_read_b32 v49, a113
    v_accvgpr_read_b32 v50, a114
    v_accvgpr_read_b32 v51, a115
    v_mul_f32 v48, v48, v3
    v_mul_f32 v49, v49, v3
    v_mul_f32 v50, v50, v3
    v_mul_f32 v51, v51, v3
    v_accvgpr_write_b32 a112, v48
    v_accvgpr_write_b32 a113, v49
    v_accvgpr_write_b32 a114, v50
    v_accvgpr_write_b32 a115, v51
    v_accvgpr_read_b32 v48, a120
    v_accvgpr_read_b32 v49, a121
    v_accvgpr_read_b32 v50, a122
    v_accvgpr_read_b32 v51, a123
    v_mul_f32 v48, v48, v3
    v_mul_f32 v49, v49, v3
    v_mul_f32 v50, v50, v3
    v_mul_f32 v51, v51, v3
    v_accvgpr_write_b32 a120, v48
    v_accvgpr_write_b32 a121, v49
    v_accvgpr_write_b32 a122, v50
    v_accvgpr_write_b32 a123, v51
    v_max3_f32 v2, v20, v21, v22
    v_max3_f32 v2, v2, v23, v28
    v_max3_f32 v2, v2, v29, v30
    v_max_f32 v2, v2, v31
    v_mov_b32 v3, v2
    s_nop 1
    v_permlane16_swap_b32 v2, v3
    s_nop 1
    v_max_f32 v2, v2, v3
    v_mov_b32 v3, v2
    s_nop 1
    v_permlane32_swap_b32 v2, v3
    s_nop 1
    v_max_f32_e64 v2, v2, v3
    v_add_f32 v2, 0x41400000, v2
    v_max_f32 v2, 0, v2
    v_sub_f32 v76, v76, v2
    v_sub_f32 v77, v77, v2
    v_sub_f32 v78, v78, v2
    v_sub_f32 v79, v79, v2
    v_sub_f32 v20, v20, v2
    v_sub_f32 v21, v21, v2
    v_sub_f32 v22, v22, v2
    v_sub_f32 v23, v23, v2
    v_sub_f32 v28, v28, v2
    v_sub_f32 v29, v29, v2
    v_sub_f32 v30, v30, v2
    v_sub_f32 v31, v31, v2
    v_sub_f32 v36, v36, v2
    v_sub_f32 v37, v37, v2
    v_sub_f32 v38, v38, v2
    v_sub_f32 v39, v39, v2
    v_sub_f32 v44, v44, v2
    v_sub_f32 v45, v45, v2
    v_sub_f32 v46, v46, v2
    v_sub_f32 v47, v47, v2
    v_sub_f32 v3, 0, v2
    v_exp_f32 v3, v3
    s_nop 0
    v_mul_f32 v84, v84, v3
    v_mul_f32 v85, v85, v3
    v_mul_f32 v86, v86, v3
    v_mul_f32 v87, v87, v3
    v_accvgpr_read_b32 v48, a4
    v_accvgpr_read_b32 v49, a5
    v_accvgpr_read_b32 v50, a6
    v_accvgpr_read_b32 v51, a7
    v_mul_f32 v48, v48, v3
    v_mul_f32 v49, v49, v3
    v_mul_f32 v50, v50, v3
    v_mul_f32 v51, v51, v3
    v_accvgpr_write_b32 a4, v48
    v_accvgpr_write_b32 a5, v49
    v_accvgpr_write_b32 a6, v50
    v_accvgpr_write_b32 a7, v51
    v_accvgpr_read_b32 v48, a12
    v_accvgpr_read_b32 v49, a13
    v_accvgpr_read_b32 v50, a14
    v_accvgpr_read_b32 v51, a15
    v_mul_f32 v48, v48, v3
    v_mul_f32 v49, v49, v3
    v_mul_f32 v50, v50, v3
    v_mul_f32 v51, v51, v3
    v_accvgpr_write_b32 a12, v48
    v_accvgpr_write_b32 a13, v49
    v_accvgpr_write_b32 a14, v50
    v_accvgpr_write_b32 a15, v51
    v_accvgpr_read_b32 v48, a20
    v_accvgpr_read_b32 v49, a21
    v_accvgpr_read_b32 v50, a22
    v_accvgpr_read_b32 v51, a23
    v_mul_f32 v48, v48, v3
    v_mul_f32 v49, v49, v3
    v_mul_f32 v50, v50, v3
    v_mul_f32 v51, v51, v3
    v_accvgpr_write_b32 a20, v48
    v_accvgpr_write_b32 a21, v49
    v_accvgpr_write_b32 a22, v50
    v_accvgpr_write_b32 a23, v51
    v_accvgpr_read_b32 v48, a28
    v_accvgpr_read_b32 v49, a29
    v_accvgpr_read_b32 v50, a30
    v_accvgpr_read_b32 v51, a31
    v_mul_f32 v48, v48, v3
    v_mul_f32 v49, v49, v3
    v_mul_f32 v50, v50, v3
    v_mul_f32 v51, v51, v3
    v_accvgpr_write_b32 a28, v48
    v_accvgpr_write_b32 a29, v49
    v_accvgpr_write_b32 a30, v50
    v_accvgpr_write_b32 a31, v51
    v_accvgpr_read_b32 v48, a36
    v_accvgpr_read_b32 v49, a37
    v_accvgpr_read_b32 v50, a38
    v_accvgpr_read_b32 v51, a39
    v_mul_f32 v48, v48, v3
    v_mul_f32 v49, v49, v3
    v_mul_f32 v50, v50, v3
    v_mul_f32 v51, v51, v3
    v_accvgpr_write_b32 a36, v48
    v_accvgpr_write_b32 a37, v49
    v_accvgpr_write_b32 a38, v50
    v_accvgpr_write_b32 a39, v51
    v_accvgpr_read_b32 v48, a44
    v_accvgpr_read_b32 v49, a45
    v_accvgpr_read_b32 v50, a46
    v_accvgpr_read_b32 v51, a47
    v_mul_f32 v48, v48, v3
    v_mul_f32 v49, v49, v3
    v_mul_f32 v50, v50, v3
    v_mul_f32 v51, v51, v3
    v_accvgpr_write_b32 a44, v48
    v_accvgpr_write_b32 a45, v49
    v_accvgpr_write_b32 a46, v50
    v_accvgpr_write_b32 a47, v51
    v_accvgpr_read_b32 v48, a52
    v_accvgpr_read_b32 v49, a53
    v_accvgpr_read_b32 v50, a54
    v_accvgpr_read_b32 v51, a55
    v_mul_f32 v48, v48, v3
    v_mul_f32 v49, v49, v3
    v_mul_f32 v50, v50, v3
    v_mul_f32 v51, v51, v3
    v_accvgpr_write_b32 a52, v48
    v_accvgpr_write_b32 a53, v49
    v_accvgpr_write_b32 a54, v50
    v_accvgpr_write_b32 a55, v51
    v_accvgpr_read_b32 v48, a60
    v_accvgpr_read_b32 v49, a61
    v_accvgpr_read_b32 v50, a62
    v_accvgpr_read_b32 v51, a63
    v_mul_f32 v48, v48, v3
    v_mul_f32 v49, v49, v3
    v_mul_f32 v50, v50, v3
    v_mul_f32 v51, v51, v3
    v_accvgpr_write_b32 a60, v48
    v_accvgpr_write_b32 a61, v49
    v_accvgpr_write_b32 a62, v50
    v_accvgpr_write_b32 a63, v51
    v_accvgpr_read_b32 v48, a68
    v_accvgpr_read_b32 v49, a69
    v_accvgpr_read_b32 v50, a70
    v_accvgpr_read_b32 v51, a71
    v_mul_f32 v48, v48, v3
    v_mul_f32 v49, v49, v3
    v_mul_f32 v50, v50, v3
    v_mul_f32 v51, v51, v3
    v_accvgpr_write_b32 a68, v48
    v_accvgpr_write_b32 a69, v49
    v_accvgpr_write_b32 a70, v50
    v_accvgpr_write_b32 a71, v51
    v_accvgpr_read_b32 v48, a76
    v_accvgpr_read_b32 v49, a77
    v_accvgpr_read_b32 v50, a78
    v_accvgpr_read_b32 v51, a79
    v_mul_f32 v48, v48, v3
    v_mul_f32 v49, v49, v3
    v_mul_f32 v50, v50, v3
    v_mul_f32 v51, v51, v3
    v_accvgpr_write_b32 a76, v48
    v_accvgpr_write_b32 a77, v49
    v_accvgpr_write_b32 a78, v50
    v_accvgpr_write_b32 a79, v51
    v_accvgpr_read_b32 v48, a84
    v_accvgpr_read_b32 v49, a85
    v_accvgpr_read_b32 v50, a86
    v_accvgpr_read_b32 v51, a87
    v_mul_f32 v48, v48, v3
    v_mul_f32 v49, v49, v3
    v_mul_f32 v50, v50, v3
    v_mul_f32 v51, v51, v3
    v_accvgpr_write_b32 a84, v48
    v_accvgpr_write_b32 a85, v49
    v_accvgpr_write_b32 a86, v50
    v_accvgpr_write_b32 a87, v51
    v_accvgpr_read_b32 v48, a92
    v_accvgpr_read_b32 v49, a93
    v_accvgpr_read_b32 v50, a94
    v_accvgpr_read_b32 v51, a95
    v_mul_f32 v48, v48, v3
    v_mul_f32 v49, v49, v3
    v_mul_f32 v50, v50, v3
    v_mul_f32 v51, v51, v3
    v_accvgpr_write_b32 a92, v48
    v_accvgpr_write_b32 a93, v49
    v_accvgpr_write_b32 a94, v50
    v_accvgpr_write_b32 a95, v51
    v_accvgpr_read_b32 v48, a100
    v_accvgpr_read_b32 v49, a101
    v_accvgpr_read_b32 v50, a102
    v_accvgpr_read_b32 v51, a103
    v_mul_f32 v48, v48, v3
    v_mul_f32 v49, v49, v3
    v_mul_f32 v50, v50, v3
    v_mul_f32 v51, v51, v3
    v_accvgpr_write_b32 a100, v48
    v_accvgpr_write_b32 a101, v49
    v_accvgpr_write_b32 a102, v50
    v_accvgpr_write_b32 a103, v51
    v_accvgpr_read_b32 v48, a108
    v_accvgpr_read_b32 v49, a109
    v_accvgpr_read_b32 v50, a110
    v_accvgpr_read_b32 v51, a111
    v_mul_f32 v48, v48, v3
    v_mul_f32 v49, v49, v3
    v_mul_f32 v50, v50, v3
    v_mul_f32 v51, v51, v3
    v_accvgpr_write_b32 a108, v48
    v_accvgpr_write_b32 a109, v49
    v_accvgpr_write_b32 a110, v50
    v_accvgpr_write_b32 a111, v51
    v_accvgpr_read_b32 v48, a116
    v_accvgpr_read_b32 v49, a117
    v_accvgpr_read_b32 v50, a118
    v_accvgpr_read_b32 v51, a119
    v_mul_f32 v48, v48, v3
    v_mul_f32 v49, v49, v3
    v_mul_f32 v50, v50, v3
    v_mul_f32 v51, v51, v3
    v_accvgpr_write_b32 a116, v48
    v_accvgpr_write_b32 a117, v49
    v_accvgpr_write_b32 a118, v50
    v_accvgpr_write_b32 a119, v51
    v_accvgpr_read_b32 v48, a124
    v_accvgpr_read_b32 v49, a125
    v_accvgpr_read_b32 v50, a126
    v_accvgpr_read_b32 v51, a127
    v_mul_f32 v48, v48, v3
    v_mul_f32 v49, v49, v3
    v_mul_f32 v50, v50, v3
    v_mul_f32 v51, v51, v3
    v_accvgpr_write_b32 a124, v48
    v_accvgpr_write_b32 a125, v49
    v_accvgpr_write_b32 a126, v50
    v_accvgpr_write_b32 a127, v51
    v_exp_f32 v48, v16
    v_exp_f32 v49, v17
    v_exp_f32 v50, v18
    v_exp_f32 v51, v19
    v_exp_f32 v52, v24
    v_exp_f32 v53, v25
    v_exp_f32 v54, v26
    v_exp_f32 v55, v27
    v_exp_f32 v56, v20
    v_exp_f32 v57, v21
    v_exp_f32 v58, v22
    v_exp_f32 v59, v23
    v_exp_f32 v60, v28
    v_exp_f32 v61, v29
    v_exp_f32 v62, v30
    v_exp_f32 v63, v31
    s_nop 0
    v_cvt_pk_bf16_f32 v64, v48, v49
    v_cvt_pk_bf16_f32 v65, v50, v51
    v_cvt_pk_bf16_f32 v66, v52, v53
    v_cvt_pk_bf16_f32 v67, v54, v55
    v_cvt_pk_bf16_f32 v68, v56, v57
    v_cvt_pk_bf16_f32 v69, v58, v59
    v_cvt_pk_bf16_f32 v70, v60, v61
    v_cvt_pk_bf16_f32 v71, v62, v63
    s_cmp_eq_u32 s50, 0
    s_cbranch_scc1 L_attn_kernel_ret_2
    s_cmp_eq_u32 s50, 2
    s_cbranch_scc1 L_attn_kernel_ret_6
    s_cmp_eq_u32 s50, 4
    s_cbranch_scc1 L_attn_kernel_ret_10
    s_cmp_eq_u32 s50, 6
    s_cbranch_scc1 L_attn_kernel_ret_14
    s_nop 1
    s_branch L_attn_kernel_ret_30
L_attn_slow_11:
    s_nop 7
    s_nop 3
    v_max3_f32 v2, v32, v33, v34
    v_max3_f32 v2, v2, v35, v40
    v_max3_f32 v2, v2, v41, v42
    v_max_f32 v2, v2, v43
    v_mov_b32 v3, v2
    s_nop 1
    v_permlane16_swap_b32 v2, v3
    s_nop 1
    v_max_f32 v2, v2, v3
    v_mov_b32 v3, v2
    s_nop 1
    v_permlane32_swap_b32 v2, v3
    s_nop 1
    v_max_f32 v2, v2, v3
    v_add_f32 v2, 0x41400000, v2
    v_max_f32 v2, 0, v2
    v_sub_f32 v72, v72, v2
    v_sub_f32 v73, v73, v2
    v_sub_f32 v74, v74, v2
    v_sub_f32 v75, v75, v2
    v_sub_f32 v32, v32, v2
    v_sub_f32 v33, v33, v2
    v_sub_f32 v34, v34, v2
    v_sub_f32 v35, v35, v2
    v_sub_f32 v40, v40, v2
    v_sub_f32 v41, v41, v2
    v_sub_f32 v42, v42, v2
    v_sub_f32 v43, v43, v2
    v_sub_f32 v16, v16, v2
    v_sub_f32 v17, v17, v2
    v_sub_f32 v18, v18, v2
    v_sub_f32 v19, v19, v2
    v_sub_f32 v24, v24, v2
    v_sub_f32 v25, v25, v2
    v_sub_f32 v26, v26, v2
    v_sub_f32 v27, v27, v2
    v_sub_f32 v3, 0, v2
    v_exp_f32 v3, v3
    s_nop 0
    v_mul_f32 v80, v80, v3
    v_mul_f32 v81, v81, v3
    v_mul_f32 v82, v82, v3
    v_mul_f32 v83, v83, v3
    v_accvgpr_read_b32 v48, a0
    v_accvgpr_read_b32 v49, a1
    v_accvgpr_read_b32 v50, a2
    v_accvgpr_read_b32 v51, a3
    v_mul_f32 v48, v48, v3
    v_mul_f32 v49, v49, v3
    v_mul_f32 v50, v50, v3
    v_mul_f32 v51, v51, v3
    v_accvgpr_write_b32 a0, v48
    v_accvgpr_write_b32 a1, v49
    v_accvgpr_write_b32 a2, v50
    v_accvgpr_write_b32 a3, v51
    v_accvgpr_read_b32 v48, a8
    v_accvgpr_read_b32 v49, a9
    v_accvgpr_read_b32 v50, a10
    v_accvgpr_read_b32 v51, a11
    v_mul_f32 v48, v48, v3
    v_mul_f32 v49, v49, v3
    v_mul_f32 v50, v50, v3
    v_mul_f32 v51, v51, v3
    v_accvgpr_write_b32 a8, v48
    v_accvgpr_write_b32 a9, v49
    v_accvgpr_write_b32 a10, v50
    v_accvgpr_write_b32 a11, v51
    v_accvgpr_read_b32 v48, a16
    v_accvgpr_read_b32 v49, a17
    v_accvgpr_read_b32 v50, a18
    v_accvgpr_read_b32 v51, a19
    v_mul_f32 v48, v48, v3
    v_mul_f32 v49, v49, v3
    v_mul_f32 v50, v50, v3
    v_mul_f32 v51, v51, v3
    v_accvgpr_write_b32 a16, v48
    v_accvgpr_write_b32 a17, v49
    v_accvgpr_write_b32 a18, v50
    v_accvgpr_write_b32 a19, v51
    v_accvgpr_read_b32 v48, a24
    v_accvgpr_read_b32 v49, a25
    v_accvgpr_read_b32 v50, a26
    v_accvgpr_read_b32 v51, a27
    v_mul_f32 v48, v48, v3
    v_mul_f32 v49, v49, v3
    v_mul_f32 v50, v50, v3
    v_mul_f32 v51, v51, v3
    v_accvgpr_write_b32 a24, v48
    v_accvgpr_write_b32 a25, v49
    v_accvgpr_write_b32 a26, v50
    v_accvgpr_write_b32 a27, v51
    v_accvgpr_read_b32 v48, a32
    v_accvgpr_read_b32 v49, a33
    v_accvgpr_read_b32 v50, a34
    v_accvgpr_read_b32 v51, a35
    v_mul_f32 v48, v48, v3
    v_mul_f32 v49, v49, v3
    v_mul_f32 v50, v50, v3
    v_mul_f32 v51, v51, v3
    v_accvgpr_write_b32 a32, v48
    v_accvgpr_write_b32 a33, v49
    v_accvgpr_write_b32 a34, v50
    v_accvgpr_write_b32 a35, v51
    v_accvgpr_read_b32 v48, a40
    v_accvgpr_read_b32 v49, a41
    v_accvgpr_read_b32 v50, a42
    v_accvgpr_read_b32 v51, a43
    v_mul_f32 v48, v48, v3
    v_mul_f32 v49, v49, v3
    v_mul_f32 v50, v50, v3
    v_mul_f32 v51, v51, v3
    v_accvgpr_write_b32 a40, v48
    v_accvgpr_write_b32 a41, v49
    v_accvgpr_write_b32 a42, v50
    v_accvgpr_write_b32 a43, v51
    v_accvgpr_read_b32 v48, a48
    v_accvgpr_read_b32 v49, a49
    v_accvgpr_read_b32 v50, a50
    v_accvgpr_read_b32 v51, a51
    v_mul_f32 v48, v48, v3
    v_mul_f32 v49, v49, v3
    v_mul_f32 v50, v50, v3
    v_mul_f32 v51, v51, v3
    v_accvgpr_write_b32 a48, v48
    v_accvgpr_write_b32 a49, v49
    v_accvgpr_write_b32 a50, v50
    v_accvgpr_write_b32 a51, v51
    v_accvgpr_read_b32 v48, a56
    v_accvgpr_read_b32 v49, a57
    v_accvgpr_read_b32 v50, a58
    v_accvgpr_read_b32 v51, a59
    v_mul_f32 v48, v48, v3
    v_mul_f32 v49, v49, v3
    v_mul_f32 v50, v50, v3
    v_mul_f32 v51, v51, v3
    v_accvgpr_write_b32 a56, v48
    v_accvgpr_write_b32 a57, v49
    v_accvgpr_write_b32 a58, v50
    v_accvgpr_write_b32 a59, v51
    v_accvgpr_read_b32 v48, a64
    v_accvgpr_read_b32 v49, a65
    v_accvgpr_read_b32 v50, a66
    v_accvgpr_read_b32 v51, a67
    v_mul_f32 v48, v48, v3
    v_mul_f32 v49, v49, v3
    v_mul_f32 v50, v50, v3
    v_mul_f32 v51, v51, v3
    v_accvgpr_write_b32 a64, v48
    v_accvgpr_write_b32 a65, v49
    v_accvgpr_write_b32 a66, v50
    v_accvgpr_write_b32 a67, v51
    v_accvgpr_read_b32 v48, a72
    v_accvgpr_read_b32 v49, a73
    v_accvgpr_read_b32 v50, a74
    v_accvgpr_read_b32 v51, a75
    v_mul_f32 v48, v48, v3
    v_mul_f32 v49, v49, v3
    v_mul_f32 v50, v50, v3
    v_mul_f32 v51, v51, v3
    v_accvgpr_write_b32 a72, v48
    v_accvgpr_write_b32 a73, v49
    v_accvgpr_write_b32 a74, v50
    v_accvgpr_write_b32 a75, v51
    v_accvgpr_read_b32 v48, a80
    v_accvgpr_read_b32 v49, a81
    v_accvgpr_read_b32 v50, a82
    v_accvgpr_read_b32 v51, a83
    v_mul_f32 v48, v48, v3
    v_mul_f32 v49, v49, v3
    v_mul_f32 v50, v50, v3
    v_mul_f32 v51, v51, v3
    v_accvgpr_write_b32 a80, v48
    v_accvgpr_write_b32 a81, v49
    v_accvgpr_write_b32 a82, v50
    v_accvgpr_write_b32 a83, v51
    v_accvgpr_read_b32 v48, a88
    v_accvgpr_read_b32 v49, a89
    v_accvgpr_read_b32 v50, a90
    v_accvgpr_read_b32 v51, a91
    v_mul_f32 v48, v48, v3
    v_mul_f32 v49, v49, v3
    v_mul_f32 v50, v50, v3
    v_mul_f32 v51, v51, v3
    v_accvgpr_write_b32 a88, v48
    v_accvgpr_write_b32 a89, v49
    v_accvgpr_write_b32 a90, v50
    v_accvgpr_write_b32 a91, v51
    v_accvgpr_read_b32 v48, a96
    v_accvgpr_read_b32 v49, a97
    v_accvgpr_read_b32 v50, a98
    v_accvgpr_read_b32 v51, a99
    v_mul_f32 v48, v48, v3
    v_mul_f32 v49, v49, v3
    v_mul_f32 v50, v50, v3
    v_mul_f32 v51, v51, v3
    v_accvgpr_write_b32 a96, v48
    v_accvgpr_write_b32 a97, v49
    v_accvgpr_write_b32 a98, v50
    v_accvgpr_write_b32 a99, v51
    v_accvgpr_read_b32 v48, a104
    v_accvgpr_read_b32 v49, a105
    v_accvgpr_read_b32 v50, a106
    v_accvgpr_read_b32 v51, a107
    v_mul_f32 v48, v48, v3
    v_mul_f32 v49, v49, v3
    v_mul_f32 v50, v50, v3
    v_mul_f32 v51, v51, v3
    v_accvgpr_write_b32 a104, v48
    v_accvgpr_write_b32 a105, v49
    v_accvgpr_write_b32 a106, v50
    v_accvgpr_write_b32 a107, v51
    v_accvgpr_read_b32 v48, a112
    v_accvgpr_read_b32 v49, a113
    v_accvgpr_read_b32 v50, a114
    v_accvgpr_read_b32 v51, a115
    v_mul_f32 v48, v48, v3
    v_mul_f32 v49, v49, v3
    v_mul_f32 v50, v50, v3
    v_mul_f32 v51, v51, v3
    v_accvgpr_write_b32 a112, v48
    v_accvgpr_write_b32 a113, v49
    v_accvgpr_write_b32 a114, v50
    v_accvgpr_write_b32 a115, v51
    v_accvgpr_read_b32 v48, a120
    v_accvgpr_read_b32 v49, a121
    v_accvgpr_read_b32 v50, a122
    v_accvgpr_read_b32 v51, a123
    v_mul_f32 v48, v48, v3
    v_mul_f32 v49, v49, v3
    v_mul_f32 v50, v50, v3
    v_mul_f32 v51, v51, v3
    v_accvgpr_write_b32 a120, v48
    v_accvgpr_write_b32 a121, v49
    v_accvgpr_write_b32 a122, v50
    v_accvgpr_write_b32 a123, v51
    v_max3_f32 v2, v36, v37, v38
    v_max3_f32 v2, v2, v39, v44
    v_max3_f32 v2, v2, v45, v46
    v_max_f32 v2, v2, v47
    v_mov_b32 v3, v2
    s_nop 1
    v_permlane16_swap_b32 v2, v3
    s_nop 1
    v_max_f32 v2, v2, v3
    v_mov_b32 v3, v2
    s_nop 1
    v_permlane32_swap_b32 v2, v3
    s_nop 1
    v_max_f32_e64 v2, v2, v3
    v_add_f32 v2, 0x41400000, v2
    v_max_f32 v2, 0, v2
    v_sub_f32 v76, v76, v2
    v_sub_f32 v77, v77, v2
    v_sub_f32 v78, v78, v2
    v_sub_f32 v79, v79, v2
    v_sub_f32 v36, v36, v2
    v_sub_f32 v37, v37, v2
    v_sub_f32 v38, v38, v2
    v_sub_f32 v39, v39, v2
    v_sub_f32 v44, v44, v2
    v_sub_f32 v45, v45, v2
    v_sub_f32 v46, v46, v2
    v_sub_f32 v47, v47, v2
    v_sub_f32 v20, v20, v2
    v_sub_f32 v21, v21, v2
    v_sub_f32 v22, v22, v2
    v_sub_f32 v23, v23, v2
    v_sub_f32 v28, v28, v2
    v_sub_f32 v29, v29, v2
    v_sub_f32 v30, v30, v2
    v_sub_f32 v31, v31, v2
    v_sub_f32 v3, 0, v2
    v_exp_f32 v3, v3
    s_nop 0
    v_mul_f32 v84, v84, v3
    v_mul_f32 v85, v85, v3
    v_mul_f32 v86, v86, v3
    v_mul_f32 v87, v87, v3
    v_accvgpr_read_b32 v48, a4
    v_accvgpr_read_b32 v49, a5
    v_accvgpr_read_b32 v50, a6
    v_accvgpr_read_b32 v51, a7
    v_mul_f32 v48, v48, v3
    v_mul_f32 v49, v49, v3
    v_mul_f32 v50, v50, v3
    v_mul_f32 v51, v51, v3
    v_accvgpr_write_b32 a4, v48
    v_accvgpr_write_b32 a5, v49
    v_accvgpr_write_b32 a6, v50
    v_accvgpr_write_b32 a7, v51
    v_accvgpr_read_b32 v48, a12
    v_accvgpr_read_b32 v49, a13
    v_accvgpr_read_b32 v50, a14
    v_accvgpr_read_b32 v51, a15
    v_mul_f32 v48, v48, v3
    v_mul_f32 v49, v49, v3
    v_mul_f32 v50, v50, v3
    v_mul_f32 v51, v51, v3
    v_accvgpr_write_b32 a12, v48
    v_accvgpr_write_b32 a13, v49
    v_accvgpr_write_b32 a14, v50
    v_accvgpr_write_b32 a15, v51
    v_accvgpr_read_b32 v48, a20
    v_accvgpr_read_b32 v49, a21
    v_accvgpr_read_b32 v50, a22
    v_accvgpr_read_b32 v51, a23
    v_mul_f32 v48, v48, v3
    v_mul_f32 v49, v49, v3
    v_mul_f32 v50, v50, v3
    v_mul_f32 v51, v51, v3
    v_accvgpr_write_b32 a20, v48
    v_accvgpr_write_b32 a21, v49
    v_accvgpr_write_b32 a22, v50
    v_accvgpr_write_b32 a23, v51
    v_accvgpr_read_b32 v48, a28
    v_accvgpr_read_b32 v49, a29
    v_accvgpr_read_b32 v50, a30
    v_accvgpr_read_b32 v51, a31
    v_mul_f32 v48, v48, v3
    v_mul_f32 v49, v49, v3
    v_mul_f32 v50, v50, v3
    v_mul_f32 v51, v51, v3
    v_accvgpr_write_b32 a28, v48
    v_accvgpr_write_b32 a29, v49
    v_accvgpr_write_b32 a30, v50
    v_accvgpr_write_b32 a31, v51
    v_accvgpr_read_b32 v48, a36
    v_accvgpr_read_b32 v49, a37
    v_accvgpr_read_b32 v50, a38
    v_accvgpr_read_b32 v51, a39
    v_mul_f32 v48, v48, v3
    v_mul_f32 v49, v49, v3
    v_mul_f32 v50, v50, v3
    v_mul_f32 v51, v51, v3
    v_accvgpr_write_b32 a36, v48
    v_accvgpr_write_b32 a37, v49
    v_accvgpr_write_b32 a38, v50
    v_accvgpr_write_b32 a39, v51
    v_accvgpr_read_b32 v48, a44
    v_accvgpr_read_b32 v49, a45
    v_accvgpr_read_b32 v50, a46
    v_accvgpr_read_b32 v51, a47
    v_mul_f32 v48, v48, v3
    v_mul_f32 v49, v49, v3
    v_mul_f32 v50, v50, v3
    v_mul_f32 v51, v51, v3
    v_accvgpr_write_b32 a44, v48
    v_accvgpr_write_b32 a45, v49
    v_accvgpr_write_b32 a46, v50
    v_accvgpr_write_b32 a47, v51
    v_accvgpr_read_b32 v48, a52
    v_accvgpr_read_b32 v49, a53
    v_accvgpr_read_b32 v50, a54
    v_accvgpr_read_b32 v51, a55
    v_mul_f32 v48, v48, v3
    v_mul_f32 v49, v49, v3
    v_mul_f32 v50, v50, v3
    v_mul_f32 v51, v51, v3
    v_accvgpr_write_b32 a52, v48
    v_accvgpr_write_b32 a53, v49
    v_accvgpr_write_b32 a54, v50
    v_accvgpr_write_b32 a55, v51
    v_accvgpr_read_b32 v48, a60
    v_accvgpr_read_b32 v49, a61
    v_accvgpr_read_b32 v50, a62
    v_accvgpr_read_b32 v51, a63
    v_mul_f32 v48, v48, v3
    v_mul_f32 v49, v49, v3
    v_mul_f32 v50, v50, v3
    v_mul_f32 v51, v51, v3
    v_accvgpr_write_b32 a60, v48
    v_accvgpr_write_b32 a61, v49
    v_accvgpr_write_b32 a62, v50
    v_accvgpr_write_b32 a63, v51
    v_accvgpr_read_b32 v48, a68
    v_accvgpr_read_b32 v49, a69
    v_accvgpr_read_b32 v50, a70
    v_accvgpr_read_b32 v51, a71
    v_mul_f32 v48, v48, v3
    v_mul_f32 v49, v49, v3
    v_mul_f32 v50, v50, v3
    v_mul_f32 v51, v51, v3
    v_accvgpr_write_b32 a68, v48
    v_accvgpr_write_b32 a69, v49
    v_accvgpr_write_b32 a70, v50
    v_accvgpr_write_b32 a71, v51
    v_accvgpr_read_b32 v48, a76
    v_accvgpr_read_b32 v49, a77
    v_accvgpr_read_b32 v50, a78
    v_accvgpr_read_b32 v51, a79
    v_mul_f32 v48, v48, v3
    v_mul_f32 v49, v49, v3
    v_mul_f32 v50, v50, v3
    v_mul_f32 v51, v51, v3
    v_accvgpr_write_b32 a76, v48
    v_accvgpr_write_b32 a77, v49
    v_accvgpr_write_b32 a78, v50
    v_accvgpr_write_b32 a79, v51
    v_accvgpr_read_b32 v48, a84
    v_accvgpr_read_b32 v49, a85
    v_accvgpr_read_b32 v50, a86
    v_accvgpr_read_b32 v51, a87
    v_mul_f32 v48, v48, v3
    v_mul_f32 v49, v49, v3
    v_mul_f32 v50, v50, v3
    v_mul_f32 v51, v51, v3
    v_accvgpr_write_b32 a84, v48
    v_accvgpr_write_b32 a85, v49
    v_accvgpr_write_b32 a86, v50
    v_accvgpr_write_b32 a87, v51
    v_accvgpr_read_b32 v48, a92
    v_accvgpr_read_b32 v49, a93
    v_accvgpr_read_b32 v50, a94
    v_accvgpr_read_b32 v51, a95
    v_mul_f32 v48, v48, v3
    v_mul_f32 v49, v49, v3
    v_mul_f32 v50, v50, v3
    v_mul_f32 v51, v51, v3
    v_accvgpr_write_b32 a92, v48
    v_accvgpr_write_b32 a93, v49
    v_accvgpr_write_b32 a94, v50
    v_accvgpr_write_b32 a95, v51
    v_accvgpr_read_b32 v48, a100
    v_accvgpr_read_b32 v49, a101
    v_accvgpr_read_b32 v50, a102
    v_accvgpr_read_b32 v51, a103
    v_mul_f32 v48, v48, v3
    v_mul_f32 v49, v49, v3
    v_mul_f32 v50, v50, v3
    v_mul_f32 v51, v51, v3
    v_accvgpr_write_b32 a100, v48
    v_accvgpr_write_b32 a101, v49
    v_accvgpr_write_b32 a102, v50
    v_accvgpr_write_b32 a103, v51
    v_accvgpr_read_b32 v48, a108
    v_accvgpr_read_b32 v49, a109
    v_accvgpr_read_b32 v50, a110
    v_accvgpr_read_b32 v51, a111
    v_mul_f32 v48, v48, v3
    v_mul_f32 v49, v49, v3
    v_mul_f32 v50, v50, v3
    v_mul_f32 v51, v51, v3
    v_accvgpr_write_b32 a108, v48
    v_accvgpr_write_b32 a109, v49
    v_accvgpr_write_b32 a110, v50
    v_accvgpr_write_b32 a111, v51
    v_accvgpr_read_b32 v48, a116
    v_accvgpr_read_b32 v49, a117
    v_accvgpr_read_b32 v50, a118
    v_accvgpr_read_b32 v51, a119
    v_mul_f32 v48, v48, v3
    v_mul_f32 v49, v49, v3
    v_mul_f32 v50, v50, v3
    v_mul_f32 v51, v51, v3
    v_accvgpr_write_b32 a116, v48
    v_accvgpr_write_b32 a117, v49
    v_accvgpr_write_b32 a118, v50
    v_accvgpr_write_b32 a119, v51
    v_accvgpr_read_b32 v48, a124
    v_accvgpr_read_b32 v49, a125
    v_accvgpr_read_b32 v50, a126
    v_accvgpr_read_b32 v51, a127
    v_mul_f32 v48, v48, v3
    v_mul_f32 v49, v49, v3
    v_mul_f32 v50, v50, v3
    v_mul_f32 v51, v51, v3
    v_accvgpr_write_b32 a124, v48
    v_accvgpr_write_b32 a125, v49
    v_accvgpr_write_b32 a126, v50
    v_accvgpr_write_b32 a127, v51
    v_exp_f32 v48, v32
    v_exp_f32 v49, v33
    v_exp_f32 v50, v34
    v_exp_f32 v51, v35
    v_exp_f32 v52, v40
    v_exp_f32 v53, v41
    v_exp_f32 v54, v42
    v_exp_f32 v55, v43
    v_exp_f32 v56, v36
    v_exp_f32 v57, v37
    v_exp_f32 v58, v38
    v_exp_f32 v59, v39
    v_exp_f32 v60, v44
    v_exp_f32 v61, v45
    v_exp_f32 v62, v46
    v_exp_f32 v63, v47
    s_nop 0
    v_cvt_pk_bf16_f32 v64, v48, v49
    v_cvt_pk_bf16_f32 v65, v50, v51
    v_cvt_pk_bf16_f32 v66, v52, v53
    v_cvt_pk_bf16_f32 v67, v54, v55
    v_cvt_pk_bf16_f32 v68, v56, v57
    v_cvt_pk_bf16_f32 v69, v58, v59
    v_cvt_pk_bf16_f32 v70, v60, v61
    v_cvt_pk_bf16_f32 v71, v62, v63
    s_cmp_eq_u32 s50, 1
    s_cbranch_scc1 L_attn_kernel_ret_4
    s_cmp_eq_u32 s50, 5
    s_cbranch_scc1 L_attn_kernel_ret_12
    s_nop 1
    s_branch L_attn_kernel_ret_20
L_attn_slow_10:
    s_nop 7
    s_nop 3
    v_max3_f32 v2, v32, v33, v34
    v_max3_f32 v2, v2, v35, v40
    v_max3_f32 v2, v2, v41, v42
    v_max_f32 v2, v2, v43
    v_mov_b32 v3, v2
    s_nop 1
    v_permlane16_swap_b32 v2, v3
    s_nop 1
    v_max_f32 v2, v2, v3
    v_mov_b32 v3, v2
    s_nop 1
    v_permlane32_swap_b32 v2, v3
    s_nop 1
    v_max_f32 v2, v2, v3
    v_add_f32 v2, 0x41400000, v2
    v_max_f32 v2, 0, v2
    v_sub_f32 v72, v72, v2
    v_sub_f32 v73, v73, v2
    v_sub_f32 v74, v74, v2
    v_sub_f32 v75, v75, v2
    v_sub_f32 v32, v32, v2
    v_sub_f32 v33, v33, v2
    v_sub_f32 v34, v34, v2
    v_sub_f32 v35, v35, v2
    v_sub_f32 v40, v40, v2
    v_sub_f32 v41, v41, v2
    v_sub_f32 v42, v42, v2
    v_sub_f32 v43, v43, v2
    v_sub_f32 v3, 0, v2
    v_exp_f32 v3, v3
    s_nop 0
    v_mul_f32 v80, v80, v3
    v_mul_f32 v81, v81, v3
    v_mul_f32 v82, v82, v3
    v_mul_f32 v83, v83, v3
    v_accvgpr_read_b32 v48, a0
    v_accvgpr_read_b32 v49, a1
    v_accvgpr_read_b32 v50, a2
    v_accvgpr_read_b32 v51, a3
    v_mul_f32 v48, v48, v3
    v_mul_f32 v49, v49, v3
    v_mul_f32 v50, v50, v3
    v_mul_f32 v51, v51, v3
    v_accvgpr_write_b32 a0, v48
    v_accvgpr_write_b32 a1, v49
    v_accvgpr_write_b32 a2, v50
    v_accvgpr_write_b32 a3, v51
    v_accvgpr_read_b32 v48, a8
    v_accvgpr_read_b32 v49, a9
    v_accvgpr_read_b32 v50, a10
    v_accvgpr_read_b32 v51, a11
    v_mul_f32 v48, v48, v3
    v_mul_f32 v49, v49, v3
    v_mul_f32 v50, v50, v3
    v_mul_f32 v51, v51, v3
    v_accvgpr_write_b32 a8, v48
    v_accvgpr_write_b32 a9, v49
    v_accvgpr_write_b32 a10, v50
    v_accvgpr_write_b32 a11, v51
    v_accvgpr_read_b32 v48, a16
    v_accvgpr_read_b32 v49, a17
    v_accvgpr_read_b32 v50, a18
    v_accvgpr_read_b32 v51, a19
    v_mul_f32 v48, v48, v3
    v_mul_f32 v49, v49, v3
    v_mul_f32 v50, v50, v3
    v_mul_f32 v51, v51, v3
    v_accvgpr_write_b32 a16, v48
    v_accvgpr_write_b32 a17, v49
    v_accvgpr_write_b32 a18, v50
    v_accvgpr_write_b32 a19, v51
    v_accvgpr_read_b32 v48, a24
    v_accvgpr_read_b32 v49, a25
    v_accvgpr_read_b32 v50, a26
    v_accvgpr_read_b32 v51, a27
    v_mul_f32 v48, v48, v3
    v_mul_f32 v49, v49, v3
    v_mul_f32 v50, v50, v3
    v_mul_f32 v51, v51, v3
    v_accvgpr_write_b32 a24, v48
    v_accvgpr_write_b32 a25, v49
    v_accvgpr_write_b32 a26, v50
    v_accvgpr_write_b32 a27, v51
    v_accvgpr_read_b32 v48, a32
    v_accvgpr_read_b32 v49, a33
    v_accvgpr_read_b32 v50, a34
    v_accvgpr_read_b32 v51, a35
    v_mul_f32 v48, v48, v3
    v_mul_f32 v49, v49, v3
    v_mul_f32 v50, v50, v3
    v_mul_f32 v51, v51, v3
    v_accvgpr_write_b32 a32, v48
    v_accvgpr_write_b32 a33, v49
    v_accvgpr_write_b32 a34, v50
    v_accvgpr_write_b32 a35, v51
    v_accvgpr_read_b32 v48, a40
    v_accvgpr_read_b32 v49, a41
    v_accvgpr_read_b32 v50, a42
    v_accvgpr_read_b32 v51, a43
    v_mul_f32 v48, v48, v3
    v_mul_f32 v49, v49, v3
    v_mul_f32 v50, v50, v3
    v_mul_f32 v51, v51, v3
    v_accvgpr_write_b32 a40, v48
    v_accvgpr_write_b32 a41, v49
    v_accvgpr_write_b32 a42, v50
    v_accvgpr_write_b32 a43, v51
    v_accvgpr_read_b32 v48, a48
    v_accvgpr_read_b32 v49, a49
    v_accvgpr_read_b32 v50, a50
    v_accvgpr_read_b32 v51, a51
    v_mul_f32 v48, v48, v3
    v_mul_f32 v49, v49, v3
    v_mul_f32 v50, v50, v3
    v_mul_f32 v51, v51, v3
    v_accvgpr_write_b32 a48, v48
    v_accvgpr_write_b32 a49, v49
    v_accvgpr_write_b32 a50, v50
    v_accvgpr_write_b32 a51, v51
    v_accvgpr_read_b32 v48, a56
    v_accvgpr_read_b32 v49, a57
    v_accvgpr_read_b32 v50, a58
    v_accvgpr_read_b32 v51, a59
    v_mul_f32 v48, v48, v3
    v_mul_f32 v49, v49, v3
    v_mul_f32 v50, v50, v3
    v_mul_f32 v51, v51, v3
    v_accvgpr_write_b32 a56, v48
    v_accvgpr_write_b32 a57, v49
    v_accvgpr_write_b32 a58, v50
    v_accvgpr_write_b32 a59, v51
    v_accvgpr_read_b32 v48, a64
    v_accvgpr_read_b32 v49, a65
    v_accvgpr_read_b32 v50, a66
    v_accvgpr_read_b32 v51, a67
    v_mul_f32 v48, v48, v3
    v_mul_f32 v49, v49, v3
    v_mul_f32 v50, v50, v3
    v_mul_f32 v51, v51, v3
    v_accvgpr_write_b32 a64, v48
    v_accvgpr_write_b32 a65, v49
    v_accvgpr_write_b32 a66, v50
    v_accvgpr_write_b32 a67, v51
    v_accvgpr_read_b32 v48, a72
    v_accvgpr_read_b32 v49, a73
    v_accvgpr_read_b32 v50, a74
    v_accvgpr_read_b32 v51, a75
    v_mul_f32 v48, v48, v3
    v_mul_f32 v49, v49, v3
    v_mul_f32 v50, v50, v3
    v_mul_f32 v51, v51, v3
    v_accvgpr_write_b32 a72, v48
    v_accvgpr_write_b32 a73, v49
    v_accvgpr_write_b32 a74, v50
    v_accvgpr_write_b32 a75, v51
    v_accvgpr_read_b32 v48, a80
    v_accvgpr_read_b32 v49, a81
    v_accvgpr_read_b32 v50, a82
    v_accvgpr_read_b32 v51, a83
    v_mul_f32 v48, v48, v3
    v_mul_f32 v49, v49, v3
    v_mul_f32 v50, v50, v3
    v_mul_f32 v51, v51, v3
    v_accvgpr_write_b32 a80, v48
    v_accvgpr_write_b32 a81, v49
    v_accvgpr_write_b32 a82, v50
    v_accvgpr_write_b32 a83, v51
    v_accvgpr_read_b32 v48, a88
    v_accvgpr_read_b32 v49, a89
    v_accvgpr_read_b32 v50, a90
    v_accvgpr_read_b32 v51, a91
    v_mul_f32 v48, v48, v3
    v_mul_f32 v49, v49, v3
    v_mul_f32 v50, v50, v3
    v_mul_f32 v51, v51, v3
    v_accvgpr_write_b32 a88, v48
    v_accvgpr_write_b32 a89, v49
    v_accvgpr_write_b32 a90, v50
    v_accvgpr_write_b32 a91, v51
    v_accvgpr_read_b32 v48, a96
    v_accvgpr_read_b32 v49, a97
    v_accvgpr_read_b32 v50, a98
    v_accvgpr_read_b32 v51, a99
    v_mul_f32 v48, v48, v3
    v_mul_f32 v49, v49, v3
    v_mul_f32 v50, v50, v3
    v_mul_f32 v51, v51, v3
    v_accvgpr_write_b32 a96, v48
    v_accvgpr_write_b32 a97, v49
    v_accvgpr_write_b32 a98, v50
    v_accvgpr_write_b32 a99, v51
    v_accvgpr_read_b32 v48, a104
    v_accvgpr_read_b32 v49, a105
    v_accvgpr_read_b32 v50, a106
    v_accvgpr_read_b32 v51, a107
    v_mul_f32 v48, v48, v3
    v_mul_f32 v49, v49, v3
    v_mul_f32 v50, v50, v3
    v_mul_f32 v51, v51, v3
    v_accvgpr_write_b32 a104, v48
    v_accvgpr_write_b32 a105, v49
    v_accvgpr_write_b32 a106, v50
    v_accvgpr_write_b32 a107, v51
    v_accvgpr_read_b32 v48, a112
    v_accvgpr_read_b32 v49, a113
    v_accvgpr_read_b32 v50, a114
    v_accvgpr_read_b32 v51, a115
    v_mul_f32 v48, v48, v3
    v_mul_f32 v49, v49, v3
    v_mul_f32 v50, v50, v3
    v_mul_f32 v51, v51, v3
    v_accvgpr_write_b32 a112, v48
    v_accvgpr_write_b32 a113, v49
    v_accvgpr_write_b32 a114, v50
    v_accvgpr_write_b32 a115, v51
    v_accvgpr_read_b32 v48, a120
    v_accvgpr_read_b32 v49, a121
    v_accvgpr_read_b32 v50, a122
    v_accvgpr_read_b32 v51, a123
    v_mul_f32 v48, v48, v3
    v_mul_f32 v49, v49, v3
    v_mul_f32 v50, v50, v3
    v_mul_f32 v51, v51, v3
    v_accvgpr_write_b32 a120, v48
    v_accvgpr_write_b32 a121, v49
    v_accvgpr_write_b32 a122, v50
    v_accvgpr_write_b32 a123, v51
    v_max3_f32 v2, v36, v37, v38
    v_max3_f32 v2, v2, v39, v44
    v_max3_f32 v2, v2, v45, v46
    v_max_f32 v2, v2, v47
    v_mov_b32 v3, v2
    s_nop 1
    v_permlane16_swap_b32 v2, v3
    s_nop 1
    v_max_f32 v2, v2, v3
    v_mov_b32 v3, v2
    s_nop 1
    v_permlane32_swap_b32 v2, v3
    s_nop 1
    v_max_f32_e64 v2, v2, v3
    v_add_f32 v2, 0x41400000, v2
    v_max_f32 v2, 0, v2
    v_sub_f32 v76, v76, v2
    v_sub_f32 v77, v77, v2
    v_sub_f32 v78, v78, v2
    v_sub_f32 v79, v79, v2
    v_sub_f32 v36, v36, v2
    v_sub_f32 v37, v37, v2
    v_sub_f32 v38, v38, v2
    v_sub_f32 v39, v39, v2
    v_sub_f32 v44, v44, v2
    v_sub_f32 v45, v45, v2
    v_sub_f32 v46, v46, v2
    v_sub_f32 v47, v47, v2
    v_sub_f32 v3, 0, v2
    v_exp_f32 v3, v3
    s_nop 0
    v_mul_f32 v84, v84, v3
    v_mul_f32 v85, v85, v3
    v_mul_f32 v86, v86, v3
    v_mul_f32 v87, v87, v3
    v_accvgpr_read_b32 v48, a4
    v_accvgpr_read_b32 v49, a5
    v_accvgpr_read_b32 v50, a6
    v_accvgpr_read_b32 v51, a7
    v_mul_f32 v48, v48, v3
    v_mul_f32 v49, v49, v3
    v_mul_f32 v50, v50, v3
    v_mul_f32 v51, v51, v3
    v_accvgpr_write_b32 a4, v48
    v_accvgpr_write_b32 a5, v49
    v_accvgpr_write_b32 a6, v50
    v_accvgpr_write_b32 a7, v51
    v_accvgpr_read_b32 v48, a12
    v_accvgpr_read_b32 v49, a13
    v_accvgpr_read_b32 v50, a14
    v_accvgpr_read_b32 v51, a15
    v_mul_f32 v48, v48, v3
    v_mul_f32 v49, v49, v3
    v_mul_f32 v50, v50, v3
    v_mul_f32 v51, v51, v3
    v_accvgpr_write_b32 a12, v48
    v_accvgpr_write_b32 a13, v49
    v_accvgpr_write_b32 a14, v50
    v_accvgpr_write_b32 a15, v51
    v_accvgpr_read_b32 v48, a20
    v_accvgpr_read_b32 v49, a21
    v_accvgpr_read_b32 v50, a22
    v_accvgpr_read_b32 v51, a23
    v_mul_f32 v48, v48, v3
    v_mul_f32 v49, v49, v3
    v_mul_f32 v50, v50, v3
    v_mul_f32 v51, v51, v3
    v_accvgpr_write_b32 a20, v48
    v_accvgpr_write_b32 a21, v49
    v_accvgpr_write_b32 a22, v50
    v_accvgpr_write_b32 a23, v51
    v_accvgpr_read_b32 v48, a28
    v_accvgpr_read_b32 v49, a29
    v_accvgpr_read_b32 v50, a30
    v_accvgpr_read_b32 v51, a31
    v_mul_f32 v48, v48, v3
    v_mul_f32 v49, v49, v3
    v_mul_f32 v50, v50, v3
    v_mul_f32 v51, v51, v3
    v_accvgpr_write_b32 a28, v48
    v_accvgpr_write_b32 a29, v49
    v_accvgpr_write_b32 a30, v50
    v_accvgpr_write_b32 a31, v51
    v_accvgpr_read_b32 v48, a36
    v_accvgpr_read_b32 v49, a37
    v_accvgpr_read_b32 v50, a38
    v_accvgpr_read_b32 v51, a39
    v_mul_f32 v48, v48, v3
    v_mul_f32 v49, v49, v3
    v_mul_f32 v50, v50, v3
    v_mul_f32 v51, v51, v3
    v_accvgpr_write_b32 a36, v48
    v_accvgpr_write_b32 a37, v49
    v_accvgpr_write_b32 a38, v50
    v_accvgpr_write_b32 a39, v51
    v_accvgpr_read_b32 v48, a44
    v_accvgpr_read_b32 v49, a45
    v_accvgpr_read_b32 v50, a46
    v_accvgpr_read_b32 v51, a47
    v_mul_f32 v48, v48, v3
    v_mul_f32 v49, v49, v3
    v_mul_f32 v50, v50, v3
    v_mul_f32 v51, v51, v3
    v_accvgpr_write_b32 a44, v48
    v_accvgpr_write_b32 a45, v49
    v_accvgpr_write_b32 a46, v50
    v_accvgpr_write_b32 a47, v51
    v_accvgpr_read_b32 v48, a52
    v_accvgpr_read_b32 v49, a53
    v_accvgpr_read_b32 v50, a54
    v_accvgpr_read_b32 v51, a55
    v_mul_f32 v48, v48, v3
    v_mul_f32 v49, v49, v3
    v_mul_f32 v50, v50, v3
    v_mul_f32 v51, v51, v3
    v_accvgpr_write_b32 a52, v48
    v_accvgpr_write_b32 a53, v49
    v_accvgpr_write_b32 a54, v50
    v_accvgpr_write_b32 a55, v51
    v_accvgpr_read_b32 v48, a60
    v_accvgpr_read_b32 v49, a61
    v_accvgpr_read_b32 v50, a62
    v_accvgpr_read_b32 v51, a63
    v_mul_f32 v48, v48, v3
    v_mul_f32 v49, v49, v3
    v_mul_f32 v50, v50, v3
    v_mul_f32 v51, v51, v3
    v_accvgpr_write_b32 a60, v48
    v_accvgpr_write_b32 a61, v49
    v_accvgpr_write_b32 a62, v50
    v_accvgpr_write_b32 a63, v51
    v_accvgpr_read_b32 v48, a68
    v_accvgpr_read_b32 v49, a69
    v_accvgpr_read_b32 v50, a70
    v_accvgpr_read_b32 v51, a71
    v_mul_f32 v48, v48, v3
    v_mul_f32 v49, v49, v3
    v_mul_f32 v50, v50, v3
    v_mul_f32 v51, v51, v3
    v_accvgpr_write_b32 a68, v48
    v_accvgpr_write_b32 a69, v49
    v_accvgpr_write_b32 a70, v50
    v_accvgpr_write_b32 a71, v51
    v_accvgpr_read_b32 v48, a76
    v_accvgpr_read_b32 v49, a77
    v_accvgpr_read_b32 v50, a78
    v_accvgpr_read_b32 v51, a79
    v_mul_f32 v48, v48, v3
    v_mul_f32 v49, v49, v3
    v_mul_f32 v50, v50, v3
    v_mul_f32 v51, v51, v3
    v_accvgpr_write_b32 a76, v48
    v_accvgpr_write_b32 a77, v49
    v_accvgpr_write_b32 a78, v50
    v_accvgpr_write_b32 a79, v51
    v_accvgpr_read_b32 v48, a84
    v_accvgpr_read_b32 v49, a85
    v_accvgpr_read_b32 v50, a86
    v_accvgpr_read_b32 v51, a87
    v_mul_f32 v48, v48, v3
    v_mul_f32 v49, v49, v3
    v_mul_f32 v50, v50, v3
    v_mul_f32 v51, v51, v3
    v_accvgpr_write_b32 a84, v48
    v_accvgpr_write_b32 a85, v49
    v_accvgpr_write_b32 a86, v50
    v_accvgpr_write_b32 a87, v51
    v_accvgpr_read_b32 v48, a92
    v_accvgpr_read_b32 v49, a93
    v_accvgpr_read_b32 v50, a94
    v_accvgpr_read_b32 v51, a95
    v_mul_f32 v48, v48, v3
    v_mul_f32 v49, v49, v3
    v_mul_f32 v50, v50, v3
    v_mul_f32 v51, v51, v3
    v_accvgpr_write_b32 a92, v48
    v_accvgpr_write_b32 a93, v49
    v_accvgpr_write_b32 a94, v50
    v_accvgpr_write_b32 a95, v51
    v_accvgpr_read_b32 v48, a100
    v_accvgpr_read_b32 v49, a101
    v_accvgpr_read_b32 v50, a102
    v_accvgpr_read_b32 v51, a103
    v_mul_f32 v48, v48, v3
    v_mul_f32 v49, v49, v3
    v_mul_f32 v50, v50, v3
    v_mul_f32 v51, v51, v3
    v_accvgpr_write_b32 a100, v48
    v_accvgpr_write_b32 a101, v49
    v_accvgpr_write_b32 a102, v50
    v_accvgpr_write_b32 a103, v51
    v_accvgpr_read_b32 v48, a108
    v_accvgpr_read_b32 v49, a109
    v_accvgpr_read_b32 v50, a110
    v_accvgpr_read_b32 v51, a111
    v_mul_f32 v48, v48, v3
    v_mul_f32 v49, v49, v3
    v_mul_f32 v50, v50, v3
    v_mul_f32 v51, v51, v3
    v_accvgpr_write_b32 a108, v48
    v_accvgpr_write_b32 a109, v49
    v_accvgpr_write_b32 a110, v50
    v_accvgpr_write_b32 a111, v51
    v_accvgpr_read_b32 v48, a116
    v_accvgpr_read_b32 v49, a117
    v_accvgpr_read_b32 v50, a118
    v_accvgpr_read_b32 v51, a119
    v_mul_f32 v48, v48, v3
    v_mul_f32 v49, v49, v3
    v_mul_f32 v50, v50, v3
    v_mul_f32 v51, v51, v3
    v_accvgpr_write_b32 a116, v48
    v_accvgpr_write_b32 a117, v49
    v_accvgpr_write_b32 a118, v50
    v_accvgpr_write_b32 a119, v51
    v_accvgpr_read_b32 v48, a124
    v_accvgpr_read_b32 v49, a125
    v_accvgpr_read_b32 v50, a126
    v_accvgpr_read_b32 v51, a127
    v_mul_f32 v48, v48, v3
    v_mul_f32 v49, v49, v3
    v_mul_f32 v50, v50, v3
    v_mul_f32 v51, v51, v3
    v_accvgpr_write_b32 a124, v48
    v_accvgpr_write_b32 a125, v49
    v_accvgpr_write_b32 a126, v50
    v_accvgpr_write_b32 a127, v51
    v_exp_f32 v48, v32
    v_exp_f32 v49, v33
    v_exp_f32 v50, v34
    v_exp_f32 v51, v35
    v_exp_f32 v52, v40
    v_exp_f32 v53, v41
    v_exp_f32 v54, v42
    v_exp_f32 v55, v43
    v_exp_f32 v56, v36
    v_exp_f32 v57, v37
    v_exp_f32 v58, v38
    v_exp_f32 v59, v39
    v_exp_f32 v60, v44
    v_exp_f32 v61, v45
    v_exp_f32 v62, v46
    v_exp_f32 v63, v47
    s_nop 0
    v_cvt_pk_bf16_f32 v64, v48, v49
    v_cvt_pk_bf16_f32 v65, v50, v51
    v_cvt_pk_bf16_f32 v66, v52, v53
    v_cvt_pk_bf16_f32 v67, v54, v55
    v_cvt_pk_bf16_f32 v68, v56, v57
    v_cvt_pk_bf16_f32 v69, v58, v59
    v_cvt_pk_bf16_f32 v70, v60, v61
    v_cvt_pk_bf16_f32 v71, v62, v63
    s_cmp_eq_u32 s50, 3
    s_cbranch_scc1 L_attn_kernel_ret_8
    s_nop 1
    s_branch L_attn_kernel_ret_36
L_attn_end:
    s_endpgm
.globl tail_kernel
.p2align 8
.type tail_kernel,@function
tail_kernel:
    s_cmp_ge_u32 s2, 224
    s_cbranch_scc1 L_tail_end
    s_load_dwordx2 s[4:5], s[0:1], 56
    s_load_dwordx2 s[6:7], s[0:1], 88
    s_load_dwordx2 s[24:25], s[0:1], 0
    s_load_dwordx4 s[60:63], s[0:1], 64
    s_and_b32 s3, s2, 7
    s_lshr_b32 s30, s2, 3
    s_cmp_ge_u32 s30, 14
    s_cselect_b32 s31, 1, 0
    s_mul_i32 s35, s31, 14
    s_sub_u32 s34, s30, s35
    s_lshl_b32 s3, s3, 1
    s_add_u32 s33, s3, s31
    v_lshrrev_b32 v2, 6, v0
    v_and_b32 v1, 63, v0
    s_nop 0
    v_readfirstlane_b32 s32, v2
    v_lshlrev_b32 v6, 4, v1
    s_nop 2
    s_lshl_b32 s35, s33, 3
    s_lshl_b32 s36, s32, 1
    s_add_u32 s39, s35, s36
    s_mul_i32 s36, s39, 14
    s_add_u32 s36, s36, s34
    s_lshl_b32 s43, s36, 10
    s_waitcnt lgkmcnt(0)
    s_lshl_b32 s37, s43, 4
    s_add_u32 s37, s37, 109051904
    s_add_u32 s36, s6, s37
    s_addc_u32 s37, s7, 0
    s_mov_b32 s8, s36
    s_and_b32 s9, s37, 0xffff
    s_mov_b32 s10, 245760
    s_mov_b32 s11, 0x00020000
    s_mov_b32 s40, 0
    buffer_load_dwordx4 v[128:131], v6, s[8:11], s40 offen offset:0
    s_mov_b32 s40, 229376
    buffer_load_dwordx4 v[132:135], v6, s[8:11], s40 offen offset:0
    s_mov_b32 s40, 0
    buffer_load_dwordx4 v[136:139], v6, s[8:11], s40 offen offset:1024
    s_mov_b32 s40, 229376
    buffer_load_dwordx4 v[140:143], v6, s[8:11], s40 offen offset:1024
    s_mov_b32 s40, 0
    buffer_load_dwordx4 v[144:147], v6, s[8:11], s40 offen offset:2048
    s_mov_b32 s40, 229376
    buffer_load_dwordx4 v[148:151], v6, s[8:11], s40 offen offset:2048
    s_mov_b32 s40, 0
    buffer_load_dwordx4 v[152:155], v6, s[8:11], s40 offen offset:3072
    s_mov_b32 s40, 229376
    buffer_load_dwordx4 v[156:159], v6, s[8:11], s40 offen offset:3072
    s_mov_b32 s40, 4096
    buffer_load_dwordx4 v[160:163], v6, s[8:11], s40 offen offset:0
    s_mov_b32 s40, 233472
    buffer_load_dwordx4 v[164:167], v6, s[8:11], s40 offen offset:0
    s_mov_b32 s40, 4096
    buffer_load_dwordx4 v[168:171], v6, s[8:11], s40 offen offset:1024
    s_mov_b32 s40, 233472
    buffer_load_dwordx4 v[172:175], v6, s[8:11], s40 offen offset:1024
    s_mov_b32 s40, 4096
    buffer_load_dwordx4 v[176:179], v6, s[8:11], s40 offen offset:2048
    s_mov_b32 s40, 233472
    buffer_load_dwordx4 v[180:183], v6, s[8:11], s40 offen offset:2048
    s_mov_b32 s40, 4096
    buffer_load_dwordx4 v[184:187], v6, s[8:11], s40 offen offset:3072
    s_mov_b32 s40, 233472
    buffer_load_dwordx4 v[188:191], v6, s[8:11], s40 offen offset:3072
    s_mov_b32 s40, 8192
    buffer_load_dwordx4 v[192:195], v6, s[8:11], s40 offen offset:0
    s_mov_b32 s40, 237568
    buffer_load_dwordx4 v[196:199], v6, s[8:11], s40 offen offset:0
    s_mov_b32 s40, 8192
    buffer_load_dwordx4 v[200:203], v6, s[8:11], s40 offen offset:1024
    s_mov_b32 s40, 237568
    buffer_load_dwordx4 v[204:207], v6, s[8:11], s40 offen offset:1024
    s_mov_b32 s40, 8192
    buffer_load_dwordx4 v[208:211], v6, s[8:11], s40 offen offset:2048
    s_mov_b32 s40, 237568
    buffer_load_dwordx4 v[212:215], v6, s[8:11], s40 offen offset:2048
    s_mov_b32 s40, 8192
    buffer_load_dwordx4 v[216:219], v6, s[8:11], s40 offen offset:3072
    s_mov_b32 s40, 237568
    buffer_load_dwordx4 v[220:223], v6, s[8:11], s40 offen offset:3072
    s_mov_b32 s40, 12288
    buffer_load_dwordx4 v[224:227], v6, s[8:11], s40 offen offset:0
    s_mov_b32 s40, 241664
    buffer_load_dwordx4 v[228:231], v6, s[8:11], s40 offen offset:0
    s_mov_b32 s40, 12288
    buffer_load_dwordx4 v[232:235], v6, s[8:11], s40 offen offset:1024
    s_mov_b32 s40, 241664
    buffer_load_dwordx4 v[236:239], v6, s[8:11], s40 offen offset:1024
    s_mov_b32 s40, 12288
    buffer_load_dwordx4 v[240:243], v6, s[8:11], s40 offen offset:2048
    s_mov_b32 s40, 241664
    buffer_load_dwordx4 v[244:247], v6, s[8:11], s40 offen offset:2048
    s_mov_b32 s40, 12288
    buffer_load_dwordx4 v[248:251], v6, s[8:11], s40 offen offset:3072
    s_mov_b32 s40, 241664
    buffer_load_dwordx4 v[252:255], v6, s[8:11], s40 offen offset:3072
    v_and_b32 v2, 15, v1
    s_lshl_b32 s37, s39, 4
    v_add_u32_e64 v5, s37, v2
    v_mul_u32_u24 v20, 896, v5
    v_lshrrev_b32_e64 v3, 4, v1
    v_lshl_add_u32 v20, v3, 3, v20
    s_lshl_b32 s37, s34, 6
    v_add_u32 v20, s37, v20
    s_mov_b32 s24, s24
    s_and_b32 s25, s25, 0xffff
    s_mov_b32 s26, 1835008
    s_mov_b32 s27, 0x00020000
    s_mov_b32 s40, 14336
    buffer_load_dwordx2 v[32:33], v20, s[24:27], 0 offen offset:0
    buffer_load_dwordx2 v[34:35], v20, s[24:27], 0 offen offset:32
    buffer_load_dwordx2 v[36:37], v20, s[24:27], s40 offen offset:0
    buffer_load_dwordx2 v[38:39], v20, s[24:27], s40 offen offset:32
    v_lshrrev_b32 v2, 4, v1
    s_and_b32 s3, s32, 1
    s_lshl_b32 s3, s3, 2
    v_or_b32 v3, s3, v2
    v_lshlrev_b32 v3, 1, v3
    v_and_b32 v4, 15, v1
    v_xor_b32 v3, v3, v4
    v_lshlrev_b32 v3, 4, v3
    s_lshl_b32 s3, s32, 2
    v_add_u32_e64 v2, s3, v2
    v_mul_u32_u24 v2, 3584, v2
    v_add_u32 v7, v2, v3
    s_lshl_b32 s35, s34, 8
    s_add_u32 s36, s4, s35
    s_addc_u32 s37, s5, 0
    s_sub_u32 s38, 1605632, s35
    s_mov_b32 s12, s36
    s_and_b32 s13, s37, 0xffff
    s_mov_b32 s14, s38
    s_mov_b32 s15, 0x00020000
    s_lshl_b32 s3, s32, 10
    v_and_b32 v2, 15, v1
    v_lshrrev_b32 v3, 2, v2
    v_lshrrev_b32 v4, 4, v1
    v_cmp_eq_u32 vcc, v3, v4
    v_and_b32 v3, 1, v2
    v_lshlrev_b32_e64 v3, 4, v3
    v_mov_b32 v4, 0x3f80
    v_lshlrev_b32 v3, v3, v4
    v_cndmask_b32 v3, 0, v3, vcc
    v_and_b32 v2, 2, v2
    v_cmp_eq_u32 vcc, 0, v2
    v_mov_b32 v26, 0
    v_mov_b32 v27, 0
    v_cndmask_b32 v24, 0, v3, vcc
    v_cndmask_b32 v25, v3, 0, vcc
    v_mov_b32 v28, 0
    v_mov_b32 v29, 0
    v_mov_b32 v30, v24
    v_mov_b32_e64 v31, v25
    s_add_u32 s37, s43, 92274688
    s_add_u32 s36, s6, s37
    s_addc_u32 s37, s7, 0
    s_mov_b32 s16, s36
    s_and_b32 s17, s37, 0xffff
    s_mov_b32 s18, 15360
    s_mov_b32 s19, 0x00020000
    s_add_u32 s36, s6, 94371840
    s_addc_u32 s37, s7, 0
    s_mov_b32 s20, s36
    s_and_b32 s21, s37, 0xffff
    s_mov_b32 s22, 229376
    s_mov_b32 s23, 0x00020000
    s_lshl_b32 s37, s33, 8
    s_add_u32 s37, s37, 95420416
    s_add_u32 s36, s6, s37
    s_addc_u32 s37, s7, 0
    s_mov_b32 s64, s36
    s_and_b32 s65, s37, 0xffff
    s_mov_b32 s66, 256
    s_mov_b32 s67, 0x00020000
    v_mul_u32_u24 v21, 112, v5
    s_add_u32 m0, s3, 0
    s_mov_b32 s40, 0
    buffer_load_dwordx4 v7, s[12:15], s40 offen lds
    s_waitcnt vmcnt(35)
    v_mfma_f32_16x16x32_bf16 v[64:67], v[24:27], v[128:131], 0
    v_mfma_f32_16x16x32_bf16 v[68:71], v[28:31], v[128:131], 0
    v_mfma_f32_16x16x32_bf16 v[72:75], v[24:27], v[132:135], 0
    v_mfma_f32_16x16x32_bf16 v[76:79], v[28:31], v[132:135], 0
    s_add_u32 m0, s3, 4096
    s_mov_b32 s40, 57344
    buffer_load_dwordx4 v7, s[12:15], s40 offen lds
    s_waitcnt vmcnt(34)
    v_mfma_f32_16x16x32_bf16 v[64:67], v[24:27], v[136:139], v[64:67]
    v_mfma_f32_16x16x32_bf16 v[68:71], v[28:31], v[136:139], v[68:71]
    v_mfma_f32_16x16x32_bf16 v[72:75], v[24:27], v[140:143], v[72:75]
    v_mfma_f32_16x16x32_bf16 v[76:79], v[28:31], v[140:143], v[76:79]
    s_add_u32 m0, s3, 8192
    s_mov_b32 s40, 114688
    buffer_load_dwordx4 v7, s[12:15], s40 offen lds
    s_waitcnt vmcnt(33)
    v_mfma_f32_16x16x32_bf16 v[64:67], v[24:27], v[144:147], v[64:67]
    v_mfma_f32_16x16x32_bf16 v[68:71], v[28:31], v[144:147], v[68:71]
    v_mfma_f32_16x16x32_bf16 v[72:75], v[24:27], v[148:151], v[72:75]
    v_mfma_f32_16x16x32_bf16 v[76:79], v[28:31], v[148:151], v[76:79]
    s_add_u32 m0, s3, 12288
    s_mov_b32 s40, 172032
    buffer_load_dwordx4 v7, s[12:15], s40 offen lds
    s_waitcnt vmcnt(32)
    v_mfma_f32_16x16x32_bf16 v[64:67], v[24:27], v[152:155], v[64:67]
    v_mfma_f32_16x16x32_bf16 v[68:71], v[28:31], v[152:155], v[68:71]
    v_mfma_f32_16x16x32_bf16 v[72:75], v[24:27], v[156:159], v[72:75]
    v_mfma_f32_16x16x32_bf16 v[76:79], v[28:31], v[156:159], v[76:79]
    s_add_u32 m0, s3, 16384
    s_mov_b32 s40, 229376
    buffer_load_dwordx4 v7, s[12:15], s40 offen lds
    s_waitcnt vmcnt(31)
    v_mfma_f32_16x16x32_bf16 v[64:67], v[24:27], v[160:163], v[64:67]
    v_mfma_f32_16x16x32_bf16 v[68:71], v[28:31], v[160:163], v[68:71]
    v_mfma_f32_16x16x32_bf16 v[72:75], v[24:27], v[164:167], v[72:75]
    v_mfma_f32_16x16x32_bf16 v[76:79], v[28:31], v[164:167], v[76:79]
    s_add_u32 m0, s3, 20480
    s_mov_b32 s40, 286720
    buffer_load_dwordx4 v7, s[12:15], s40 offen lds
    s_waitcnt vmcnt(30)
    v_mfma_f32_16x16x32_bf16 v[64:67], v[24:27], v[168:171], v[64:67]
    v_mfma_f32_16x16x32_bf16 v[68:71], v[28:31], v[168:171], v[68:71]
    v_mfma_f32_16x16x32_bf16 v[72:75], v[24:27], v[172:175], v[72:75]
    v_mfma_f32_16x16x32_bf16 v[76:79], v[28:31], v[172:175], v[76:79]
    s_add_u32 m0, s3, 24576
    s_mov_b32 s40, 344064
    buffer_load_dwordx4 v7, s[12:15], s40 offen lds
    s_waitcnt vmcnt(29)
    v_mfma_f32_16x16x32_bf16 v[64:67], v[24:27], v[176:179], v[64:67]
    v_mfma_f32_16x16x32_bf16 v[68:71], v[28:31], v[176:179], v[68:71]
    v_mfma_f32_16x16x32_bf16 v[72:75], v[24:27], v[180:183], v[72:75]
    v_mfma_f32_16x16x32_bf16 v[76:79], v[28:31], v[180:183], v[76:79]
    s_add_u32 m0, s3, 28672
    s_mov_b32 s40, 401408
    buffer_load_dwordx4 v7, s[12:15], s40 offen lds
    s_waitcnt vmcnt(28)
    v_mfma_f32_16x16x32_bf16 v[64:67], v[24:27], v[184:187], v[64:67]
    v_mfma_f32_16x16x32_bf16 v[68:71], v[28:31], v[184:187], v[68:71]
    v_mfma_f32_16x16x32_bf16 v[72:75], v[24:27], v[188:191], v[72:75]
    v_mfma_f32_16x16x32_bf16 v[76:79], v[28:31], v[188:191], v[76:79]
    s_add_u32 m0, s3, 32768
    s_mov_b32 s40, 458752
    buffer_load_dwordx4 v7, s[12:15], s40 offen lds
    s_waitcnt vmcnt(27)
    v_mfma_f32_16x16x32_bf16 v[64:67], v[24:27], v[192:195], v[64:67]
    v_mfma_f32_16x16x32_bf16 v[68:71], v[28:31], v[192:195], v[68:71]
    v_mfma_f32_16x16x32_bf16 v[72:75], v[24:27], v[196:199], v[72:75]
    v_mfma_f32_16x16x32_bf16 v[76:79], v[28:31], v[196:199], v[76:79]
    s_add_u32 m0, s3, 36864
    s_mov_b32 s40, 516096
    buffer_load_dwordx4 v7, s[12:15], s40 offen lds
    s_waitcnt vmcnt(26)
    v_mfma_f32_16x16x32_bf16 v[64:67], v[24:27], v[200:203], v[64:67]
    v_mfma_f32_16x16x32_bf16 v[68:71], v[28:31], v[200:203], v[68:71]
    v_mfma_f32_16x16x32_bf16 v[72:75], v[24:27], v[204:207], v[72:75]
    v_mfma_f32_16x16x32_bf16 v[76:79], v[28:31], v[204:207], v[76:79]
    s_waitcnt vmcnt(24)
    v_mfma_f32_16x16x32_bf16 v[64:67], v[24:27], v[208:211], v[64:67]
    v_mfma_f32_16x16x32_bf16 v[68:71], v[28:31], v[208:211], v[68:71]
    v_mfma_f32_16x16x32_bf16 v[72:75], v[24:27], v[212:215], v[72:75]
    v_mfma_f32_16x16x32_bf16 v[76:79], v[28:31], v[212:215], v[76:79]
    s_waitcnt vmcnt(22)
    v_mfma_f32_16x16x32_bf16 v[64:67], v[24:27], v[216:219], v[64:67]
    v_mfma_f32_16x16x32_bf16 v[68:71], v[28:31], v[216:219], v[68:71]
    v_mfma_f32_16x16x32_bf16 v[72:75], v[24:27], v[220:223], v[72:75]
    v_mfma_f32_16x16x32_bf16 v[76:79], v[28:31], v[220:223], v[76:79]
    s_waitcnt vmcnt(20)
    v_mfma_f32_16x16x32_bf16 v[64:67], v[24:27], v[224:227], v[64:67]
    v_mfma_f32_16x16x32_bf16 v[68:71], v[28:31], v[224:227], v[68:71]
    v_mfma_f32_16x16x32_bf16 v[72:75], v[24:27], v[228:231], v[72:75]
    v_mfma_f32_16x16x32_bf16 v[76:79], v[28:31], v[228:231], v[76:79]
    s_waitcnt vmcnt(18)
    v_mfma_f32_16x16x32_bf16 v[64:67], v[24:27], v[232:235], v[64:67]
    v_mfma_f32_16x16x32_bf16 v[68:71], v[28:31], v[232:235], v[68:71]
    v_mfma_f32_16x16x32_bf16 v[72:75], v[24:27], v[236:239], v[72:75]
    v_mfma_f32_16x16x32_bf16 v[76:79], v[28:31], v[236:239], v[76:79]
    s_waitcnt vmcnt(16)
    v_mfma_f32_16x16x32_bf16 v[64:67], v[24:27], v[240:243], v[64:67]
    v_mfma_f32_16x16x32_bf16 v[68:71], v[28:31], v[240:243], v[68:71]
    v_mfma_f32_16x16x32_bf16 v[72:75], v[24:27], v[244:247], v[72:75]
    v_mfma_f32_16x16x32_bf16 v[76:79], v[28:31], v[244:247], v[76:79]
    s_waitcnt vmcnt(14)
    v_mfma_f32_16x16x32_bf16 v[64:67], v[24:27], v[248:251], v[64:67]
    v_mfma_f32_16x16x32_bf16 v[68:71], v[28:31], v[248:251], v[68:71]
    v_mfma_f32_16x16x32_bf16 v[72:75], v[24:27], v[252:255], v[72:75]
    v_mfma_f32_16x16x32_bf16 v[76:79], v[28:31], v[252:255], v[76:79]
    s_waitcnt vmcnt(10)
    s_nop 7
    v_cvt_pk_bf16_f32 v128, v64, v65
    v_cvt_pk_bf16_f32 v129, v66, v67
    v_cvt_pk_bf16_f32 v130, v68, v69
    v_cvt_pk_bf16_f32 v131, v70, v71
    v_lshlrev_b32 v64, 16, v128
    v_and_b32 v65, 0xffff0000, v128
    v_lshlrev_b32_e64 v136, 16, v32
    v_and_b32 v137, 0xffff0000, v32
    v_lshlrev_b32_e64 v66, 16, v129
    v_and_b32 v67, 0xffff0000, v129
    v_lshlrev_b32_e64 v138, 16, v33
    v_and_b32 v139, 0xffff0000, v33
    v_lshlrev_b32_e64 v68, 16, v130
    v_and_b32 v69, 0xffff0000, v130
    v_lshlrev_b32_e64 v140, 16, v34
    v_and_b32 v141, 0xffff0000, v34
    v_lshlrev_b32_e64 v70, 16, v131
    v_and_b32 v71, 0xffff0000, v131
    v_lshlrev_b32_e64 v142, 16, v35
    v_and_b32 v143, 0xffff0000, v35
    v_add_f32 v64, v64, v136
    v_add_f32 v65, v65, v137
    v_add_f32 v66, v66, v138
    v_add_f32 v67, v67, v139
    v_add_f32 v68, v68, v140
    v_add_f32 v69, v69, v141
    v_add_f32 v70, v70, v142
    v_add_f32 v71, v71, v143
    v_cvt_pk_bf16_f32 v128, v64, v65
    v_cvt_pk_bf16_f32 v129, v66, v67
    v_cvt_pk_bf16_f32 v130, v68, v69
    v_cvt_pk_bf16_f32 v131, v70, v71
    s_mov_b32 s40, 0
    buffer_store_dwordx4 v[128:131], v6, s[16:19], s40 offen sc1
    v_lshlrev_b32 v64, 16, v128
    v_and_b32 v65, 0xffff0000, v128
    v_lshlrev_b32_e64 v66, 16, v129
    v_and_b32 v67, 0xffff0000, v129
    v_lshlrev_b32_e64 v68, 16, v130
    v_and_b32 v69, 0xffff0000, v130
    v_lshlrev_b32_e64 v70, 16, v131
    v_and_b32 v71, 0xffff0000, v131
    v_add_f32 v144, v64, v65
    v_mul_f32 v145, v64, v64
    v_fmac_f32 v145, v65, v65
    v_add_f32 v144, v144, v66
    v_fmac_f32 v145, v66, v66
    v_add_f32 v144, v144, v67
    v_fmac_f32 v145, v67, v67
    v_add_f32 v144, v144, v68
    v_fmac_f32 v145, v68, v68
    v_add_f32 v144, v144, v69
    v_fmac_f32 v145, v69, v69
    v_add_f32 v144, v144, v70
    v_fmac_f32 v145, v70, v70
    v_add_f32 v144, v144, v71
    v_fmac_f32 v145, v71, v71
    v_mov_b32 v146, v144
    v_mov_b32 v147, v145
    s_nop 1
    v_permlane16_swap_b32 v144, v146
    v_permlane16_swap_b32 v145, v147
    s_nop 1
    v_add_f32 v144, v144, v146
    v_add_f32 v145, v145, v147
    v_mov_b32 v146, v144
    v_mov_b32 v147, v145
    s_nop 1
    v_permlane32_swap_b32 v144, v146
    v_permlane32_swap_b32 v145, v147
    s_nop 1
    v_add_f32 v144, v144, v146
    v_add_f32_e64 v145, v145, v147
    v_cvt_pk_bf16_f32 v132, v72, v73
    v_cvt_pk_bf16_f32 v133, v74, v75
    v_cvt_pk_bf16_f32 v134, v76, v77
    v_cvt_pk_bf16_f32 v135, v78, v79
    v_lshlrev_b32_e64 v72, 16, v132
    v_and_b32 v73, 0xffff0000, v132
    v_lshlrev_b32_e64 v136, 16, v36
    v_and_b32 v137, 0xffff0000, v36
    v_lshlrev_b32_e64 v74, 16, v133
    v_and_b32 v75, 0xffff0000, v133
    v_lshlrev_b32_e64 v138, 16, v37
    v_and_b32 v139, 0xffff0000, v37
    v_lshlrev_b32_e64 v76, 16, v134
    v_and_b32 v77, 0xffff0000, v134
    v_lshlrev_b32_e64 v140, 16, v38
    v_and_b32 v141, 0xffff0000, v38
    v_lshlrev_b32_e64 v78, 16, v135
    v_and_b32 v79, 0xffff0000, v135
    v_lshlrev_b32_e64 v142, 16, v39
    v_and_b32 v143, 0xffff0000, v39
    v_add_f32 v72, v72, v136
    v_add_f32 v73, v73, v137
    v_add_f32 v74, v74, v138
    v_add_f32 v75, v75, v139
    v_add_f32 v76, v76, v140
    v_add_f32 v77, v77, v141
    v_add_f32 v78, v78, v142
    v_add_f32 v79, v79, v143
    v_cvt_pk_bf16_f32 v132, v72, v73
    v_cvt_pk_bf16_f32 v133, v74, v75
    v_cvt_pk_bf16_f32 v134, v76, v77
    v_cvt_pk_bf16_f32 v135, v78, v79
    s_mov_b32 s40, 14336
    buffer_store_dwordx4 v[132:135], v6, s[16:19], s40 offen sc1
    v_lshlrev_b32_e64 v72, 16, v132
    v_and_b32 v73, 0xffff0000, v132
    v_lshlrev_b32_e64 v74, 16, v133
    v_and_b32 v75, 0xffff0000, v133
    v_lshlrev_b32_e64 v76, 16, v134
    v_and_b32 v77, 0xffff0000, v134
    v_lshlrev_b32_e64 v78, 16, v135
    v_and_b32 v79, 0xffff0000, v135
    v_add_f32 v148, v72, v73
    v_mul_f32 v149, v72, v72
    v_fmac_f32 v149, v73, v73
    v_add_f32 v148, v148, v74
    v_fmac_f32 v149, v74, v74
    v_add_f32 v148, v148, v75
    v_fmac_f32 v149, v75, v75
    v_add_f32 v148, v148, v76
    v_fmac_f32 v149, v76, v76
    v_add_f32 v148, v148, v77
    v_fmac_f32 v149, v77, v77
    v_add_f32 v148, v148, v78
    v_fmac_f32 v149, v78, v78
    v_add_f32 v148, v148, v79
    v_fmac_f32 v149, v79, v79
    v_mov_b32 v150, v148
    v_mov_b32 v151, v149
    s_nop 1
    v_permlane16_swap_b32 v148, v150
    v_permlane16_swap_b32 v149, v151
    s_nop 1
    v_add_f32 v148, v148, v150
    v_add_f32 v149, v149, v151
    v_mov_b32 v150, v148
    v_mov_b32 v151, v149
    s_nop 1
    v_permlane32_swap_b32 v148, v150
    v_permlane32_swap_b32 v149, v151
    s_nop 1
    v_add_f32 v148, v148, v150
    v_add_f32 v149, v149, v151
    s_lshl_b32 s40, s34, 3
    s_add_u32 s41, s40, 1792
    s_mov_b64 exec, 0xffff
    buffer_store_dwordx2 v[144:145], v21, s[20:23], s40 offen sc1
    buffer_store_dwordx2 v[148:149], v21, s[20:23], s41 offen sc1
    s_mov_b64 exec, -1
    s_waitcnt vmcnt(0)
    s_barrier
    v_mov_b32 v43, 0
    s_cmp_lg_u32 s32, 0
    s_cbranch_scc1 L_tail_aa
    v_mov_b32 v2, 1
    s_mov_b64 exec, 1
    buffer_atomic_add v2, v43, s[64:67], 0 offen sc1
    s_mov_b64 exec, -1
L_tail_aa:
    s_add_u32 m0, s3, 40960
    s_mov_b32 s40, 573440
    buffer_load_dwordx4 v7, s[12:15], s40 offen lds
    s_add_u32 m0, s3, 45056
    s_mov_b32 s40, 630784
    buffer_load_dwordx4 v7, s[12:15], s40 offen lds
    s_add_u32 m0, s3, 49152
    s_mov_b32 s40, 688128
    buffer_load_dwordx4 v7, s[12:15], s40 offen lds
    s_add_u32 m0, s3, 53248
    s_mov_b32 s40, 745472
    buffer_load_dwordx4 v7, s[12:15], s40 offen lds
    s_add_u32 m0, s3, 57344
    s_mov_b32 s40, 802816
    buffer_load_dwordx4 v7, s[12:15], s40 offen lds
    s_add_u32 m0, s3, 61440
    s_mov_b32 s40, 860160
    buffer_load_dwordx4 v7, s[12:15], s40 offen lds
    s_add_u32 m0, s3, 65536
    s_mov_b32 s40, 917504
    buffer_load_dwordx4 v7, s[12:15], s40 offen lds
    s_add_u32 m0, s3, 69632
    s_mov_b32 s40, 974848
    buffer_load_dwordx4 v7, s[12:15], s40 offen lds
    s_add_u32 m0, s3, 73728
    s_mov_b32 s40, 1032192
    buffer_load_dwordx4 v7, s[12:15], s40 offen lds
    s_add_u32 m0, s3, 77824
    s_mov_b32 s40, 1089536
    buffer_load_dwordx4 v7, s[12:15], s40 offen lds
    s_add_u32 m0, s3, 81920
    s_mov_b32 s40, 1146880
    buffer_load_dwordx4 v7, s[12:15], s40 offen lds
    s_add_u32 m0, s3, 86016
    s_mov_b32 s40, 1204224
    buffer_load_dwordx4 v7, s[12:15], s40 offen lds
    s_add_u32 m0, s3, 90112
    s_mov_b32 s40, 1261568
    buffer_load_dwordx4 v7, s[12:15], s40 offen lds
    s_add_u32 m0, s3, 94208
    s_mov_b32 s40, 1318912
    buffer_load_dwordx4 v7, s[12:15], s40 offen lds
    s_add_u32 m0, s3, 98304
    s_mov_b32 s40, 1376256
    buffer_load_dwordx4 v7, s[12:15], s40 offen lds
    s_add_u32 m0, s3, 102400
    s_mov_b32 s40, 1433600
    buffer_load_dwordx4 v7, s[12:15], s40 offen lds
    s_add_u32 m0, s3, 106496
    s_mov_b32 s40, 1490944
    buffer_load_dwordx4 v7, s[12:15], s40 offen lds
    s_add_u32 m0, s3, 110592
    s_mov_b32 s40, 1548288
    buffer_load_dwordx4 v7, s[12:15], s40 offen lds
    v_lshrrev_b32 v2, 2, v1
    v_and_b32 v3, 7, v2
    v_and_b32 v4, 3, v1
    v_lshlrev_b32_e64 v4, 3, v4
    v_lshl_add_u32 v4, v2, 8, v4
    s_lshl_b32 s35, s32, 1
    s_add_u32 s36, s35, 0
    s_and_b32 s36, s36, 7
    v_xor_b32 v5, s36, v3
    v_lshl_add_u32 v8, v5, 5, v4
    s_add_u32 s36, s35, 1
    s_and_b32 s36, s36, 7
    v_xor_b32_e64 v5, s36, v3
    v_lshl_add_u32 v9, v5, 5, v4
    s_add_u32 s36, s35, 2
    s_and_b32 s36, s36, 7
    v_xor_b32_e64 v5, s36, v3
    v_lshl_add_u32 v10, v5, 5, v4
    s_add_u32 s36, s35, 3
    s_and_b32 s36, s36, 7
    v_xor_b32_e64 v5, s36, v3
    v_lshl_add_u32 v11, v5, 5, v4
    s_add_u32 s36, s35, 4
    s_and_b32 s36, s36, 7
    v_xor_b32_e64 v5, s36, v3
    v_lshl_add_u32 v12, v5, 5, v4
    s_add_u32 s36, s35, 5
    s_and_b32 s36, s36, 7
    v_xor_b32_e64 v5, s36, v3
    v_lshl_add_u32 v13, v5, 5, v4
    s_add_u32 s36, s35, 6
    s_and_b32 s36, s36, 7
    v_xor_b32_e64 v5, s36, v3
    v_lshl_add_u32 v14, v5, 5, v4
    s_add_u32 s36, s35, 7
    s_and_b32 s36, s36, 7
    v_xor_b32_e64 v5, s36, v3
    v_lshl_add_u32 v15, v5, 5, v4
    v_lshrrev_b32 v2, 4, v1
    v_lshlrev_b32 v2, 4, v2
    v_add_u32 v2, 114688, v2
    s_add_u32 s36, s32, 0
    s_and_b32 s36, s36, 3
    s_lshl_b32 s44, s36, 10
    s_lshl_b32 s36, s36, 7
    v_add_u32 v16, s36, v2
    s_add_u32 s36, s32, 1
    s_and_b32 s36, s36, 3
    s_lshl_b32 s45, s36, 10
    s_lshl_b32 s36, s36, 7
    v_add_u32 v17, s36, v2
    s_add_u32 s36, s32, 2
    s_and_b32 s36, s36, 3
    s_lshl_b32 s46, s36, 10
    s_lshl_b32 s36, s36, 7
    v_add_u32 v18, s36, v2
    s_add_u32 s36, s32, 3
    s_and_b32 s36, s36, 3
    s_lshl_b32 s47, s36, 10
    s_lshl_b32 s36, s36, 7
    v_add_u32 v19, s36, v2
    v_mov_b32 v44, 0x3f803f80
    v_mov_b32 v45, 0x3f803f80
    v_mov_b32 v46, 0x3f803f80
    v_mov_b32 v47, 0x3f803f80
    s_mul_i32 s35, s39, 14336
    s_add_u32 s35, s35, 92274688
    s_add_u32 s36, s6, s35
    s_addc_u32 s37, s7, 0
    s_mov_b32 s8, s36
    s_and_b32 s9, s37, 0xffff
    s_mov_b32 s10, 28672
    s_mov_b32 s11, 0x00020000
    s_mul_i32 s35, s39, 57344
    s_lshl_b32 s36, s34, 12
    s_add_u32 s35, s35, s36
    s_add_u32 s35, s35, 96468992
    s_add_u32 s36, s6, s35
    s_addc_u32 s37, s7, 0
    s_mov_b32 s16, s36
    s_and_b32 s17, s37, 0xffff
    s_mov_b32 s18, 61440
    s_mov_b32 s19, 0x00020000
    s_cmp_lg_u32 s32, 0
    s_cbranch_scc1 L_tail_wa
L_tail_pa:
    buffer_load_dword v2, v43, s[64:67], 0 offen sc1
    s_waitcnt vmcnt(0)
    v_readfirstlane_b32 s35, v2
    s_nop 3
    s_cmp_ge_u32 s35, 14
    s_cbranch_scc1 L_tail_wa
    s_sleep 1
    s_branch L_tail_pa
L_tail_wa:
    s_waitcnt vmcnt(0)
    s_barrier
    s_mov_b32 s41, 0
    buffer_load_dwordx4 v[128:131], v6, s[8:11], s41 offen sc1
    s_mov_b32 s41, 14336
    buffer_load_dwordx4 v[132:135], v6, s[8:11], s41 offen sc1
    s_mov_b32 s41, 1024
    buffer_load_dwordx4 v[136:139], v6, s[8:11], s41 offen sc1
    s_mov_b32 s41, 15360
    buffer_load_dwordx4 v[140:143], v6, s[8:11], s41 offen sc1
    s_mov_b32 s41, 2048
    buffer_load_dwordx4 v[144:147], v6, s[8:11], s41 offen sc1
    s_mov_b32 s41, 16384
    buffer_load_dwordx4 v[148:151], v6, s[8:11], s41 offen sc1
    s_mov_b32 s41, 3072
    buffer_load_dwordx4 v[152:155], v6, s[8:11], s41 offen sc1
    s_mov_b32 s41, 17408
    buffer_load_dwordx4 v[156:159], v6, s[8:11], s41 offen sc1
    s_mov_b32 s41, 4096
    buffer_load_dwordx4 v[160:163], v6, s[8:11], s41 offen sc1
    s_mov_b32 s41, 18432
    buffer_load_dwordx4 v[164:167], v6, s[8:11], s41 offen sc1
    ds_read_b64_tr_b16 a[0:1], v8 offset:0
    ds_read_b64_tr_b16 a[2:3], v8 offset:4096
    ds_read_b64_tr_b16 a[4:5], v9 offset:0
    ds_read_b64_tr_b16 a[6:7], v9 offset:4096
    ds_read_b64_tr_b16 a[8:9], v10 offset:0
    ds_read_b64_tr_b16 a[10:11], v10 offset:4096
    ds_read_b64_tr_b16 a[12:13], v11 offset:0
    ds_read_b64_tr_b16 a[14:15], v11 offset:4096
    ds_read_b64_tr_b16 a[16:17], v12 offset:0
    ds_read_b64_tr_b16 a[18:19], v12 offset:4096
    ds_read_b64_tr_b16 a[20:21], v13 offset:0
    ds_read_b64_tr_b16 a[22:23], v13 offset:4096
    ds_read_b64_tr_b16 a[24:25], v14 offset:0
    ds_read_b64_tr_b16 a[26:27], v14 offset:4096
    ds_read_b64_tr_b16 a[28:29], v15 offset:0
    ds_read_b64_tr_b16 a[30:31], v15 offset:4096
    s_waitcnt vmcnt(8) lgkmcnt(0)
    v_mfma_f32_16x16x32_bf16 v[64:67], a[0:3], v[128:131], 0
    ds_read_b64_tr_b16 a[32:33], v8 offset:8192
    v_mfma_f32_16x16x32_bf16 v[96:99], a[0:3], v[132:135], 0
    ds_read_b64_tr_b16 a[34:35], v8 offset:12288
    s_mov_b32 s41, 0
    buffer_load_dwordx4 a[64:67], v21, s[20:23], s41 offen offset:0 sc1
    v_mfma_f32_16x16x32_bf16 v[68:71], a[4:7], v[128:131], 0
    ds_read_b64_tr_b16 a[36:37], v9 offset:8192
    v_mfma_f32_16x16x32_bf16 v[100:103], a[4:7], v[132:135], 0
    ds_read_b64_tr_b16 a[38:39], v9 offset:12288
    v_mfma_f32_16x16x32_bf16 v[72:75], a[8:11], v[128:131], 0
    ds_read_b64_tr_b16 a[40:41], v10 offset:8192
    s_mov_b32 s41, 0
    buffer_load_dwordx4 a[68:71], v21, s[20:23], s41 offen offset:16 sc1
    v_mfma_f32_16x16x32_bf16 v[104:107], a[8:11], v[132:135], 0
    ds_read_b64_tr_b16 a[42:43], v10 offset:12288
    v_mfma_f32_16x16x32_bf16 v[76:79], a[12:15], v[128:131], 0
    ds_read_b64_tr_b16 a[44:45], v11 offset:8192
    v_mfma_f32_16x16x32_bf16 v[108:111], a[12:15], v[132:135], 0
    ds_read_b64_tr_b16 a[46:47], v11 offset:12288
    s_mov_b32 s41, 0
    buffer_load_dwordx4 a[72:75], v21, s[20:23], s41 offen offset:32 sc1
    v_mfma_f32_16x16x32_bf16 v[80:83], a[16:19], v[128:131], 0
    ds_read_b64_tr_b16 a[48:49], v12 offset:8192
    v_mfma_f32_16x16x32_bf16 v[112:115], a[16:19], v[132:135], 0
    ds_read_b64_tr_b16 a[50:51], v12 offset:12288
    v_mfma_f32_16x16x32_bf16 v[84:87], a[20:23], v[128:131], 0
    ds_read_b64_tr_b16 a[52:53], v13 offset:8192
    s_mov_b32 s41, 0
    buffer_load_dwordx4 a[76:79], v21, s[20:23], s41 offen offset:48 sc1
    v_mfma_f32_16x16x32_bf16 v[116:119], a[20:23], v[132:135], 0
    ds_read_b64_tr_b16 a[54:55], v13 offset:12288
    v_mfma_f32_16x16x32_bf16 v[88:91], a[24:27], v[128:131], 0
    ds_read_b64_tr_b16 a[56:57], v14 offset:8192
    v_mfma_f32_16x16x32_bf16 v[120:123], a[24:27], v[132:135], 0
    ds_read_b64_tr_b16 a[58:59], v14 offset:12288
    s_mov_b32 s41, 5120
    buffer_load_dwordx4 v[168:171], v6, s[8:11], s41 offen sc1
    v_mfma_f32_16x16x32_bf16 v[92:95], a[28:31], v[128:131], 0
    ds_read_b64_tr_b16 a[60:61], v15 offset:8192
    v_mfma_f32_16x16x32_bf16 v[124:127], a[28:31], v[132:135], 0
    ds_read_b64_tr_b16 a[62:63], v15 offset:12288
    v_mfma_f32_16x16x32_bf16 v[48:51], a[0:3], v[44:47], 0
    s_mov_b32 s41, 19456
    buffer_load_dwordx4 v[172:175], v6, s[8:11], s41 offen sc1
    v_mfma_f32_16x16x32_bf16 v[52:55], a[4:7], v[44:47], 0
    s_waitcnt vmcnt(12) lgkmcnt(0)
    v_mfma_f32_16x16x32_bf16 v[64:67], a[32:35], v[136:139], v[64:67]
    ds_read_b64_tr_b16 a[0:1], v8 offset:16384
    v_mfma_f32_16x16x32_bf16 v[96:99], a[32:35], v[140:143], v[96:99]
    ds_read_b64_tr_b16 a[2:3], v8 offset:20480
    s_mov_b32 s41, 0
    buffer_load_dwordx4 a[80:83], v21, s[20:23], s41 offen offset:64 sc1
    v_mfma_f32_16x16x32_bf16 v[68:71], a[36:39], v[136:139], v[68:71]
    ds_read_b64_tr_b16 a[4:5], v9 offset:16384
    v_mfma_f32_16x16x32_bf16 v[100:103], a[36:39], v[140:143], v[100:103]
    ds_read_b64_tr_b16 a[6:7], v9 offset:20480
    v_mfma_f32_16x16x32_bf16 v[72:75], a[40:43], v[136:139], v[72:75]
    ds_read_b64_tr_b16 a[8:9], v10 offset:16384
    s_mov_b32 s41, 0
    buffer_load_dwordx4 a[84:87], v21, s[20:23], s41 offen offset:80 sc1
    v_mfma_f32_16x16x32_bf16 v[104:107], a[40:43], v[140:143], v[104:107]
    ds_read_b64_tr_b16 a[10:11], v10 offset:20480
    v_mfma_f32_16x16x32_bf16 v[76:79], a[44:47], v[136:139], v[76:79]
    ds_read_b64_tr_b16 a[12:13], v11 offset:16384
    v_mfma_f32_16x16x32_bf16 v[108:111], a[44:47], v[140:143], v[108:111]
    ds_read_b64_tr_b16 a[14:15], v11 offset:20480
    s_mov_b32 s41, 0
    buffer_load_dwordx4 a[88:91], v21, s[20:23], s41 offen offset:96 sc1
    v_mfma_f32_16x16x32_bf16 v[80:83], a[48:51], v[136:139], v[80:83]
    ds_read_b64_tr_b16 a[16:17], v12 offset:16384
    v_mfma_f32_16x16x32_bf16 v[112:115], a[48:51], v[140:143], v[112:115]
    ds_read_b64_tr_b16 a[18:19], v12 offset:20480
    v_mfma_f32_16x16x32_bf16 v[84:87], a[52:55], v[136:139], v[84:87]
    ds_read_b64_tr_b16 a[20:21], v13 offset:16384
    s_mov_b32 s41, 1792
    buffer_load_dwordx4 a[92:95], v21, s[20:23], s41 offen offset:0 sc1
    v_mfma_f32_16x16x32_bf16 v[116:119], a[52:55], v[140:143], v[116:119]
    ds_read_b64_tr_b16 a[22:23], v13 offset:20480
    v_mfma_f32_16x16x32_bf16 v[88:91], a[56:59], v[136:139], v[88:91]
    ds_read_b64_tr_b16 a[24:25], v14 offset:16384
    v_mfma_f32_16x16x32_bf16 v[120:123], a[56:59], v[140:143], v[120:123]
    ds_read_b64_tr_b16 a[26:27], v14 offset:20480
    s_mov_b32 s41, 6144
    buffer_load_dwordx4 v[176:179], v6, s[8:11], s41 offen sc1
    v_mfma_f32_16x16x32_bf16 v[92:95], a[60:63], v[136:139], v[92:95]
    ds_read_b64_tr_b16 a[28:29], v15 offset:16384
    v_mfma_f32_16x16x32_bf16 v[124:127], a[60:63], v[140:143], v[124:127]
    ds_read_b64_tr_b16 a[30:31], v15 offset:20480
    v_mfma_f32_16x16x32_bf16 v[48:51], a[32:35], v[44:47], v[48:51]
    s_mov_b32 s41, 20480
    buffer_load_dwordx4 v[180:183], v6, s[8:11], s41 offen sc1
    v_mfma_f32_16x16x32_bf16 v[52:55], a[36:39], v[44:47], v[52:55]
    s_waitcnt vmcnt(16) lgkmcnt(0)
    v_mfma_f32_16x16x32_bf16 v[64:67], a[0:3], v[144:147], v[64:67]
    ds_read_b64_tr_b16 a[32:33], v8 offset:24576
    v_mfma_f32_16x16x32_bf16 v[96:99], a[0:3], v[148:151], v[96:99]
    ds_read_b64_tr_b16 a[34:35], v8 offset:28672
    s_mov_b32 s41, 1792
    buffer_load_dwordx4 a[96:99], v21, s[20:23], s41 offen offset:16 sc1
    v_mfma_f32_16x16x32_bf16 v[68:71], a[4:7], v[144:147], v[68:71]
    ds_read_b64_tr_b16 a[36:37], v9 offset:24576
    v_mfma_f32_16x16x32_bf16 v[100:103], a[4:7], v[148:151], v[100:103]
    ds_read_b64_tr_b16 a[38:39], v9 offset:28672
    v_mfma_f32_16x16x32_bf16 v[72:75], a[8:11], v[144:147], v[72:75]
    ds_read_b64_tr_b16 a[40:41], v10 offset:24576
    s_mov_b32 s41, 1792
    buffer_load_dwordx4 a[100:103], v21, s[20:23], s41 offen offset:32 sc1
    v_mfma_f32_16x16x32_bf16 v[104:107], a[8:11], v[148:151], v[104:107]
    ds_read_b64_tr_b16 a[42:43], v10 offset:28672
    v_mfma_f32_16x16x32_bf16 v[76:79], a[12:15], v[144:147], v[76:79]
    ds_read_b64_tr_b16 a[44:45], v11 offset:24576
    v_mfma_f32_16x16x32_bf16 v[108:111], a[12:15], v[148:151], v[108:111]
    ds_read_b64_tr_b16 a[46:47], v11 offset:28672
    s_mov_b32 s41, 1792
    buffer_load_dwordx4 a[104:107], v21, s[20:23], s41 offen offset:48 sc1
    v_mfma_f32_16x16x32_bf16 v[80:83], a[16:19], v[144:147], v[80:83]
    ds_read_b64_tr_b16 a[48:49], v12 offset:24576
    v_mfma_f32_16x16x32_bf16 v[112:115], a[16:19], v[148:151], v[112:115]
    ds_read_b64_tr_b16 a[50:51], v12 offset:28672
    v_mfma_f32_16x16x32_bf16 v[84:87], a[20:23], v[144:147], v[84:87]
    ds_read_b64_tr_b16 a[52:53], v13 offset:24576
    s_mov_b32 s41, 1792
    buffer_load_dwordx4 a[108:111], v21, s[20:23], s41 offen offset:64 sc1
    v_mfma_f32_16x16x32_bf16 v[116:119], a[20:23], v[148:151], v[116:119]
    ds_read_b64_tr_b16 a[54:55], v13 offset:28672
    v_mfma_f32_16x16x32_bf16 v[88:91], a[24:27], v[144:147], v[88:91]
    ds_read_b64_tr_b16 a[56:57], v14 offset:24576
    v_mfma_f32_16x16x32_bf16 v[120:123], a[24:27], v[148:151], v[120:123]
    ds_read_b64_tr_b16 a[58:59], v14 offset:28672
    s_mov_b32 s41, 7168
    buffer_load_dwordx4 v[184:187], v6, s[8:11], s41 offen sc1
    v_mfma_f32_16x16x32_bf16 v[92:95], a[28:31], v[144:147], v[92:95]
    ds_read_b64_tr_b16 a[60:61], v15 offset:24576
    v_mfma_f32_16x16x32_bf16 v[124:127], a[28:31], v[148:151], v[124:127]
    ds_read_b64_tr_b16 a[62:63], v15 offset:28672
    v_mfma_f32_16x16x32_bf16 v[48:51], a[0:3], v[44:47], v[48:51]
    s_mov_b32 s41, 21504
    buffer_load_dwordx4 v[188:191], v6, s[8:11], s41 offen sc1
    v_mfma_f32_16x16x32_bf16 v[52:55], a[4:7], v[44:47], v[52:55]
    s_waitcnt vmcnt(20) lgkmcnt(0)
    v_mfma_f32_16x16x32_bf16 v[64:67], a[32:35], v[152:155], v[64:67]
    ds_read_b64_tr_b16 a[0:1], v8 offset:32768
    v_mfma_f32_16x16x32_bf16 v[96:99], a[32:35], v[156:159], v[96:99]
    ds_read_b64_tr_b16 a[2:3], v8 offset:36864
    s_mov_b32 s41, 1792
    buffer_load_dwordx4 a[112:115], v21, s[20:23], s41 offen offset:80 sc1
    v_mfma_f32_16x16x32_bf16 v[68:71], a[36:39], v[152:155], v[68:71]
    ds_read_b64_tr_b16 a[4:5], v9 offset:32768
    v_mfma_f32_16x16x32_bf16 v[100:103], a[36:39], v[156:159], v[100:103]
    ds_read_b64_tr_b16 a[6:7], v9 offset:36864
    v_mfma_f32_16x16x32_bf16 v[72:75], a[40:43], v[152:155], v[72:75]
    ds_read_b64_tr_b16 a[8:9], v10 offset:32768
    s_mov_b32 s41, 1792
    buffer_load_dwordx4 a[116:119], v21, s[20:23], s41 offen offset:96 sc1
    v_mfma_f32_16x16x32_bf16 v[104:107], a[40:43], v[156:159], v[104:107]
    ds_read_b64_tr_b16 a[10:11], v10 offset:36864
    v_mfma_f32_16x16x32_bf16 v[76:79], a[44:47], v[152:155], v[76:79]
    ds_read_b64_tr_b16 a[12:13], v11 offset:32768
    v_mfma_f32_16x16x32_bf16 v[108:111], a[44:47], v[156:159], v[108:111]
    ds_read_b64_tr_b16 a[14:15], v11 offset:36864
    s_mov_b32 s41, 8192
    buffer_load_dwordx4 v[192:195], v6, s[8:11], s41 offen sc1
    v_mfma_f32_16x16x32_bf16 v[80:83], a[48:51], v[152:155], v[80:83]
    ds_read_b64_tr_b16 a[16:17], v12 offset:32768
    v_mfma_f32_16x16x32_bf16 v[112:115], a[48:51], v[156:159], v[112:115]
    ds_read_b64_tr_b16 a[18:19], v12 offset:36864
    v_mfma_f32_16x16x32_bf16 v[84:87], a[52:55], v[152:155], v[84:87]
    ds_read_b64_tr_b16 a[20:21], v13 offset:32768
    s_mov_b32 s41, 22528
    buffer_load_dwordx4 v[196:199], v6, s[8:11], s41 offen sc1
    v_mfma_f32_16x16x32_bf16 v[116:119], a[52:55], v[156:159], v[116:119]
    ds_read_b64_tr_b16 a[22:23], v13 offset:36864
    v_mfma_f32_16x16x32_bf16 v[88:91], a[56:59], v[152:155], v[88:91]
    ds_read_b64_tr_b16 a[24:25], v14 offset:32768
    v_mfma_f32_16x16x32_bf16 v[120:123], a[56:59], v[156:159], v[120:123]
    ds_read_b64_tr_b16 a[26:27], v14 offset:36864
    v_mfma_f32_16x16x32_bf16 v[92:95], a[60:63], v[152:155], v[92:95]
    ds_read_b64_tr_b16 a[28:29], v15 offset:32768
    v_mfma_f32_16x16x32_bf16 v[124:127], a[60:63], v[156:159], v[124:127]
    ds_read_b64_tr_b16 a[30:31], v15 offset:36864
    v_mfma_f32_16x16x32_bf16 v[48:51], a[32:35], v[44:47], v[48:51]
    v_mfma_f32_16x16x32_bf16 v[52:55], a[36:39], v[44:47], v[52:55]
    s_waitcnt vmcnt(22) lgkmcnt(0)
    v_mfma_f32_16x16x32_bf16 v[64:67], a[0:3], v[160:163], v[64:67]
    ds_read_b64_tr_b16 a[32:33], v8 offset:40960
    v_mfma_f32_16x16x32_bf16 v[96:99], a[0:3], v[164:167], v[96:99]
    ds_read_b64_tr_b16 a[34:35], v8 offset:45056
    s_mov_b32 s41, 9216
    buffer_load_dwordx4 v[200:203], v6, s[8:11], s41 offen sc1
    v_mfma_f32_16x16x32_bf16 v[68:71], a[4:7], v[160:163], v[68:71]
    ds_read_b64_tr_b16 a[36:37], v9 offset:40960
    v_mfma_f32_16x16x32_bf16 v[100:103], a[4:7], v[164:167], v[100:103]
    ds_read_b64_tr_b16 a[38:39], v9 offset:45056
    v_mfma_f32_16x16x32_bf16 v[72:75], a[8:11], v[160:163], v[72:75]
    ds_read_b64_tr_b16 a[40:41], v10 offset:40960
    s_mov_b32 s41, 23552
    buffer_load_dwordx4 v[204:207], v6, s[8:11], s41 offen sc1
    v_mfma_f32_16x16x32_bf16 v[104:107], a[8:11], v[164:167], v[104:107]
    ds_read_b64_tr_b16 a[42:43], v10 offset:45056
    v_mfma_f32_16x16x32_bf16 v[76:79], a[12:15], v[160:163], v[76:79]
    ds_read_b64_tr_b16 a[44:45], v11 offset:40960
    v_mfma_f32_16x16x32_bf16 v[108:111], a[12:15], v[164:167], v[108:111]
    ds_read_b64_tr_b16 a[46:47], v11 offset:45056
    v_mfma_f32_16x16x32_bf16 v[80:83], a[16:19], v[160:163], v[80:83]
    ds_read_b64_tr_b16 a[48:49], v12 offset:40960
    v_mfma_f32_16x16x32_bf16 v[112:115], a[16:19], v[164:167], v[112:115]
    ds_read_b64_tr_b16 a[50:51], v12 offset:45056
    v_mfma_f32_16x16x32_bf16 v[84:87], a[20:23], v[160:163], v[84:87]
    ds_read_b64_tr_b16 a[52:53], v13 offset:40960
    v_mfma_f32_16x16x32_bf16 v[116:119], a[20:23], v[164:167], v[116:119]
    ds_read_b64_tr_b16 a[54:55], v13 offset:45056
    v_mfma_f32_16x16x32_bf16 v[88:91], a[24:27], v[160:163], v[88:91]
    ds_read_b64_tr_b16 a[56:57], v14 offset:40960
    v_mfma_f32_16x16x32_bf16 v[120:123], a[24:27], v[164:167], v[120:123]
    ds_read_b64_tr_b16 a[58:59], v14 offset:45056
    v_mfma_f32_16x16x32_bf16 v[92:95], a[28:31], v[160:163], v[92:95]
    ds_read_b64_tr_b16 a[60:61], v15 offset:40960
    v_mfma_f32_16x16x32_bf16 v[124:127], a[28:31], v[164:167], v[124:127]
    ds_read_b64_tr_b16 a[62:63], v15 offset:45056
    v_mfma_f32_16x16x32_bf16 v[48:51], a[0:3], v[44:47], v[48:51]
    v_mfma_f32_16x16x32_bf16 v[52:55], a[4:7], v[44:47], v[52:55]
    s_waitcnt vmcnt(18) lgkmcnt(0)
    v_mfma_f32_16x16x32_bf16 v[64:67], a[32:35], v[168:171], v[64:67]
    ds_read_b64_tr_b16 a[0:1], v8 offset:49152
    v_mfma_f32_16x16x32_bf16 v[96:99], a[32:35], v[172:175], v[96:99]
    ds_read_b64_tr_b16 a[2:3], v8 offset:53248
    s_mov_b32 s41, 10240
    buffer_load_dwordx4 v[208:211], v6, s[8:11], s41 offen sc1
    v_mfma_f32_16x16x32_bf16 v[68:71], a[36:39], v[168:171], v[68:71]
    ds_read_b64_tr_b16 a[4:5], v9 offset:49152
    v_mfma_f32_16x16x32_bf16 v[100:103], a[36:39], v[172:175], v[100:103]
    ds_read_b64_tr_b16 a[6:7], v9 offset:53248
    v_mfma_f32_16x16x32_bf16 v[72:75], a[40:43], v[168:171], v[72:75]
    ds_read_b64_tr_b16 a[8:9], v10 offset:49152
    s_mov_b32 s41, 24576
    buffer_load_dwordx4 v[212:215], v6, s[8:11], s41 offen sc1
    v_mfma_f32_16x16x32_bf16 v[104:107], a[40:43], v[172:175], v[104:107]
    ds_read_b64_tr_b16 a[10:11], v10 offset:53248
    v_mfma_f32_16x16x32_bf16 v[76:79], a[44:47], v[168:171], v[76:79]
    ds_read_b64_tr_b16 a[12:13], v11 offset:49152
    v_mfma_f32_16x16x32_bf16 v[108:111], a[44:47], v[172:175], v[108:111]
    ds_read_b64_tr_b16 a[14:15], v11 offset:53248
    v_mfma_f32_16x16x32_bf16 v[80:83], a[48:51], v[168:171], v[80:83]
    ds_read_b64_tr_b16 a[16:17], v12 offset:49152
    v_mfma_f32_16x16x32_bf16 v[112:115], a[48:51], v[172:175], v[112:115]
    ds_read_b64_tr_b16 a[18:19], v12 offset:53248
    v_mfma_f32_16x16x32_bf16 v[84:87], a[52:55], v[168:171], v[84:87]
    ds_read_b64_tr_b16 a[20:21], v13 offset:49152
    v_mfma_f32_16x16x32_bf16 v[116:119], a[52:55], v[172:175], v[116:119]
    ds_read_b64_tr_b16 a[22:23], v13 offset:53248
    v_mfma_f32_16x16x32_bf16 v[88:91], a[56:59], v[168:171], v[88:91]
    ds_read_b64_tr_b16 a[24:25], v14 offset:49152
    v_mfma_f32_16x16x32_bf16 v[120:123], a[56:59], v[172:175], v[120:123]
    ds_read_b64_tr_b16 a[26:27], v14 offset:53248
    v_mfma_f32_16x16x32_bf16 v[92:95], a[60:63], v[168:171], v[92:95]
    ds_read_b64_tr_b16 a[28:29], v15 offset:49152
    v_mfma_f32_16x16x32_bf16 v[124:127], a[60:63], v[172:175], v[124:127]
    ds_read_b64_tr_b16 a[30:31], v15 offset:53248
    v_mfma_f32_16x16x32_bf16 v[48:51], a[32:35], v[44:47], v[48:51]
    v_mfma_f32_16x16x32_bf16 v[52:55], a[36:39], v[44:47], v[52:55]
    s_waitcnt vmcnt(14) lgkmcnt(0)
    v_mfma_f32_16x16x32_bf16 v[64:67], a[0:3], v[176:179], v[64:67]
    ds_read_b64_tr_b16 a[32:33], v8 offset:57344
    v_mfma_f32_16x16x32_bf16 v[96:99], a[0:3], v[180:183], v[96:99]
    ds_read_b64_tr_b16 a[34:35], v8 offset:61440
    s_mov_b32 s41, 11264
    buffer_load_dwordx4 v[216:219], v6, s[8:11], s41 offen sc1
    v_mfma_f32_16x16x32_bf16 v[68:71], a[4:7], v[176:179], v[68:71]
    ds_read_b64_tr_b16 a[36:37], v9 offset:57344
    v_mfma_f32_16x16x32_bf16 v[100:103], a[4:7], v[180:183], v[100:103]
    ds_read_b64_tr_b16 a[38:39], v9 offset:61440
    v_mfma_f32_16x16x32_bf16 v[72:75], a[8:11], v[176:179], v[72:75]
    ds_read_b64_tr_b16 a[40:41], v10 offset:57344
    s_mov_b32 s41, 25600
    buffer_load_dwordx4 v[220:223], v6, s[8:11], s41 offen sc1
    v_mfma_f32_16x16x32_bf16 v[104:107], a[8:11], v[180:183], v[104:107]
    ds_read_b64_tr_b16 a[42:43], v10 offset:61440
    v_mfma_f32_16x16x32_bf16 v[76:79], a[12:15], v[176:179], v[76:79]
    ds_read_b64_tr_b16 a[44:45], v11 offset:57344
    v_mfma_f32_16x16x32_bf16 v[108:111], a[12:15], v[180:183], v[108:111]
    ds_read_b64_tr_b16 a[46:47], v11 offset:61440
    v_mfma_f32_16x16x32_bf16 v[80:83], a[16:19], v[176:179], v[80:83]
    ds_read_b64_tr_b16 a[48:49], v12 offset:57344
    v_mfma_f32_16x16x32_bf16 v[112:115], a[16:19], v[180:183], v[112:115]
    ds_read_b64_tr_b16 a[50:51], v12 offset:61440
    v_mfma_f32_16x16x32_bf16 v[84:87], a[20:23], v[176:179], v[84:87]
    ds_read_b64_tr_b16 a[52:53], v13 offset:57344
    v_mfma_f32_16x16x32_bf16 v[116:119], a[20:23], v[180:183], v[116:119]
    ds_read_b64_tr_b16 a[54:55], v13 offset:61440
    v_mfma_f32_16x16x32_bf16 v[88:91], a[24:27], v[176:179], v[88:91]
    ds_read_b64_tr_b16 a[56:57], v14 offset:57344
    v_mfma_f32_16x16x32_bf16 v[120:123], a[24:27], v[180:183], v[120:123]
    ds_read_b64_tr_b16 a[58:59], v14 offset:61440
    v_mfma_f32_16x16x32_bf16 v[92:95], a[28:31], v[176:179], v[92:95]
    ds_read_b64_tr_b16 a[60:61], v15 offset:57344
    v_mfma_f32_16x16x32_bf16 v[124:127], a[28:31], v[180:183], v[124:127]
    ds_read_b64_tr_b16 a[62:63], v15 offset:61440
    v_mfma_f32_16x16x32_bf16 v[48:51], a[0:3], v[44:47], v[48:51]
    v_mfma_f32_16x16x32_bf16 v[52:55], a[4:7], v[44:47], v[52:55]
    v_add_u32 v8, 65536, v8
    v_add_u32 v9, 65536, v9
    v_add_u32 v10, 65536, v10
    v_add_u32 v11, 65536, v11
    v_add_u32 v12, 65536, v12
    v_add_u32 v13, 65536, v13
    v_add_u32 v14, 65536, v14
    v_add_u32 v15, 65536, v15
    s_waitcnt vmcnt(10) lgkmcnt(0)
    v_mfma_f32_16x16x32_bf16 v[64:67], a[32:35], v[184:187], v[64:67]
    ds_read_b64_tr_b16 a[0:1], v8 offset:0
    v_mfma_f32_16x16x32_bf16 v[96:99], a[32:35], v[188:191], v[96:99]
    ds_read_b64_tr_b16 a[2:3], v8 offset:4096
    s_mov_b32 s41, 12288
    buffer_load_dwordx4 v[224:227], v6, s[8:11], s41 offen sc1
    v_mfma_f32_16x16x32_bf16 v[68:71], a[36:39], v[184:187], v[68:71]
    ds_read_b64_tr_b16 a[4:5], v9 offset:0
    v_mfma_f32_16x16x32_bf16 v[100:103], a[36:39], v[188:191], v[100:103]
    ds_read_b64_tr_b16 a[6:7], v9 offset:4096
    v_mfma_f32_16x16x32_bf16 v[72:75], a[40:43], v[184:187], v[72:75]
    ds_read_b64_tr_b16 a[8:9], v10 offset:0
    s_mov_b32 s41, 26624
    buffer_load_dwordx4 v[228:231], v6, s[8:11], s41 offen sc1
    v_mfma_f32_16x16x32_bf16 v[104:107], a[40:43], v[188:191], v[104:107]
    ds_read_b64_tr_b16 a[10:11], v10 offset:4096
    v_mfma_f32_16x16x32_bf16 v[76:79], a[44:47], v[184:187], v[76:79]
    ds_read_b64_tr_b16 a[12:13], v11 offset:0
    v_mfma_f32_16x16x32_bf16 v[108:111], a[44:47], v[188:191], v[108:111]
    ds_read_b64_tr_b16 a[14:15], v11 offset:4096
    v_mfma_f32_16x16x32_bf16 v[80:83], a[48:51], v[184:187], v[80:83]
    ds_read_b64_tr_b16 a[16:17], v12 offset:0
    v_mfma_f32_16x16x32_bf16 v[112:115], a[48:51], v[188:191], v[112:115]
    ds_read_b64_tr_b16 a[18:19], v12 offset:4096
    v_mfma_f32_16x16x32_bf16 v[84:87], a[52:55], v[184:187], v[84:87]
    ds_read_b64_tr_b16 a[20:21], v13 offset:0
    v_mfma_f32_16x16x32_bf16 v[116:119], a[52:55], v[188:191], v[116:119]
    ds_read_b64_tr_b16 a[22:23], v13 offset:4096
    v_mfma_f32_16x16x32_bf16 v[88:91], a[56:59], v[184:187], v[88:91]
    ds_read_b64_tr_b16 a[24:25], v14 offset:0
    v_mfma_f32_16x16x32_bf16 v[120:123], a[56:59], v[188:191], v[120:123]
    ds_read_b64_tr_b16 a[26:27], v14 offset:4096
    v_mfma_f32_16x16x32_bf16 v[92:95], a[60:63], v[184:187], v[92:95]
    ds_read_b64_tr_b16 a[28:29], v15 offset:0
    v_mfma_f32_16x16x32_bf16 v[124:127], a[60:63], v[188:191], v[124:127]
    ds_read_b64_tr_b16 a[30:31], v15 offset:4096
    v_mfma_f32_16x16x32_bf16 v[48:51], a[32:35], v[44:47], v[48:51]
    v_mfma_f32_16x16x32_bf16 v[52:55], a[36:39], v[44:47], v[52:55]
    s_waitcnt vmcnt(8) lgkmcnt(0)
    v_mfma_f32_16x16x32_bf16 v[64:67], a[0:3], v[192:195], v[64:67]
    ds_read_b64_tr_b16 a[32:33], v8 offset:8192
    v_accvgpr_read_b32 v24, a64
    v_accvgpr_read_b32 v25, a65
    v_mfma_f32_16x16x32_bf16 v[96:99], a[0:3], v[196:199], v[96:99]
    ds_read_b64_tr_b16 a[34:35], v8 offset:12288
    s_mov_b32 s41, 13312
    buffer_load_dwordx4 v[232:235], v6, s[8:11], s41 offen sc1
    v_mfma_f32_16x16x32_bf16 v[68:71], a[4:7], v[192:195], v[68:71]
    ds_read_b64_tr_b16 a[36:37], v9 offset:8192
    v_accvgpr_read_b32 v34, a66
    v_accvgpr_read_b32 v35, a67
    v_mfma_f32_16x16x32_bf16 v[100:103], a[4:7], v[196:199], v[100:103]
    ds_read_b64_tr_b16 a[38:39], v9 offset:12288
    v_add_f32 v24, v24, v34
    v_add_f32 v25, v25, v35
    v_mfma_f32_16x16x32_bf16 v[72:75], a[8:11], v[192:195], v[72:75]
    ds_read_b64_tr_b16 a[40:41], v10 offset:8192
    s_mov_b32 s41, 27648
    buffer_load_dwordx4 v[236:239], v6, s[8:11], s41 offen sc1
    v_mfma_f32_16x16x32_bf16 v[104:107], a[8:11], v[196:199], v[104:107]
    ds_read_b64_tr_b16 a[42:43], v10 offset:12288
    v_accvgpr_read_b32 v36, a68
    v_accvgpr_read_b32 v37, a69
    v_mfma_f32_16x16x32_bf16 v[76:79], a[12:15], v[192:195], v[76:79]
    ds_read_b64_tr_b16 a[44:45], v11 offset:8192
    v_add_f32 v24, v24, v36
    v_add_f32 v25, v25, v37
    v_mfma_f32_16x16x32_bf16 v[108:111], a[12:15], v[196:199], v[108:111]
    ds_read_b64_tr_b16 a[46:47], v11 offset:12288
    v_accvgpr_read_b32 v38, a70
    v_accvgpr_read_b32 v39, a71
    v_mfma_f32_16x16x32_bf16 v[80:83], a[16:19], v[192:195], v[80:83]
    ds_read_b64_tr_b16 a[48:49], v12 offset:8192
    v_add_f32 v24, v24, v38
    v_add_f32 v25, v25, v39
    v_mfma_f32_16x16x32_bf16 v[112:115], a[16:19], v[196:199], v[112:115]
    ds_read_b64_tr_b16 a[50:51], v12 offset:12288
    v_accvgpr_read_b32 v32, a72
    v_accvgpr_read_b32 v33, a73
    v_mfma_f32_16x16x32_bf16 v[84:87], a[20:23], v[192:195], v[84:87]
    ds_read_b64_tr_b16 a[52:53], v13 offset:8192
    v_add_f32 v24, v24, v32
    v_add_f32 v25, v25, v33
    v_mfma_f32_16x16x32_bf16 v[116:119], a[20:23], v[196:199], v[116:119]
    ds_read_b64_tr_b16 a[54:55], v13 offset:12288
    v_accvgpr_read_b32 v34, a74
    v_accvgpr_read_b32 v35, a75
    v_mfma_f32_16x16x32_bf16 v[88:91], a[24:27], v[192:195], v[88:91]
    ds_read_b64_tr_b16 a[56:57], v14 offset:8192
    v_add_f32 v24, v24, v34
    v_add_f32 v25, v25, v35
    v_mfma_f32_16x16x32_bf16 v[120:123], a[24:27], v[196:199], v[120:123]
    ds_read_b64_tr_b16 a[58:59], v14 offset:12288
    v_accvgpr_read_b32 v36, a76
    v_accvgpr_read_b32 v37, a77
    v_mfma_f32_16x16x32_bf16 v[92:95], a[28:31], v[192:195], v[92:95]
    ds_read_b64_tr_b16 a[60:61], v15 offset:8192
    v_add_f32 v24, v24, v36
    v_add_f32 v25, v25, v37
    v_mfma_f32_16x16x32_bf16 v[124:127], a[28:31], v[196:199], v[124:127]
    ds_read_b64_tr_b16 a[62:63], v15 offset:12288
    v_accvgpr_read_b32 v38, a78
    v_accvgpr_read_b32 v39, a79
    v_mfma_f32_16x16x32_bf16 v[48:51], a[0:3], v[44:47], v[48:51]
    v_add_f32 v24, v24, v38
    v_add_f32 v25, v25, v39
    v_mfma_f32_16x16x32_bf16 v[52:55], a[4:7], v[44:47], v[52:55]
    v_accvgpr_read_b32 v32, a80
    v_accvgpr_read_b32 v33, a81
    s_waitcnt vmcnt(8) lgkmcnt(0)
    v_mfma_f32_16x16x32_bf16 v[64:67], a[32:35], v[200:203], v[64:67]
    ds_read_b64_tr_b16 a[0:1], v8 offset:16384
    v_add_f32 v24, v24, v32
    v_add_f32_e64 v25, v25, v33
    v_mfma_f32_16x16x32_bf16 v[96:99], a[32:35], v[204:207], v[96:99]
    ds_read_b64_tr_b16 a[2:3], v8 offset:20480
    v_accvgpr_read_b32 v34, a82
    v_accvgpr_read_b32 v35, a83
    v_mfma_f32_16x16x32_bf16 v[68:71], a[36:39], v[200:203], v[68:71]
    ds_read_b64_tr_b16 a[4:5], v9 offset:16384
    v_add_f32 v24, v24, v34
    v_add_f32 v25, v25, v35
    v_mfma_f32_16x16x32_bf16 v[100:103], a[36:39], v[204:207], v[100:103]
    ds_read_b64_tr_b16 a[6:7], v9 offset:20480
    v_accvgpr_read_b32 v36, a84
    v_accvgpr_read_b32 v37, a85
    v_mfma_f32_16x16x32_bf16 v[72:75], a[40:43], v[200:203], v[72:75]
    ds_read_b64_tr_b16 a[8:9], v10 offset:16384
    v_add_f32 v24, v24, v36
    v_add_f32 v25, v25, v37
    v_mfma_f32_16x16x32_bf16 v[104:107], a[40:43], v[204:207], v[104:107]
    ds_read_b64_tr_b16 a[10:11], v10 offset:20480
    v_accvgpr_read_b32 v38, a86
    v_accvgpr_read_b32 v39, a87
    v_mfma_f32_16x16x32_bf16 v[76:79], a[44:47], v[200:203], v[76:79]
    ds_read_b64_tr_b16 a[12:13], v11 offset:16384
    v_add_f32 v24, v24, v38
    v_add_f32 v25, v25, v39
    v_mfma_f32_16x16x32_bf16 v[108:111], a[44:47], v[204:207], v[108:111]
    ds_read_b64_tr_b16 a[14:15], v11 offset:20480
    v_accvgpr_read_b32 v32, a88
    v_accvgpr_read_b32 v33, a89
    v_mfma_f32_16x16x32_bf16 v[80:83], a[48:51], v[200:203], v[80:83]
    ds_read_b64_tr_b16 a[16:17], v12 offset:16384
    v_add_f32 v24, v24, v32
    v_add_f32 v25, v25, v33
    v_mfma_f32_16x16x32_bf16 v[112:115], a[48:51], v[204:207], v[112:115]
    ds_read_b64_tr_b16 a[18:19], v12 offset:20480
    v_accvgpr_read_b32 v34, a90
    v_accvgpr_read_b32 v35, a91
    v_mfma_f32_16x16x32_bf16 v[84:87], a[52:55], v[200:203], v[84:87]
    ds_read_b64_tr_b16 a[20:21], v13 offset:16384
    v_add_f32 v24, v24, v34
    v_add_f32 v25, v25, v35
    v_mfma_f32_16x16x32_bf16 v[116:119], a[52:55], v[204:207], v[116:119]
    ds_read_b64_tr_b16 a[22:23], v13 offset:20480
    v_mul_f32 v56, 0xbb124925, v24
    v_mul_f32_e64 v4, v56, v56
    v_mfma_f32_16x16x32_bf16 v[88:91], a[56:59], v[200:203], v[88:91]
    ds_read_b64_tr_b16 a[24:25], v14 offset:16384
    v_mul_f32 v25, 0x3b124925, v25
    v_sub_f32_e64 v4, v25, v4
    v_mfma_f32_16x16x32_bf16 v[120:123], a[56:59], v[204:207], v[120:123]
    ds_read_b64_tr_b16 a[26:27], v14 offset:20480
    v_max_f32_e64 v4, 0, v4
    v_add_f32 v4, 0x3727c5ac, v4
    v_mfma_f32_16x16x32_bf16 v[92:95], a[60:63], v[200:203], v[92:95]
    ds_read_b64_tr_b16 a[28:29], v15 offset:16384
    v_rsq_f32 v57, v4
    s_nop 0
    v_mfma_f32_16x16x32_bf16 v[124:127], a[60:63], v[204:207], v[124:127]
    ds_read_b64_tr_b16 a[30:31], v15 offset:20480
    v_mul_f32 v58, 0xbfb8aa3b, v57
    v_accvgpr_read_b32 v26, a92
    v_mfma_f32_16x16x32_bf16 v[48:51], a[32:35], v[44:47], v[48:51]
    v_accvgpr_read_b32 v27, a93
    v_accvgpr_read_b32 v34, a94
    v_mfma_f32_16x16x32_bf16 v[52:55], a[36:39], v[44:47], v[52:55]
    v_accvgpr_read_b32 v35, a95
    v_add_f32 v26, v26, v34
    s_waitcnt vmcnt(6) lgkmcnt(0)
    v_mfma_f32_16x16x32_bf16 v[64:67], a[0:3], v[208:211], v[64:67]
    ds_read_b64_tr_b16 a[32:33], v8 offset:24576
    v_add_f32_e64 v27, v27, v35
    v_accvgpr_read_b32 v36, a96
    v_mfma_f32_16x16x32_bf16 v[96:99], a[0:3], v[212:215], v[96:99]
    ds_read_b64_tr_b16 a[34:35], v8 offset:28672
    v_accvgpr_read_b32 v37, a97
    v_add_f32_e64 v26, v26, v36
    v_mfma_f32_16x16x32_bf16 v[68:71], a[4:7], v[208:211], v[68:71]
    ds_read_b64_tr_b16 a[36:37], v9 offset:24576
    v_add_f32_e64 v27, v27, v37
    v_accvgpr_read_b32 v38, a98
    v_mfma_f32_16x16x32_bf16 v[100:103], a[4:7], v[212:215], v[100:103]
    ds_read_b64_tr_b16 a[38:39], v9 offset:28672
    v_accvgpr_read_b32 v39, a99
    v_add_f32_e64 v26, v26, v38
    v_mfma_f32_16x16x32_bf16 v[72:75], a[8:11], v[208:211], v[72:75]
    ds_read_b64_tr_b16 a[40:41], v10 offset:24576
    v_add_f32_e64 v27, v27, v39
    v_accvgpr_read_b32 v32, a100
    v_mfma_f32_16x16x32_bf16 v[104:107], a[8:11], v[212:215], v[104:107]
    ds_read_b64_tr_b16 a[42:43], v10 offset:28672
    v_accvgpr_read_b32 v33, a101
    v_add_f32_e64 v26, v26, v32
    v_mfma_f32_16x16x32_bf16 v[76:79], a[12:15], v[208:211], v[76:79]
    ds_read_b64_tr_b16 a[44:45], v11 offset:24576
    v_add_f32_e64 v27, v27, v33
    v_accvgpr_read_b32 v34, a102
    v_mfma_f32_16x16x32_bf16 v[108:111], a[12:15], v[212:215], v[108:111]
    ds_read_b64_tr_b16 a[46:47], v11 offset:28672
    v_accvgpr_read_b32 v35, a103
    v_add_f32_e64 v26, v26, v34
    v_mfma_f32_16x16x32_bf16 v[80:83], a[16:19], v[208:211], v[80:83]
    ds_read_b64_tr_b16 a[48:49], v12 offset:24576
    v_add_f32_e64 v27, v27, v35
    v_accvgpr_read_b32 v36, a104
    v_mfma_f32_16x16x32_bf16 v[112:115], a[16:19], v[212:215], v[112:115]
    ds_read_b64_tr_b16 a[50:51], v12 offset:28672
    v_accvgpr_read_b32 v37, a105
    v_add_f32_e64 v26, v26, v36
    v_mfma_f32_16x16x32_bf16 v[84:87], a[20:23], v[208:211], v[84:87]
    ds_read_b64_tr_b16 a[52:53], v13 offset:24576
    v_add_f32_e64 v27, v27, v37
    v_accvgpr_read_b32 v38, a106
    v_mfma_f32_16x16x32_bf16 v[116:119], a[20:23], v[212:215], v[116:119]
    ds_read_b64_tr_b16 a[54:55], v13 offset:28672
    v_accvgpr_read_b32 v39, a107
    v_add_f32_e64 v26, v26, v38
    v_mfma_f32_16x16x32_bf16 v[88:91], a[24:27], v[208:211], v[88:91]
    ds_read_b64_tr_b16 a[56:57], v14 offset:24576
    v_add_f32_e64 v27, v27, v39
    v_accvgpr_read_b32 v32, a108
    v_mfma_f32_16x16x32_bf16 v[120:123], a[24:27], v[212:215], v[120:123]
    ds_read_b64_tr_b16 a[58:59], v14 offset:28672
    v_accvgpr_read_b32 v33, a109
    v_add_f32_e64 v26, v26, v32
    v_mfma_f32_16x16x32_bf16 v[92:95], a[28:31], v[208:211], v[92:95]
    ds_read_b64_tr_b16 a[60:61], v15 offset:24576
    v_add_f32_e64 v27, v27, v33
    v_accvgpr_read_b32 v34, a110
    v_mfma_f32_16x16x32_bf16 v[124:127], a[28:31], v[212:215], v[124:127]
    ds_read_b64_tr_b16 a[62:63], v15 offset:28672
    v_accvgpr_read_b32 v35, a111
    v_add_f32_e64 v26, v26, v34
    v_mfma_f32_16x16x32_bf16 v[48:51], a[0:3], v[44:47], v[48:51]
    v_add_f32_e64 v27, v27, v35
    v_accvgpr_read_b32 v36, a112
    v_mfma_f32_16x16x32_bf16 v[52:55], a[4:7], v[44:47], v[52:55]
    v_accvgpr_read_b32 v37, a113
    v_add_f32 v26, v26, v36
    s_waitcnt vmcnt(4) lgkmcnt(0)
    v_mfma_f32_16x16x32_bf16 v[64:67], a[32:35], v[216:219], v[64:67]
    ds_read_b64_tr_b16 a[0:1], v8 offset:32768
    v_add_f32_e64 v27, v27, v37
    v_accvgpr_read_b32 v38, a114
    v_mfma_f32_16x16x32_bf16 v[96:99], a[32:35], v[220:223], v[96:99]
    ds_read_b64_tr_b16 a[2:3], v8 offset:36864
    v_accvgpr_read_b32 v39, a115
    v_add_f32_e64 v26, v26, v38
    v_mfma_f32_16x16x32_bf16 v[68:71], a[36:39], v[216:219], v[68:71]
    ds_read_b64_tr_b16 a[4:5], v9 offset:32768
    v_add_f32_e64 v27, v27, v39
    v_accvgpr_read_b32 v32, a116
    v_mfma_f32_16x16x32_bf16 v[100:103], a[36:39], v[220:223], v[100:103]
    ds_read_b64_tr_b16 a[6:7], v9 offset:36864
    v_accvgpr_read_b32 v33, a117
    v_add_f32_e64 v26, v26, v32
    v_mfma_f32_16x16x32_bf16 v[72:75], a[40:43], v[216:219], v[72:75]
    ds_read_b64_tr_b16 a[8:9], v10 offset:32768
    v_add_f32_e64 v27, v27, v33
    v_accvgpr_read_b32 v34, a118
    v_mfma_f32_16x16x32_bf16 v[104:107], a[40:43], v[220:223], v[104:107]
    ds_read_b64_tr_b16 a[10:11], v10 offset:36864
    v_accvgpr_read_b32 v35, a119
    v_add_f32_e64 v26, v26, v34
    v_mfma_f32_16x16x32_bf16 v[76:79], a[44:47], v[216:219], v[76:79]
    ds_read_b64_tr_b16 a[12:13], v11 offset:32768
    v_add_f32_e64 v27, v27, v35
    v_mul_f32 v59, 0xbb124925, v26
    v_mfma_f32_16x16x32_bf16 v[108:111], a[44:47], v[220:223], v[108:111]
    ds_read_b64_tr_b16 a[14:15], v11 offset:36864
    v_mul_f32_e64 v4, v59, v59
    v_mul_f32 v27, 0x3b124925, v27
    v_mfma_f32_16x16x32_bf16 v[80:83], a[48:51], v[216:219], v[80:83]
    ds_read_b64_tr_b16 a[16:17], v12 offset:32768
    v_sub_f32 v4, v27, v4
    v_max_f32 v4, 0, v4
    v_mfma_f32_16x16x32_bf16 v[112:115], a[48:51], v[220:223], v[112:115]
    ds_read_b64_tr_b16 a[18:19], v12 offset:36864
    v_add_f32 v4, 0x3727c5ac, v4
    v_rsq_f32_e64 v60, v4
    v_mfma_f32_16x16x32_bf16 v[84:87], a[52:55], v[216:219], v[84:87]
    ds_read_b64_tr_b16 a[20:21], v13 offset:32768
    s_nop 0
    v_mul_f32 v61, 0xbfb8aa3b, v60
    v_mfma_f32_16x16x32_bf16 v[116:119], a[52:55], v[220:223], v[116:119]
    ds_read_b64_tr_b16 a[22:23], v13 offset:36864
    v_mfma_f32_16x16x32_bf16 v[88:91], a[56:59], v[216:219], v[88:91]
    ds_read_b64_tr_b16 a[24:25], v14 offset:32768
    v_mfma_f32_16x16x32_bf16 v[120:123], a[56:59], v[220:223], v[120:123]
    ds_read_b64_tr_b16 a[26:27], v14 offset:36864
    v_mfma_f32_16x16x32_bf16 v[92:95], a[60:63], v[216:219], v[92:95]
    ds_read_b64_tr_b16 a[28:29], v15 offset:32768
    v_mfma_f32_16x16x32_bf16 v[124:127], a[60:63], v[220:223], v[124:127]
    ds_read_b64_tr_b16 a[30:31], v15 offset:36864
    v_mfma_f32_16x16x32_bf16 v[48:51], a[32:35], v[44:47], v[48:51]
    v_mfma_f32_16x16x32_bf16 v[52:55], a[36:39], v[44:47], v[52:55]
    s_waitcnt vmcnt(2) lgkmcnt(0)
    v_mfma_f32_16x16x32_bf16 v[64:67], a[0:3], v[224:227], v[64:67]
    ds_read_b64_tr_b16 a[32:33], v8 offset:40960
    v_mfma_f32_16x16x32_bf16 v[96:99], a[0:3], v[228:231], v[96:99]
    ds_read_b64_tr_b16 a[34:35], v8 offset:45056
    v_mfma_f32_16x16x32_bf16 v[68:71], a[4:7], v[224:227], v[68:71]
    ds_read_b64_tr_b16 a[36:37], v9 offset:40960
    v_mfma_f32_16x16x32_bf16 v[100:103], a[4:7], v[228:231], v[100:103]
    ds_read_b64_tr_b16 a[38:39], v9 offset:45056
    v_mfma_f32_16x16x32_bf16 v[72:75], a[8:11], v[224:227], v[72:75]
    ds_read_b64_tr_b16 a[40:41], v10 offset:40960
    v_mfma_f32_16x16x32_bf16 v[104:107], a[8:11], v[228:231], v[104:107]
    ds_read_b64_tr_b16 a[42:43], v10 offset:45056
    v_mfma_f32_16x16x32_bf16 v[76:79], a[12:15], v[224:227], v[76:79]
    ds_read_b64_tr_b16 a[44:45], v11 offset:40960
    v_mfma_f32_16x16x32_bf16 v[108:111], a[12:15], v[228:231], v[108:111]
    ds_read_b64_tr_b16 a[46:47], v11 offset:45056
    v_mfma_f32_16x16x32_bf16 v[80:83], a[16:19], v[224:227], v[80:83]
    ds_read_b64_tr_b16 a[48:49], v12 offset:40960
    v_mfma_f32_16x16x32_bf16 v[112:115], a[16:19], v[228:231], v[112:115]
    ds_read_b64_tr_b16 a[50:51], v12 offset:45056
    v_mfma_f32_16x16x32_bf16 v[84:87], a[20:23], v[224:227], v[84:87]
    ds_read_b64_tr_b16 a[52:53], v13 offset:40960
    v_mfma_f32_16x16x32_bf16 v[116:119], a[20:23], v[228:231], v[116:119]
    ds_read_b64_tr_b16 a[54:55], v13 offset:45056
    v_mfma_f32_16x16x32_bf16 v[88:91], a[24:27], v[224:227], v[88:91]
    ds_read_b64_tr_b16 a[56:57], v14 offset:40960
    v_mfma_f32_16x16x32_bf16 v[120:123], a[24:27], v[228:231], v[120:123]
    ds_read_b64_tr_b16 a[58:59], v14 offset:45056
    v_mfma_f32_16x16x32_bf16 v[92:95], a[28:31], v[224:227], v[92:95]
    ds_read_b64_tr_b16 a[60:61], v15 offset:40960
    v_mfma_f32_16x16x32_bf16 v[124:127], a[28:31], v[228:231], v[124:127]
    ds_read_b64_tr_b16 a[62:63], v15 offset:45056
    v_mfma_f32_16x16x32_bf16 v[48:51], a[0:3], v[44:47], v[48:51]
    v_mfma_f32_16x16x32_bf16 v[52:55], a[4:7], v[44:47], v[52:55]
    s_waitcnt vmcnt(0) lgkmcnt(0)
    v_mfma_f32_16x16x32_bf16 v[64:67], a[32:35], v[232:235], v[64:67]
    v_mfma_f32_16x16x32_bf16 v[96:99], a[32:35], v[236:239], v[96:99]
    v_mfma_f32_16x16x32_bf16 v[68:71], a[36:39], v[232:235], v[68:71]
    v_mfma_f32_16x16x32_bf16 v[100:103], a[36:39], v[236:239], v[100:103]
    v_mfma_f32_16x16x32_bf16 v[72:75], a[40:43], v[232:235], v[72:75]
    v_mfma_f32_16x16x32_bf16 v[104:107], a[40:43], v[236:239], v[104:107]
    v_mfma_f32_16x16x32_bf16 v[76:79], a[44:47], v[232:235], v[76:79]
    v_mfma_f32_16x16x32_bf16 v[108:111], a[44:47], v[236:239], v[108:111]
    v_mfma_f32_16x16x32_bf16 v[80:83], a[48:51], v[232:235], v[80:83]
    v_mfma_f32_16x16x32_bf16 v[112:115], a[48:51], v[236:239], v[112:115]
    v_mfma_f32_16x16x32_bf16 v[84:87], a[52:55], v[232:235], v[84:87]
    v_mfma_f32_16x16x32_bf16 v[116:119], a[52:55], v[236:239], v[116:119]
    v_mfma_f32_16x16x32_bf16 v[88:91], a[56:59], v[232:235], v[88:91]
    v_mfma_f32_16x16x32_bf16 v[120:123], a[56:59], v[236:239], v[120:123]
    v_mfma_f32_16x16x32_bf16 v[92:95], a[60:63], v[232:235], v[92:95]
    v_mfma_f32_16x16x32_bf16 v[124:127], a[60:63], v[236:239], v[124:127]
    v_mfma_f32_16x16x32_bf16 v[48:51], a[32:35], v[44:47], v[48:51]
    v_mfma_f32_16x16x32_bf16 v[52:55], a[36:39], v[44:47], v[52:55]
    s_nop 7
    ds_write_b128 v16, v[48:51]
    ds_write_b128 v16, v[52:55] offset:64
    s_waitcnt lgkmcnt(0)
    s_barrier
    ds_read_b128 v[128:131], v16 offset:0
    ds_read_b128 v[132:135], v16 offset:64
    ds_read_b128 v[136:139], v17 offset:0
    ds_read_b128 v[140:143], v17 offset:64
    ds_read_b128 v[144:147], v18 offset:0
    ds_read_b128 v[148:151], v18 offset:64
    ds_read_b128 v[152:155], v19 offset:0
    ds_read_b128 v[156:159], v19 offset:64
    s_cmp_ge_u32 s34, 7
    s_cselect_b32 s30, 1, 0
    s_mul_i32 s31, s30, 7
    s_sub_u32 s31, s34, s31
    s_lshl_b32 s35, s33, 1
    s_add_u32 s30, s30, s35
    v_lshrrev_b32 v2, 3, v1
    v_and_b32 v3, 6, v2
    v_and_b32 v4, 7, v1
    v_xor_b32 v3, v3, v4
    v_lshlrev_b32_e64 v3, 4, v3
    v_mul_u32_u24 v2, 896, v2
    v_add_u32_e64 v20, v2, v3
    v_add_u32 v21, 7168, v20
    v_add_u32 v22, 14336, v20
    v_add_u32 v23, 21504, v20
    s_mul_i32 s35, s32, 401408
    s_lshl_b32 s36, s31, 7
    s_add_u32 s35, s35, s36
    s_add_u32 s36, s60, s35
    s_addc_u32 s37, s61, 0
    s_sub_u32 s38, 1605632, s35
    s_mov_b32 s52, s36
    s_and_b32 s53, s37, 0xffff
    s_mov_b32 s54, s38
    s_mov_b32 s55, 0x00020000
    s_mul_i32 s3, s32, 24576
    s_waitcnt lgkmcnt(0)
    v_fmac_f32 v64, v128, v56
    v_fmac_f32 v65, v129, v56
    v_fmac_f32 v66, v130, v56
    v_fmac_f32 v67, v131, v56
    v_fmac_f32 v68, v132, v56
    v_fmac_f32 v69, v133, v56
    v_fmac_f32 v70, v134, v56
    v_fmac_f32 v71, v135, v56
    v_mul_f32 v160, v64, v58
    v_mul_f32 v161, v65, v58
    v_mul_f32 v162, v66, v58
    v_mul_f32 v163, v67, v58
    v_mul_f32 v164, v68, v58
    v_mul_f32 v165, v69, v58
    v_mul_f32 v166, v70, v58
    v_mul_f32 v167, v71, v58
    v_exp_f32 v160, v160
    v_mul_f32 v64, v64, v57
    v_exp_f32 v161, v161
    v_mul_f32 v65, v65, v57
    v_exp_f32 v162, v162
    v_mul_f32 v66, v66, v57
    v_exp_f32 v163, v163
    v_mul_f32 v67, v67, v57
    v_exp_f32 v164, v164
    v_mul_f32 v68, v68, v57
    v_exp_f32 v165, v165
    v_mul_f32 v69, v69, v57
    v_exp_f32 v166, v166
    v_mul_f32 v70, v70, v57
    v_exp_f32 v167, v167
    v_mul_f32 v71, v71, v57
    v_add_f32 v160, 1.0, v160
    v_add_f32 v161, 1.0, v161
    v_add_f32 v162, 1.0, v162
    v_add_f32 v163, 1.0, v163
    v_add_f32 v164, 1.0, v164
    v_add_f32 v165, 1.0, v165
    v_add_f32 v166, 1.0, v166
    v_add_f32 v167, 1.0, v167
    v_rcp_f32 v160, v160
    v_rcp_f32 v161, v161
    v_rcp_f32 v162, v162
    v_rcp_f32 v163, v163
    v_rcp_f32 v164, v164
    v_rcp_f32 v165, v165
    v_rcp_f32 v166, v166
    v_rcp_f32 v167, v167
    s_nop 0
    v_mul_f32 v168, v64, v160
    v_mul_f32 v169, v65, v161
    v_mul_f32 v170, v66, v162
    v_mul_f32 v171, v67, v163
    v_mul_f32 v172, v68, v164
    v_mul_f32 v173, v69, v165
    v_mul_f32 v174, v70, v166
    v_mul_f32 v175, v71, v167
    v_cvt_pk_bf16_f32 v176, v168, v169
    v_cvt_pk_bf16_f32 v177, v170, v171
    v_cvt_pk_bf16_f32 v178, v172, v173
    v_cvt_pk_bf16_f32 v179, v174, v175
    buffer_store_dwordx4 v[176:179], v6, s[16:19], s44 offen sc1
    v_fmac_f32 v72, v136, v56
    v_fmac_f32 v73, v137, v56
    v_fmac_f32 v74, v138, v56
    v_fmac_f32 v75, v139, v56
    v_fmac_f32 v76, v140, v56
    v_fmac_f32 v77, v141, v56
    v_fmac_f32 v78, v142, v56
    v_fmac_f32 v79, v143, v56
    v_mul_f32 v184, v72, v58
    v_mul_f32 v185, v73, v58
    v_mul_f32 v186, v74, v58
    v_mul_f32 v187, v75, v58
    v_mul_f32 v188, v76, v58
    v_mul_f32 v189, v77, v58
    v_mul_f32 v190, v78, v58
    v_mul_f32 v191, v79, v58
    v_exp_f32 v184, v184
    v_mul_f32 v72, v72, v57
    v_exp_f32 v185, v185
    v_mul_f32 v73, v73, v57
    v_exp_f32 v186, v186
    v_mul_f32 v74, v74, v57
    v_exp_f32 v187, v187
    v_mul_f32 v75, v75, v57
    v_exp_f32 v188, v188
    v_mul_f32 v76, v76, v57
    v_exp_f32 v189, v189
    v_mul_f32 v77, v77, v57
    v_exp_f32 v190, v190
    v_mul_f32 v78, v78, v57
    v_exp_f32 v191, v191
    v_mul_f32 v79, v79, v57
    v_add_f32 v184, 1.0, v184
    v_add_f32 v185, 1.0, v185
    v_add_f32 v186, 1.0, v186
    v_add_f32 v187, 1.0, v187
    v_add_f32 v188, 1.0, v188
    v_add_f32 v189, 1.0, v189
    v_add_f32 v190, 1.0, v190
    v_add_f32 v191, 1.0, v191
    v_rcp_f32 v184, v184
    v_rcp_f32 v185, v185
    v_rcp_f32 v186, v186
    v_rcp_f32 v187, v187
    v_rcp_f32 v188, v188
    v_rcp_f32 v189, v189
    v_rcp_f32 v190, v190
    v_rcp_f32 v191, v191
    s_nop 0
    v_mul_f32 v192, v72, v184
    v_mul_f32 v193, v73, v185
    v_mul_f32 v194, v74, v186
    v_mul_f32 v195, v75, v187
    v_mul_f32 v196, v76, v188
    v_mul_f32 v197, v77, v189
    v_mul_f32 v198, v78, v190
    v_mul_f32_e64 v199, v79, v191
    v_cvt_pk_bf16_f32 v200, v192, v193
    v_cvt_pk_bf16_f32 v201, v194, v195
    v_cvt_pk_bf16_f32 v202, v196, v197
    v_cvt_pk_bf16_f32 v203, v198, v199
    buffer_store_dwordx4 v[200:203], v6, s[16:19], s45 offen sc1
    v_fmac_f32 v80, v144, v56
    v_fmac_f32 v81, v145, v56
    v_fmac_f32 v82, v146, v56
    v_fmac_f32 v83, v147, v56
    v_fmac_f32 v84, v148, v56
    v_fmac_f32 v85, v149, v56
    v_fmac_f32 v86, v150, v56
    v_fmac_f32 v87, v151, v56
    v_mul_f32 v208, v80, v58
    v_mul_f32 v209, v81, v58
    v_mul_f32 v210, v82, v58
    v_mul_f32 v211, v83, v58
    v_mul_f32 v212, v84, v58
    v_mul_f32 v213, v85, v58
    v_mul_f32 v214, v86, v58
    v_mul_f32 v215, v87, v58
    v_exp_f32 v208, v208
    v_mul_f32 v80, v80, v57
    v_exp_f32 v209, v209
    v_mul_f32 v81, v81, v57
    v_exp_f32 v210, v210
    v_mul_f32 v82, v82, v57
    v_exp_f32 v211, v211
    v_mul_f32 v83, v83, v57
    v_exp_f32 v212, v212
    v_mul_f32 v84, v84, v57
    v_exp_f32 v213, v213
    v_mul_f32 v85, v85, v57
    v_exp_f32 v214, v214
    v_mul_f32 v86, v86, v57
    v_exp_f32 v215, v215
    v_mul_f32 v87, v87, v57
    v_add_f32 v208, 1.0, v208
    v_add_f32 v209, 1.0, v209
    v_add_f32 v210, 1.0, v210
    v_add_f32 v211, 1.0, v211
    v_add_f32 v212, 1.0, v212
    v_add_f32 v213, 1.0, v213
    v_add_f32 v214, 1.0, v214
    v_add_f32 v215, 1.0, v215
    v_rcp_f32 v208, v208
    v_rcp_f32 v209, v209
    v_rcp_f32 v210, v210
    v_rcp_f32 v211, v211
    v_rcp_f32 v212, v212
    v_rcp_f32 v213, v213
    v_rcp_f32 v214, v214
    v_rcp_f32 v215, v215
    s_nop 0
    v_mul_f32 v216, v80, v208
    v_mul_f32 v217, v81, v209
    v_mul_f32 v218, v82, v210
    v_mul_f32 v219, v83, v211
    v_mul_f32 v220, v84, v212
    v_mul_f32 v221, v85, v213
    v_mul_f32 v222, v86, v214
    v_mul_f32_e64 v223, v87, v215
    v_cvt_pk_bf16_f32 v224, v216, v217
    v_cvt_pk_bf16_f32 v225, v218, v219
    v_cvt_pk_bf16_f32 v226, v220, v221
    v_cvt_pk_bf16_f32 v227, v222, v223
    buffer_store_dwordx4 v[224:227], v6, s[16:19], s46 offen sc1
    v_fmac_f32 v88, v152, v56
    v_fmac_f32 v89, v153, v56
    v_fmac_f32 v90, v154, v56
    v_fmac_f32 v91, v155, v56
    v_fmac_f32 v92, v156, v56
    v_fmac_f32 v93, v157, v56
    v_fmac_f32 v94, v158, v56
    v_fmac_f32 v95, v159, v56
    v_mul_f32 v160, v88, v58
    v_mul_f32 v161, v89, v58
    v_mul_f32 v162, v90, v58
    v_mul_f32 v163, v91, v58
    v_mul_f32 v164, v92, v58
    v_mul_f32 v165, v93, v58
    v_mul_f32 v166, v94, v58
    v_mul_f32 v167, v95, v58
    v_exp_f32 v160, v160
    v_mul_f32 v88, v88, v57
    v_exp_f32 v161, v161
    v_mul_f32 v89, v89, v57
    v_exp_f32 v162, v162
    v_mul_f32 v90, v90, v57
    v_exp_f32 v163, v163
    v_mul_f32 v91, v91, v57
    v_exp_f32 v164, v164
    v_mul_f32 v92, v92, v57
    v_exp_f32 v165, v165
    v_mul_f32 v93, v93, v57
    v_exp_f32 v166, v166
    v_mul_f32 v94, v94, v57
    v_exp_f32 v167, v167
    v_mul_f32 v95, v95, v57
    v_add_f32 v160, 1.0, v160
    v_add_f32 v161, 1.0, v161
    v_add_f32 v162, 1.0, v162
    v_add_f32 v163, 1.0, v163
    v_add_f32 v164, 1.0, v164
    v_add_f32 v165, 1.0, v165
    v_add_f32 v166, 1.0, v166
    v_add_f32 v167, 1.0, v167
    v_rcp_f32 v160, v160
    v_rcp_f32 v161, v161
    v_rcp_f32 v162, v162
    v_rcp_f32 v163, v163
    v_rcp_f32 v164, v164
    v_rcp_f32 v165, v165
    v_rcp_f32 v166, v166
    v_rcp_f32 v167, v167
    s_nop 0
    v_mul_f32 v168, v88, v160
    v_mul_f32 v169, v89, v161
    v_mul_f32 v170, v90, v162
    v_mul_f32 v171, v91, v163
    v_mul_f32 v172, v92, v164
    v_mul_f32 v173, v93, v165
    v_mul_f32 v174, v94, v166
    v_mul_f32_e64 v175, v95, v167
    v_cvt_pk_bf16_f32 v176, v168, v169
    v_cvt_pk_bf16_f32 v177, v170, v171
    v_cvt_pk_bf16_f32 v178, v172, v173
    v_cvt_pk_bf16_f32 v179, v174, v175
    buffer_store_dwordx4 v[176:179], v6, s[16:19], s47 offen sc1
    v_fmac_f32 v96, v128, v59
    v_fmac_f32 v97, v129, v59
    v_fmac_f32 v98, v130, v59
    v_fmac_f32 v99, v131, v59
    v_fmac_f32 v100, v132, v59
    v_fmac_f32 v101, v133, v59
    v_fmac_f32 v102, v134, v59
    v_fmac_f32 v103, v135, v59
    v_mul_f32 v184, v96, v61
    v_mul_f32 v185, v97, v61
    v_mul_f32 v186, v98, v61
    v_mul_f32 v187, v99, v61
    v_mul_f32 v188, v100, v61
    v_mul_f32 v189, v101, v61
    v_mul_f32 v190, v102, v61
    v_mul_f32 v191, v103, v61
    v_exp_f32 v184, v184
    v_mul_f32 v96, v96, v60
    v_exp_f32 v185, v185
    v_mul_f32 v97, v97, v60
    v_exp_f32 v186, v186
    v_mul_f32 v98, v98, v60
    v_exp_f32 v187, v187
    v_mul_f32 v99, v99, v60
    v_exp_f32 v188, v188
    v_mul_f32 v100, v100, v60
    v_exp_f32 v189, v189
    v_mul_f32 v101, v101, v60
    v_exp_f32 v190, v190
    v_mul_f32 v102, v102, v60
    v_exp_f32 v191, v191
    v_mul_f32 v103, v103, v60
    v_add_f32 v184, 1.0, v184
    v_add_f32 v185, 1.0, v185
    v_add_f32 v186, 1.0, v186
    v_add_f32 v187, 1.0, v187
    v_add_f32 v188, 1.0, v188
    v_add_f32 v189, 1.0, v189
    v_add_f32 v190, 1.0, v190
    v_add_f32 v191, 1.0, v191
    v_rcp_f32 v184, v184
    v_rcp_f32 v185, v185
    v_rcp_f32 v186, v186
    v_rcp_f32 v187, v187
    v_rcp_f32 v188, v188
    v_rcp_f32 v189, v189
    v_rcp_f32 v190, v190
    v_rcp_f32 v191, v191
    s_nop 0
    v_mul_f32 v192, v96, v184
    v_mul_f32 v193, v97, v185
    v_mul_f32 v194, v98, v186
    v_mul_f32 v195, v99, v187
    v_mul_f32 v196, v100, v188
    v_mul_f32 v197, v101, v189
    v_mul_f32 v198, v102, v190
    v_mul_f32_e64 v199, v103, v191
    v_cvt_pk_bf16_f32 v200, v192, v193
    v_cvt_pk_bf16_f32 v201, v194, v195
    v_cvt_pk_bf16_f32 v202, v196, v197
    v_cvt_pk_bf16_f32 v203, v198, v199
    s_add_u32 s44, s44, 57344
    buffer_store_dwordx4 v[200:203], v6, s[16:19], s44 offen sc1
    v_fmac_f32 v104, v136, v59
    v_fmac_f32 v105, v137, v59
    v_fmac_f32 v106, v138, v59
    v_fmac_f32 v107, v139, v59
    v_fmac_f32 v108, v140, v59
    v_fmac_f32 v109, v141, v59
    v_fmac_f32 v110, v142, v59
    v_fmac_f32 v111, v143, v59
    v_mul_f32 v208, v104, v61
    v_mul_f32 v209, v105, v61
    v_mul_f32 v210, v106, v61
    v_mul_f32 v211, v107, v61
    v_mul_f32 v212, v108, v61
    v_mul_f32 v213, v109, v61
    v_mul_f32 v214, v110, v61
    v_mul_f32 v215, v111, v61
    v_exp_f32 v208, v208
    v_mul_f32 v104, v104, v60
    v_exp_f32 v209, v209
    v_mul_f32 v105, v105, v60
    v_exp_f32 v210, v210
    v_mul_f32 v106, v106, v60
    v_exp_f32 v211, v211
    v_mul_f32 v107, v107, v60
    v_exp_f32 v212, v212
    v_mul_f32 v108, v108, v60
    v_exp_f32 v213, v213
    v_mul_f32 v109, v109, v60
    v_exp_f32 v214, v214
    v_mul_f32 v110, v110, v60
    v_exp_f32 v215, v215
    v_mul_f32 v111, v111, v60
    v_add_f32 v208, 1.0, v208
    v_add_f32 v209, 1.0, v209
    v_add_f32 v210, 1.0, v210
    v_add_f32 v211, 1.0, v211
    v_add_f32 v212, 1.0, v212
    v_add_f32 v213, 1.0, v213
    v_add_f32 v214, 1.0, v214
    v_add_f32 v215, 1.0, v215
    v_rcp_f32 v208, v208
    v_rcp_f32 v209, v209
    v_rcp_f32 v210, v210
    v_rcp_f32 v211, v211
    v_rcp_f32 v212, v212
    v_rcp_f32 v213, v213
    v_rcp_f32 v214, v214
    v_rcp_f32 v215, v215
    s_nop 0
    v_mul_f32 v216, v104, v208
    v_mul_f32 v217, v105, v209
    v_mul_f32 v218, v106, v210
    v_mul_f32 v219, v107, v211
    v_mul_f32 v220, v108, v212
    v_mul_f32 v221, v109, v213
    v_mul_f32 v222, v110, v214
    v_mul_f32_e64 v223, v111, v215
    v_cvt_pk_bf16_f32 v224, v216, v217
    v_cvt_pk_bf16_f32 v225, v218, v219
    v_cvt_pk_bf16_f32 v226, v220, v221
    v_cvt_pk_bf16_f32 v227, v222, v223
    s_add_u32 s45, s45, 57344
    buffer_store_dwordx4 v[224:227], v6, s[16:19], s45 offen sc1
    v_fmac_f32 v112, v144, v59
    v_fmac_f32 v113, v145, v59
    v_fmac_f32 v114, v146, v59
    v_fmac_f32 v115, v147, v59
    v_fmac_f32 v116, v148, v59
    v_fmac_f32 v117, v149, v59
    v_fmac_f32 v118, v150, v59
    v_fmac_f32 v119, v151, v59
    v_mul_f32 v160, v112, v61
    v_mul_f32 v161, v113, v61
    v_mul_f32 v162, v114, v61
    v_mul_f32 v163, v115, v61
    v_mul_f32 v164, v116, v61
    v_mul_f32 v165, v117, v61
    v_mul_f32 v166, v118, v61
    v_mul_f32 v167, v119, v61
    v_exp_f32 v160, v160
    v_mul_f32 v112, v112, v60
    v_exp_f32 v161, v161
    v_mul_f32 v113, v113, v60
    v_exp_f32 v162, v162
    v_mul_f32 v114, v114, v60
    v_exp_f32 v163, v163
    v_mul_f32 v115, v115, v60
    v_exp_f32 v164, v164
    v_mul_f32 v116, v116, v60
    v_exp_f32 v165, v165
    v_mul_f32 v117, v117, v60
    v_exp_f32 v166, v166
    v_mul_f32 v118, v118, v60
    v_exp_f32 v167, v167
    v_mul_f32 v119, v119, v60
    v_add_f32 v160, 1.0, v160
    v_add_f32 v161, 1.0, v161
    v_add_f32 v162, 1.0, v162
    v_add_f32 v163, 1.0, v163
    v_add_f32 v164, 1.0, v164
    v_add_f32 v165, 1.0, v165
    v_add_f32 v166, 1.0, v166
    v_add_f32 v167, 1.0, v167
    v_rcp_f32 v160, v160
    v_rcp_f32 v161, v161
    v_rcp_f32 v162, v162
    v_rcp_f32 v163, v163
    v_rcp_f32 v164, v164
    v_rcp_f32 v165, v165
    v_rcp_f32 v166, v166
    v_rcp_f32 v167, v167
    s_nop 0
    v_mul_f32 v168, v112, v160
    v_mul_f32 v169, v113, v161
    v_mul_f32 v170, v114, v162
    v_mul_f32 v171, v115, v163
    v_mul_f32 v172, v116, v164
    v_mul_f32 v173, v117, v165
    v_mul_f32 v174, v118, v166
    v_mul_f32_e64 v175, v119, v167
    v_cvt_pk_bf16_f32 v176, v168, v169
    v_cvt_pk_bf16_f32 v177, v170, v171
    v_cvt_pk_bf16_f32 v178, v172, v173
    v_cvt_pk_bf16_f32 v179, v174, v175
    s_add_u32 s46, s46, 57344
    buffer_store_dwordx4 v[176:179], v6, s[16:19], s46 offen sc1
    v_fmac_f32 v120, v152, v59
    v_fmac_f32 v121, v153, v59
    v_fmac_f32 v122, v154, v59
    v_fmac_f32 v123, v155, v59
    v_fmac_f32 v124, v156, v59
    v_fmac_f32 v125, v157, v59
    v_fmac_f32 v126, v158, v59
    v_fmac_f32 v127, v159, v59
    v_mul_f32 v184, v120, v61
    v_mul_f32 v185, v121, v61
    v_mul_f32 v186, v122, v61
    v_mul_f32 v187, v123, v61
    v_mul_f32 v188, v124, v61
    v_mul_f32 v189, v125, v61
    v_mul_f32 v190, v126, v61
    v_mul_f32 v191, v127, v61
    v_exp_f32 v184, v184
    v_mul_f32 v120, v120, v60
    v_exp_f32 v185, v185
    v_mul_f32 v121, v121, v60
    v_exp_f32 v186, v186
    v_mul_f32 v122, v122, v60
    v_exp_f32 v187, v187
    v_mul_f32 v123, v123, v60
    v_exp_f32 v188, v188
    v_mul_f32 v124, v124, v60
    v_exp_f32 v189, v189
    v_mul_f32 v125, v125, v60
    v_exp_f32 v190, v190
    v_mul_f32 v126, v126, v60
    v_exp_f32 v191, v191
    v_mul_f32 v127, v127, v60
    v_add_f32 v184, 1.0, v184
    v_add_f32 v185, 1.0, v185
    v_add_f32 v186, 1.0, v186
    v_add_f32 v187, 1.0, v187
    v_add_f32 v188, 1.0, v188
    v_add_f32 v189, 1.0, v189
    v_add_f32 v190, 1.0, v190
    v_add_f32 v191, 1.0, v191
    v_rcp_f32 v184, v184
    v_rcp_f32 v185, v185
    v_rcp_f32 v186, v186
    v_rcp_f32 v187, v187
    v_rcp_f32 v188, v188
    v_rcp_f32 v189, v189
    v_rcp_f32 v190, v190
    v_rcp_f32 v191, v191
    s_nop 0
    v_mul_f32 v192, v120, v184
    v_mul_f32 v193, v121, v185
    v_mul_f32 v194, v122, v186
    v_mul_f32 v195, v123, v187
    v_mul_f32 v196, v124, v188
    v_mul_f32 v197, v125, v189
    v_mul_f32 v198, v126, v190
    v_mul_f32_e64 v199, v127, v191
    v_cvt_pk_bf16_f32 v200, v192, v193
    v_cvt_pk_bf16_f32 v201, v194, v195
    v_cvt_pk_bf16_f32 v202, v196, v197
    v_cvt_pk_bf16_f32 v203, v198, v199
    s_add_u32 s47, s47, 57344
    buffer_store_dwordx4 v[200:203], v6, s[16:19], s47 offen sc1
    s_waitcnt vmcnt(0)
    s_barrier
    v_mov_b32 v43, 128
    s_cmp_lg_u32 s32, 0
    s_cbranch_scc1 L_tail_ab
    v_mov_b32 v2, 1
    s_mov_b64 exec, 1
    buffer_atomic_add v2, v43, s[64:67], 0 offen sc1
    s_mov_b64 exec, -1
L_tail_ab:
    s_add_u32 m0, s3, 0
    s_mov_b32 s40, 0
    buffer_load_dwordx4 v20, s[52:55], s40 offen lds
    s_add_u32 m0, s3, 1024
    s_nop 0
    buffer_load_dwordx4 v21, s[52:55], s40 offen lds
    s_add_u32 m0, s3, 2048
    s_nop 0
    buffer_load_dwordx4 v22, s[52:55], s40 offen lds
    s_add_u32 m0, s3, 3072
    s_nop 0
    buffer_load_dwordx4 v23, s[52:55], s40 offen lds
    s_add_u32 m0, s3, 4096
    s_mov_b32 s40, 28672
    buffer_load_dwordx4 v20, s[52:55], s40 offen lds
    s_add_u32 m0, s3, 5120
    s_nop 0
    buffer_load_dwordx4 v21, s[52:55], s40 offen lds
    s_add_u32 m0, s3, 6144
    s_nop 0
    buffer_load_dwordx4 v22, s[52:55], s40 offen lds
    s_add_u32 m0, s3, 7168
    s_nop 0
    buffer_load_dwordx4 v23, s[52:55], s40 offen lds
    s_add_u32 m0, s3, 8192
    s_mov_b32 s40, 57344
    buffer_load_dwordx4 v20, s[52:55], s40 offen lds
    s_add_u32 m0, s3, 9216
    s_nop 0
    buffer_load_dwordx4 v21, s[52:55], s40 offen lds
    s_add_u32 m0, s3, 10240
    s_nop 0
    buffer_load_dwordx4 v22, s[52:55], s40 offen lds
    s_add_u32 m0, s3, 11264
    s_nop 0
    buffer_load_dwordx4 v23, s[52:55], s40 offen lds
    s_add_u32 m0, s3, 12288
    s_mov_b32 s40, 86016
    buffer_load_dwordx4 v20, s[52:55], s40 offen lds
    s_add_u32 m0, s3, 13312
    s_nop 0
    buffer_load_dwordx4 v21, s[52:55], s40 offen lds
    s_add_u32 m0, s3, 14336
    s_nop 0
    buffer_load_dwordx4 v22, s[52:55], s40 offen lds
    s_add_u32 m0, s3, 15360
    s_nop 0
    buffer_load_dwordx4 v23, s[52:55], s40 offen lds
    s_add_u32 m0, s3, 16384
    s_mov_b32 s40, 114688
    buffer_load_dwordx4 v20, s[52:55], s40 offen lds
    s_add_u32 m0, s3, 17408
    s_nop 0
    buffer_load_dwordx4 v21, s[52:55], s40 offen lds
    s_add_u32 m0, s3, 18432
    s_nop 0
    buffer_load_dwordx4 v22, s[52:55], s40 offen lds
    s_add_u32 m0, s3, 19456
    s_nop 0
    buffer_load_dwordx4 v23, s[52:55], s40 offen lds
    s_add_u32 m0, s3, 20480
    s_mov_b32 s40, 143360
    buffer_load_dwordx4 v20, s[52:55], s40 offen lds
    s_add_u32 m0, s3, 21504
    s_nop 0
    buffer_load_dwordx4 v21, s[52:55], s40 offen lds
    s_add_u32 m0, s3, 22528
    s_nop 0
    buffer_load_dwordx4 v22, s[52:55], s40 offen lds
    s_add_u32 m0, s3, 23552
    s_nop 0
    buffer_load_dwordx4 v23, s[52:55], s40 offen lds
    v_lshrrev_b32 v2, 2, v1
    v_bfe_u32 v3, v1, 3, 2
    v_and_b32 v4, 3, v1
    v_lshlrev_b32 v4, 3, v4
    v_lshl_add_u32 v4, v2, 7, v4
    v_add_u32 v4, s3, v4
    v_xor_b32 v5, 0, v3
    v_lshl_add_u32 v28, v5, 5, v4
    v_xor_b32_e64 v5, 1, v3
    v_lshl_add_u32 v29, v5, 5, v4
    v_xor_b32_e64 v5, 2, v3
    v_lshl_add_u32 v30, v5, 5, v4
    v_xor_b32_e64 v5, 3, v3
    v_lshl_add_u32 v31, v5, 5, v4
    s_mul_i32 s35, s30, 229376
    s_mul_i32 s36, s32, 14336
    s_add_u32 s35, s35, s36
    s_add_u32 s35, s35, 96468992
    s_add_u32 s36, s6, s35
    s_addc_u32 s37, s7, 0
    s_mov_b32 s8, s36
    s_and_b32 s9, s37, 0xffff
    s_mov_b32 s10, 186368
    s_mov_b32 s11, 0x00020000
    s_lshl_b32 s35, s30, 2
    s_add_u32 s35, s35, s32
    v_and_b32 v2, 15, v1
    s_lshl_b32 s36, s35, 4
    v_add_u32_e64 v2, s36, v2
    v_mul_u32_u24 v40, 896, v2
    v_lshrrev_b32_e64 v3, 4, v1
    v_lshl_add_u32 v40, v3, 3, v40
    s_lshl_b32 s36, s31, 7
    v_add_u32 v40, s36, v40
    s_mov_b32 s56, s62
    s_and_b32 s57, s63, 0xffff
    s_mov_b32 s58, 1835008
    s_mov_b32 s59, 0x00020000
    s_mul_i32 s36, s35, 14336
    s_lshl_b32 s37, s31, 11
    s_add_u32 s36, s36, s37
    s_add_u32 s36, s36, 92274688
    s_add_u32 s36, s6, s36
    s_addc_u32 s37, s7, 0
    s_mov_b32 s16, s36
    s_and_b32 s17, s37, 0xffff
    s_mov_b32 s18, 2048
    s_mov_b32 s19, 0x00020000
    s_cmp_lg_u32 s32, 0
    s_cbranch_scc1 L_tail_wb
L_tail_pb:
    buffer_load_dword v2, v43, s[64:67], 0 offen sc1
    s_waitcnt vmcnt(0)
    v_readfirstlane_b32 s35, v2
    s_nop 3
    s_cmp_ge_u32 s35, 14
    s_cbranch_scc1 L_tail_wb
    s_sleep 1
    s_branch L_tail_pb
L_tail_wb:
    s_barrier
    buffer_load_dwordx4 v[32:35], v6, s[16:19], 0 offen sc1
    buffer_load_dwordx4 v[36:39], v6, s[16:19], 0 offen offset:1024 sc1
    s_mov_b32 s41, 0
    buffer_load_dwordx4 v[128:131], v6, s[8:11], s41 offen sc1
    s_mov_b32 s41, 57344
    buffer_load_dwordx4 v[132:135], v6, s[8:11], s41 offen sc1
    s_mov_b32 s41, 114688
    buffer_load_dwordx4 v[136:139], v6, s[8:11], s41 offen sc1
    s_mov_b32 s41, 172032
    buffer_load_dwordx4 v[140:143], v6, s[8:11], s41 offen sc1
    s_mov_b32 s41, 1024
    buffer_load_dwordx4 v[144:147], v6, s[8:11], s41 offen sc1
    s_mov_b32 s41, 58368
    buffer_load_dwordx4 v[148:151], v6, s[8:11], s41 offen sc1
    s_mov_b32 s41, 115712
    buffer_load_dwordx4 v[152:155], v6, s[8:11], s41 offen sc1
    s_mov_b32 s41, 173056
    buffer_load_dwordx4 v[156:159], v6, s[8:11], s41 offen sc1
    s_mov_b32 s41, 2048
    buffer_load_dwordx4 v[160:163], v6, s[8:11], s41 offen sc1
    s_mov_b32 s41, 59392
    buffer_load_dwordx4 v[164:167], v6, s[8:11], s41 offen sc1
    s_mov_b32 s41, 116736
    buffer_load_dwordx4 v[168:171], v6, s[8:11], s41 offen sc1
    s_mov_b32 s41, 174080
    buffer_load_dwordx4 v[172:175], v6, s[8:11], s41 offen sc1
    s_mov_b32 s41, 3072
    buffer_load_dwordx4 v[176:179], v6, s[8:11], s41 offen sc1
    s_mov_b32 s41, 60416
    buffer_load_dwordx4 v[180:183], v6, s[8:11], s41 offen sc1
    s_mov_b32 s41, 117760
    buffer_load_dwordx4 v[184:187], v6, s[8:11], s41 offen sc1
    s_mov_b32 s41, 175104
    buffer_load_dwordx4 v[188:191], v6, s[8:11], s41 offen sc1
    s_mov_b32 s41, 4096
    buffer_load_dwordx4 v[192:195], v6, s[8:11], s41 offen sc1
    s_mov_b32 s41, 61440
    buffer_load_dwordx4 v[196:199], v6, s[8:11], s41 offen sc1
    s_mov_b32 s41, 118784
    buffer_load_dwordx4 v[200:203], v6, s[8:11], s41 offen sc1
    s_mov_b32 s41, 176128
    buffer_load_dwordx4 v[204:207], v6, s[8:11], s41 offen sc1
    s_mov_b32 s41, 5120
    buffer_load_dwordx4 v[208:211], v6, s[8:11], s41 offen sc1
    s_mov_b32 s41, 62464
    buffer_load_dwordx4 v[212:215], v6, s[8:11], s41 offen sc1
    s_mov_b32 s41, 119808
    buffer_load_dwordx4 v[216:219], v6, s[8:11], s41 offen sc1
    s_mov_b32 s41, 177152
    buffer_load_dwordx4 v[220:223], v6, s[8:11], s41 offen sc1
    s_waitcnt vmcnt(20) lgkmcnt(0)
    ds_read_b64_tr_b16 v[96:97], v28 offset:0
    ds_read_b64_tr_b16 v[98:99], v28 offset:2048
    ds_read_b64_tr_b16 v[100:101], v29 offset:0
    ds_read_b64_tr_b16 v[102:103], v29 offset:2048
    ds_read_b64_tr_b16 v[104:105], v30 offset:0
    ds_read_b64_tr_b16 v[106:107], v30 offset:2048
    ds_read_b64_tr_b16 v[108:109], v31 offset:0
    ds_read_b64_tr_b16 v[110:111], v31 offset:2048
    s_waitcnt lgkmcnt(0)
    v_mfma_f32_16x16x32_bf16 a[0:3], v[96:99], v[128:131], 0
    ds_read_b64_tr_b16 v[112:113], v28 offset:4096
    v_mfma_f32_16x16x32_bf16 a[4:7], v[100:103], v[128:131], 0
    ds_read_b64_tr_b16 v[114:115], v28 offset:6144
    v_mfma_f32_16x16x32_bf16 a[8:11], v[104:107], v[128:131], 0
    ds_read_b64_tr_b16 v[116:117], v29 offset:4096
    v_mfma_f32_16x16x32_bf16 a[12:15], v[108:111], v[128:131], 0
    ds_read_b64_tr_b16 v[118:119], v29 offset:6144
    v_mfma_f32_16x16x32_bf16 a[16:19], v[96:99], v[132:135], 0
    ds_read_b64_tr_b16 v[120:121], v30 offset:4096
    v_mfma_f32_16x16x32_bf16 a[20:23], v[100:103], v[132:135], 0
    ds_read_b64_tr_b16 v[122:123], v30 offset:6144
    v_mfma_f32_16x16x32_bf16 a[24:27], v[104:107], v[132:135], 0
    ds_read_b64_tr_b16 v[124:125], v31 offset:4096
    v_mfma_f32_16x16x32_bf16 a[28:31], v[108:111], v[132:135], 0
    ds_read_b64_tr_b16 v[126:127], v31 offset:6144
    v_mfma_f32_16x16x32_bf16 a[32:35], v[96:99], v[136:139], 0
    v_mfma_f32_16x16x32_bf16 a[36:39], v[100:103], v[136:139], 0
    v_mfma_f32_16x16x32_bf16 a[40:43], v[104:107], v[136:139], 0
    v_mfma_f32_16x16x32_bf16 a[44:47], v[108:111], v[136:139], 0
    v_mfma_f32_16x16x32_bf16 a[48:51], v[96:99], v[140:143], 0
    v_mfma_f32_16x16x32_bf16 a[52:55], v[100:103], v[140:143], 0
    v_mfma_f32_16x16x32_bf16 a[56:59], v[104:107], v[140:143], 0
    v_mfma_f32_16x16x32_bf16 a[60:63], v[108:111], v[140:143], 0
    s_add_u32 m0, s3, 0
    s_mov_b32 s40, 172032
    buffer_load_dwordx4 v20, s[52:55], s40 offen lds
    s_add_u32 m0, s3, 1024
    s_nop 0
    buffer_load_dwordx4 v21, s[52:55], s40 offen lds
    s_add_u32 m0, s3, 2048
    s_nop 0
    buffer_load_dwordx4 v22, s[52:55], s40 offen lds
    s_add_u32 m0, s3, 3072
    s_nop 0
    buffer_load_dwordx4 v23, s[52:55], s40 offen lds
    s_mov_b32 s41, 6144
    buffer_load_dwordx4 v[128:131], v6, s[8:11], s41 offen sc1
    s_mov_b32 s41, 63488
    buffer_load_dwordx4 v[132:135], v6, s[8:11], s41 offen sc1
    s_mov_b32 s41, 120832
    buffer_load_dwordx4 v[136:139], v6, s[8:11], s41 offen sc1
    s_mov_b32 s41, 178176
    buffer_load_dwordx4 v[140:143], v6, s[8:11], s41 offen sc1
    s_waitcnt vmcnt(24) lgkmcnt(0)
    v_mfma_f32_16x16x32_bf16 a[0:3], v[112:115], v[144:147], a[0:3]
    ds_read_b64_tr_b16 v[96:97], v28 offset:8192
    v_mfma_f32_16x16x32_bf16 a[4:7], v[116:119], v[144:147], a[4:7]
    ds_read_b64_tr_b16 v[98:99], v28 offset:10240
    v_mfma_f32_16x16x32_bf16 a[8:11], v[120:123], v[144:147], a[8:11]
    ds_read_b64_tr_b16 v[100:101], v29 offset:8192
    v_mfma_f32_16x16x32_bf16 a[12:15], v[124:127], v[144:147], a[12:15]
    ds_read_b64_tr_b16 v[102:103], v29 offset:10240
    v_mfma_f32_16x16x32_bf16 a[16:19], v[112:115], v[148:151], a[16:19]
    ds_read_b64_tr_b16 v[104:105], v30 offset:8192
    v_mfma_f32_16x16x32_bf16 a[20:23], v[116:119], v[148:151], a[20:23]
    ds_read_b64_tr_b16 v[106:107], v30 offset:10240
    v_mfma_f32_16x16x32_bf16 a[24:27], v[120:123], v[148:151], a[24:27]
    ds_read_b64_tr_b16 v[108:109], v31 offset:8192
    v_mfma_f32_16x16x32_bf16 a[28:31], v[124:127], v[148:151], a[28:31]
    ds_read_b64_tr_b16 v[110:111], v31 offset:10240
    v_mfma_f32_16x16x32_bf16 a[32:35], v[112:115], v[152:155], a[32:35]
    v_mfma_f32_16x16x32_bf16 a[36:39], v[116:119], v[152:155], a[36:39]
    v_mfma_f32_16x16x32_bf16 a[40:43], v[120:123], v[152:155], a[40:43]
    v_mfma_f32_16x16x32_bf16 a[44:47], v[124:127], v[152:155], a[44:47]
    v_mfma_f32_16x16x32_bf16 a[48:51], v[112:115], v[156:159], a[48:51]
    v_mfma_f32_16x16x32_bf16 a[52:55], v[116:119], v[156:159], a[52:55]
    v_mfma_f32_16x16x32_bf16 a[56:59], v[120:123], v[156:159], a[56:59]
    v_mfma_f32_16x16x32_bf16 a[60:63], v[124:127], v[156:159], a[60:63]
    s_add_u32 m0, s3, 4096
    s_mov_b32 s40, 200704
    buffer_load_dwordx4 v20, s[52:55], s40 offen lds
    s_add_u32 m0, s3, 5120
    s_nop 0
    buffer_load_dwordx4 v21, s[52:55], s40 offen lds
    s_add_u32 m0, s3, 6144
    s_nop 0
    buffer_load_dwordx4 v22, s[52:55], s40 offen lds
    s_add_u32 m0, s3, 7168
    s_nop 0
    buffer_load_dwordx4 v23, s[52:55], s40 offen lds
    s_mov_b32 s41, 7168
    buffer_load_dwordx4 v[144:147], v6, s[8:11], s41 offen sc1
    s_mov_b32 s41, 64512
    buffer_load_dwordx4 v[148:151], v6, s[8:11], s41 offen sc1
    s_mov_b32 s41, 121856
    buffer_load_dwordx4 v[152:155], v6, s[8:11], s41 offen sc1
    s_mov_b32 s41, 179200
    buffer_load_dwordx4 v[156:159], v6, s[8:11], s41 offen sc1
    s_waitcnt vmcnt(28) lgkmcnt(0)
    v_mfma_f32_16x16x32_bf16 a[0:3], v[96:99], v[160:163], a[0:3]
    ds_read_b64_tr_b16 v[112:113], v28 offset:12288
    v_mfma_f32_16x16x32_bf16 a[4:7], v[100:103], v[160:163], a[4:7]
    ds_read_b64_tr_b16 v[114:115], v28 offset:14336
    v_mfma_f32_16x16x32_bf16 a[8:11], v[104:107], v[160:163], a[8:11]
    ds_read_b64_tr_b16 v[116:117], v29 offset:12288
    v_mfma_f32_16x16x32_bf16 a[12:15], v[108:111], v[160:163], a[12:15]
    ds_read_b64_tr_b16 v[118:119], v29 offset:14336
    v_mfma_f32_16x16x32_bf16 a[16:19], v[96:99], v[164:167], a[16:19]
    ds_read_b64_tr_b16 v[120:121], v30 offset:12288
    v_mfma_f32_16x16x32_bf16 a[20:23], v[100:103], v[164:167], a[20:23]
    ds_read_b64_tr_b16 v[122:123], v30 offset:14336
    v_mfma_f32_16x16x32_bf16 a[24:27], v[104:107], v[164:167], a[24:27]
    ds_read_b64_tr_b16 v[124:125], v31 offset:12288
    v_mfma_f32_16x16x32_bf16 a[28:31], v[108:111], v[164:167], a[28:31]
    ds_read_b64_tr_b16 v[126:127], v31 offset:14336
    v_mfma_f32_16x16x32_bf16 a[32:35], v[96:99], v[168:171], a[32:35]
    v_mfma_f32_16x16x32_bf16 a[36:39], v[100:103], v[168:171], a[36:39]
    v_mfma_f32_16x16x32_bf16 a[40:43], v[104:107], v[168:171], a[40:43]
    v_mfma_f32_16x16x32_bf16 a[44:47], v[108:111], v[168:171], a[44:47]
    v_mfma_f32_16x16x32_bf16 a[48:51], v[96:99], v[172:175], a[48:51]
    v_mfma_f32_16x16x32_bf16 a[52:55], v[100:103], v[172:175], a[52:55]
    v_mfma_f32_16x16x32_bf16 a[56:59], v[104:107], v[172:175], a[56:59]
    v_mfma_f32_16x16x32_bf16 a[60:63], v[108:111], v[172:175], a[60:63]
    s_add_u32 m0, s3, 8192
    s_mov_b32 s40, 229376
    buffer_load_dwordx4 v20, s[52:55], s40 offen lds
    s_add_u32 m0, s3, 9216
    s_nop 0
    buffer_load_dwordx4 v21, s[52:55], s40 offen lds
    s_add_u32 m0, s3, 10240
    s_nop 0
    buffer_load_dwordx4 v22, s[52:55], s40 offen lds
    s_add_u32 m0, s3, 11264
    s_nop 0
    buffer_load_dwordx4 v23, s[52:55], s40 offen lds
    s_mov_b32 s41, 8192
    buffer_load_dwordx4 v[160:163], v6, s[8:11], s41 offen sc1
    s_mov_b32 s41, 65536
    buffer_load_dwordx4 v[164:167], v6, s[8:11], s41 offen sc1
    s_mov_b32 s41, 122880
    buffer_load_dwordx4 v[168:171], v6, s[8:11], s41 offen sc1
    s_mov_b32 s41, 180224
    buffer_load_dwordx4 v[172:175], v6, s[8:11], s41 offen sc1
    s_waitcnt vmcnt(32) lgkmcnt(0)
    v_mfma_f32_16x16x32_bf16 a[0:3], v[112:115], v[176:179], a[0:3]
    ds_read_b64_tr_b16 v[96:97], v28 offset:16384
    v_mfma_f32_16x16x32_bf16 a[4:7], v[116:119], v[176:179], a[4:7]
    ds_read_b64_tr_b16 v[98:99], v28 offset:18432
    v_mfma_f32_16x16x32_bf16 a[8:11], v[120:123], v[176:179], a[8:11]
    ds_read_b64_tr_b16 v[100:101], v29 offset:16384
    v_mfma_f32_16x16x32_bf16 a[12:15], v[124:127], v[176:179], a[12:15]
    ds_read_b64_tr_b16 v[102:103], v29 offset:18432
    v_mfma_f32_16x16x32_bf16 a[16:19], v[112:115], v[180:183], a[16:19]
    ds_read_b64_tr_b16 v[104:105], v30 offset:16384
    v_mfma_f32_16x16x32_bf16 a[20:23], v[116:119], v[180:183], a[20:23]
    ds_read_b64_tr_b16 v[106:107], v30 offset:18432
    v_mfma_f32_16x16x32_bf16 a[24:27], v[120:123], v[180:183], a[24:27]
    ds_read_b64_tr_b16 v[108:109], v31 offset:16384
    v_mfma_f32_16x16x32_bf16 a[28:31], v[124:127], v[180:183], a[28:31]
    ds_read_b64_tr_b16 v[110:111], v31 offset:18432
    v_mfma_f32_16x16x32_bf16 a[32:35], v[112:115], v[184:187], a[32:35]
    v_mfma_f32_16x16x32_bf16 a[36:39], v[116:119], v[184:187], a[36:39]
    v_mfma_f32_16x16x32_bf16 a[40:43], v[120:123], v[184:187], a[40:43]
    v_mfma_f32_16x16x32_bf16 a[44:47], v[124:127], v[184:187], a[44:47]
    v_mfma_f32_16x16x32_bf16 a[48:51], v[112:115], v[188:191], a[48:51]
    v_mfma_f32_16x16x32_bf16 a[52:55], v[116:119], v[188:191], a[52:55]
    v_mfma_f32_16x16x32_bf16 a[56:59], v[120:123], v[188:191], a[56:59]
    v_mfma_f32_16x16x32_bf16 a[60:63], v[124:127], v[188:191], a[60:63]
    s_add_u32 m0, s3, 12288
    s_mov_b32 s40, 258048
    buffer_load_dwordx4 v20, s[52:55], s40 offen lds
    s_add_u32 m0, s3, 13312
    s_nop 0
    buffer_load_dwordx4 v21, s[52:55], s40 offen lds
    s_add_u32 m0, s3, 14336
    s_nop 0
    buffer_load_dwordx4 v22, s[52:55], s40 offen lds
    s_add_u32 m0, s3, 15360
    s_nop 0
    buffer_load_dwordx4 v23, s[52:55], s40 offen lds
    s_mov_b32 s41, 9216
    buffer_load_dwordx4 v[176:179], v6, s[8:11], s41 offen sc1
    s_mov_b32 s41, 66560
    buffer_load_dwordx4 v[180:183], v6, s[8:11], s41 offen sc1
    s_mov_b32 s41, 123904
    buffer_load_dwordx4 v[184:187], v6, s[8:11], s41 offen sc1
    s_mov_b32 s41, 181248
    buffer_load_dwordx4 v[188:191], v6, s[8:11], s41 offen sc1
    s_waitcnt vmcnt(36) lgkmcnt(0)
    v_mfma_f32_16x16x32_bf16 a[0:3], v[96:99], v[192:195], a[0:3]
    ds_read_b64_tr_b16 v[112:113], v28 offset:20480
    v_mfma_f32_16x16x32_bf16 a[4:7], v[100:103], v[192:195], a[4:7]
    ds_read_b64_tr_b16 v[114:115], v28 offset:22528
    v_mfma_f32_16x16x32_bf16 a[8:11], v[104:107], v[192:195], a[8:11]
    ds_read_b64_tr_b16 v[116:117], v29 offset:20480
    v_mfma_f32_16x16x32_bf16 a[12:15], v[108:111], v[192:195], a[12:15]
    ds_read_b64_tr_b16 v[118:119], v29 offset:22528
    v_mfma_f32_16x16x32_bf16 a[16:19], v[96:99], v[196:199], a[16:19]
    ds_read_b64_tr_b16 v[120:121], v30 offset:20480
    v_mfma_f32_16x16x32_bf16 a[20:23], v[100:103], v[196:199], a[20:23]
    ds_read_b64_tr_b16 v[122:123], v30 offset:22528
    v_mfma_f32_16x16x32_bf16 a[24:27], v[104:107], v[196:199], a[24:27]
    ds_read_b64_tr_b16 v[124:125], v31 offset:20480
    v_mfma_f32_16x16x32_bf16 a[28:31], v[108:111], v[196:199], a[28:31]
    ds_read_b64_tr_b16 v[126:127], v31 offset:22528
    v_mfma_f32_16x16x32_bf16 a[32:35], v[96:99], v[200:203], a[32:35]
    v_mfma_f32_16x16x32_bf16 a[36:39], v[100:103], v[200:203], a[36:39]
    v_mfma_f32_16x16x32_bf16 a[40:43], v[104:107], v[200:203], a[40:43]
    v_mfma_f32_16x16x32_bf16 a[44:47], v[108:111], v[200:203], a[44:47]
    v_mfma_f32_16x16x32_bf16 a[48:51], v[96:99], v[204:207], a[48:51]
    v_mfma_f32_16x16x32_bf16 a[52:55], v[100:103], v[204:207], a[52:55]
    v_mfma_f32_16x16x32_bf16 a[56:59], v[104:107], v[204:207], a[56:59]
    v_mfma_f32_16x16x32_bf16 a[60:63], v[108:111], v[204:207], a[60:63]
    s_add_u32 m0, s3, 16384
    s_mov_b32 s40, 286720
    buffer_load_dwordx4 v20, s[52:55], s40 offen lds
    s_add_u32 m0, s3, 17408
    s_nop 0
    buffer_load_dwordx4 v21, s[52:55], s40 offen lds
    s_add_u32 m0, s3, 18432
    s_nop 0
    buffer_load_dwordx4 v22, s[52:55], s40 offen lds
    s_add_u32 m0, s3, 19456
    s_nop 0
    buffer_load_dwordx4 v23, s[52:55], s40 offen lds
    s_mov_b32 s41, 10240
    buffer_load_dwordx4 v[192:195], v6, s[8:11], s41 offen sc1
    s_mov_b32 s41, 67584
    buffer_load_dwordx4 v[196:199], v6, s[8:11], s41 offen sc1
    s_mov_b32 s41, 124928
    buffer_load_dwordx4 v[200:203], v6, s[8:11], s41 offen sc1
    s_mov_b32 s41, 182272
    buffer_load_dwordx4 v[204:207], v6, s[8:11], s41 offen sc1
    s_waitcnt vmcnt(40) lgkmcnt(0)
    v_mfma_f32_16x16x32_bf16 a[0:3], v[112:115], v[208:211], a[0:3]
    s_waitcnt vmcnt(36)
    v_mfma_f32_16x16x32_bf16 a[4:7], v[116:119], v[208:211], a[4:7]
    ds_read_b64_tr_b16 v[96:97], v28 offset:0
    v_mfma_f32_16x16x32_bf16 a[8:11], v[120:123], v[208:211], a[8:11]
    ds_read_b64_tr_b16 v[98:99], v28 offset:2048
    v_mfma_f32_16x16x32_bf16 a[12:15], v[124:127], v[208:211], a[12:15]
    ds_read_b64_tr_b16 v[100:101], v29 offset:0
    v_mfma_f32_16x16x32_bf16 a[16:19], v[112:115], v[212:215], a[16:19]
    ds_read_b64_tr_b16 v[102:103], v29 offset:2048
    v_mfma_f32_16x16x32_bf16 a[20:23], v[116:119], v[212:215], a[20:23]
    ds_read_b64_tr_b16 v[104:105], v30 offset:0
    v_mfma_f32_16x16x32_bf16 a[24:27], v[120:123], v[212:215], a[24:27]
    ds_read_b64_tr_b16 v[106:107], v30 offset:2048
    v_mfma_f32_16x16x32_bf16 a[28:31], v[124:127], v[212:215], a[28:31]
    ds_read_b64_tr_b16 v[108:109], v31 offset:0
    v_mfma_f32_16x16x32_bf16 a[32:35], v[112:115], v[216:219], a[32:35]
    ds_read_b64_tr_b16 v[110:111], v31 offset:2048
    v_mfma_f32_16x16x32_bf16 a[36:39], v[116:119], v[216:219], a[36:39]
    v_mfma_f32_16x16x32_bf16 a[40:43], v[120:123], v[216:219], a[40:43]
    v_mfma_f32_16x16x32_bf16 a[44:47], v[124:127], v[216:219], a[44:47]
    v_mfma_f32_16x16x32_bf16 a[48:51], v[112:115], v[220:223], a[48:51]
    v_mfma_f32_16x16x32_bf16 a[52:55], v[116:119], v[220:223], a[52:55]
    v_mfma_f32_16x16x32_bf16 a[56:59], v[120:123], v[220:223], a[56:59]
    v_mfma_f32_16x16x32_bf16 a[60:63], v[124:127], v[220:223], a[60:63]
    s_add_u32 m0, s3, 20480
    s_mov_b32 s40, 315392
    buffer_load_dwordx4 v20, s[52:55], s40 offen lds
    s_add_u32 m0, s3, 21504
    s_nop 0
    buffer_load_dwordx4 v21, s[52:55], s40 offen lds
    s_add_u32 m0, s3, 22528
    s_nop 0
    buffer_load_dwordx4 v22, s[52:55], s40 offen lds
    s_add_u32 m0, s3, 23552
    s_nop 0
    buffer_load_dwordx4 v23, s[52:55], s40 offen lds
    s_mov_b32 s41, 11264
    buffer_load_dwordx4 v[208:211], v6, s[8:11], s41 offen sc1
    s_mov_b32 s41, 68608
    buffer_load_dwordx4 v[212:215], v6, s[8:11], s41 offen sc1
    s_mov_b32 s41, 125952
    buffer_load_dwordx4 v[216:219], v6, s[8:11], s41 offen sc1
    s_mov_b32 s41, 183296
    buffer_load_dwordx4 v[220:223], v6, s[8:11], s41 offen sc1
    s_waitcnt vmcnt(40) lgkmcnt(0)
    v_mfma_f32_16x16x32_bf16 a[0:3], v[96:99], v[128:131], a[0:3]
    s_waitcnt vmcnt(36)
    v_mfma_f32_16x16x32_bf16 a[4:7], v[100:103], v[128:131], a[4:7]
    ds_read_b64_tr_b16 v[112:113], v28 offset:4096
    v_mfma_f32_16x16x32_bf16 a[8:11], v[104:107], v[128:131], a[8:11]
    ds_read_b64_tr_b16 v[114:115], v28 offset:6144
    v_mfma_f32_16x16x32_bf16 a[12:15], v[108:111], v[128:131], a[12:15]
    ds_read_b64_tr_b16 v[116:117], v29 offset:4096
    v_mfma_f32_16x16x32_bf16 a[16:19], v[96:99], v[132:135], a[16:19]
    ds_read_b64_tr_b16 v[118:119], v29 offset:6144
    v_mfma_f32_16x16x32_bf16 a[20:23], v[100:103], v[132:135], a[20:23]
    ds_read_b64_tr_b16 v[120:121], v30 offset:4096
    v_mfma_f32_16x16x32_bf16 a[24:27], v[104:107], v[132:135], a[24:27]
    ds_read_b64_tr_b16 v[122:123], v30 offset:6144
    v_mfma_f32_16x16x32_bf16 a[28:31], v[108:111], v[132:135], a[28:31]
    ds_read_b64_tr_b16 v[124:125], v31 offset:4096
    v_mfma_f32_16x16x32_bf16 a[32:35], v[96:99], v[136:139], a[32:35]
    ds_read_b64_tr_b16 v[126:127], v31 offset:6144
    v_mfma_f32_16x16x32_bf16 a[36:39], v[100:103], v[136:139], a[36:39]
    v_mfma_f32_16x16x32_bf16 a[40:43], v[104:107], v[136:139], a[40:43]
    v_mfma_f32_16x16x32_bf16 a[44:47], v[108:111], v[136:139], a[44:47]
    v_mfma_f32_16x16x32_bf16 a[48:51], v[96:99], v[140:143], a[48:51]
    v_mfma_f32_16x16x32_bf16 a[52:55], v[100:103], v[140:143], a[52:55]
    v_mfma_f32_16x16x32_bf16 a[56:59], v[104:107], v[140:143], a[56:59]
    v_mfma_f32_16x16x32_bf16 a[60:63], v[108:111], v[140:143], a[60:63]
    s_add_u32 m0, s3, 0
    s_mov_b32 s40, 344064
    buffer_load_dwordx4 v20, s[52:55], s40 offen lds
    s_add_u32 m0, s3, 1024
    s_nop 0
    buffer_load_dwordx4 v21, s[52:55], s40 offen lds
    s_add_u32 m0, s3, 2048
    s_nop 0
    buffer_load_dwordx4 v22, s[52:55], s40 offen lds
    s_add_u32 m0, s3, 3072
    s_nop 0
    buffer_load_dwordx4 v23, s[52:55], s40 offen lds
    s_mov_b32 s41, 12288
    buffer_load_dwordx4 v[128:131], v6, s[8:11], s41 offen sc1
    s_mov_b32 s41, 69632
    buffer_load_dwordx4 v[132:135], v6, s[8:11], s41 offen sc1
    s_mov_b32 s41, 126976
    buffer_load_dwordx4 v[136:139], v6, s[8:11], s41 offen sc1
    s_mov_b32 s41, 184320
    buffer_load_dwordx4 v[140:143], v6, s[8:11], s41 offen sc1
    s_waitcnt vmcnt(40) lgkmcnt(0)
    v_mfma_f32_16x16x32_bf16 a[0:3], v[112:115], v[144:147], a[0:3]
    s_waitcnt vmcnt(36)
    v_mfma_f32_16x16x32_bf16 a[4:7], v[116:119], v[144:147], a[4:7]
    ds_read_b64_tr_b16 v[96:97], v28 offset:8192
    v_mfma_f32_16x16x32_bf16 a[8:11], v[120:123], v[144:147], a[8:11]
    ds_read_b64_tr_b16 v[98:99], v28 offset:10240
    v_mfma_f32_16x16x32_bf16 a[12:15], v[124:127], v[144:147], a[12:15]
    ds_read_b64_tr_b16 v[100:101], v29 offset:8192
    v_mfma_f32_16x16x32_bf16 a[16:19], v[112:115], v[148:151], a[16:19]
    ds_read_b64_tr_b16 v[102:103], v29 offset:10240
    v_mfma_f32_16x16x32_bf16 a[20:23], v[116:119], v[148:151], a[20:23]
    ds_read_b64_tr_b16 v[104:105], v30 offset:8192
    v_mfma_f32_16x16x32_bf16 a[24:27], v[120:123], v[148:151], a[24:27]
    ds_read_b64_tr_b16 v[106:107], v30 offset:10240
    v_mfma_f32_16x16x32_bf16 a[28:31], v[124:127], v[148:151], a[28:31]
    ds_read_b64_tr_b16 v[108:109], v31 offset:8192
    v_mfma_f32_16x16x32_bf16 a[32:35], v[112:115], v[152:155], a[32:35]
    ds_read_b64_tr_b16 v[110:111], v31 offset:10240
    v_mfma_f32_16x16x32_bf16 a[36:39], v[116:119], v[152:155], a[36:39]
    v_mfma_f32_16x16x32_bf16 a[40:43], v[120:123], v[152:155], a[40:43]
    v_mfma_f32_16x16x32_bf16 a[44:47], v[124:127], v[152:155], a[44:47]
    v_mfma_f32_16x16x32_bf16 a[48:51], v[112:115], v[156:159], a[48:51]
    v_mfma_f32_16x16x32_bf16 a[52:55], v[116:119], v[156:159], a[52:55]
    v_mfma_f32_16x16x32_bf16 a[56:59], v[120:123], v[156:159], a[56:59]
    v_mfma_f32_16x16x32_bf16 a[60:63], v[124:127], v[156:159], a[60:63]
    s_add_u32 m0, s3, 4096
    s_mov_b32 s40, 372736
    buffer_load_dwordx4 v20, s[52:55], s40 offen lds
    s_add_u32 m0, s3, 5120
    s_nop 0
    buffer_load_dwordx4 v21, s[52:55], s40 offen lds
    s_add_u32 m0, s3, 6144
    s_nop 0
    buffer_load_dwordx4 v22, s[52:55], s40 offen lds
    s_add_u32 m0, s3, 7168
    s_nop 0
    buffer_load_dwordx4 v23, s[52:55], s40 offen lds
    s_mov_b32 s41, 13312
    buffer_load_dwordx4 v[144:147], v6, s[8:11], s41 offen sc1
    s_mov_b32 s41, 70656
    buffer_load_dwordx4 v[148:151], v6, s[8:11], s41 offen sc1
    s_mov_b32 s41, 128000
    buffer_load_dwordx4 v[152:155], v6, s[8:11], s41 offen sc1
    s_mov_b32 s41, 185344
    buffer_load_dwordx4 v[156:159], v6, s[8:11], s41 offen sc1
    s_waitcnt vmcnt(40) lgkmcnt(0)
    v_mfma_f32_16x16x32_bf16 a[0:3], v[96:99], v[160:163], a[0:3]
    s_waitcnt vmcnt(36)
    v_mfma_f32_16x16x32_bf16 a[4:7], v[100:103], v[160:163], a[4:7]
    ds_read_b64_tr_b16 v[112:113], v28 offset:12288
    v_mfma_f32_16x16x32_bf16 a[8:11], v[104:107], v[160:163], a[8:11]
    ds_read_b64_tr_b16 v[114:115], v28 offset:14336
    v_mfma_f32_16x16x32_bf16 a[12:15], v[108:111], v[160:163], a[12:15]
    ds_read_b64_tr_b16 v[116:117], v29 offset:12288
    v_mfma_f32_16x16x32_bf16 a[16:19], v[96:99], v[164:167], a[16:19]
    ds_read_b64_tr_b16 v[118:119], v29 offset:14336
    v_mfma_f32_16x16x32_bf16 a[20:23], v[100:103], v[164:167], a[20:23]
    ds_read_b64_tr_b16 v[120:121], v30 offset:12288
    v_mfma_f32_16x16x32_bf16 a[24:27], v[104:107], v[164:167], a[24:27]
    ds_read_b64_tr_b16 v[122:123], v30 offset:14336
    v_mfma_f32_16x16x32_bf16 a[28:31], v[108:111], v[164:167], a[28:31]
    ds_read_b64_tr_b16 v[124:125], v31 offset:12288
    v_mfma_f32_16x16x32_bf16 a[32:35], v[96:99], v[168:171], a[32:35]
    ds_read_b64_tr_b16 v[126:127], v31 offset:14336
    v_mfma_f32_16x16x32_bf16 a[36:39], v[100:103], v[168:171], a[36:39]
    v_mfma_f32_16x16x32_bf16 a[40:43], v[104:107], v[168:171], a[40:43]
    v_mfma_f32_16x16x32_bf16 a[44:47], v[108:111], v[168:171], a[44:47]
    v_mfma_f32_16x16x32_bf16 a[48:51], v[96:99], v[172:175], a[48:51]
    v_mfma_f32_16x16x32_bf16 a[52:55], v[100:103], v[172:175], a[52:55]
    v_mfma_f32_16x16x32_bf16 a[56:59], v[104:107], v[172:175], a[56:59]
    v_mfma_f32_16x16x32_bf16 a[60:63], v[108:111], v[172:175], a[60:63]
    s_waitcnt vmcnt(32) lgkmcnt(0)
    v_mfma_f32_16x16x32_bf16 a[0:3], v[112:115], v[176:179], a[0:3]
    s_waitcnt vmcnt(28)
    v_mfma_f32_16x16x32_bf16 a[4:7], v[116:119], v[176:179], a[4:7]
    ds_read_b64_tr_b16 v[96:97], v28 offset:16384
    v_mfma_f32_16x16x32_bf16 a[8:11], v[120:123], v[176:179], a[8:11]
    ds_read_b64_tr_b16 v[98:99], v28 offset:18432
    v_mfma_f32_16x16x32_bf16 a[12:15], v[124:127], v[176:179], a[12:15]
    ds_read_b64_tr_b16 v[100:101], v29 offset:16384
    v_mfma_f32_16x16x32_bf16 a[16:19], v[112:115], v[180:183], a[16:19]
    ds_read_b64_tr_b16 v[102:103], v29 offset:18432
    v_mfma_f32_16x16x32_bf16 a[20:23], v[116:119], v[180:183], a[20:23]
    ds_read_b64_tr_b16 v[104:105], v30 offset:16384
    v_mfma_f32_16x16x32_bf16 a[24:27], v[120:123], v[180:183], a[24:27]
    ds_read_b64_tr_b16 v[106:107], v30 offset:18432
    v_mfma_f32_16x16x32_bf16 a[28:31], v[124:127], v[180:183], a[28:31]
    ds_read_b64_tr_b16 v[108:109], v31 offset:16384
    v_mfma_f32_16x16x32_bf16 a[32:35], v[112:115], v[184:187], a[32:35]
    ds_read_b64_tr_b16 v[110:111], v31 offset:18432
    v_mfma_f32_16x16x32_bf16 a[36:39], v[116:119], v[184:187], a[36:39]
    v_mfma_f32_16x16x32_bf16 a[40:43], v[120:123], v[184:187], a[40:43]
    v_mfma_f32_16x16x32_bf16 a[44:47], v[124:127], v[184:187], a[44:47]
    v_mfma_f32_16x16x32_bf16 a[48:51], v[112:115], v[188:191], a[48:51]
    v_mfma_f32_16x16x32_bf16 a[52:55], v[116:119], v[188:191], a[52:55]
    v_mfma_f32_16x16x32_bf16 a[56:59], v[120:123], v[188:191], a[56:59]
    v_mfma_f32_16x16x32_bf16 a[60:63], v[124:127], v[188:191], a[60:63]
    s_waitcnt vmcnt(24) lgkmcnt(0)
    v_mfma_f32_16x16x32_bf16 a[0:3], v[96:99], v[192:195], a[0:3]
    s_waitcnt vmcnt(20)
    v_mfma_f32_16x16x32_bf16 a[4:7], v[100:103], v[192:195], a[4:7]
    ds_read_b64_tr_b16 v[112:113], v28 offset:20480
    v_mfma_f32_16x16x32_bf16 a[8:11], v[104:107], v[192:195], a[8:11]
    ds_read_b64_tr_b16 v[114:115], v28 offset:22528
    v_mfma_f32_16x16x32_bf16 a[12:15], v[108:111], v[192:195], a[12:15]
    ds_read_b64_tr_b16 v[116:117], v29 offset:20480
    v_mfma_f32_16x16x32_bf16 a[16:19], v[96:99], v[196:199], a[16:19]
    ds_read_b64_tr_b16 v[118:119], v29 offset:22528
    v_mfma_f32_16x16x32_bf16 a[20:23], v[100:103], v[196:199], a[20:23]
    ds_read_b64_tr_b16 v[120:121], v30 offset:20480
    v_mfma_f32_16x16x32_bf16 a[24:27], v[104:107], v[196:199], a[24:27]
    ds_read_b64_tr_b16 v[122:123], v30 offset:22528
    v_mfma_f32_16x16x32_bf16 a[28:31], v[108:111], v[196:199], a[28:31]
    ds_read_b64_tr_b16 v[124:125], v31 offset:20480
    v_mfma_f32_16x16x32_bf16 a[32:35], v[96:99], v[200:203], a[32:35]
    ds_read_b64_tr_b16 v[126:127], v31 offset:22528
    v_mfma_f32_16x16x32_bf16 a[36:39], v[100:103], v[200:203], a[36:39]
    v_mfma_f32_16x16x32_bf16 a[40:43], v[104:107], v[200:203], a[40:43]
    v_mfma_f32_16x16x32_bf16 a[44:47], v[108:111], v[200:203], a[44:47]
    v_mfma_f32_16x16x32_bf16 a[48:51], v[96:99], v[204:207], a[48:51]
    v_mfma_f32_16x16x32_bf16 a[52:55], v[100:103], v[204:207], a[52:55]
    v_mfma_f32_16x16x32_bf16 a[56:59], v[104:107], v[204:207], a[56:59]
    v_mfma_f32_16x16x32_bf16 a[60:63], v[108:111], v[204:207], a[60:63]
    s_waitcnt vmcnt(16) lgkmcnt(0)
    v_mfma_f32_16x16x32_bf16 a[0:3], v[112:115], v[208:211], a[0:3]
    s_waitcnt vmcnt(12)
    v_mfma_f32_16x16x32_bf16 a[4:7], v[116:119], v[208:211], a[4:7]
    ds_read_b64_tr_b16 v[96:97], v28 offset:0
    v_mfma_f32_16x16x32_bf16 a[8:11], v[120:123], v[208:211], a[8:11]
    ds_read_b64_tr_b16 v[98:99], v28 offset:2048
    v_mfma_f32_16x16x32_bf16 a[12:15], v[124:127], v[208:211], a[12:15]
    ds_read_b64_tr_b16 v[100:101], v29 offset:0
    v_mfma_f32_16x16x32_bf16 a[16:19], v[112:115], v[212:215], a[16:19]
    ds_read_b64_tr_b16 v[102:103], v29 offset:2048
    v_mfma_f32_16x16x32_bf16 a[20:23], v[116:119], v[212:215], a[20:23]
    ds_read_b64_tr_b16 v[104:105], v30 offset:0
    v_mfma_f32_16x16x32_bf16 a[24:27], v[120:123], v[212:215], a[24:27]
    ds_read_b64_tr_b16 v[106:107], v30 offset:2048
    v_mfma_f32_16x16x32_bf16 a[28:31], v[124:127], v[212:215], a[28:31]
    ds_read_b64_tr_b16 v[108:109], v31 offset:0
    v_mfma_f32_16x16x32_bf16 a[32:35], v[112:115], v[216:219], a[32:35]
    ds_read_b64_tr_b16 v[110:111], v31 offset:2048
    v_mfma_f32_16x16x32_bf16 a[36:39], v[116:119], v[216:219], a[36:39]
    v_mfma_f32_16x16x32_bf16 a[40:43], v[120:123], v[216:219], a[40:43]
    v_mfma_f32_16x16x32_bf16 a[44:47], v[124:127], v[216:219], a[44:47]
    v_mfma_f32_16x16x32_bf16 a[48:51], v[112:115], v[220:223], a[48:51]
    v_mfma_f32_16x16x32_bf16 a[52:55], v[116:119], v[220:223], a[52:55]
    v_mfma_f32_16x16x32_bf16 a[56:59], v[120:123], v[220:223], a[56:59]
    v_mfma_f32_16x16x32_bf16 a[60:63], v[124:127], v[220:223], a[60:63]
    s_waitcnt vmcnt(8) lgkmcnt(0)
    v_mfma_f32_16x16x32_bf16 a[0:3], v[96:99], v[128:131], a[0:3]
    s_waitcnt vmcnt(4)
    v_mfma_f32_16x16x32_bf16 a[4:7], v[100:103], v[128:131], a[4:7]
    ds_read_b64_tr_b16 v[112:113], v28 offset:4096
    v_mfma_f32_16x16x32_bf16 a[8:11], v[104:107], v[128:131], a[8:11]
    ds_read_b64_tr_b16 v[114:115], v28 offset:6144
    v_mfma_f32_16x16x32_bf16 a[12:15], v[108:111], v[128:131], a[12:15]
    ds_read_b64_tr_b16 v[116:117], v29 offset:4096
    v_mfma_f32_16x16x32_bf16 a[16:19], v[96:99], v[132:135], a[16:19]
    ds_read_b64_tr_b16 v[118:119], v29 offset:6144
    v_mfma_f32_16x16x32_bf16 a[20:23], v[100:103], v[132:135], a[20:23]
    ds_read_b64_tr_b16 v[120:121], v30 offset:4096
    v_mfma_f32_16x16x32_bf16 a[24:27], v[104:107], v[132:135], a[24:27]
    ds_read_b64_tr_b16 v[122:123], v30 offset:6144
    v_mfma_f32_16x16x32_bf16 a[28:31], v[108:111], v[132:135], a[28:31]
    ds_read_b64_tr_b16 v[124:125], v31 offset:4096
    v_mfma_f32_16x16x32_bf16 a[32:35], v[96:99], v[136:139], a[32:35]
    ds_read_b64_tr_b16 v[126:127], v31 offset:6144
    v_mfma_f32_16x16x32_bf16 a[36:39], v[100:103], v[136:139], a[36:39]
    v_mfma_f32_16x16x32_bf16 a[40:43], v[104:107], v[136:139], a[40:43]
    v_mfma_f32_16x16x32_bf16 a[44:47], v[108:111], v[136:139], a[44:47]
    v_mfma_f32_16x16x32_bf16 a[48:51], v[96:99], v[140:143], a[48:51]
    v_mfma_f32_16x16x32_bf16 a[52:55], v[100:103], v[140:143], a[52:55]
    v_mfma_f32_16x16x32_bf16 a[56:59], v[104:107], v[140:143], a[56:59]
    v_mfma_f32_16x16x32_bf16 a[60:63], v[108:111], v[140:143], a[60:63]
    s_waitcnt vmcnt(0) lgkmcnt(0)
    v_mfma_f32_16x16x32_bf16 a[0:3], v[112:115], v[144:147], a[0:3]
    v_mfma_f32_16x16x32_bf16 a[4:7], v[116:119], v[144:147], a[4:7]
    v_mfma_f32_16x16x32_bf16 a[8:11], v[120:123], v[144:147], a[8:11]
    v_mfma_f32_16x16x32_bf16 a[12:15], v[124:127], v[144:147], a[12:15]
    v_mfma_f32_16x16x32_bf16 a[16:19], v[112:115], v[148:151], a[16:19]
    v_mfma_f32_16x16x32_bf16 a[20:23], v[116:119], v[148:151], a[20:23]
    v_mfma_f32_16x16x32_bf16 a[24:27], v[120:123], v[148:151], a[24:27]
    v_mfma_f32_16x16x32_bf16 a[28:31], v[124:127], v[148:151], a[28:31]
    v_mfma_f32_16x16x32_bf16 a[32:35], v[112:115], v[152:155], a[32:35]
    v_mfma_f32_16x16x32_bf16 a[36:39], v[116:119], v[152:155], a[36:39]
    v_mfma_f32_16x16x32_bf16 a[40:43], v[120:123], v[152:155], a[40:43]
    v_mfma_f32_16x16x32_bf16 a[44:47], v[124:127], v[152:155], a[44:47]
    v_mfma_f32_16x16x32_bf16 a[48:51], v[112:115], v[156:159], a[48:51]
    v_mfma_f32_16x16x32_bf16 a[52:55], v[116:119], v[156:159], a[52:55]
    v_mfma_f32_16x16x32_bf16 a[56:59], v[120:123], v[156:159], a[56:59]
    v_mfma_f32_16x16x32_bf16 a[60:63], v[124:127], v[156:159], a[60:63]
    v_add_u32 v2, s3, v6
    s_nop 7
    s_cmp_eq_u32 s32, 0
    s_cbranch_scc1 L_tail_sk0
    ds_write_b128 v2, a[0:3] offset:0
    ds_write_b128 v2, a[4:7] offset:1024
    ds_write_b128 v2, a[8:11] offset:2048
    ds_write_b128 v2, a[12:15] offset:3072
    s_branch L_tail_sj0
L_tail_sk0:
    v_accvgpr_read_b32 v96, a0
    v_accvgpr_read_b32 v97, a1
    v_accvgpr_read_b32 v98, a2
    v_accvgpr_read_b32 v99, a3
    v_accvgpr_read_b32 v100, a4
    v_accvgpr_read_b32 v101, a5
    v_accvgpr_read_b32 v102, a6
    v_accvgpr_read_b32 v103, a7
    v_accvgpr_read_b32 v104, a8
    v_accvgpr_read_b32 v105, a9
    v_accvgpr_read_b32 v106, a10
    v_accvgpr_read_b32 v107, a11
    v_accvgpr_read_b32 v108, a12
    v_accvgpr_read_b32 v109, a13
    v_accvgpr_read_b32 v110, a14
    v_accvgpr_read_b32 v111, a15
L_tail_sj0:
    s_cmp_eq_u32 s32, 1
    s_cbranch_scc1 L_tail_sk1
    ds_write_b128 v2, a[16:19] offset:4096
    ds_write_b128 v2, a[20:23] offset:5120
    ds_write_b128 v2, a[24:27] offset:6144
    ds_write_b128 v2, a[28:31] offset:7168
    s_branch L_tail_sj1
L_tail_sk1:
    v_accvgpr_read_b32 v96, a16
    v_accvgpr_read_b32 v97, a17
    v_accvgpr_read_b32 v98, a18
    v_accvgpr_read_b32 v99, a19
    v_accvgpr_read_b32 v100, a20
    v_accvgpr_read_b32 v101, a21
    v_accvgpr_read_b32 v102, a22
    v_accvgpr_read_b32 v103, a23
    v_accvgpr_read_b32 v104, a24
    v_accvgpr_read_b32 v105, a25
    v_accvgpr_read_b32 v106, a26
    v_accvgpr_read_b32 v107, a27
    v_accvgpr_read_b32 v108, a28
    v_accvgpr_read_b32 v109, a29
    v_accvgpr_read_b32 v110, a30
    v_accvgpr_read_b32 v111, a31
L_tail_sj1:
    s_cmp_eq_u32 s32, 2
    s_cbranch_scc1 L_tail_sk2
    ds_write_b128 v2, a[32:35] offset:8192
    ds_write_b128 v2, a[36:39] offset:9216
    ds_write_b128 v2, a[40:43] offset:10240
    ds_write_b128 v2, a[44:47] offset:11264
    s_branch L_tail_sj2
L_tail_sk2:
    v_accvgpr_read_b32 v96, a32
    v_accvgpr_read_b32 v97, a33
    v_accvgpr_read_b32 v98, a34
    v_accvgpr_read_b32 v99, a35
    v_accvgpr_read_b32 v100, a36
    v_accvgpr_read_b32 v101, a37
    v_accvgpr_read_b32 v102, a38
    v_accvgpr_read_b32 v103, a39
    v_accvgpr_read_b32 v104, a40
    v_accvgpr_read_b32 v105, a41
    v_accvgpr_read_b32 v106, a42
    v_accvgpr_read_b32 v107, a43
    v_accvgpr_read_b32 v108, a44
    v_accvgpr_read_b32 v109, a45
    v_accvgpr_read_b32 v110, a46
    v_accvgpr_read_b32 v111, a47
L_tail_sj2:
    s_cmp_eq_u32 s32, 3
    s_cbranch_scc1 L_tail_sk3
    ds_write_b128 v2, a[48:51] offset:12288
    ds_write_b128 v2, a[52:55] offset:13312
    ds_write_b128 v2, a[56:59] offset:14336
    ds_write_b128 v2, a[60:63] offset:15360
    s_branch L_tail_sj3
L_tail_sk3:
    v_accvgpr_read_b32 v96, a48
    v_accvgpr_read_b32 v97, a49
    v_accvgpr_read_b32 v98, a50
    v_accvgpr_read_b32 v99, a51
    v_accvgpr_read_b32 v100, a52
    v_accvgpr_read_b32 v101, a53
    v_accvgpr_read_b32 v102, a54
    v_accvgpr_read_b32 v103, a55
    v_accvgpr_read_b32 v104, a56
    v_accvgpr_read_b32 v105, a57
    v_accvgpr_read_b32 v106, a58
    v_accvgpr_read_b32 v107, a59
    v_accvgpr_read_b32 v108, a60
    v_accvgpr_read_b32 v109, a61
    v_accvgpr_read_b32 v110, a62
    v_accvgpr_read_b32 v111, a63
L_tail_sj3:
    s_waitcnt lgkmcnt(0)
    s_barrier
    s_lshl_b32 s36, s32, 12
    v_add_u32 v2, s36, v6
    s_add_u32 s37, s32, 1
    s_and_b32 s37, s37, 3
    s_mul_i32 s37, s37, 24576
    v_add_u32_e64 v3, s37, v2
    ds_read_b128 v[144:147], v3 offset:0
    ds_read_b128 v[148:151], v3 offset:1024
    ds_read_b128 v[152:155], v3 offset:2048
    ds_read_b128 v[156:159], v3 offset:3072
    s_add_u32 s37, s32, 2
    s_and_b32 s37, s37, 3
    s_mul_i32 s37, s37, 24576
    v_add_u32_e64 v3, s37, v2
    ds_read_b128 v[160:163], v3 offset:0
    ds_read_b128 v[164:167], v3 offset:1024
    ds_read_b128 v[168:171], v3 offset:2048
    ds_read_b128 v[172:175], v3 offset:3072
    s_add_u32 s37, s32, 3
    s_and_b32 s37, s37, 3
    s_mul_i32 s37, s37, 24576
    v_add_u32_e64 v3, s37, v2
    ds_read_b128 v[176:179], v3 offset:0
    ds_read_b128 v[180:183], v3 offset:1024
    ds_read_b128 v[184:187], v3 offset:2048
    ds_read_b128 v[188:191], v3 offset:3072
    v_lshlrev_b32_e64 v128, 16, v32
    v_and_b32 v129, 0xffff0000, v32
    v_lshlrev_b32_e64 v130, 16, v33
    v_and_b32 v131, 0xffff0000, v33
    v_lshlrev_b32_e64 v132, 16, v34
    v_and_b32 v133, 0xffff0000, v34
    v_lshlrev_b32_e64 v134, 16, v35
    v_and_b32 v135, 0xffff0000, v35
    v_lshlrev_b32_e64 v136, 16, v36
    v_and_b32 v137, 0xffff0000, v36
    v_lshlrev_b32_e64 v138, 16, v37
    v_and_b32 v139, 0xffff0000, v37
    v_lshlrev_b32_e64 v140, 16, v38
    v_and_b32 v141, 0xffff0000, v38
    v_lshlrev_b32_e64 v142, 16, v39
    v_and_b32 v143, 0xffff0000, v39
    s_waitcnt lgkmcnt(8)
    v_add_f32 v96, v96, v144
    v_add_f32 v97, v97, v145
    v_add_f32 v98, v98, v146
    v_add_f32 v99, v99, v147
    v_add_f32 v100, v100, v148
    v_add_f32 v101, v101, v149
    v_add_f32 v102, v102, v150
    v_add_f32 v103, v103, v151
    v_add_f32 v104, v104, v152
    v_add_f32 v105, v105, v153
    v_add_f32 v106, v106, v154
    v_add_f32 v107, v107, v155
    v_add_f32 v108, v108, v156
    v_add_f32 v109, v109, v157
    v_add_f32 v110, v110, v158
    v_add_f32 v111, v111, v159
    s_waitcnt lgkmcnt(4)
    v_add_f32 v96, v96, v160
    v_add_f32 v97, v97, v161
    v_add_f32 v98, v98, v162
    v_add_f32 v99, v99, v163
    v_add_f32 v100, v100, v164
    v_add_f32 v101, v101, v165
    v_add_f32 v102, v102, v166
    v_add_f32 v103, v103, v167
    v_add_f32 v104, v104, v168
    v_add_f32 v105, v105, v169
    v_add_f32 v106, v106, v170
    v_add_f32 v107, v107, v171
    v_add_f32 v108, v108, v172
    v_add_f32 v109, v109, v173
    v_add_f32 v110, v110, v174
    v_add_f32 v111, v111, v175
    s_waitcnt lgkmcnt(0)
    v_add_f32 v96, v96, v176
    v_add_f32 v97, v97, v177
    v_add_f32 v98, v98, v178
    v_add_f32 v99, v99, v179
    v_add_f32 v100, v100, v180
    v_add_f32 v101, v101, v181
    v_add_f32 v102, v102, v182
    v_add_f32 v103, v103, v183
    v_add_f32 v104, v104, v184
    v_add_f32 v105, v105, v185
    v_add_f32 v106, v106, v186
    v_add_f32 v107, v107, v187
    v_add_f32 v108, v108, v188
    v_add_f32 v109, v109, v189
    v_add_f32 v110, v110, v190
    v_add_f32_e64 v111, v111, v191
    v_cvt_pk_bf16_f32 v112, v96, v97
    v_cvt_pk_bf16_f32 v113, v98, v99
    v_cvt_pk_bf16_f32 v114, v100, v101
    v_cvt_pk_bf16_f32 v115, v102, v103
    v_cvt_pk_bf16_f32 v116, v104, v105
    v_cvt_pk_bf16_f32 v117, v106, v107
    v_cvt_pk_bf16_f32 v118, v108, v109
    v_cvt_pk_bf16_f32 v119, v110, v111
    v_lshlrev_b32_e64 v96, 16, v112
    v_and_b32 v97, 0xffff0000, v112
    v_lshlrev_b32_e64 v98, 16, v113
    v_and_b32 v99, 0xffff0000, v113
    v_lshlrev_b32_e64 v100, 16, v114
    v_and_b32 v101, 0xffff0000, v114
    v_lshlrev_b32_e64 v102, 16, v115
    v_and_b32 v103, 0xffff0000, v115
    v_lshlrev_b32_e64 v104, 16, v116
    v_and_b32 v105, 0xffff0000, v116
    v_lshlrev_b32_e64 v106, 16, v117
    v_and_b32 v107, 0xffff0000, v117
    v_lshlrev_b32_e64 v108, 16, v118
    v_and_b32 v109, 0xffff0000, v118
    v_lshlrev_b32_e64 v110, 16, v119
    v_and_b32 v111, 0xffff0000, v119
    v_add_f32 v96, v96, v128
    v_add_f32 v97, v97, v129
    v_add_f32 v98, v98, v130
    v_add_f32 v99, v99, v131
    v_add_f32 v100, v100, v132
    v_add_f32 v101, v101, v133
    v_add_f32 v102, v102, v134
    v_add_f32 v103, v103, v135
    v_add_f32 v104, v104, v136
    v_add_f32 v105, v105, v137
    v_add_f32 v106, v106, v138
    v_add_f32 v107, v107, v139
    v_add_f32 v108, v108, v140
    v_add_f32 v109, v109, v141
    v_add_f32 v110, v110, v142
    v_add_f32 v111, v111, v143
    v_cvt_pk_bf16_f32 v112, v96, v97
    v_cvt_pk_bf16_f32 v113, v98, v99
    v_cvt_pk_bf16_f32 v114, v100, v101
    v_cvt_pk_bf16_f32 v115, v102, v103
    v_cvt_pk_bf16_f32 v116, v104, v105
    v_cvt_pk_bf16_f32 v117, v106, v107
    v_cvt_pk_bf16_f32 v118, v108, v109
    v_cvt_pk_bf16_f32 v119, v110, v111
    buffer_store_dwordx2 v[112:113], v40, s[56:59], 0 offen offset:0
    buffer_store_dwordx2 v[114:115], v40, s[56:59], 0 offen offset:32
    buffer_store_dwordx2 v[116:117], v40, s[56:59], 0 offen offset:64
    buffer_store_dwordx2 v[118:119], v40, s[56:59], 0 offen offset:96
L_tail_end:
    s_endpgm
L_text_end:
.section .rodata,"a"
.p2align 6
.amdhsa_kernel qkv_kernel
  .amdhsa_next_free_vgpr 512
  .amdhsa_next_free_sgpr 88
  .amdhsa_accum_offset 256
  .amdhsa_group_segment_fixed_size 0
  .amdhsa_kernarg_size 96
  .amdhsa_user_sgpr_count 2
  .amdhsa_user_sgpr_kernarg_segment_ptr 1
  .amdhsa_system_sgpr_workgroup_id_x 1
.end_amdhsa_kernel
.p2align 6
.amdhsa_kernel attn_kernel
  .amdhsa_next_free_vgpr 512
  .amdhsa_next_free_sgpr 96
  .amdhsa_accum_offset 256
  .amdhsa_group_segment_fixed_size 0
  .amdhsa_kernarg_size 96
  .amdhsa_user_sgpr_count 2
  .amdhsa_user_sgpr_kernarg_segment_ptr 1
  .amdhsa_system_sgpr_workgroup_id_x 1
.end_amdhsa_kernel
.p2align 6
.amdhsa_kernel tail_kernel
  .amdhsa_next_free_vgpr 376
  .amdhsa_next_free_sgpr 68
  .amdhsa_accum_offset 256
  .amdhsa_group_segment_fixed_size 0
  .amdhsa_kernarg_size 96
  .amdhsa_user_sgpr_count 2
  .amdhsa_user_sgpr_kernarg_segment_ptr 1
  .amdhsa_system_sgpr_workgroup_id_x 1
.end_amdhsa_kernel
```
